```python
import torch

def _softmax(x, axis=-1):
    return torch.softmax(x, dim=axis)

def _gelu(x):
    return torch.nn.functional.gelu(x, approximate='tanh')

def _silu(x):
    return torch.nn.functional.silu(x)

def _sigmoid(x):
    return torch.sigmoid(x)

def _layernorm(x, axis=-1, eps=1e-05):
    m = x.mean(dim=axis, keepdim=True)
    v = x.var(dim=axis, keepdim=True, unbiased=False)
    return (x - m) / torch.sqrt(v + eps)

def _scatter_add(tgt, idx, src, axis=0):
    return tgt.clone().index_add_(axis, idx, src)

def _segment_sum(src, seg, n):
    out = torch.zeros((n,) + src.shape[1:], dtype=src.dtype)
    return out.index_add_(0, seg, src)

def _pad(x, pw):
    flat = tuple((v for pair in reversed(pw) for v in pair))
    return torch.nn.functional.pad(x, flat)
kernel_name = 'recurrent_scan__memory_aug_recurrent_mem_tr__dense_activation_silu__prompt'

def setup_inputs():

    _w = lambda a: (lambda t: t.to(torch.bfloat16) if t.is_floating_point() else t)(torch.as_tensor(a))

    def _A_setup():
        B, S, Dm = (1, 2048, 576)
        H, Dh = (32, 128)
        M, seg = (8, 32)
        seg = min(seg, S)
        S = S // seg * seg
        return {'x': _w((lambda *s: torch.randn(*s, dtype=torch.bfloat16) * 0.05)(B, S, Dm)), 'mem0': _w((lambda *s: torch.randn(*s, dtype=torch.bfloat16) * 0.8)(B, M, Dm)), 'Wq': _w((lambda *s: torch.randn(*s, dtype=torch.bfloat16) * 1.6)(Dm, H, Dh) * Dm ** (-0.5)), 'Wk': _w((lambda *s: torch.randn(*s, dtype=torch.bfloat16) * 1.6)(Dm, H, Dh) * Dm ** (-0.5)), 'Wv': _w((lambda *s: torch.randn(*s, dtype=torch.bfloat16) * 0.8)(Dm, H, Dh) * Dm ** (-0.5)), 'Wo': _w((lambda *s: torch.randn(*s, dtype=torch.bfloat16) * 0.8)(H, Dh, Dm) * (H * Dh) ** (-0.5)), 'seg_len': seg}
    _A_in = _A_setup()

    def _B_setup():
        B, S, D, F = (1, 2048, 576, 4608)
        return {'x': _w((lambda *s: torch.randn(*s, dtype=torch.bfloat16) * 0.05)(B, S, D)), 'w1': _w((lambda *s: torch.randn(*s, dtype=torch.bfloat16) * 0.8)(D, F) * D ** (-0.5)), 'w2': _w((lambda *s: torch.randn(*s, dtype=torch.bfloat16) * 0.2)(F, D) * F ** (-0.5))}
    _B_in = _B_setup()
    return {'A_x': _A_in['x'], 'A_mem0': _A_in['mem0'], 'A_Wq': _A_in['Wq'], 'A_Wk': _A_in['Wk'], 'A_Wv': _A_in['Wv'], 'A_Wo': _A_in['Wo'], 'A_seg_len': _A_in['seg_len'], 'B_x': _B_in['x'], 'B_w1': _B_in['w1'], 'B_w2': _B_in['w2']}

def reference(A_x, A_mem0, A_Wq, A_Wk, A_Wv, A_Wo, A_seg_len, B_x, B_w1, B_w2):

    def _A_ref(x, mem0, Wq, Wk, Wv, Wo, seg_len):
        B, S, Dm = x.shape
        H, Dh = (Wq.shape[1], Wq.shape[2])
        M = mem0.shape[1]
        scale = Dh ** (-0.5)
        n_seg = S // seg_len
        L = M + seg_len
        idx = torch.arange(L)
        mask = (idx[:, None] < M) | (idx[:, None] >= idx[None, :])
        mem = mem0
        outs = []
        for s in range(n_seg):
            xs = x[:, s * seg_len:(s + 1) * seg_len, :].clone()
            h = torch.concatenate([mem, xs], axis=1)
            q = torch.einsum('btd,dhe->bhte', h, Wq)
            k = torch.einsum('btd,dhe->bhte', h, Wk)
            v = torch.einsum('btd,dhe->bhte', h, Wv)
            scores = torch.einsum('bhqe,bhke->bhqk', q, k) * scale
            scores = torch.where(mask[None, None], scores, -1000000000.0)
            p = _softmax(scores, axis=-1)
            o = torch.einsum('bhqk,bhke->bhqe', p, v)
            o = torch.einsum('bhte,hed->btd', o, Wo)
            mem = o[:, :M, :].clone()
            outs.append(o[:, M:, :])
        return torch.concatenate(outs, axis=1)

    def _B_ref(x, w1, w2):
        h = torch.einsum('bsd,df->bsf', x, w1)
        h = _silu(h)
        out = torch.einsum('bsf,fd->bsd', h, w2)
        return out
    x = A_x
    xn = _layernorm(x, axis=-1)
    s = _A_ref(xn, A_mem0, A_Wq, A_Wk, A_Wv, A_Wo, A_seg_len)
    g = _silu(_B_ref(xn, B_w1, B_w2))
    return x + s * g
```

```asm
; @launch grid=(256,1,1) block=(256,1,1) lds=163840
.amdgcn_target "amdgcn-amd-amdhsa--gfx950"
.text
.globl recurrent_scan__memory_aug_recurrent_mem_tr__dense_activation_silu__prompt_kernel
.p2align 8
.type recurrent_scan__memory_aug_recurrent_mem_tr__dense_activation_silu__prompt_kernel,@function
recurrent_scan__memory_aug_recurrent_mem_tr__dense_activation_silu__prompt_kernel:
    s_cmp_ge_u32 s2, 256
    s_cbranch_scc1 fin0
    s_load_dwordx2 s[60:61], s[0:1], 0
    s_load_dwordx2 s[48:49], s[0:1], 8
    s_load_dwordx2 s[50:51], s[0:1], 16
    s_load_dwordx4 s[52:55], s[0:1], 24
    s_load_dwordx2 s[56:57], s[0:1], 40
    s_load_dwordx2 s[62:63], s[0:1], 64
    s_load_dwordx4 s[64:67], s[0:1], 72
    s_load_dwordx2 s[12:13], s[0:1], 88
    s_load_dwordx2 s[4:5], s[0:1], 96
    s_waitcnt lgkmcnt(0)
    s_mov_b32 s6, 268435456
    s_mov_b32 s7, 0x20000
    v_lshrrev_b32 v1, 6, v0
    v_and_b32 v0, 63, v0
    v_readfirstlane_b32 s14, v1
    s_getreg_b32 s59, hwreg(HW_REG_XCC_ID, 0, 4)
    v_mov_b32 v2, 15360
    s_cmp_lg_u32 s14, 0
    s_cbranch_scc1 el_1
    s_mov_b64 exec, 1
    v_mov_b32 v4, 1
    s_mov_b32 s43, 0x76540132
    s_and_b32 s42, s59, 7
    s_lshl_b32 s42, s42, 2
    s_lshr_b32 s16, s43, s42
    s_and_b32 s16, s16, 7
    s_mov_b32 s17, 8
    s_mov_b32 s18, 0x10006080
    s_mov_b32 s19, 0x70503020
el_2:
    s_lshl_b32 s42, s16, 3
    s_lshr_b64 s[20:21], s[18:19], s42
    s_and_b32 s42, s20, 255
    v_mov_b32 v3, s42
    global_atomic_add v5, v3, v4, s[12:13] sc0
    s_waitcnt vmcnt(0)
    v_readfirstlane_b32 s42, v5
    s_lshl_b32 s15, s16, 5
    s_add_u32 s15, s15, s42
    s_cmp_lt_u32 s42, 32
    s_cbranch_scc1 el_4
    s_mov_b32 s15, 256
    s_sub_u32 s17, s17, 1
    s_mov_b32 s16, s17
    s_cmp_ge_i32 s17, 0
    s_cbranch_scc1 el_2
el_4:
    v_mov_b32 v5, s15
    ds_write_b32 v2, v5
    s_mov_b64 exec, -1
    s_waitcnt lgkmcnt(0)
el_1:
    s_barrier
    ds_read_b32 v5, v2
    s_waitcnt lgkmcnt(0)
    v_readfirstlane_b32 s15, v5
    s_barrier
    s_cmp_lt_u32 s15, 32
    s_cbranch_scc1 chain_far
    s_cmp_ge_u32 s15, 256
    s_cbranch_scc1 fin0
    s_sub_u32 s15, s15, 32
    s_branch bulk
chain_far:
    s_branch chain
fin0:
    s_endpgm
chain:
    v_mov_b32 v14, v0
    v_and_b32 v15, 15, v14
    v_lshrrev_b32 v16, 4, v14
    v_lshrrev_b32 v17, 1, v16
    v_and_b32 v18, 1, v16
    v_lshlrev_b32 v19, 2, v16
    v_xor_b32 v19, v19, v15
    v_lshlrev_b32 v19, 4, v19
    v_lshlrev_b32 v22, 1, v17
    v_lshl_add_u32 v22, v18, 4, v22
    v_lshl_add_u32 v22, v22, 13, v19
    v_lshl_add_u32 v20, v17, 3, v18
    v_lshl_add_u32 v23, v20, 13, v19
    v_mul_u32_u24 v24, 1152, v20
    v_add_u32 v24, v24, v19
    v_bfe_u32 v17, v14, 4, 1
    v_bfe_u32 v18, v14, 3, 1
    v_lshl_add_u32 v17, v17, 3, v18
    v_lshrrev_b32 v18, 5, v14
    v_lshl_add_u32 v17, v18, 1, v17
    v_mul_u32_u24 v25, 1152, v17
    v_and_b32 v18, 7, v14
    v_lshl_add_u32 v25, v18, 4, v25
    s_lshl_b32 s44, s15, 8
    s_lshl_b32 s42, s14, 15
    s_add_u32 s86, s44, s42
    s_lshl_b32 s42, s14, 17
    s_add_u32 s44, s44, s42
    s_lshl_b32 s45, s15, 3
    s_add_u32 s45, s45, s14
    s_mul_i32 s45, s45, 18432
    s_mul_i32 s33, s14, 36864
    s_add_u32 s33, s33, 16384
    s_mov_b32 s8, s50
    s_mov_b32 s9, s51
    s_mov_b32 s10, 4718592
    s_mov_b32 s11, 0x20000
    s_add_u32 m0, s33, 0
    s_add_u32 s42, s86, 0
    buffer_load_dwordx4 v22, s[8:11], s42 offen nt lds
    s_add_u32 m0, s33, 1024
    s_add_u32 s42, s86, 1048576
    buffer_load_dwordx4 v22, s[8:11], s42 offen nt lds
    s_add_u32 m0, s33, 2048
    s_add_u32 s42, s86, 8192
    buffer_load_dwordx4 v22, s[8:11], s42 offen nt lds
    s_add_u32 m0, s33, 3072
    s_add_u32 s42, s86, 1056768
    buffer_load_dwordx4 v22, s[8:11], s42 offen nt lds
    s_add_u32 m0, s33, 4096
    s_add_u32 s42, s86, 262144
    buffer_load_dwordx4 v22, s[8:11], s42 offen nt lds
    s_add_u32 m0, s33, 5120
    s_add_u32 s42, s86, 1310720
    buffer_load_dwordx4 v22, s[8:11], s42 offen nt lds
    s_add_u32 m0, s33, 6144
    s_add_u32 s42, s86, 270336
    buffer_load_dwordx4 v22, s[8:11], s42 offen nt lds
    s_add_u32 m0, s33, 7168
    s_add_u32 s42, s86, 1318912
    buffer_load_dwordx4 v22, s[8:11], s42 offen nt lds
    s_add_u32 m0, s33, 8192
    s_add_u32 s42, s86, 524288
    buffer_load_dwordx4 v22, s[8:11], s42 offen nt lds
    s_add_u32 m0, s33, 9216
    s_add_u32 s42, s86, 1572864
    buffer_load_dwordx4 v22, s[8:11], s42 offen nt lds
    s_add_u32 m0, s33, 10240
    s_add_u32 s42, s86, 532480
    buffer_load_dwordx4 v22, s[8:11], s42 offen nt lds
    s_add_u32 m0, s33, 11264
    s_add_u32 s42, s86, 1581056
    buffer_load_dwordx4 v22, s[8:11], s42 offen nt lds
    s_add_u32 m0, s33, 12288
    s_add_u32 s42, s86, 786432
    buffer_load_dwordx4 v22, s[8:11], s42 offen nt lds
    s_add_u32 m0, s33, 13312
    s_add_u32 s42, s86, 1835008
    buffer_load_dwordx4 v22, s[8:11], s42 offen nt lds
    s_add_u32 m0, s33, 14336
    s_add_u32 s42, s86, 794624
    buffer_load_dwordx4 v22, s[8:11], s42 offen nt lds
    s_add_u32 m0, s33, 15360
    s_add_u32 s42, s86, 1843200
    buffer_load_dwordx4 v22, s[8:11], s42 offen nt lds
    s_add_u32 m0, s33, 16384
    s_add_u32 s42, s44, 4194304
    buffer_load_dwordx4 v23, s[8:11], s42 offen nt lds
    s_add_u32 m0, s33, 17408
    s_add_u32 s42, s44, 4210688
    buffer_load_dwordx4 v23, s[8:11], s42 offen nt lds
    s_add_u32 m0, s33, 18432
    s_add_u32 s42, s44, 4227072
    buffer_load_dwordx4 v23, s[8:11], s42 offen nt lds
    s_add_u32 m0, s33, 19456
    s_add_u32 s42, s44, 4243456
    buffer_load_dwordx4 v23, s[8:11], s42 offen nt lds
    s_add_u32 m0, s33, 20480
    s_add_u32 s42, s86, 2097152
    buffer_load_dwordx4 v22, s[8:11], s42 offen nt lds
    s_add_u32 m0, s33, 21504
    s_add_u32 s42, s86, 3145728
    buffer_load_dwordx4 v22, s[8:11], s42 offen nt lds
    s_add_u32 m0, s33, 22528
    s_add_u32 s42, s86, 2105344
    buffer_load_dwordx4 v22, s[8:11], s42 offen nt lds
    s_add_u32 m0, s33, 23552
    s_add_u32 s42, s86, 3153920
    buffer_load_dwordx4 v22, s[8:11], s42 offen nt lds
    s_add_u32 m0, s33, 24576
    s_add_u32 s42, s86, 2359296
    buffer_load_dwordx4 v22, s[8:11], s42 offen nt lds
    s_add_u32 m0, s33, 25600
    s_add_u32 s42, s86, 3407872
    buffer_load_dwordx4 v22, s[8:11], s42 offen nt lds
    s_add_u32 m0, s33, 26624
    s_add_u32 s42, s86, 2367488
    buffer_load_dwordx4 v22, s[8:11], s42 offen nt lds
    s_add_u32 m0, s33, 27648
    s_add_u32 s42, s86, 3416064
    buffer_load_dwordx4 v22, s[8:11], s42 offen nt lds
    s_add_u32 m0, s33, 28672
    s_add_u32 s42, s86, 2621440
    buffer_load_dwordx4 v22, s[8:11], s42 offen nt lds
    s_add_u32 m0, s33, 29696
    s_add_u32 s42, s86, 3670016
    buffer_load_dwordx4 v22, s[8:11], s42 offen nt lds
    s_add_u32 m0, s33, 30720
    s_add_u32 s42, s86, 2629632
    buffer_load_dwordx4 v22, s[8:11], s42 offen nt lds
    s_add_u32 m0, s33, 31744
    s_add_u32 s42, s86, 3678208
    buffer_load_dwordx4 v22, s[8:11], s42 offen nt lds
    v_lshlrev_b32 v0, 4, v14
    v_lshrrev_b32 v17, 1, v16
    v_mul_u32_u24 v21, 36864, v17
    v_add_u32 v21, 16384, v21
    v_and_b32 v17, 1, v16
    v_lshrrev_b32 v18, 2, v15
    v_lshl_add_u32 v17, v17, 3, v18
    v_and_b32 v19, 3, v15
    v_lshl_add_u32 v30, v17, 7, v21
    v_lshl_add_u32 v30, v19, 3, v30
    s_lshl_b32 s42, s14, 5
    v_add_u32 v30, s42, v30
    v_lshl_add_u32 v26, v17, 8, v21
    v_xor_b32 v20, s14, v18
    v_lshl_add_u32 v26, v20, 6, v26
    v_lshl_add_u32 v28, v19, 4, v26
    v_lshl_add_u32 v26, v19, 3, v26
    v_and_b32 v17, 1, v16
    v_lshl_add_u32 v33, v17, 11, v21
    v_lshl_add_u32 v33, v19, 3, v33
    v_lshrrev_b32 v17, 1, v18
    v_lshl_add_u32 v33, v17, 5, v33
    v_and_b32 v17, 1, v18
    v_or_b32 v17, 0, v17
    v_lshl_add_u32 v36, v17, 8, v33
    v_xor_b32 v17, s14, v17
    v_lshl_add_u32 v36, v17, 6, v36
    v_and_b32 v17, 1, v18
    v_or_b32 v17, 2, v17
    v_lshl_add_u32 v38, v17, 8, v33
    v_xor_b32 v17, s14, v17
    v_lshl_add_u32 v38, v17, 6, v38
    v_add_u32 v27, 73728, v26
    v_add_u32 v29, 73728, v28
    v_add_u32 v31, 73728, v30
    v_add_u32 v37, 73728, v36
    v_add_u32 v39, 73728, v38
    v_add_u32 v4, s33, v0
    v_bfe_u32 v17, v15, 1, 1
    v_mul_u32_u24 v20, 0xaaaa, v17
    v_add_u32 v1, 0x4444, v20
    v_and_b32 v19, 1, v15
    v_lshlrev_b32 v20, 4, v19
    v_mov_b32 v21, 0x3f80
    v_lshlrev_b32 v20, v20, v21
    v_cmp_eq_u32 vcc, v18, v16
    s_nop 1
    v_cndmask_b32 v20, 0, v20, vcc
    v_cmp_eq_u32 vcc, 0, v17
    s_nop 1
    v_cndmask_b32 v2, 0, v20, vcc
    v_cndmask_b32 v3, v20, 0, vcc
    v_lshl_add_u32 v20, v18, 1, v19
    v_lshlrev_b32 v5, 8, v16
    v_lshl_add_u32 v5, v20, 4, v5
    v_lshl_add_u32 v5, v17, 7, v5
    v_lshrrev_b32 v20, 1, v15
    v_lshlrev_b32 v6, 6, v20
    v_lshl_add_u32 v6, v19, 4, v6
    v_lshrrev_b32 v20, 1, v16
    v_lshl_add_u32 v6, v20, 5, v6
    v_and_b32 v20, 1, v16
    v_lshl_add_u32 v6, v20, 3, v6
    v_lshlrev_b32 v9, 9, v16
    v_lshl_add_u32 v9, v15, 4, v9
    s_mov_b32 s16, 0
    s_mov_b32 s17, 115343360
    s_mov_b32 s47, 115392512
    s_mov_b32 s46, 1
    s_lshl_b32 s58, s15, 7
    s_add_u32 s32, s58, 116408320
    s_add_u32 s58, s58, 116420608
    s_mul_i32 s42, s15, 9216
    s_lshl_b32 s43, s14, 8
    s_add_u32 s20, s42, s43
    s_add_u32 s20, s20, 113254400
    s_lshl_b32 s43, s14, 10
    s_add_u32 s42, s42, s43
    s_add_u32 s18, s42, 113246208
    s_add_u32 s19, s42, 113250304
    s_mov_b32 s24, 113246208
    s_mov_b32 s25, 113319936
    s_mov_b32 s26, 113393664
    s_mov_b32 s27, 113467392
    s_mov_b32 s28, 0x00ff00ff
    s_mov_b32 s29, 0
    s_mov_b32 s30, 0x11111111
    s_mov_b32 s31, 0x11111111
    s_lshl_b32 s42, s15, 12
    s_add_u32 s42, s42, s43
    s_add_u32 s23, s42, 100532224
    s_lshl_b32 s42, s42, 1
    s_add_u32 s21, s42, 4194304
    s_add_u32 s22, s42, 20971520
    s_mov_b32 s34, 0x33333333
    s_mov_b32 s35, 0x33333333
    s_mov_b32 s36, 0x3f803f80
    s_mov_b32 s37, 0x3f803f80
    s_mov_b32 s40, 0x3e0293ee
    s_mov_b32 s2, s40
    s_mov_b32 s3, s40
    s_lshr_b32 s42, s15, 3
    s_bfe_u32 s43, s15, 0x20001
    v_mul_u32_u24 v32, 576, v20
    s_mul_i32 s41, s43, 1152
    v_add_u32 v32, s41, v32
    s_cmp_lt_u32 s14, 2
    s_cbranch_scc1 rq_5
    s_cmp_eq_u32 s14, 3
    s_cbranch_scc1 r3_7
    v_lshrrev_b32 v18, 1, v14
    v_mul_u32_u24 v7, 9216, v18
    v_lshl_add_u32 v7, v19, 4, v7
    s_lshl_b32 s41, s15, 5
    v_add_u32 v7, s41, v7
    v_add_u32 v7, 8192, v7
    v_lshlrev_b32 v8, 4, v20
    v_lshl_add_u32 v8, v19, 3, v8
    v_add_u32 v8, s41, v8
    v_add_u32 v8, 4096, v8
    s_lshl_b32 s42, s42, 4
    s_and_b32 s43, s15, 1
    s_lshl_b32 s43, s43, 3
    s_add_u32 s42, s42, s43
    s_add_u32 s42, s42, 512
    v_lshl_add_u32 v32, v19, 2, v32
    v_add_lshl_u32 v32, v32, s42, 1
    s_mov_b32 s28, 0x00030003
    s_mov_b32 s42, 2
    s_mov_b32 s43, 4
    s_branch rx_6
r3_7:
    v_min_u32 v7, 1, v14
    v_lshlrev_b32 v7, 30, v7
    v_mov_b32 v8, 0
    s_branch rx_6
rq_5:
    v_lshrrev_b32 v18, 3, v14
    v_mul_u32_u24 v7, 9216, v18
    v_and_b32 v18, 7, v14
    v_lshl_add_u32 v7, v18, 4, v7
    s_lshl_b32 s41, s14, 5
    s_add_u32 s41, s41, s15
    s_lshl_b32 s41, s41, 7
    v_add_u32 v7, s41, v7
    v_bfe_u32 v21, v14, 2, 1
    v_lshlrev_b32 v8, 8, v21
    v_lshl_add_u32 v8, v17, 5, v8
    v_lshl_add_u32 v8, v20, 4, v8
    v_lshl_add_u32 v8, v19, 3, v8
    s_mul_i32 s41, s14, 5
    s_add_u32 s41, s41, s42
    s_lshl_b32 s41, s41, 10
    s_lshl_b32 s43, s43, 6
    s_add_u32 s41, s41, s43
    s_and_b32 s43, s15, 1
    s_lshl_b32 s39, s43, 9
    s_add_u32 s41, s41, s39
    v_add_u32 v8, s41, v8
    s_lshl_b32 s42, s42, 5
    s_lshl_b32 s43, s43, 3
    s_add_u32 s42, s42, s43
    s_lshl_b32 s43, s14, 8
    s_add_u32 s42, s42, s43
    v_add_u32 v32, v32, v18
    v_add_lshl_u32 v32, v32, s42, 1
    s_mov_b32 s42, 32
    s_mov_b32 s43, 256
rx_6:
    s_mov_b32 s68, s48
    s_mov_b32 s69, s49
    s_mov_b32 s70, 9216
    s_mov_b32 s71, 0x20000
    v_mov_b32 v40, 0
    v_mov_b32 v41, 0
    v_mov_b32 v42, 0
    v_mov_b32 v43, 0
    v_mov_b64 v[76:77], -1
    v_mov_b64 v[78:79], 0
    s_add_u32 s41, s42, s43
    s_cmp_eq_u32 s14, 3
    s_cbranch_scc1 ix_8
    buffer_load_ushort v48, v32, s[68:71], 0 offen
    buffer_load_ushort v49, v32, s[68:71], s42 offen
    buffer_load_ushort v50, v32, s[68:71], s43 offen
    buffer_load_ushort v51, v32, s[68:71], s41 offen
    s_mov_b64 exec, s[28:29]
    s_mov_b32 s42, 115359744
    buffer_store_dwordx2 v[76:77], v8, s[4:7], s42 offen sc1
    s_mov_b32 s42, 115376128
    buffer_store_dwordx2 v[76:77], v8, s[4:7], s42 offen sc1
    s_mov_b32 s42, 115392512
    buffer_store_dwordx2 v[76:77], v8, s[4:7], s42 offen sc1
    s_mov_b64 exec, -1
ix_8:
    buffer_store_dwordx4 v[40:43], v0, s[4:7], s18 offen sc1
    s_xor_b32 s42, s18, 0x100000
    buffer_store_dwordx4 v[40:43], v0, s[4:7], s42 offen sc1
    buffer_store_dwordx4 v[40:43], v0, s[4:7], s19 offen sc1
    s_xor_b32 s42, s19, 0x100000
    buffer_store_dwordx4 v[40:43], v0, s[4:7], s42 offen sc1
    s_mov_b64 exec, 0xffff
    buffer_store_dwordx4 v[40:43], v0, s[4:7], s20 offen sc1
    s_xor_b32 s42, s20, 0x100000
    buffer_store_dwordx4 v[40:43], v0, s[4:7], s42 offen sc1
    s_mov_b64 exec, -1
    s_waitcnt vmcnt(28)
    s_barrier
    s_add_u32 m0, s33, 32768
    s_add_u32 s42, s86, 2883584
    buffer_load_dwordx4 v22, s[8:11], s42 offen nt lds
    s_add_u32 m0, s33, 33792
    s_add_u32 s42, s86, 3932160
    buffer_load_dwordx4 v22, s[8:11], s42 offen nt lds
    s_add_u32 m0, s33, 34816
    s_add_u32 s42, s86, 2891776
    buffer_load_dwordx4 v22, s[8:11], s42 offen nt lds
    s_add_u32 m0, s33, 35840
    s_add_u32 s42, s86, 3940352
    buffer_load_dwordx4 v22, s[8:11], s42 offen nt lds
    ds_read_b64_tr_b16 a[0:1], v28 offset:0
    ds_read_b64_tr_b16 a[2:3], v28 offset:1024
    ds_read_b64_tr_b16 a[4:5], v29 offset:0
    ds_read_b64_tr_b16 a[6:7], v29 offset:1024
    ds_read_b64_tr_b16 a[8:9], v28 offset:8
    ds_read_b64_tr_b16 a[10:11], v28 offset:1032
    ds_read_b64_tr_b16 a[12:13], v29 offset:8
    ds_read_b64_tr_b16 a[14:15], v29 offset:1032
    s_waitcnt lgkmcnt(0)
    s_waitcnt vmcnt(28)
    s_barrier
    s_mov_b32 s8, s52
    s_mov_b32 s9, s53
    s_mov_b32 s10, 4718592
    s_mov_b32 s11, 0x20000
    s_add_u32 m0, s33, 0
    s_add_u32 s42, s86, 0
    buffer_load_dwordx4 v22, s[8:11], s42 offen nt lds
    s_add_u32 m0, s33, 1024
    s_add_u32 s42, s86, 1048576
    buffer_load_dwordx4 v22, s[8:11], s42 offen nt lds
    s_add_u32 m0, s33, 2048
    s_add_u32 s42, s86, 8192
    buffer_load_dwordx4 v22, s[8:11], s42 offen nt lds
    s_add_u32 m0, s33, 3072
    s_add_u32 s42, s86, 1056768
    buffer_load_dwordx4 v22, s[8:11], s42 offen nt lds
    ds_read_b64_tr_b16 a[16:17], v28 offset:4096
    ds_read_b64_tr_b16 a[18:19], v28 offset:5120
    ds_read_b64_tr_b16 a[20:21], v29 offset:4096
    ds_read_b64_tr_b16 a[22:23], v29 offset:5120
    ds_read_b64_tr_b16 a[24:25], v28 offset:4104
    ds_read_b64_tr_b16 a[26:27], v28 offset:5128
    ds_read_b64_tr_b16 a[28:29], v29 offset:4104
    ds_read_b64_tr_b16 a[30:31], v29 offset:5128
    s_waitcnt lgkmcnt(0)
    s_waitcnt vmcnt(28)
    s_barrier
    s_add_u32 m0, s33, 4096
    s_add_u32 s42, s86, 524288
    buffer_load_dwordx4 v22, s[8:11], s42 offen nt lds
    s_add_u32 m0, s33, 5120
    s_add_u32 s42, s86, 1572864
    buffer_load_dwordx4 v22, s[8:11], s42 offen nt lds
    s_add_u32 m0, s33, 6144
    s_add_u32 s42, s86, 532480
    buffer_load_dwordx4 v22, s[8:11], s42 offen nt lds
    s_add_u32 m0, s33, 7168
    s_add_u32 s42, s86, 1581056
    buffer_load_dwordx4 v22, s[8:11], s42 offen nt lds
    ds_read_b64_tr_b16 a[32:33], v28 offset:8192
    ds_read_b64_tr_b16 a[34:35], v28 offset:9216
    ds_read_b64_tr_b16 a[36:37], v29 offset:8192
    ds_read_b64_tr_b16 a[38:39], v29 offset:9216
    ds_read_b64_tr_b16 a[40:41], v28 offset:8200
    ds_read_b64_tr_b16 a[42:43], v28 offset:9224
    ds_read_b64_tr_b16 a[44:45], v29 offset:8200
    ds_read_b64_tr_b16 a[46:47], v29 offset:9224
    s_waitcnt lgkmcnt(0)
    s_waitcnt vmcnt(28)
    s_barrier
    s_add_u32 m0, s33, 8192
    s_add_u32 s42, s44, 4194304
    buffer_load_dwordx4 v23, s[8:11], s42 offen nt lds
    s_add_u32 m0, s33, 9216
    s_add_u32 s42, s44, 4210688
    buffer_load_dwordx4 v23, s[8:11], s42 offen nt lds
    s_add_u32 m0, s33, 10240
    s_add_u32 s42, s44, 4227072
    buffer_load_dwordx4 v23, s[8:11], s42 offen nt lds
    s_add_u32 m0, s33, 11264
    s_add_u32 s42, s44, 4243456
    buffer_load_dwordx4 v23, s[8:11], s42 offen nt lds
    ds_read_b64_tr_b16 a[48:49], v28 offset:12288
    ds_read_b64_tr_b16 a[50:51], v28 offset:13312
    ds_read_b64_tr_b16 a[52:53], v29 offset:12288
    ds_read_b64_tr_b16 a[54:55], v29 offset:13312
    ds_read_b64_tr_b16 a[56:57], v28 offset:12296
    ds_read_b64_tr_b16 a[58:59], v28 offset:13320
    ds_read_b64_tr_b16 a[60:61], v29 offset:12296
    ds_read_b64_tr_b16 a[62:63], v29 offset:13320
    s_waitcnt lgkmcnt(0)
    s_waitcnt vmcnt(28)
    s_barrier
    s_add_u32 m0, s33, 12288
    s_add_u32 s42, s86, 2359296
    buffer_load_dwordx4 v22, s[8:11], s42 offen nt lds
    s_add_u32 m0, s33, 13312
    s_add_u32 s42, s86, 3407872
    buffer_load_dwordx4 v22, s[8:11], s42 offen nt lds
    s_add_u32 m0, s33, 14336
    s_add_u32 s42, s86, 2367488
    buffer_load_dwordx4 v22, s[8:11], s42 offen nt lds
    s_add_u32 m0, s33, 15360
    s_add_u32 s42, s86, 3416064
    buffer_load_dwordx4 v22, s[8:11], s42 offen nt lds
    ds_read_b64_tr_b16 a[64:65], v28 offset:16384
    ds_read_b64_tr_b16 a[66:67], v28 offset:17408
    ds_read_b64_tr_b16 a[68:69], v29 offset:16384
    ds_read_b64_tr_b16 a[70:71], v29 offset:17408
    ds_read_b64_tr_b16 a[72:73], v28 offset:16392
    ds_read_b64_tr_b16 a[74:75], v28 offset:17416
    ds_read_b64_tr_b16 a[76:77], v29 offset:16392
    ds_read_b64_tr_b16 a[78:79], v29 offset:17416
    s_waitcnt lgkmcnt(0)
    s_waitcnt vmcnt(28)
    s_barrier
    s_add_u32 m0, s33, 16384
    s_add_u32 s42, s86, 2883584
    buffer_load_dwordx4 v22, s[8:11], s42 offen nt lds
    s_add_u32 m0, s33, 17408
    s_add_u32 s42, s86, 3932160
    buffer_load_dwordx4 v22, s[8:11], s42 offen nt lds
    s_add_u32 m0, s33, 18432
    s_add_u32 s42, s86, 2891776
    buffer_load_dwordx4 v22, s[8:11], s42 offen nt lds
    s_add_u32 m0, s33, 19456
    s_add_u32 s42, s86, 3940352
    buffer_load_dwordx4 v22, s[8:11], s42 offen nt lds
    ds_read_b64_tr_b16 a[80:81], v28 offset:20480
    ds_read_b64_tr_b16 a[82:83], v28 offset:21504
    ds_read_b64_tr_b16 a[84:85], v29 offset:20480
    ds_read_b64_tr_b16 a[86:87], v29 offset:21504
    ds_read_b64_tr_b16 a[88:89], v28 offset:20488
    ds_read_b64_tr_b16 a[90:91], v28 offset:21512
    ds_read_b64_tr_b16 a[92:93], v29 offset:20488
    ds_read_b64_tr_b16 a[94:95], v29 offset:21512
    s_waitcnt lgkmcnt(0)
    s_waitcnt vmcnt(28)
    s_barrier
    s_mov_b32 s8, s54
    s_mov_b32 s9, s55
    s_mov_b32 s10, 4718592
    s_mov_b32 s11, 0x20000
    s_add_u32 m0, s33, 20480
    s_add_u32 s42, s86, 0
    buffer_load_dwordx4 v22, s[8:11], s42 offen nt lds
    s_add_u32 m0, s33, 21504
    s_add_u32 s42, s86, 1048576
    buffer_load_dwordx4 v22, s[8:11], s42 offen nt lds
    s_add_u32 m0, s33, 22528
    s_add_u32 s42, s86, 8192
    buffer_load_dwordx4 v22, s[8:11], s42 offen nt lds
    s_add_u32 m0, s33, 23552
    s_add_u32 s42, s86, 1056768
    buffer_load_dwordx4 v22, s[8:11], s42 offen nt lds
    ds_read_b64_tr_b16 a[96:97], v28 offset:24576
    ds_read_b64_tr_b16 a[98:99], v28 offset:25600
    ds_read_b64_tr_b16 a[100:101], v29 offset:24576
    ds_read_b64_tr_b16 a[102:103], v29 offset:25600
    ds_read_b64_tr_b16 a[104:105], v28 offset:24584
    ds_read_b64_tr_b16 a[106:107], v28 offset:25608
    ds_read_b64_tr_b16 a[108:109], v29 offset:24584
    ds_read_b64_tr_b16 a[110:111], v29 offset:25608
    s_waitcnt lgkmcnt(0)
    s_waitcnt vmcnt(28)
    s_barrier
    s_add_u32 m0, s33, 24576
    s_add_u32 s42, s86, 262144
    buffer_load_dwordx4 v22, s[8:11], s42 offen nt lds
    s_add_u32 m0, s33, 25600
    s_add_u32 s42, s86, 1310720
    buffer_load_dwordx4 v22, s[8:11], s42 offen nt lds
    s_add_u32 m0, s33, 26624
    s_add_u32 s42, s86, 270336
    buffer_load_dwordx4 v22, s[8:11], s42 offen nt lds
    s_add_u32 m0, s33, 27648
    s_add_u32 s42, s86, 1318912
    buffer_load_dwordx4 v22, s[8:11], s42 offen nt lds
    ds_read_b64_tr_b16 a[112:113], v28 offset:28672
    ds_read_b64_tr_b16 a[114:115], v28 offset:29696
    ds_read_b64_tr_b16 a[116:117], v29 offset:28672
    ds_read_b64_tr_b16 a[118:119], v29 offset:29696
    ds_read_b64_tr_b16 a[120:121], v28 offset:28680
    ds_read_b64_tr_b16 a[122:123], v28 offset:29704
    ds_read_b64_tr_b16 a[124:125], v29 offset:28680
    ds_read_b64_tr_b16 a[126:127], v29 offset:29704
    s_waitcnt lgkmcnt(0)
    s_waitcnt vmcnt(28)
    s_barrier
    s_add_u32 m0, s33, 28672
    s_add_u32 s42, s86, 786432
    buffer_load_dwordx4 v22, s[8:11], s42 offen nt lds
    s_add_u32 m0, s33, 29696
    s_add_u32 s42, s86, 1835008
    buffer_load_dwordx4 v22, s[8:11], s42 offen nt lds
    s_add_u32 m0, s33, 30720
    s_add_u32 s42, s86, 794624
    buffer_load_dwordx4 v22, s[8:11], s42 offen nt lds
    s_add_u32 m0, s33, 31744
    s_add_u32 s42, s86, 1843200
    buffer_load_dwordx4 v22, s[8:11], s42 offen nt lds
    ds_read_b64_tr_b16 a[128:129], v28 offset:32768
    ds_read_b64_tr_b16 a[130:131], v28 offset:33792
    ds_read_b64_tr_b16 a[132:133], v29 offset:32768
    ds_read_b64_tr_b16 a[134:135], v29 offset:33792
    ds_read_b64_tr_b16 a[136:137], v28 offset:32776
    ds_read_b64_tr_b16 a[138:139], v28 offset:33800
    ds_read_b64_tr_b16 a[140:141], v29 offset:32776
    ds_read_b64_tr_b16 a[142:143], v29 offset:33800
    s_waitcnt lgkmcnt(0)
    s_waitcnt vmcnt(28)
    s_barrier
    s_add_u32 m0, s33, 32768
    s_add_u32 s42, s44, 4194304
    buffer_load_dwordx4 v23, s[8:11], s42 offen nt lds
    s_add_u32 m0, s33, 33792
    s_add_u32 s42, s44, 4210688
    buffer_load_dwordx4 v23, s[8:11], s42 offen nt lds
    s_add_u32 m0, s33, 34816
    s_add_u32 s42, s44, 4227072
    buffer_load_dwordx4 v23, s[8:11], s42 offen nt lds
    s_add_u32 m0, s33, 35840
    s_add_u32 s42, s44, 4243456
    buffer_load_dwordx4 v23, s[8:11], s42 offen nt lds
    s_cmp_eq_u32 s14, 3
    s_cbranch_scc1 m0_9
    v_lshl_or_b32 v34, v49, 16, v48
    v_lshl_or_b32 v35, v51, 16, v50
    v_min_u32 v34, -2, v34
    s_mov_b64 exec, s[28:29]
    buffer_store_dwordx2 v[34:35], v8, s[4:7], s17 offen sc1
    s_mov_b64 exec, -1
m0_9:
    ds_read_b64_tr_b16 a[144:145], v28 offset:0
    ds_read_b64_tr_b16 a[146:147], v28 offset:1024
    ds_read_b64_tr_b16 a[148:149], v29 offset:0
    ds_read_b64_tr_b16 a[150:151], v29 offset:1024
    ds_read_b64_tr_b16 a[152:153], v28 offset:8
    ds_read_b64_tr_b16 a[154:155], v28 offset:1032
    ds_read_b64_tr_b16 a[156:157], v29 offset:8
    ds_read_b64_tr_b16 a[158:159], v29 offset:1032
    s_waitcnt lgkmcnt(0)
    s_waitcnt vmcnt(28)
    s_barrier
    s_add_u32 m0, s33, 0
    s_add_u32 s42, s86, 2097152
    buffer_load_dwordx4 v22, s[8:11], s42 offen nt lds
    s_add_u32 m0, s33, 1024
    s_add_u32 s42, s86, 3145728
    buffer_load_dwordx4 v22, s[8:11], s42 offen nt lds
    s_add_u32 m0, s33, 2048
    s_add_u32 s42, s86, 2105344
    buffer_load_dwordx4 v22, s[8:11], s42 offen nt lds
    s_add_u32 m0, s33, 3072
    s_add_u32 s42, s86, 3153920
    buffer_load_dwordx4 v22, s[8:11], s42 offen nt lds
    ds_read_b64_tr_b16 a[160:161], v28 offset:4096
    ds_read_b64_tr_b16 a[162:163], v28 offset:5120
    ds_read_b64_tr_b16 a[164:165], v29 offset:4096
    ds_read_b64_tr_b16 a[166:167], v29 offset:5120
    ds_read_b64_tr_b16 a[168:169], v28 offset:4104
    ds_read_b64_tr_b16 a[170:171], v28 offset:5128
    ds_read_b64_tr_b16 a[172:173], v29 offset:4104
    ds_read_b64_tr_b16 a[174:175], v29 offset:5128
    s_waitcnt lgkmcnt(0)
    s_waitcnt vmcnt(28)
    s_barrier
    s_add_u32 m0, s33, 4096
    s_add_u32 s42, s86, 2359296
    buffer_load_dwordx4 v22, s[8:11], s42 offen nt lds
    s_add_u32 m0, s33, 5120
    s_add_u32 s42, s86, 3407872
    buffer_load_dwordx4 v22, s[8:11], s42 offen nt lds
    s_add_u32 m0, s33, 6144
    s_add_u32 s42, s86, 2367488
    buffer_load_dwordx4 v22, s[8:11], s42 offen nt lds
    s_add_u32 m0, s33, 7168
    s_add_u32 s42, s86, 3416064
    buffer_load_dwordx4 v22, s[8:11], s42 offen nt lds
    ds_read_b64_tr_b16 a[176:177], v28 offset:8192
    ds_read_b64_tr_b16 a[178:179], v28 offset:9216
    ds_read_b64_tr_b16 a[180:181], v29 offset:8192
    ds_read_b64_tr_b16 a[182:183], v29 offset:9216
    ds_read_b64_tr_b16 a[184:185], v28 offset:8200
    ds_read_b64_tr_b16 a[186:187], v28 offset:9224
    ds_read_b64_tr_b16 a[188:189], v29 offset:8200
    ds_read_b64_tr_b16 a[190:191], v29 offset:9224
    s_waitcnt lgkmcnt(0)
    s_waitcnt vmcnt(28)
    s_barrier
    s_add_u32 m0, s33, 8192
    s_add_u32 s42, s86, 2621440
    buffer_load_dwordx4 v22, s[8:11], s42 offen nt lds
    s_add_u32 m0, s33, 9216
    s_add_u32 s42, s86, 3670016
    buffer_load_dwordx4 v22, s[8:11], s42 offen nt lds
    s_add_u32 m0, s33, 10240
    s_add_u32 s42, s86, 2629632
    buffer_load_dwordx4 v22, s[8:11], s42 offen nt lds
    s_add_u32 m0, s33, 11264
    s_add_u32 s42, s86, 3678208
    buffer_load_dwordx4 v22, s[8:11], s42 offen nt lds
    s_getpc_b64 s[70:71]
    v_lshlrev_b32 v53, 7, v14
    s_lshl_b32 s42, s14, 13
    v_add_u32 v53, s42, v53
    global_load_dword v52, v53, s[70:71]
    ds_read_b64_tr_b16 a[192:193], v28 offset:12288
    ds_read_b64_tr_b16 a[194:195], v28 offset:13312
    ds_read_b64_tr_b16 a[196:197], v29 offset:12288
    ds_read_b64_tr_b16 a[198:199], v29 offset:13312
    ds_read_b64_tr_b16 a[200:201], v28 offset:12296
    ds_read_b64_tr_b16 a[202:203], v28 offset:13320
    ds_read_b64_tr_b16 a[204:205], v29 offset:12296
    ds_read_b64_tr_b16 a[206:207], v29 offset:13320
    s_waitcnt lgkmcnt(0)
    s_waitcnt vmcnt(29)
    s_barrier
    s_add_u32 m0, s33, 12288
    s_add_u32 s42, s86, 2883584
    buffer_load_dwordx4 v22, s[8:11], s42 offen nt lds
    s_add_u32 m0, s33, 13312
    s_add_u32 s42, s86, 3932160
    buffer_load_dwordx4 v22, s[8:11], s42 offen nt lds
    s_add_u32 m0, s33, 14336
    s_add_u32 s42, s86, 2891776
    buffer_load_dwordx4 v22, s[8:11], s42 offen nt lds
    s_add_u32 m0, s33, 15360
    s_add_u32 s42, s86, 3940352
    buffer_load_dwordx4 v22, s[8:11], s42 offen nt lds
    ds_read_b64_tr_b16 a[208:209], v28 offset:16384
    ds_read_b64_tr_b16 a[210:211], v28 offset:17408
    ds_read_b64_tr_b16 a[212:213], v29 offset:16384
    ds_read_b64_tr_b16 a[214:215], v29 offset:17408
    ds_read_b64_tr_b16 a[216:217], v28 offset:16392
    ds_read_b64_tr_b16 a[218:219], v28 offset:17416
    ds_read_b64_tr_b16 a[220:221], v29 offset:16392
    ds_read_b64_tr_b16 a[222:223], v29 offset:17416
    s_waitcnt lgkmcnt(0)
    s_waitcnt vmcnt(29)
    s_barrier
    s_mov_b32 s8, s56
    s_mov_b32 s9, s57
    s_mov_b32 s10, 4718592
    s_mov_b32 s11, 0x20000
    s_add_u32 m0, s33, 16384
    s_add_u32 s42, s45, 0
    buffer_load_dwordx4 v24, s[8:11], s42 offen  lds
    s_add_u32 m0, s33, 17408
    s_add_u32 s42, s45, 2304
    buffer_load_dwordx4 v24, s[8:11], s42 offen  lds
    s_add_u32 m0, s33, 18432
    s_add_u32 s42, s45, 4608
    buffer_load_dwordx4 v24, s[8:11], s42 offen  lds
    s_add_u32 m0, s33, 19456
    s_add_u32 s42, s45, 6912
    buffer_load_dwordx4 v24, s[8:11], s42 offen  lds
    ds_read_b64_tr_b16 a[224:225], v26 offset:20480
    ds_read_b64_tr_b16 a[226:227], v26 offset:21504
    ds_read_b64_tr_b16 a[228:229], v27 offset:20480
    ds_read_b64_tr_b16 a[230:231], v27 offset:21504
    ds_read_b64_tr_b16 a[232:233], v26 offset:20512
    ds_read_b64_tr_b16 a[234:235], v26 offset:21536
    ds_read_b64_tr_b16 a[236:237], v27 offset:20512
    ds_read_b64_tr_b16 a[238:239], v27 offset:21536
    s_waitcnt lgkmcnt(0)
    s_waitcnt vmcnt(29)
    s_barrier
    s_add_u32 m0, s33, 20480
    s_add_u32 s42, s45, 256
    buffer_load_dwordx4 v24, s[8:11], s42 offen  lds
    s_add_u32 m0, s33, 21504
    s_add_u32 s42, s45, 2560
    buffer_load_dwordx4 v24, s[8:11], s42 offen  lds
    s_add_u32 m0, s33, 22528
    s_add_u32 s42, s45, 4864
    buffer_load_dwordx4 v24, s[8:11], s42 offen  lds
    s_add_u32 m0, s33, 23552
    s_add_u32 s42, s45, 7168
    buffer_load_dwordx4 v24, s[8:11], s42 offen  lds
    ds_read_b64_tr_b16 a[240:241], v26 offset:24576
    ds_read_b64_tr_b16 a[242:243], v26 offset:25600
    ds_read_b64_tr_b16 a[244:245], v27 offset:24576
    ds_read_b64_tr_b16 a[246:247], v27 offset:25600
    ds_read_b64_tr_b16 a[248:249], v26 offset:24608
    ds_read_b64_tr_b16 a[250:251], v26 offset:25632
    ds_read_b64_tr_b16 a[252:253], v27 offset:24608
    ds_read_b64_tr_b16 a[254:255], v27 offset:25632
    s_waitcnt lgkmcnt(0)
    s_waitcnt vmcnt(29)
    s_barrier
    s_add_u32 m0, s33, 24576
    s_add_u32 s42, s45, 512
    buffer_load_dwordx4 v24, s[8:11], s42 offen  lds
    s_add_u32 m0, s33, 25600
    s_add_u32 s42, s45, 2816
    buffer_load_dwordx4 v24, s[8:11], s42 offen  lds
    s_add_u32 m0, s33, 26624
    s_add_u32 s42, s45, 5120
    buffer_load_dwordx4 v24, s[8:11], s42 offen  lds
    s_add_u32 m0, s33, 27648
    s_add_u32 s42, s45, 7424
    buffer_load_dwordx4 v24, s[8:11], s42 offen  lds
    ds_read_b64_tr_b16 v[80:81], v26 offset:28672
    ds_read_b64_tr_b16 v[82:83], v26 offset:29696
    ds_read_b64_tr_b16 v[84:85], v27 offset:28672
    ds_read_b64_tr_b16 v[86:87], v27 offset:29696
    ds_read_b64_tr_b16 v[88:89], v26 offset:28704
    ds_read_b64_tr_b16 v[90:91], v26 offset:29728
    ds_read_b64_tr_b16 v[92:93], v27 offset:28704
    ds_read_b64_tr_b16 v[94:95], v27 offset:29728
    s_waitcnt lgkmcnt(0)
    s_waitcnt vmcnt(29)
    s_barrier
    s_add_u32 m0, s33, 28672
    s_add_u32 s42, s45, 768
    buffer_load_dwordx4 v24, s[8:11], s42 offen  lds
    s_add_u32 m0, s33, 29696
    s_add_u32 s42, s45, 3072
    buffer_load_dwordx4 v24, s[8:11], s42 offen  lds
    s_add_u32 m0, s33, 30720
    s_add_u32 s42, s45, 5376
    buffer_load_dwordx4 v24, s[8:11], s42 offen  lds
    s_add_u32 m0, s33, 31744
    s_add_u32 s42, s45, 7680
    buffer_load_dwordx4 v24, s[8:11], s42 offen  lds
    ds_read_b64_tr_b16 v[96:97], v26 offset:32768
    ds_read_b64_tr_b16 v[98:99], v26 offset:33792
    ds_read_b64_tr_b16 v[100:101], v27 offset:32768
    ds_read_b64_tr_b16 v[102:103], v27 offset:33792
    ds_read_b64_tr_b16 v[104:105], v26 offset:32800
    ds_read_b64_tr_b16 v[106:107], v26 offset:33824
    ds_read_b64_tr_b16 v[108:109], v27 offset:32800
    ds_read_b64_tr_b16 v[110:111], v27 offset:33824
    s_waitcnt lgkmcnt(0)
    s_waitcnt vmcnt(29)
    s_barrier
    s_add_u32 m0, s33, 32768
    s_add_u32 s42, s45, 1024
    buffer_load_dwordx4 v25, s[8:11], s42 offen  lds
    s_add_u32 m0, s33, 33792
    s_add_u32 s42, s45, 5632
    buffer_load_dwordx4 v25, s[8:11], s42 offen  lds
    s_add_u32 m0, s33, 34816
    s_add_u32 s42, s45, 74752
    buffer_load_dwordx4 v25, s[8:11], s42 offen  lds
    s_add_u32 m0, s33, 35840
    s_add_u32 s42, s45, 79360
    buffer_load_dwordx4 v25, s[8:11], s42 offen  lds
    ds_read_b64_tr_b16 v[112:113], v26 offset:0
    ds_read_b64_tr_b16 v[114:115], v26 offset:1024
    ds_read_b64_tr_b16 v[116:117], v27 offset:0
    ds_read_b64_tr_b16 v[118:119], v27 offset:1024
    ds_read_b64_tr_b16 v[120:121], v26 offset:32
    ds_read_b64_tr_b16 v[122:123], v26 offset:1056
    ds_read_b64_tr_b16 v[124:125], v27 offset:32
    ds_read_b64_tr_b16 v[126:127], v27 offset:1056
    s_waitcnt lgkmcnt(0)
    s_waitcnt vmcnt(29)
    s_barrier
    s_mov_b32 s8, s52
    s_mov_b32 s9, s53
    s_mov_b32 s10, 4718592
    s_mov_b32 s11, 0x20000
    s_add_u32 m0, s33, 0
    s_add_u32 s42, s86, 262144
    buffer_load_dwordx4 v22, s[8:11], s42 offen nt lds
    s_add_u32 m0, s33, 1024
    s_add_u32 s42, s86, 1310720
    buffer_load_dwordx4 v22, s[8:11], s42 offen nt lds
    s_add_u32 m0, s33, 2048
    s_add_u32 s42, s86, 270336
    buffer_load_dwordx4 v22, s[8:11], s42 offen nt lds
    s_add_u32 m0, s33, 3072
    s_add_u32 s42, s86, 1318912
    buffer_load_dwordx4 v22, s[8:11], s42 offen nt lds
    s_cmp_lg_u32 s14, 0
    s_cbranch_scc1 si_10
    s_cmp_eq_u32 s59, 3
    s_cselect_b32 s42, 1, 0x10001
    s_mov_b64 exec, 1
    v_mov_b32 v34, 192
    v_mov_b32 v35, s42
    global_atomic_add v34, v35, s[12:13]
    s_mov_b64 exec, -1
si_10:
    ds_read_b64_tr_b16 v[128:129], v26 offset:4096
    ds_read_b64_tr_b16 v[130:131], v26 offset:5120
    ds_read_b64_tr_b16 v[132:133], v27 offset:4096
    ds_read_b64_tr_b16 v[134:135], v27 offset:5120
    ds_read_b64_tr_b16 v[136:137], v26 offset:4128
    ds_read_b64_tr_b16 v[138:139], v26 offset:5152
    ds_read_b64_tr_b16 v[140:141], v27 offset:4128
    ds_read_b64_tr_b16 v[142:143], v27 offset:5152
    s_waitcnt lgkmcnt(0)
    s_waitcnt vmcnt(29)
    s_barrier
    s_add_u32 m0, s33, 4096
    s_add_u32 s42, s86, 786432
    buffer_load_dwordx4 v22, s[8:11], s42 offen nt lds
    s_add_u32 m0, s33, 5120
    s_add_u32 s42, s86, 1835008
    buffer_load_dwordx4 v22, s[8:11], s42 offen nt lds
    s_add_u32 m0, s33, 6144
    s_add_u32 s42, s86, 794624
    buffer_load_dwordx4 v22, s[8:11], s42 offen nt lds
    s_add_u32 m0, s33, 7168
    s_add_u32 s42, s86, 1843200
    buffer_load_dwordx4 v22, s[8:11], s42 offen nt lds
    ds_read_b64_tr_b16 v[144:145], v26 offset:8192
    ds_read_b64_tr_b16 v[146:147], v26 offset:9216
    ds_read_b64_tr_b16 v[148:149], v27 offset:8192
    ds_read_b64_tr_b16 v[150:151], v27 offset:9216
    ds_read_b64_tr_b16 v[152:153], v26 offset:8224
    ds_read_b64_tr_b16 v[154:155], v26 offset:9248
    ds_read_b64_tr_b16 v[156:157], v27 offset:8224
    ds_read_b64_tr_b16 v[158:159], v27 offset:9248
    s_waitcnt lgkmcnt(0)
    s_waitcnt vmcnt(28)
    s_barrier
    s_add_u32 m0, s33, 8192
    s_add_u32 s42, s86, 2097152
    buffer_load_dwordx4 v22, s[8:11], s42 offen nt lds
    s_add_u32 m0, s33, 9216
    s_add_u32 s42, s86, 3145728
    buffer_load_dwordx4 v22, s[8:11], s42 offen nt lds
    s_add_u32 m0, s33, 10240
    s_add_u32 s42, s86, 2105344
    buffer_load_dwordx4 v22, s[8:11], s42 offen nt lds
    s_add_u32 m0, s33, 11264
    s_add_u32 s42, s86, 3153920
    buffer_load_dwordx4 v22, s[8:11], s42 offen nt lds
    ds_read_b64_tr_b16 v[160:161], v26 offset:12288
    ds_read_b64_tr_b16 v[162:163], v26 offset:13312
    ds_read_b64_tr_b16 v[164:165], v27 offset:12288
    ds_read_b64_tr_b16 v[166:167], v27 offset:13312
    ds_read_b64_tr_b16 v[168:169], v26 offset:12320
    ds_read_b64_tr_b16 v[170:171], v26 offset:13344
    ds_read_b64_tr_b16 v[172:173], v27 offset:12320
    ds_read_b64_tr_b16 v[174:175], v27 offset:13344
    s_waitcnt lgkmcnt(0)
    s_waitcnt vmcnt(28)
    s_barrier
    s_add_u32 m0, s33, 12288
    s_add_u32 s42, s86, 2621440
    buffer_load_dwordx4 v22, s[8:11], s42 offen nt lds
    s_add_u32 m0, s33, 13312
    s_add_u32 s42, s86, 3670016
    buffer_load_dwordx4 v22, s[8:11], s42 offen nt lds
    s_add_u32 m0, s33, 14336
    s_add_u32 s42, s86, 2629632
    buffer_load_dwordx4 v22, s[8:11], s42 offen nt lds
    s_add_u32 m0, s33, 15360
    s_add_u32 s42, s86, 3678208
    buffer_load_dwordx4 v22, s[8:11], s42 offen nt lds
    ds_read_b64_tr_b16 v[176:177], v36 offset:16384
    ds_read_b64_tr_b16 v[178:179], v36 offset:17408
    ds_read_b64_tr_b16 v[180:181], v37 offset:16384
    ds_read_b64_tr_b16 v[182:183], v37 offset:17408
    ds_read_b64_tr_b16 v[184:185], v38 offset:16384
    ds_read_b64_tr_b16 v[186:187], v38 offset:17408
    ds_read_b64_tr_b16 v[188:189], v39 offset:16384
    ds_read_b64_tr_b16 v[190:191], v39 offset:17408
    s_waitcnt lgkmcnt(0)
    s_waitcnt vmcnt(28)
    s_barrier
    s_mov_b32 s8, s54
    s_mov_b32 s9, s55
    s_mov_b32 s10, 4718592
    s_mov_b32 s11, 0x20000
    s_add_u32 m0, s33, 16384
    s_add_u32 s42, s86, 524288
    buffer_load_dwordx4 v22, s[8:11], s42 offen nt lds
    s_add_u32 m0, s33, 17408
    s_add_u32 s42, s86, 1572864
    buffer_load_dwordx4 v22, s[8:11], s42 offen nt lds
    s_add_u32 m0, s33, 18432
    s_add_u32 s42, s86, 532480
    buffer_load_dwordx4 v22, s[8:11], s42 offen nt lds
    s_add_u32 m0, s33, 19456
    s_add_u32 s42, s86, 1581056
    buffer_load_dwordx4 v22, s[8:11], s42 offen nt lds
    ds_read_b64_tr_b16 v[192:193], v36 offset:20480
    ds_read_b64_tr_b16 v[194:195], v36 offset:21504
    ds_read_b64_tr_b16 v[196:197], v37 offset:20480
    ds_read_b64_tr_b16 v[198:199], v37 offset:21504
    ds_read_b64_tr_b16 v[200:201], v38 offset:20480
    ds_read_b64_tr_b16 v[202:203], v38 offset:21504
    ds_read_b64_tr_b16 v[204:205], v39 offset:20480
    ds_read_b64_tr_b16 v[206:207], v39 offset:21504
    s_waitcnt lgkmcnt(0)
    s_waitcnt vmcnt(28)
    s_barrier
    s_mov_b32 s8, s56
    s_mov_b32 s9, s57
    s_mov_b32 s10, 4718592
    s_mov_b32 s11, 0x20000
    s_add_u32 m0, s33, 20480
    s_add_u32 s42, s45, 73728
    buffer_load_dwordx4 v24, s[8:11], s42 offen  lds
    s_add_u32 m0, s33, 21504
    s_add_u32 s42, s45, 76032
    buffer_load_dwordx4 v24, s[8:11], s42 offen  lds
    s_add_u32 m0, s33, 22528
    s_add_u32 s42, s45, 78336
    buffer_load_dwordx4 v24, s[8:11], s42 offen  lds
    s_add_u32 m0, s33, 23552
    s_add_u32 s42, s45, 80640
    buffer_load_dwordx4 v24, s[8:11], s42 offen  lds
    ds_read_b64_tr_b16 v[208:209], v36 offset:24576
    ds_read_b64_tr_b16 v[210:211], v36 offset:25600
    ds_read_b64_tr_b16 v[212:213], v37 offset:24576
    ds_read_b64_tr_b16 v[214:215], v37 offset:25600
    ds_read_b64_tr_b16 v[216:217], v38 offset:24576
    ds_read_b64_tr_b16 v[218:219], v38 offset:25600
    ds_read_b64_tr_b16 v[220:221], v39 offset:24576
    ds_read_b64_tr_b16 v[222:223], v39 offset:25600
    s_waitcnt lgkmcnt(0)
    s_waitcnt vmcnt(28)
    s_barrier
    s_add_u32 m0, s33, 24576
    s_add_u32 s42, s45, 73984
    buffer_load_dwordx4 v24, s[8:11], s42 offen  lds
    s_add_u32 m0, s33, 25600
    s_add_u32 s42, s45, 76288
    buffer_load_dwordx4 v24, s[8:11], s42 offen  lds
    s_add_u32 m0, s33, 26624
    s_add_u32 s42, s45, 78592
    buffer_load_dwordx4 v24, s[8:11], s42 offen  lds
    s_add_u32 m0, s33, 27648
    s_add_u32 s42, s45, 80896
    buffer_load_dwordx4 v24, s[8:11], s42 offen  lds
    ds_read_b64_tr_b16 v[224:225], v36 offset:28672
    ds_read_b64_tr_b16 v[226:227], v36 offset:29696
    ds_read_b64_tr_b16 v[228:229], v37 offset:28672
    ds_read_b64_tr_b16 v[230:231], v37 offset:29696
    ds_read_b64_tr_b16 v[232:233], v38 offset:28672
    ds_read_b64_tr_b16 v[234:235], v38 offset:29696
    ds_read_b64_tr_b16 v[236:237], v39 offset:28672
    ds_read_b64_tr_b16 v[238:239], v39 offset:29696
    s_waitcnt lgkmcnt(0)
    s_waitcnt vmcnt(28)
    s_barrier
    s_add_u32 m0, s33, 28672
    s_add_u32 s42, s45, 74240
    buffer_load_dwordx4 v24, s[8:11], s42 offen  lds
    s_add_u32 m0, s33, 29696
    s_add_u32 s42, s45, 76544
    buffer_load_dwordx4 v24, s[8:11], s42 offen  lds
    s_add_u32 m0, s33, 30720
    s_add_u32 s42, s45, 78848
    buffer_load_dwordx4 v24, s[8:11], s42 offen  lds
    s_add_u32 m0, s33, 31744
    s_add_u32 s42, s45, 81152
    buffer_load_dwordx4 v24, s[8:11], s42 offen  lds
    ds_read_b64_tr_b16 v[240:241], v30 offset:32768
    ds_read_b64_tr_b16 v[242:243], v30 offset:33280
    ds_read_b64_tr_b16 v[244:245], v31 offset:32768
    ds_read_b64_tr_b16 v[246:247], v31 offset:33280
    ds_read_b64_tr_b16 v[248:249], v30 offset:34816
    ds_read_b64_tr_b16 v[250:251], v30 offset:35328
    ds_read_b64_tr_b16 v[252:253], v31 offset:34816
    ds_read_b64_tr_b16 v[254:255], v31 offset:35328
    s_waitcnt lgkmcnt(0)
    s_waitcnt vmcnt(28)
    s_barrier
    s_add_u32 m0, s33, 32768
    s_add_u32 s42, s45, 74496
    buffer_load_dwordx4 v24, s[8:11], s42 offen  lds
    s_add_u32 m0, s33, 33792
    s_add_u32 s42, s45, 76800
    buffer_load_dwordx4 v24, s[8:11], s42 offen  lds
    s_add_u32 m0, s33, 34816
    s_add_u32 s42, s45, 79104
    buffer_load_dwordx4 v24, s[8:11], s42 offen  lds
    s_add_u32 m0, s33, 35840
    s_add_u32 s42, s45, 81408
    buffer_load_dwordx4 v24, s[8:11], s42 offen  lds
    ds_read_b64_tr_b16 v[60:61], v28 offset:0
    ds_read_b64_tr_b16 v[62:63], v28 offset:1024
    ds_read_b64_tr_b16 v[64:65], v29 offset:0
    ds_read_b64_tr_b16 v[66:67], v29 offset:1024
    ds_read_b64_tr_b16 v[68:69], v28 offset:8
    ds_read_b64_tr_b16 v[70:71], v28 offset:1032
    ds_read_b64_tr_b16 v[72:73], v29 offset:8
    ds_read_b64_tr_b16 v[74:75], v29 offset:1032
    s_waitcnt lgkmcnt(0)
    s_barrier
    ds_write_b128 v4, v[60:63] offset:0
    ds_write_b128 v4, v[64:67] offset:1024
    ds_write_b128 v4, v[68:71] offset:2048
    ds_write_b128 v4, v[72:75] offset:3072
    s_waitcnt lgkmcnt(0)
    s_waitcnt vmcnt(28)
    s_barrier
    ds_read_b64_tr_b16 v[60:61], v28 offset:4096
    ds_read_b64_tr_b16 v[62:63], v28 offset:5120
    ds_read_b64_tr_b16 v[64:65], v29 offset:4096
    ds_read_b64_tr_b16 v[66:67], v29 offset:5120
    ds_read_b64_tr_b16 v[68:69], v28 offset:4104
    ds_read_b64_tr_b16 v[70:71], v28 offset:5128
    ds_read_b64_tr_b16 v[72:73], v29 offset:4104
    ds_read_b64_tr_b16 v[74:75], v29 offset:5128
    s_waitcnt lgkmcnt(0)
    s_barrier
    ds_write_b128 v4, v[60:63] offset:4096
    ds_write_b128 v4, v[64:67] offset:5120
    ds_write_b128 v4, v[68:71] offset:6144
    ds_write_b128 v4, v[72:75] offset:7168
    s_waitcnt lgkmcnt(0)
    s_waitcnt vmcnt(24)
    s_barrier
    ds_read_b64_tr_b16 v[60:61], v28 offset:8192
    ds_read_b64_tr_b16 v[62:63], v28 offset:9216
    ds_read_b64_tr_b16 v[64:65], v29 offset:8192
    ds_read_b64_tr_b16 v[66:67], v29 offset:9216
    ds_read_b64_tr_b16 v[68:69], v28 offset:8200
    ds_read_b64_tr_b16 v[70:71], v28 offset:9224
    ds_read_b64_tr_b16 v[72:73], v29 offset:8200
    ds_read_b64_tr_b16 v[74:75], v29 offset:9224
    s_waitcnt lgkmcnt(0)
    s_barrier
    ds_write_b128 v4, v[60:63] offset:8192
    ds_write_b128 v4, v[64:67] offset:9216
    ds_write_b128 v4, v[68:71] offset:10240
    ds_write_b128 v4, v[72:75] offset:11264
    s_waitcnt lgkmcnt(0)
    s_waitcnt vmcnt(20)
    s_barrier
    ds_read_b64_tr_b16 v[60:61], v28 offset:12288
    ds_read_b64_tr_b16 v[62:63], v28 offset:13312
    ds_read_b64_tr_b16 v[64:65], v29 offset:12288
    ds_read_b64_tr_b16 v[66:67], v29 offset:13312
    ds_read_b64_tr_b16 v[68:69], v28 offset:12296
    ds_read_b64_tr_b16 v[70:71], v28 offset:13320
    ds_read_b64_tr_b16 v[72:73], v29 offset:12296
    ds_read_b64_tr_b16 v[74:75], v29 offset:13320
    s_waitcnt lgkmcnt(0)
    s_barrier
    ds_write_b128 v4, v[60:63] offset:12288
    ds_write_b128 v4, v[64:67] offset:13312
    ds_write_b128 v4, v[68:71] offset:14336
    ds_write_b128 v4, v[72:75] offset:15360
    s_waitcnt lgkmcnt(0)
    s_waitcnt vmcnt(16)
    s_barrier
    ds_read_b64_tr_b16 v[60:61], v26 offset:16384
    ds_read_b64_tr_b16 v[62:63], v26 offset:17408
    ds_read_b64_tr_b16 v[64:65], v27 offset:16384
    ds_read_b64_tr_b16 v[66:67], v27 offset:17408
    ds_read_b64_tr_b16 v[68:69], v26 offset:16416
    ds_read_b64_tr_b16 v[70:71], v26 offset:17440
    ds_read_b64_tr_b16 v[72:73], v27 offset:16416
    ds_read_b64_tr_b16 v[74:75], v27 offset:17440
    s_waitcnt lgkmcnt(0)
    s_barrier
    ds_write_b128 v4, v[60:63] offset:16384
    ds_write_b128 v4, v[64:67] offset:17408
    ds_write_b128 v4, v[68:71] offset:18432
    ds_write_b128 v4, v[72:75] offset:19456
    s_waitcnt lgkmcnt(0)
    s_waitcnt vmcnt(12)
    s_barrier
    ds_read_b64_tr_b16 v[60:61], v36 offset:20480
    ds_read_b64_tr_b16 v[62:63], v36 offset:21504
    ds_read_b64_tr_b16 v[64:65], v37 offset:20480
    ds_read_b64_tr_b16 v[66:67], v37 offset:21504
    ds_read_b64_tr_b16 v[68:69], v38 offset:20480
    ds_read_b64_tr_b16 v[70:71], v38 offset:21504
    ds_read_b64_tr_b16 v[72:73], v39 offset:20480
    ds_read_b64_tr_b16 v[74:75], v39 offset:21504
    s_waitcnt lgkmcnt(0)
    s_barrier
    ds_write_b128 v4, v[60:63] offset:20480
    ds_write_b128 v4, v[64:67] offset:21504
    ds_write_b128 v4, v[68:71] offset:22528
    ds_write_b128 v4, v[72:75] offset:23552
    s_waitcnt lgkmcnt(0)
    s_waitcnt vmcnt(8)
    s_barrier
    ds_read_b64_tr_b16 v[60:61], v36 offset:24576
    ds_read_b64_tr_b16 v[62:63], v36 offset:25600
    ds_read_b64_tr_b16 v[64:65], v37 offset:24576
    ds_read_b64_tr_b16 v[66:67], v37 offset:25600
    ds_read_b64_tr_b16 v[68:69], v38 offset:24576
    ds_read_b64_tr_b16 v[70:71], v38 offset:25600
    ds_read_b64_tr_b16 v[72:73], v39 offset:24576
    ds_read_b64_tr_b16 v[74:75], v39 offset:25600
    s_waitcnt lgkmcnt(0)
    s_barrier
    ds_write_b128 v4, v[60:63] offset:24576
    ds_write_b128 v4, v[64:67] offset:25600
    ds_write_b128 v4, v[68:71] offset:26624
    ds_write_b128 v4, v[72:75] offset:27648
    s_waitcnt lgkmcnt(0)
    s_waitcnt vmcnt(4)
    s_barrier
    ds_read_b64_tr_b16 v[60:61], v36 offset:28672
    ds_read_b64_tr_b16 v[62:63], v36 offset:29696
    ds_read_b64_tr_b16 v[64:65], v37 offset:28672
    ds_read_b64_tr_b16 v[66:67], v37 offset:29696
    ds_read_b64_tr_b16 v[68:69], v38 offset:28672
    ds_read_b64_tr_b16 v[70:71], v38 offset:29696
    ds_read_b64_tr_b16 v[72:73], v39 offset:28672
    ds_read_b64_tr_b16 v[74:75], v39 offset:29696
    s_waitcnt lgkmcnt(0)
    s_barrier
    ds_write_b128 v4, v[60:63] offset:28672
    ds_write_b128 v4, v[64:67] offset:29696
    ds_write_b128 v4, v[68:71] offset:30720
    ds_write_b128 v4, v[72:75] offset:31744
    s_waitcnt lgkmcnt(0)
    s_waitcnt vmcnt(0)
    s_barrier
    ds_read_b64_tr_b16 v[60:61], v36 offset:32768
    ds_read_b64_tr_b16 v[62:63], v36 offset:33792
    ds_read_b64_tr_b16 v[64:65], v37 offset:32768
    ds_read_b64_tr_b16 v[66:67], v37 offset:33792
    ds_read_b64_tr_b16 v[68:69], v38 offset:32768
    ds_read_b64_tr_b16 v[70:71], v38 offset:33792
    ds_read_b64_tr_b16 v[72:73], v39 offset:32768
    ds_read_b64_tr_b16 v[74:75], v39 offset:33792
    s_waitcnt lgkmcnt(0)
    s_barrier
    ds_write_b128 v4, v[60:63] offset:32768
    ds_write_b128 v4, v[64:67] offset:33792
    ds_write_b128 v4, v[68:71] offset:34816
    ds_write_b128 v4, v[72:75] offset:35840
    s_waitcnt lgkmcnt(0)
    s_mov_b32 s41, 0
    v_mov_b32 v34, 192
ww_11:
    global_load_dword v35, v34, s[12:13] sc1
    s_waitcnt vmcnt(0)
    v_readfirstlane_b32 s43, v35
    s_nop 0
    s_and_b32 s42, s43, 65535
    s_cmp_ge_u32 s42, 32
    s_cbranch_scc1 ww_12
    s_sleep 2
    s_add_u32 s41, s41, 1
    s_cmp_lt_u32 s41, 2000000
    s_cbranch_scc1 ww_11
    s_branch fin1
ww_12:
    s_lshr_b32 s59, s43, 16
    s_mov_b32 s39, 2
    s_mov_b32 s33, 0
    s_cmp_lg_u32 s14, 3
    s_cbranch_scc1 st_13
    s_mov_b32 s41, 0
    v_mov_b32 v34, 224
ww_14:
    global_load_dword v35, v34, s[12:13] sc1
    s_waitcnt vmcnt(0)
    v_readfirstlane_b32 s43, v35
    s_nop 0
    s_and_b32 s42, s43, -1
    s_cmp_ge_u32 s42, 1
    s_cbranch_scc1 ww_15
    s_sleep 2
    s_add_u32 s41, s41, 1
    s_cmp_lt_u32 s41, 2000000
    s_cbranch_scc1 ww_14
    s_branch fin1
ww_15:
    v_min_u32 v34, 32, v0
    v_lshlrev_b32 v34, 10, v34
    s_mov_b32 s41, 0
rd_16:
    buffer_load_dword v35, v34, s[4:7], s32 offen sc1
    s_waitcnt vmcnt(0)
    v_cmp_eq_u32 vcc, 0, v35
    s_cbranch_vccz rd_17
    s_sleep 4
    s_add_u32 s41, s41, 1
    s_cmp_lt_u32 s41, 2000000
    s_cbranch_scc1 rd_16
    s_branch fin1
rd_17:
st_13:
    s_cmp_lg_u32 s59, 0
    s_cbranch_scc1 slow_18
    s_cmp_eq_u32 s14, 1
    s_cbranch_scc1 role_20
    s_cmp_eq_u32 s14, 2
    s_cbranch_scc1 role_21
    s_cmp_eq_u32 s14, 3
    s_cbranch_scc1 role_22
role_19:
.p2align 6
step_23:
    s_mov_b32 s41, 0
    s_add_u32 s86, s17, 5120
    s_mov_b32 m0, 5120
    s_mov_b32 s72, s23
    s_mov_b32 s76, 0
    v_mov_b64 v[14:15], 0
    v_mov_b64 v[16:17], 0
    v_mov_b64 v[18:19], 0
    v_mov_b64 v[20:21], 0
    v_mov_b64 v[22:23], 0
    v_mov_b64 v[24:25], 0
    v_mov_b64 v[26:27], 0
    v_mov_b64 v[28:29], 0
    s_nop 9
    buffer_load_dwordx4 v[40:43], v0, s[4:7], s17 offen offset:0 sc1
    buffer_load_dwordx4 v[44:47], v0, s[4:7], s17 offen offset:1024 sc1
    s_nop 15
    s_nop 7
    buffer_load_dwordx4 v[60:63], v0, s[4:7], s17 offen offset:0 sc1
    buffer_load_dwordx4 v[64:67], v0, s[4:7], s17 offen offset:1024 sc1
    s_waitcnt vmcnt(3)
    ds_write_b128 v0, v[40:43] offset:0
    v_max_u32 v34, v40, v42
    s_waitcnt vmcnt(2)
    ds_write_b128 v0, v[44:47] offset:1024
    v_max3_u32 v34, v34, v44, v46
    v_cmp_eq_u32 vcc, -1, v34
    s_cbranch_vccnz pp_24
ok_25:
redo_26:
    s_waitcnt lgkmcnt(0)
    s_barrier
    ds_read_b128 v[48:51], v0 offset:0
    buffer_load_dwordx4 v0, s[4:7], s86 offen offset:0 sc1 lds
    ds_read_b128 v[52:55], v0 offset:1024
    ds_read_b128 v[56:59], v0 offset:2048
    s_waitcnt lgkmcnt(2)
    v_smfmac_f32_16x16x64_bf16 v[14:17], v[48:51], a[0:7], v1
    s_waitcnt vmcnt(1)
    ds_read_b128 v[60:63], v4 offset:0
    ds_read_b128 v[64:67], v4 offset:1024
    v_smfmac_f32_16x16x64_bf16 v[22:25], v[48:51], a[8:15], v1
    ds_read_b128 v[68:71], v4 offset:2048
    ds_read_b128 v[72:75], v4 offset:3072
    v_smfmac_f32_16x16x64_bf16 v[18:21], v[48:51], a[144:151], v1
    ds_read_b128 v[10:13], v0 offset:3072
    v_smfmac_f32_16x16x64_bf16 v[26:29], v[48:51], a[152:159], v1
    ds_read_b128 v[48:51], v0 offset:4096
    s_waitcnt lgkmcnt(6)
    v_smfmac_f32_16x16x64_bf16 v[14:17], v[52:55], a[16:23], v1
    buffer_load_dwordx4 v[40:43], v9, s[4:7], s21 offen sc1 nt
    v_smfmac_f32_16x16x64_bf16 v[22:25], v[52:55], a[24:31], v1
    buffer_load_dwordx4 v[44:47], v9, s[4:7], s21 offen offset:256 sc1 nt
    s_waitcnt lgkmcnt(2)
    v_smfmac_f32_16x16x64_bf16 v[18:21], v[52:55], v[60:67], v1
    ds_read_b128 v[60:63], v4 offset:4096
    v_smfmac_f32_16x16x64_bf16 v[26:29], v[52:55], v[68:75], v1
    ds_read_b128 v[64:67], v4 offset:5120
    v_smfmac_f32_16x16x64_bf16 v[14:17], v[56:59], a[32:39], v1
    ds_read_b128 v[68:71], v4 offset:6144
    v_smfmac_f32_16x16x64_bf16 v[22:25], v[56:59], a[40:47], v1
    ds_read_b128 v[72:75], v4 offset:7168
    v_smfmac_f32_16x16x64_bf16 v[18:21], v[56:59], a[160:167], v1
    buffer_load_dwordx4 v[30:33], v9, s[4:7], s22 offen sc1 nt
    v_smfmac_f32_16x16x64_bf16 v[26:29], v[56:59], a[168:175], v1
    buffer_load_dwordx4 v[36:39], v9, s[4:7], s22 offen offset:256 sc1 nt
    s_waitcnt lgkmcnt(2)
    v_smfmac_f32_16x16x64_bf16 v[14:17], v[10:13], a[48:55], v1
    v_smfmac_f32_16x16x64_bf16 v[22:25], v[10:13], a[56:63], v1
    v_smfmac_f32_16x16x64_bf16 v[18:21], v[10:13], v[60:67], v1
    ds_read_b128 v[60:63], v4 offset:8192
    s_waitcnt lgkmcnt(1)
    v_smfmac_f32_16x16x64_bf16 v[26:29], v[10:13], v[68:75], v1
    ds_read_b128 v[64:67], v4 offset:9216
    v_smfmac_f32_16x16x64_bf16 v[14:17], v[48:51], a[64:71], v1
    ds_read_b128 v[68:71], v4 offset:10240
    s_waitcnt vmcnt(4)
    s_barrier
    ds_read_b128 v[52:55], v0 offset:5120
    v_smfmac_f32_16x16x64_bf16 v[22:25], v[48:51], a[72:79], v1
    ds_read_b128 v[56:59], v0 offset:6144
    v_smfmac_f32_16x16x64_bf16 v[18:21], v[48:51], a[176:183], v1
    ds_read_b128 v[10:13], v0 offset:7168
    v_smfmac_f32_16x16x64_bf16 v[26:29], v[48:51], a[184:191], v1
    ds_read_b128 v[72:75], v4 offset:11264
    s_waitcnt lgkmcnt(3)
    v_smfmac_f32_16x16x64_bf16 v[14:17], v[52:55], a[80:87], v1
    ds_read_b128 v[48:51], v0 offset:8192
    v_smfmac_f32_16x16x64_bf16 v[22:25], v[52:55], a[88:95], v1
    buffer_store_dwordx4 v[76:79], v0, s[4:7], s72 offen sc1
    v_smfmac_f32_16x16x64_bf16 v[18:21], v[52:55], v[60:67], v1
    ds_read_b128 v[60:63], v4 offset:12288
    s_waitcnt lgkmcnt(2)
    v_smfmac_f32_16x16x64_bf16 v[26:29], v[52:55], v[68:75], v1
    ds_read_b128 v[64:67], v4 offset:13312
    v_smfmac_f32_16x16x64_bf16 v[14:17], v[56:59], a[96:103], v1
    ds_read_b128 v[68:71], v4 offset:14336
    v_smfmac_f32_16x16x64_bf16 v[22:25], v[56:59], a[104:111], v1
    ds_read_b128 v[72:75], v4 offset:15360
    v_smfmac_f32_16x16x64_bf16 v[18:21], v[56:59], a[192:199], v1
    ds_read_b128 v[52:55], v0 offset:0
    v_smfmac_f32_16x16x64_bf16 v[26:29], v[56:59], a[200:207], v1
    ds_read_b128 v[56:59], v0 offset:1024
    s_mov_b64 vcc, s[34:35]
    v_smfmac_f32_16x16x64_bf16 v[14:17], v[10:13], a[112:119], v1
    s_waitcnt lgkmcnt(3)
    v_smfmac_f32_16x16x64_bf16 v[14:17], v[48:51], a[128:135], v1
    v_smfmac_f32_16x16x64_bf16 v[18:21], v[48:51], a[208:215], v1
    v_smfmac_f32_16x16x64_bf16 v[18:21], v[10:13], v[60:67], v1
    ds_read_b128 v[60:63], v4 offset:16384
    v_add_f32 v14, v14, v16
    v_smfmac_f32_16x16x64_bf16 v[22:25], v[48:51], a[136:143], v1
    ds_read_b128 v[64:67], v4 offset:17408
    v_add_f32 v15, v15, v17
    v_cvt_pk_bf16_f32 v76, v14, v15
    v_smfmac_f32_16x16x64_bf16 v[22:25], v[10:13], a[120:127], v1
    v_add_f32 v18, v18, v20
    v_add_f32 v19, v19, v21
    v_smfmac_f32_16x16x64_bf16 v[26:29], v[48:51], a[216:223], v1
    v_cvt_pk_bf16_f32 v77, v18, v19
    v_mov_b64 v[14:15], 0
    s_waitcnt lgkmcnt(2)
    v_smfmac_f32_16x16x64_bf16 v[26:29], v[10:13], v[68:75], v1
    ds_read_b128 v[68:71], v4 offset:18432
    v_mov_b64 v[16:17], 0
    v_mfma_f32_16x16x16_bf16 v[18:21], v[76:77], v[2:3], 0
    v_add_f32 v22, v22, v24
    v_add_f32 v23, v23, v25
    v_cvt_pk_bf16_f32 v78, v22, v23
    ds_read_b128 v[72:75], v4 offset:19456
    v_add_f32 v26, v26, v28
    v_add_f32 v27, v27, v29
    v_cvt_pk_bf16_f32 v79, v26, v27
    v_cmp_u_f32 s[74:75], v22, v23
    v_cvt_pk_bf16_f32 v22, v18, v19
    v_mfma_f32_16x16x16_bf16 v[26:29], v[78:79], v[2:3], 0
    v_cvt_pk_bf16_f32 v23, v20, v21
    v_mov_b64 v[18:19], 0
    v_smfmac_f32_16x16x64_bf16 v[14:17], v[52:55], a[224:231], v1
    ds_read_b128 v[10:13], v0 offset:2048
    v_mov_b64 v[20:21], 0
    v_smfmac_f32_16x16x64_bf16 v[14:17], v[56:59], a[240:247], v1
    ds_read_b128 v[48:51], v0 offset:3072
    v_cvt_pk_bf16_f32 v24, v26, v27
    v_cvt_pk_bf16_f32 v25, v28, v29
    s_waitcnt vmcnt(3)
    s_nop 0
    v_mfma_f32_16x16x32_bf16 v[40:43], v[40:43], v[22:25], 0
    v_mfma_f32_16x16x32_bf16 v[44:47], v[44:47], v[22:25], 0
    s_cmp_lg_u64 s[74:75], 0
    v_mfma_f32_16x16x32_bf16 v[26:29], v[22:25], v[22:25], 0
    s_cbranch_scc1 nan_27
back_28:
    v_smfmac_f32_16x16x64_bf16 v[18:21], v[52:55], a[232:239], v1
    ds_read_b128 v[52:55], v0 offset:4096
    v_cndmask_b32_dpp v40, v44, v40, vcc quad_perm:[0,1,0,1] row_mask:0xf bank_mask:0xf
    v_cndmask_b32_dpp v41, v45, v41, vcc quad_perm:[0,1,0,1] row_mask:0xf bank_mask:0xf
    v_cndmask_b32_dpp v42, v46, v42, vcc quad_perm:[0,1,0,1] row_mask:0xf bank_mask:0xf
    v_cndmask_b32_dpp v43, v47, v43, vcc quad_perm:[0,1,0,1] row_mask:0xf bank_mask:0xf
    ds_write_b128 v5, v[40:43] offset:9216
    v_cndmask_b32_dpp v28, v29, v28, vcc quad_perm:[0,1,0,1] row_mask:0xf bank_mask:0xf
    ds_write_b32 v5, v28 offset:13312
    v_smfmac_f32_16x16x64_bf16 v[18:21], v[56:59], a[248:255], v1
    ds_read_b128 v[56:59], v0 offset:5120
    v_mov_b32 v42, 0
    s_waitcnt lgkmcnt(4)
    v_smfmac_f32_16x16x64_bf16 v[14:17], v[10:13], v[60:67], v1
    v_mov_b32 v47, 0
    v_smfmac_f32_16x16x64_bf16 v[18:21], v[10:13], v[68:75], v1
    ds_read_b128 v[10:13], v0 offset:6144
    v_mov_b32 v28, 0
    v_smfmac_f32_16x16x64_bf16 v[14:17], v[48:51], v[80:87], v1
    v_mov_b32 v41, 0
    v_smfmac_f32_16x16x64_bf16 v[18:21], v[48:51], v[88:95], v1
    ds_read_b128 v[48:51], v0 offset:7168
    s_waitcnt lgkmcnt(3)
    s_barrier
    ds_read_b128 v[60:63], v0 offset:9216
    v_smfmac_f32_16x16x64_bf16 v[14:17], v[52:55], v[96:103], v1
    ds_read_b128 v[64:67], v0 offset:10240
    v_smfmac_f32_16x16x64_bf16 v[18:21], v[52:55], v[104:111], v1
    ds_read_b128 v[68:71], v0 offset:11264
    s_waitcnt lgkmcnt(4)
    v_smfmac_f32_16x16x64_bf16 v[14:17], v[56:59], v[112:119], v1
    ds_read_b128 v[72:75], v0 offset:12288
    v_smfmac_f32_16x16x64_bf16 v[18:21], v[56:59], v[120:127], v1
    ds_read_b128 v[22:25], v0 offset:13312
    v_smfmac_f32_16x16x64_bf16 v[14:17], v[10:13], v[128:135], v1
    ds_read_b128 v[52:55], v0 offset:8192
    s_waitcnt lgkmcnt(4)
    v_add_f32 v60, v60, v64
    v_smfmac_f32_16x16x64_bf16 v[18:21], v[10:13], v[136:143], v1
    v_add_f32 v61, v61, v65
    v_smfmac_f32_16x16x64_bf16 v[14:17], v[48:51], v[144:151], v1
    v_add_f32 v62, v62, v66
    v_smfmac_f32_16x16x64_bf16 v[18:21], v[48:51], v[152:159], v1
    v_add_f32 v63, v63, v67
    s_waitcnt lgkmcnt(0)
    v_smfmac_f32_16x16x64_bf16 v[14:17], v[52:55], v[160:167], v1
    v_add_f32 v22, v22, v23
    v_smfmac_f32_16x16x64_bf16 v[18:21], v[52:55], v[168:175], v1
    v_add_f32 v24, v24, v25
    v_add_f32 v22, v22, v24
    v_add_f32 v68, v68, v72
    v_add_f32 v69, v69, v73
    v_pk_add_f32 v[70:71], v[70:71], v[74:75]
    v_pk_add_f32 v[60:61], v[60:61], v[68:69]
    v_pk_add_f32 v[62:63], v[62:63], v[70:71]
    v_max3_f32 v24, v60, v61, v22
    v_max3_f32 v24, v24, v62, v63
    v_pk_add_f32 v[14:15], v[14:15], v[16:17]
    v_pk_add_f32 v[18:19], v[18:19], v[20:21]
    v_max_f32_dpp v25, v24, v24 row_ror:8 row_mask:0xf bank_mask:0xf
    v_max_f32_dpp v24, v24, v24 row_ror:8 row_mask:0xf bank_mask:0xf
    v_cvt_pk_bf16_f32 v29, v14, v15
    v_cvt_pk_bf16_f32 v35, v18, v19
    v_permlane16_swap_b32 v24, v25
    v_max_f32 v23, v24, v25
    v_max_f32 v24, v24, v25
    v_lshrrev_b32 v34, 16, v29
    v_lshrrev_b32 v40, 16, v35
    v_permlane32_swap_b32 v24, v23
    v_max_f32 v24, v24, v23
    v_sub_f32 v22, v22, v24
    v_pk_add_f32 v[60:61], v[60:61], v[24:25] op_sel_hi:[1,0] neg_lo:[0,1] neg_hi:[0,1]
    v_pk_add_f32 v[62:63], v[62:63], v[24:25] op_sel_hi:[1,0] neg_lo:[0,1] neg_hi:[0,1]
    v_mul_f32 v22, s40, v22
    v_pk_mul_f32 v[60:61], v[60:61], s[2:3]
    v_pk_mul_f32 v[62:63], v[62:63], s[2:3]
    v_exp_f32 v22, v22
    v_exp_f32 v60, v60
    v_exp_f32 v61, v61
    v_exp_f32 v62, v62
    v_exp_f32 v63, v63
    v_cvt_pk_bf16_f32 v46, v22, 0
    v_cvt_pk_bf16_f32 v44, v60, v61
    v_cvt_pk_bf16_f32 v45, v62, v63
    v_cvt_pk_bf16_f32 v43, v22, 0
    s_waitcnt vmcnt(1)
    v_mfma_f32_16x16x32_bf16 v[64:67], v[32:35], v[44:47], 0
    v_mov_b64 v[48:49], s[36:37]
    v_mov_b64 v[50:51], s[36:37]
    v_mfma_f32_16x16x32_bf16 v[60:63], v[28:31], v[42:45], 0
    v_min_u32 v76, -2, v29
    v_mov_b32 v78, v35
    v_mfma_f32_16x16x32_bf16 v[52:55], v[48:51], v[42:45], 0
    v_mov_b64 v[14:15], 0
    v_mov_b64 v[16:17], 0
    v_mfma_f32_16x16x32_bf16 v[68:71], v[34:37], v[42:45], 0
    v_add_f32_dpp v56, v64, v60 row_ror:8 row_mask:0xf bank_mask:0x3
    v_add_f32_dpp v57, v65, v61 row_ror:8 row_mask:0xf bank_mask:0x3
    v_mfma_f32_16x16x32_bf16 v[72:75], v[38:41], v[44:47], 0
    v_add_f32_dpp v50, v52, v52 row_ror:8 row_mask:0xf bank_mask:0xf
    v_add_f32_dpp v58, v66, v62 row_ror:8 row_mask:0xf bank_mask:0x3
    v_add_f32_dpp v59, v67, v63 row_ror:8 row_mask:0xf bank_mask:0x3
    v_rcp_f32 v50, v50
    v_and_b32 v10, 0xffffffdf, v0
    v_lshrrev_b32 v11, 2, v0
    v_mov_b64 v[18:19], 0
    v_mov_b64 v[20:21], 0
    v_add_f32_dpp v56, v68, v72 row_ror:8 row_mask:0xf bank_mask:0xc
    v_add_f32_dpp v57, v69, v73 row_ror:8 row_mask:0xf bank_mask:0xc
    v_add_f32_dpp v58, v70, v74 row_ror:8 row_mask:0xf bank_mask:0xc
    v_add_f32_dpp v59, v71, v75 row_ror:8 row_mask:0xf bank_mask:0xc
    v_pk_mul_f32 v[56:57], v[56:57], v[50:51] op_sel_hi:[1,0]
    v_pk_mul_f32 v[58:59], v[58:59], v[50:51] op_sel_hi:[1,0]
    v_cvt_pk_bf16_f32 v56, v56, v57
    v_cvt_pk_bf16_f32 v57, v58, v59
    ds_write_b64 v6, v[56:57] offset:0
    v_mfma_f32_16x16x32_bf16 v[22:25], v[14:17], v[14:17], 0
    ds_read_b128 v[60:63], v4 offset:20480
    ds_read_b128 v[64:67], v4 offset:21504
    ds_read_b128 v[68:71], v4 offset:24576
    ds_read_b128 v[72:75], v4 offset:25600
    v_mfma_f32_16x16x32_bf16 v[26:29], v[14:17], v[14:17], 0
    s_waitcnt lgkmcnt(4)
    s_barrier
    ds_read_b128 v[42:45], v10 offset:0
    ds_read_b128 v[50:53], v10 offset:1024
    v_mfma_f32_16x16x32_bf16 v[30:33], v[14:17], v[14:17], 0
    ds_read_b128 v[34:37], v0 offset:0
    ds_read_b128 v[46:49], v10 offset:32
    s_waitcnt lgkmcnt(3)
    v_smfmac_f32_16x16x64_bf16 v[18:21], v[42:45], v[176:183], v1
    ds_read_b128 v[38:41], v0 offset:1024
    v_smfmac_f32_16x16x64_bf16 v[22:25], v[42:45], v[192:199], v1
    ds_read_b128 v[54:57], v10 offset:1056
    s_waitcnt lgkmcnt(4)
    v_smfmac_f32_16x16x64_bf16 v[18:21], v[50:53], v[60:67], v1
    ds_read_b128 v[60:63], v4 offset:22528
    v_smfmac_f32_16x16x64_bf16 v[22:25], v[50:53], v[68:75], v1
    ds_read_b128 v[64:67], v4 offset:23552
    s_waitcnt lgkmcnt(4)
    v_smfmac_f32_16x16x64_bf16 v[14:17], v[34:37], v[240:247], v1
    ds_read_b128 v[68:71], v4 offset:26624
    v_smfmac_f32_16x16x64_bf16 v[18:21], v[46:49], v[184:191], v1
    ds_read_b128 v[72:75], v4 offset:27648
    s_waitcnt lgkmcnt(4)
    v_smfmac_f32_16x16x64_bf16 v[14:17], v[38:41], v[248:255], v1
    ds_read_b128 v[34:37], v4 offset:28672
    v_smfmac_f32_16x16x64_bf16 v[22:25], v[46:49], v[200:207], v1
    ds_read_b128 v[38:41], v4 offset:29696
    s_waitcnt lgkmcnt(4)
    v_smfmac_f32_16x16x64_bf16 v[18:21], v[54:57], v[60:67], v1
    ds_read_b128 v[60:63], v4 offset:30720
    v_add_f32 v14, v14, v16
    v_add_f32 v15, v15, v17
    s_waitcnt lgkmcnt(3)
    v_smfmac_f32_16x16x64_bf16 v[22:25], v[54:57], v[68:75], v1
    ds_read_b128 v[64:67], v4 offset:31744
    v_cvt_pk_bf16_f32 v58, v14, v15
    v_and_or_b32 v58, v58, -2, s46
    buffer_store_dword v58, v11, s[4:7], s20 offen
    v_smfmac_f32_16x16x64_bf16 v[26:29], v[42:45], v[208:215], v1
    ds_read_b128 v[68:71], v4 offset:32768
    v_cvt_pk_bf16_f32 v18, v18, v19
    v_cvt_pk_bf16_f32 v19, v20, v21
    v_and_or_b32 v18, v18, -2, s46
    v_smfmac_f32_16x16x64_bf16 v[26:29], v[46:49], v[216:223], v1
    ds_read_b128 v[72:75], v4 offset:33792
    v_cvt_pk_bf16_f32 v20, v22, v23
    v_cvt_pk_bf16_f32 v21, v24, v25
    buffer_store_dwordx4 v[18:21], v0, s[4:7], s18 offen
    s_waitcnt lgkmcnt(4)
    v_smfmac_f32_16x16x64_bf16 v[26:29], v[50:53], v[34:41], v1
    ds_read_b128 v[34:37], v4 offset:34816
    v_smfmac_f32_16x16x64_bf16 v[30:33], v[42:45], v[224:231], v1
    ds_read_b128 v[38:41], v4 offset:35840
    s_waitcnt lgkmcnt(4)
    v_smfmac_f32_16x16x64_bf16 v[26:29], v[54:57], v[60:67], v1
    s_waitcnt lgkmcnt(2)
    v_smfmac_f32_16x16x64_bf16 v[30:33], v[50:53], v[68:75], v1
    v_smfmac_f32_16x16x64_bf16 v[30:33], v[46:49], v[232:239], v1
    v_cvt_pk_bf16_f32 v26, v26, v27
    v_cvt_pk_bf16_f32 v27, v28, v29
    s_waitcnt lgkmcnt(0)
    v_smfmac_f32_16x16x64_bf16 v[30:33], v[54:57], v[34:41], v1
    v_and_or_b32 v26, v26, -2, s46
    s_nop 6
    v_cvt_pk_bf16_f32 v28, v30, v31
    v_cvt_pk_bf16_f32 v29, v32, v33
    buffer_store_dwordx4 v[26:29], v0, s[4:7], s19 offen
    v_bfe_u32 v58, v0, 6, 1
    v_lshlrev_b32 v58, 4, v58
    v_mov_b32 v59, 0x3f80
    v_lshlrev_b32 v58, v58, v59
    v_cndmask_b32 v10, 0, v58, s[30:31]
    s_lshl_b64 vcc, s[30:31], 1
    v_cndmask_b32 v11, 0, v58, vcc
    s_lshl_b64 vcc, s[30:31], 2
    v_cndmask_b32 v12, 0, v58, vcc
    s_lshl_b64 vcc, s[30:31], 3
    v_cndmask_b32 v13, 0, v58, vcc
    v_mov_b64 v[54:55], -1
    s_mov_b32 s41, 0
    s_xor_b32 s18, s18, 0x100000
    s_xor_b32 s19, s19, 0x100000
    s_xor_b32 s20, s20, 0x100000
    s_add_u32 s17, s17, 0x4000
    s_and_b32 s17, s17, 0xfffeffff
    s_add_u32 s21, s21, 262144
    s_add_u32 s22, s22, 262144
    s_add_u32 s23, s23, 131072
    s_nop 15
    s_nop 15
    s_nop 15
    s_nop 1
    buffer_load_dwordx4 v[34:37], v7, s[4:7], s24 offen sc1
    buffer_load_dwordx4 v[38:41], v7, s[4:7], s25 offen sc1
    buffer_load_dwordx4 v[42:45], v7, s[4:7], s26 offen sc1
    buffer_load_dwordx4 v[46:49], v7, s[4:7], s27 offen sc1
    s_waitcnt vmcnt(3)
    v_mfma_f32_16x16x32_bf16 v[50:53], v[10:13], v[34:37], 0
    s_waitcnt vmcnt(2)
    v_mfma_f32_16x16x32_bf16 v[50:53], v[10:13], v[38:41], v[50:53]
    v_bitop3_b32 v58, v34, v38, s46 bitop3:0x7e
    s_waitcnt vmcnt(1)
    v_mfma_f32_16x16x32_bf16 v[50:53], v[10:13], v[42:45], v[50:53]
    s_waitcnt vmcnt(0)
    v_mfma_f32_16x16x32_bf16 v[50:53], v[10:13], v[46:49], v[50:53]
    v_bitop3_b32 v59, v42, v46, s46 bitop3:0x7e
    v_or_b32 v58, v58, v59
    v_and_b32 v58, 1, v58
    v_cmp_ne_u32 vcc, 0, v58
    s_cbranch_vccnz pp_29
ok_30:
    s_nop 2
    v_add_f32_dpp v50, v50, v50 row_ror:8 row_mask:0xf bank_mask:0xf
    v_add_f32_dpp v51, v51, v51 row_ror:8 row_mask:0xf bank_mask:0xf
    v_add_f32_dpp v52, v52, v52 row_ror:8 row_mask:0xf bank_mask:0xf
    v_add_f32_dpp v53, v53, v53 row_ror:8 row_mask:0xf bank_mask:0xf
    s_mov_b64 exec, s[28:29]
    v_cvt_pk_bf16_f32 v58, v50, v51
    v_cvt_pk_bf16_f32 v59, v52, v53
    v_min_u32 v58, -2, v58
    buffer_store_dwordx2 v[58:59], v8, s[4:7], s17 offen
    buffer_store_dwordx2 v[54:55], v8, s[4:7], s47 offen
    s_mov_b64 exec, -1
    s_wakeup
    s_xor_b32 s24, s24, 0x100000
    s_xor_b32 s25, s25, 0x100000
    s_xor_b32 s26, s26, 0x100000
    s_xor_b32 s27, s27, 0x100000
    s_add_u32 s47, s47, 0x4000
    s_and_b32 s47, s47, 0xfffeffff
    s_and_b32 s42, s16, 1
    s_xor_b32 s46, s46, s42
    s_add_u32 s16, s16, 1
    s_cmp_lt_u32 s16, 63
    s_cbranch_scc1 step_23
step_31:
    s_mov_b32 s41, 0
    s_add_u32 s86, s17, 5120
    s_mov_b32 m0, 5120
    s_mov_b32 s72, s23
    s_mov_b32 s76, 0
    v_mov_b64 v[14:15], 0
    v_mov_b64 v[16:17], 0
    v_mov_b64 v[18:19], 0
    v_mov_b64 v[20:21], 0
    v_mov_b64 v[22:23], 0
    v_mov_b64 v[24:25], 0
    v_mov_b64 v[26:27], 0
    v_mov_b64 v[28:29], 0
    s_nop 9
    buffer_load_dwordx4 v[40:43], v0, s[4:7], s17 offen offset:0 sc1
    buffer_load_dwordx4 v[44:47], v0, s[4:7], s17 offen offset:1024 sc1
    s_nop 15
    s_nop 7
    buffer_load_dwordx4 v[60:63], v0, s[4:7], s17 offen offset:0 sc1
    buffer_load_dwordx4 v[64:67], v0, s[4:7], s17 offen offset:1024 sc1
    s_waitcnt vmcnt(3)
    ds_write_b128 v0, v[40:43] offset:0
    v_max_u32 v34, v40, v42
    s_waitcnt vmcnt(2)
    ds_write_b128 v0, v[44:47] offset:1024
    v_max3_u32 v34, v34, v44, v46
    v_cmp_eq_u32 vcc, -1, v34
    s_cbranch_vccnz pp_32
ok_33:
redo_34:
    s_waitcnt lgkmcnt(0)
    s_barrier
    ds_read_b128 v[48:51], v0 offset:0
    buffer_load_dwordx4 v0, s[4:7], s86 offen offset:0 sc1 lds
    ds_read_b128 v[52:55], v0 offset:1024
    ds_read_b128 v[56:59], v0 offset:2048
    s_waitcnt lgkmcnt(2)
    v_smfmac_f32_16x16x64_bf16 v[14:17], v[48:51], a[224:231], v1
    s_waitcnt vmcnt(1)
    ds_read_b128 v[60:63], v4 offset:0
    ds_read_b128 v[64:67], v4 offset:1024
    v_smfmac_f32_16x16x64_bf16 v[22:25], v[48:51], a[232:239], v1
    ds_read_b128 v[68:71], v4 offset:2048
    ds_read_b128 v[72:75], v4 offset:3072
    v_smfmac_f32_16x16x64_bf16 v[18:21], v[48:51], a[144:151], v1
    ds_read_b128 v[10:13], v0 offset:3072
    v_smfmac_f32_16x16x64_bf16 v[26:29], v[48:51], a[152:159], v1
    buffer_store_dwordx4 v[76:79], v0, s[4:7], s72 offen sc1
    s_waitcnt lgkmcnt(5)
    v_smfmac_f32_16x16x64_bf16 v[14:17], v[52:55], a[240:247], v1
    v_smfmac_f32_16x16x64_bf16 v[22:25], v[52:55], a[248:255], v1
    s_waitcnt lgkmcnt(1)
    v_smfmac_f32_16x16x64_bf16 v[18:21], v[52:55], v[60:67], v1
    ds_read_b128 v[60:63], v4 offset:4096
    v_smfmac_f32_16x16x64_bf16 v[26:29], v[52:55], v[68:75], v1
    ds_read_b128 v[64:67], v4 offset:5120
    v_smfmac_f32_16x16x64_bf16 v[18:21], v[56:59], a[160:167], v1
    ds_read_b128 v[68:71], v4 offset:6144
    v_smfmac_f32_16x16x64_bf16 v[26:29], v[56:59], a[168:175], v1
    ds_read_b128 v[72:75], v4 offset:7168
    s_waitcnt vmcnt(1)
    s_barrier
    ds_read_b128 v[48:51], v0 offset:4096
    s_waitcnt lgkmcnt(5)
    v_smfmac_f32_16x16x64_bf16 v[14:17], v[10:13], v[80:87], v1
    ds_read_b128 v[52:55], v0 offset:5120
    v_smfmac_f32_16x16x64_bf16 v[22:25], v[10:13], v[88:95], v1
    ds_read_b128 v[56:59], v0 offset:6144
    s_waitcnt lgkmcnt(5)
    v_smfmac_f32_16x16x64_bf16 v[18:21], v[10:13], v[60:67], v1
    ds_read_b128 v[60:63], v4 offset:8192
    s_waitcnt lgkmcnt(4)
    v_smfmac_f32_16x16x64_bf16 v[26:29], v[10:13], v[68:75], v1
    ds_read_b128 v[64:67], v4 offset:9216
    s_waitcnt lgkmcnt(4)
    v_smfmac_f32_16x16x64_bf16 v[14:17], v[48:51], v[96:103], v1
    ds_read_b128 v[10:13], v0 offset:7168
    v_smfmac_f32_16x16x64_bf16 v[22:25], v[48:51], v[104:111], v1
    ds_read_b128 v[68:71], v4 offset:10240
    v_smfmac_f32_16x16x64_bf16 v[18:21], v[48:51], a[176:183], v1
    ds_read_b128 v[72:75], v4 offset:11264
    v_smfmac_f32_16x16x64_bf16 v[26:29], v[48:51], a[184:191], v1
    s_waitcnt lgkmcnt(3)
    v_smfmac_f32_16x16x64_bf16 v[14:17], v[52:55], v[112:119], v1
    ds_read_b128 v[48:51], v0 offset:8192
    v_smfmac_f32_16x16x64_bf16 v[22:25], v[52:55], v[120:127], v1
    v_smfmac_f32_16x16x64_bf16 v[18:21], v[52:55], v[60:67], v1
    ds_read_b128 v[60:63], v4 offset:12288
    s_waitcnt lgkmcnt(2)
    v_smfmac_f32_16x16x64_bf16 v[26:29], v[52:55], v[68:75], v1
    ds_read_b128 v[64:67], v4 offset:13312
    v_smfmac_f32_16x16x64_bf16 v[14:17], v[56:59], v[128:135], v1
    ds_read_b128 v[68:71], v4 offset:14336
    v_smfmac_f32_16x16x64_bf16 v[22:25], v[56:59], v[136:143], v1
    ds_read_b128 v[72:75], v4 offset:15360
    v_smfmac_f32_16x16x64_bf16 v[18:21], v[56:59], a[192:199], v1
    v_smfmac_f32_16x16x64_bf16 v[26:29], v[56:59], a[200:207], v1
    v_smfmac_f32_16x16x64_bf16 v[14:17], v[10:13], v[144:151], v1
    v_smfmac_f32_16x16x64_bf16 v[22:25], v[10:13], v[152:159], v1
    s_waitcnt lgkmcnt(0)
    v_smfmac_f32_16x16x64_bf16 v[18:21], v[10:13], v[60:67], v1
    ds_read_b128 v[60:63], v4 offset:16384
    v_smfmac_f32_16x16x64_bf16 v[26:29], v[10:13], v[68:75], v1
    ds_read_b128 v[64:67], v4 offset:17408
    v_smfmac_f32_16x16x64_bf16 v[14:17], v[48:51], v[160:167], v1
    ds_read_b128 v[10:13], v0 offset:2048
    v_smfmac_f32_16x16x64_bf16 v[22:25], v[48:51], v[168:175], v1
    ds_read_b128 v[68:71], v4 offset:18432
    v_smfmac_f32_16x16x64_bf16 v[18:21], v[48:51], a[208:215], v1
    ds_read_b128 v[72:75], v4 offset:19456
    v_smfmac_f32_16x16x64_bf16 v[26:29], v[48:51], a[216:223], v1
    s_waitcnt lgkmcnt(2)
    v_smfmac_f32_16x16x64_bf16 v[14:17], v[10:13], v[60:67], v1
    s_waitcnt lgkmcnt(0)
    v_smfmac_f32_16x16x64_bf16 v[22:25], v[10:13], v[68:75], v1
    v_add_f32 v18, v18, v20
    v_add_f32 v19, v19, v21
    v_cvt_pk_bf16_f32 v77, v18, v19
    v_add_f32 v26, v26, v28
    v_add_f32 v27, v27, v29
    v_cvt_pk_bf16_f32 v79, v26, v27
    v_add_f32 v14, v14, v16
    v_add_f32 v15, v15, v17
    v_cvt_pk_bf16_f32 v76, v14, v15
    v_add_f32 v22, v22, v24
    v_add_f32 v23, v23, v25
    v_cvt_pk_bf16_f32 v78, v22, v23
    v_cmp_u_f32 s[74:75], v26, v27
    v_min_u32 v76, -2, v76
    s_cmp_lg_u64 s[74:75], 0
    s_cbranch_scc1 nan_35
back_36:
    s_add_u32 s23, s23, 131072
    buffer_store_dwordx4 v[76:79], v0, s[4:7], s23 offen sc1
    s_branch done
pp_32:
    buffer_load_dwordx4 v[40:43], v0, s[4:7], s17 offen offset:0 sc1
    buffer_load_dwordx4 v[44:47], v0, s[4:7], s17 offen offset:1024 sc1
    s_add_u32 s41, s41, 1
    s_cmp_gt_u32 s41, 2000000
    s_cbranch_scc1 fin1
    s_waitcnt vmcnt(3)
    ds_write_b128 v0, v[60:63] offset:0
    v_max_u32 v34, v60, v62
    s_waitcnt vmcnt(2)
    ds_write_b128 v0, v[64:67] offset:1024
    v_max3_u32 v34, v34, v64, v66
    v_cmp_eq_u32 vcc, -1, v34
    s_cbranch_vccz ok_33
    buffer_load_dwordx4 v[60:63], v0, s[4:7], s17 offen offset:0 sc1
    buffer_load_dwordx4 v[64:67], v0, s[4:7], s17 offen offset:1024 sc1
    s_add_u32 s41, s41, 1
    s_waitcnt vmcnt(3)
    ds_write_b128 v0, v[40:43] offset:0
    v_max_u32 v34, v40, v42
    s_waitcnt vmcnt(2)
    ds_write_b128 v0, v[44:47] offset:1024
    v_max3_u32 v34, v34, v44, v46
    v_cmp_eq_u32 vcc, -1, v34
    s_cbranch_vccnz pp_32
    s_branch ok_33
nan_35:
    v_mov_b32 v34, 0
    ds_read_b32 v35, v0 offset:4096
    s_waitcnt lgkmcnt(0)
    v_max_u32 v34, v34, v35
    ds_read_b32 v35, v0 offset:4104
    s_waitcnt lgkmcnt(0)
    v_max_u32 v34, v34, v35
    ds_read_b32 v35, v0 offset:5120
    s_waitcnt lgkmcnt(0)
    v_max_u32 v34, v34, v35
    ds_read_b32 v35, v0 offset:5128
    s_waitcnt lgkmcnt(0)
    v_max_u32 v34, v34, v35
    ds_read_b32 v35, v0 offset:6144
    s_waitcnt lgkmcnt(0)
    v_max_u32 v34, v34, v35
    ds_read_b32 v35, v0 offset:6152
    s_waitcnt lgkmcnt(0)
    v_max_u32 v34, v34, v35
    ds_read_b32 v35, v0 offset:7168
    s_waitcnt lgkmcnt(0)
    v_max_u32 v34, v34, v35
    ds_read_b32 v35, v0 offset:7176
    s_waitcnt lgkmcnt(0)
    v_max_u32 v34, v34, v35
    ds_read_b32 v35, v0 offset:8192
    s_waitcnt lgkmcnt(0)
    v_max_u32 v34, v34, v35
    ds_read_b32 v35, v0 offset:8200
    s_waitcnt lgkmcnt(0)
    v_max_u32 v34, v34, v35
    v_cmp_eq_u32 s[74:75], -1, v34
    s_nop 0
    s_cmp_eq_u64 s[74:75], 0
    s_cbranch_scc1 back_36
    s_add_u32 s76, s76, 1
    s_cmp_gt_u32 s76, 2000000
    s_cbranch_scc1 fin1
    s_mov_b32 s72, 100662272
    v_mov_b64 v[14:15], 0
    v_mov_b64 v[16:17], 0
    v_mov_b64 v[18:19], 0
    v_mov_b64 v[20:21], 0
    v_mov_b64 v[22:23], 0
    v_mov_b64 v[24:25], 0
    v_mov_b64 v[26:27], 0
    v_mov_b64 v[28:29], 0
    s_waitcnt vmcnt(0)
    s_barrier
    s_branch redo_34
pp_24:
    buffer_load_dwordx4 v[40:43], v0, s[4:7], s17 offen offset:0 sc1
    buffer_load_dwordx4 v[44:47], v0, s[4:7], s17 offen offset:1024 sc1
    s_add_u32 s41, s41, 1
    s_cmp_gt_u32 s41, 2000000
    s_cbranch_scc1 fin1
    s_waitcnt vmcnt(3)
    ds_write_b128 v0, v[60:63] offset:0
    v_max_u32 v34, v60, v62
    s_waitcnt vmcnt(2)
    ds_write_b128 v0, v[64:67] offset:1024
    v_max3_u32 v34, v34, v64, v66
    v_cmp_eq_u32 vcc, -1, v34
    s_cbranch_vccz ok_25
    buffer_load_dwordx4 v[60:63], v0, s[4:7], s17 offen offset:0 sc1
    buffer_load_dwordx4 v[64:67], v0, s[4:7], s17 offen offset:1024 sc1
    s_add_u32 s41, s41, 1
    s_waitcnt vmcnt(3)
    ds_write_b128 v0, v[40:43] offset:0
    v_max_u32 v34, v40, v42
    s_waitcnt vmcnt(2)
    ds_write_b128 v0, v[44:47] offset:1024
    v_max3_u32 v34, v34, v44, v46
    v_cmp_eq_u32 vcc, -1, v34
    s_cbranch_vccnz pp_24
    s_branch ok_25
nan_27:
    v_mov_b32 v34, 0
    ds_read_b32 v35, v0 offset:4096
    s_waitcnt lgkmcnt(0)
    v_max_u32 v34, v34, v35
    ds_read_b32 v35, v0 offset:4104
    s_waitcnt lgkmcnt(0)
    v_max_u32 v34, v34, v35
    ds_read_b32 v35, v0 offset:5120
    s_waitcnt lgkmcnt(0)
    v_max_u32 v34, v34, v35
    ds_read_b32 v35, v0 offset:5128
    s_waitcnt lgkmcnt(0)
    v_max_u32 v34, v34, v35
    ds_read_b32 v35, v0 offset:6144
    s_waitcnt lgkmcnt(0)
    v_max_u32 v34, v34, v35
    ds_read_b32 v35, v0 offset:6152
    s_waitcnt lgkmcnt(0)
    v_max_u32 v34, v34, v35
    ds_read_b32 v35, v0 offset:7168
    s_waitcnt lgkmcnt(0)
    v_max_u32 v34, v34, v35
    ds_read_b32 v35, v0 offset:7176
    s_waitcnt lgkmcnt(0)
    v_max_u32 v34, v34, v35
    ds_read_b32 v35, v0 offset:8192
    s_waitcnt lgkmcnt(0)
    v_max_u32 v34, v34, v35
    ds_read_b32 v35, v0 offset:8200
    s_waitcnt lgkmcnt(0)
    v_max_u32 v34, v34, v35
    v_cmp_eq_u32 s[74:75], -1, v34
    s_nop 0
    s_cmp_eq_u64 s[74:75], 0
    s_cbranch_scc1 back_28
    s_add_u32 s76, s76, 1
    s_cmp_gt_u32 s76, 2000000
    s_cbranch_scc1 fin1
    s_mov_b32 s72, 100662272
    v_mov_b64 v[14:15], 0
    v_mov_b64 v[16:17], 0
    v_mov_b64 v[18:19], 0
    v_mov_b64 v[20:21], 0
    v_mov_b64 v[22:23], 0
    v_mov_b64 v[24:25], 0
    v_mov_b64 v[26:27], 0
    v_mov_b64 v[28:29], 0
    s_waitcnt vmcnt(0)
    s_barrier
    s_branch redo_26
pp_29:
    buffer_load_dwordx4 v[34:37], v7, s[4:7], s24 offen sc1
    buffer_load_dwordx4 v[38:41], v7, s[4:7], s25 offen sc1
    buffer_load_dwordx4 v[42:45], v7, s[4:7], s26 offen sc1
    buffer_load_dwordx4 v[46:49], v7, s[4:7], s27 offen sc1
    s_add_u32 s41, s41, 1
    s_cmp_gt_u32 s41, 2000000
    s_cbranch_scc1 fin1
    s_waitcnt vmcnt(3)
    v_mfma_f32_16x16x32_bf16 v[50:53], v[10:13], v[34:37], 0
    s_waitcnt vmcnt(2)
    v_mfma_f32_16x16x32_bf16 v[50:53], v[10:13], v[38:41], v[50:53]
    v_bitop3_b32 v58, v34, v38, s46 bitop3:0x7e
    s_waitcnt vmcnt(1)
    v_mfma_f32_16x16x32_bf16 v[50:53], v[10:13], v[42:45], v[50:53]
    s_waitcnt vmcnt(0)
    v_mfma_f32_16x16x32_bf16 v[50:53], v[10:13], v[46:49], v[50:53]
    v_bitop3_b32 v59, v42, v46, s46 bitop3:0x7e
    v_or_b32 v58, v58, v59
    v_and_b32 v58, 1, v58
    v_cmp_ne_u32 vcc, 0, v58
    s_cbranch_vccnz pp_29
    s_branch ok_30
role_20:
.p2align 6
step_37:
    s_mov_b32 s41, 0
    s_add_u32 s86, s17, 6144
    s_mov_b32 m0, 6144
    s_mov_b32 s72, s23
    s_mov_b32 s76, 0
    v_mov_b64 v[14:15], 0
    v_mov_b64 v[16:17], 0
    v_mov_b64 v[18:19], 0
    v_mov_b64 v[20:21], 0
    v_mov_b64 v[22:23], 0
    v_mov_b64 v[24:25], 0
    v_mov_b64 v[26:27], 0
    v_mov_b64 v[28:29], 0
redo_38:
    s_waitcnt lgkmcnt(0)
    s_barrier
    ds_read_b128 v[48:51], v0 offset:0
    s_mov_b32 m0, 6144
    s_nop 0
    buffer_load_dwordx4 v0, s[4:7], s86 offen offset:0 sc1 lds
    ds_read_b128 v[52:55], v0 offset:1024
    ds_read_b128 v[56:59], v0 offset:2048
    s_mov_b32 m0, 15616
    ds_read_b128 v[60:63], v4 offset:0
    ds_read_b128 v[64:67], v4 offset:1024
    s_waitcnt lgkmcnt(4)
    v_smfmac_f32_16x16x64_bf16 v[14:17], v[48:51], a[0:7], v1
    ds_read_b128 v[68:71], v4 offset:2048
    ds_read_b128 v[72:75], v4 offset:3072
    ds_read_b128 v[10:13], v0 offset:3072
    v_smfmac_f32_16x16x64_bf16 v[22:25], v[48:51], a[8:15], v1
    buffer_load_dwordx4 v[40:43], v9, s[4:7], s21 offen sc1 nt
    buffer_load_dwordx4 v[44:47], v9, s[4:7], s21 offen offset:256 sc1 nt
    v_smfmac_f32_16x16x64_bf16 v[18:21], v[48:51], a[144:151], v1
    buffer_load_dwordx4 v[30:33], v9, s[4:7], s22 offen sc1 nt
    v_smfmac_f32_16x16x64_bf16 v[26:29], v[48:51], a[152:159], v1
    ds_read_b128 v[48:51], v0 offset:4096
    s_waitcnt lgkmcnt(4)
    v_smfmac_f32_16x16x64_bf16 v[14:17], v[52:55], a[16:23], v1
    buffer_load_dwordx4 v[36:39], v9, s[4:7], s22 offen offset:256 sc1 nt
    v_smfmac_f32_16x16x64_bf16 v[22:25], v[52:55], a[24:31], v1
    v_smfmac_f32_16x16x64_bf16 v[18:21], v[52:55], v[60:67], v1
    ds_read_b128 v[60:63], v4 offset:4096
    s_waitcnt lgkmcnt(2)
    v_smfmac_f32_16x16x64_bf16 v[26:29], v[52:55], v[68:75], v1
    ds_read_b128 v[64:67], v4 offset:5120
    v_smfmac_f32_16x16x64_bf16 v[14:17], v[56:59], a[32:39], v1
    ds_read_b128 v[68:71], v4 offset:6144
    v_smfmac_f32_16x16x64_bf16 v[22:25], v[56:59], a[40:47], v1
    ds_read_b128 v[72:75], v4 offset:7168
    v_smfmac_f32_16x16x64_bf16 v[18:21], v[56:59], a[160:167], v1
    v_smfmac_f32_16x16x64_bf16 v[26:29], v[56:59], a[168:175], v1
    v_smfmac_f32_16x16x64_bf16 v[14:17], v[10:13], a[48:55], v1
    v_smfmac_f32_16x16x64_bf16 v[22:25], v[10:13], a[56:63], v1
    s_waitcnt lgkmcnt(0)
    v_smfmac_f32_16x16x64_bf16 v[18:21], v[10:13], v[60:67], v1
    ds_read_b128 v[60:63], v4 offset:8192
    v_smfmac_f32_16x16x64_bf16 v[26:29], v[10:13], v[68:75], v1
    ds_read_b128 v[64:67], v4 offset:9216
    v_lshlrev_b32 v35, 3, v0
    v_smfmac_f32_16x16x64_bf16 v[14:17], v[48:51], a[64:71], v1
    ds_read_b128 v[68:71], v4 offset:10240
    s_waitcnt vmcnt(4)
    s_barrier
    ds_read_b128 v[52:55], v0 offset:5120
    v_smfmac_f32_16x16x64_bf16 v[22:25], v[48:51], a[72:79], v1
    ds_read_b128 v[56:59], v0 offset:6144
    v_smfmac_f32_16x16x64_bf16 v[18:21], v[48:51], a[176:183], v1
    ds_read_b128 v[10:13], v0 offset:7168
    v_smfmac_f32_16x16x64_bf16 v[26:29], v[48:51], a[184:191], v1
    ds_read_b128 v[72:75], v4 offset:11264
    s_waitcnt lgkmcnt(3)
    v_smfmac_f32_16x16x64_bf16 v[14:17], v[52:55], a[80:87], v1
    ds_read_b128 v[48:51], v0 offset:8192
    v_smfmac_f32_16x16x64_bf16 v[22:25], v[52:55], a[88:95], v1
    buffer_store_dwordx4 v[76:79], v0, s[4:7], s72 offen sc1
    v_smfmac_f32_16x16x64_bf16 v[18:21], v[52:55], v[60:67], v1
    ds_read_b128 v[60:63], v4 offset:12288
    s_waitcnt lgkmcnt(2)
    v_smfmac_f32_16x16x64_bf16 v[26:29], v[52:55], v[68:75], v1
    ds_read_b128 v[64:67], v4 offset:13312
    v_smfmac_f32_16x16x64_bf16 v[14:17], v[56:59], a[96:103], v1
    ds_read_b128 v[68:71], v4 offset:14336
    v_smfmac_f32_16x16x64_bf16 v[22:25], v[56:59], a[104:111], v1
    ds_read_b128 v[72:75], v4 offset:15360
    v_smfmac_f32_16x16x64_bf16 v[18:21], v[56:59], a[192:199], v1
    ds_read_b128 v[52:55], v0 offset:0
    v_smfmac_f32_16x16x64_bf16 v[26:29], v[56:59], a[200:207], v1
    ds_read_b128 v[56:59], v0 offset:1024
    s_mov_b64 vcc, s[34:35]
    v_smfmac_f32_16x16x64_bf16 v[14:17], v[10:13], a[112:119], v1
    s_add_u32 s42, s21, 522240
    buffer_load_dword v35, s[4:7], s42 offen sc1 lds
    s_waitcnt lgkmcnt(3)
    v_smfmac_f32_16x16x64_bf16 v[14:17], v[48:51], a[128:135], v1
    v_smfmac_f32_16x16x64_bf16 v[18:21], v[48:51], a[208:215], v1
    v_smfmac_f32_16x16x64_bf16 v[18:21], v[10:13], v[60:67], v1
    ds_read_b128 v[60:63], v4 offset:16384
    v_add_f32 v14, v14, v16
    v_smfmac_f32_16x16x64_bf16 v[22:25], v[48:51], a[136:143], v1
    ds_read_b128 v[64:67], v4 offset:17408
    v_add_f32 v15, v15, v17
    v_cvt_pk_bf16_f32 v76, v14, v15
    v_smfmac_f32_16x16x64_bf16 v[22:25], v[10:13], a[120:127], v1
    v_add_f32 v18, v18, v20
    v_add_f32 v19, v19, v21
    v_smfmac_f32_16x16x64_bf16 v[26:29], v[48:51], a[216:223], v1
    v_cvt_pk_bf16_f32 v77, v18, v19
    v_mov_b64 v[14:15], 0
    s_waitcnt lgkmcnt(2)
    v_smfmac_f32_16x16x64_bf16 v[26:29], v[10:13], v[68:75], v1
    ds_read_b128 v[68:71], v4 offset:18432
    v_mov_b64 v[16:17], 0
    v_mfma_f32_16x16x16_bf16 v[18:21], v[76:77], v[2:3], 0
    v_add_f32 v22, v22, v24
    v_add_f32 v23, v23, v25
    v_cvt_pk_bf16_f32 v78, v22, v23
    ds_read_b128 v[72:75], v4 offset:19456
    v_add_f32 v26, v26, v28
    v_add_f32 v27, v27, v29
    v_cvt_pk_bf16_f32 v79, v26, v27
    v_cmp_u_f32 s[74:75], v22, v23
    v_cvt_pk_bf16_f32 v22, v18, v19
    v_mfma_f32_16x16x16_bf16 v[26:29], v[78:79], v[2:3], 0
    v_cvt_pk_bf16_f32 v23, v20, v21
    v_mov_b64 v[18:19], 0
    v_smfmac_f32_16x16x64_bf16 v[14:17], v[52:55], a[224:231], v1
    ds_read_b128 v[10:13], v0 offset:2048
    v_mov_b64 v[20:21], 0
    v_smfmac_f32_16x16x64_bf16 v[14:17], v[56:59], a[240:247], v1
    ds_read_b128 v[48:51], v0 offset:3072
    v_cvt_pk_bf16_f32 v24, v26, v27
    v_cvt_pk_bf16_f32 v25, v28, v29
    s_waitcnt vmcnt(4)
    s_nop 0
    v_mfma_f32_16x16x32_bf16 v[40:43], v[40:43], v[22:25], 0
    v_mfma_f32_16x16x32_bf16 v[44:47], v[44:47], v[22:25], 0
    s_cmp_lg_u64 s[74:75], 0
    v_mfma_f32_16x16x32_bf16 v[26:29], v[22:25], v[22:25], 0
    s_cbranch_scc1 nan_39
back_40:
    v_smfmac_f32_16x16x64_bf16 v[18:21], v[52:55], a[232:239], v1
    ds_read_b128 v[52:55], v0 offset:4096
    v_cndmask_b32_dpp v40, v44, v40, vcc quad_perm:[0,1,0,1] row_mask:0xf bank_mask:0xf
    v_cndmask_b32_dpp v41, v45, v41, vcc quad_perm:[0,1,0,1] row_mask:0xf bank_mask:0xf
    v_cndmask_b32_dpp v42, v46, v42, vcc quad_perm:[0,1,0,1] row_mask:0xf bank_mask:0xf
    v_cndmask_b32_dpp v43, v47, v43, vcc quad_perm:[0,1,0,1] row_mask:0xf bank_mask:0xf
    ds_write_b128 v5, v[40:43] offset:10240
    v_cndmask_b32_dpp v28, v29, v28, vcc quad_perm:[0,1,0,1] row_mask:0xf bank_mask:0xf
    ds_write_b32 v5, v28 offset:13316
    v_smfmac_f32_16x16x64_bf16 v[18:21], v[56:59], a[248:255], v1
    ds_read_b128 v[56:59], v0 offset:5120
    v_mov_b32 v42, 0
    s_waitcnt lgkmcnt(4)
    v_smfmac_f32_16x16x64_bf16 v[14:17], v[10:13], v[60:67], v1
    v_mov_b32 v47, 0
    v_smfmac_f32_16x16x64_bf16 v[18:21], v[10:13], v[68:75], v1
    ds_read_b128 v[10:13], v0 offset:6144
    v_mov_b32 v28, 0
    v_smfmac_f32_16x16x64_bf16 v[14:17], v[48:51], v[80:87], v1
    v_mov_b32 v41, 0
    v_smfmac_f32_16x16x64_bf16 v[18:21], v[48:51], v[88:95], v1
    ds_read_b128 v[48:51], v0 offset:7168
    s_waitcnt lgkmcnt(3)
    s_barrier
    ds_read_b128 v[60:63], v0 offset:9216
    v_smfmac_f32_16x16x64_bf16 v[14:17], v[52:55], v[96:103], v1
    ds_read_b128 v[64:67], v0 offset:10240
    v_smfmac_f32_16x16x64_bf16 v[18:21], v[52:55], v[104:111], v1
    ds_read_b128 v[68:71], v0 offset:11264
    s_waitcnt lgkmcnt(4)
    v_smfmac_f32_16x16x64_bf16 v[14:17], v[56:59], v[112:119], v1
    ds_read_b128 v[72:75], v0 offset:12288
    v_smfmac_f32_16x16x64_bf16 v[18:21], v[56:59], v[120:127], v1
    ds_read_b128 v[22:25], v0 offset:13312
    v_smfmac_f32_16x16x64_bf16 v[14:17], v[10:13], v[128:135], v1
    ds_read_b128 v[52:55], v0 offset:8192
    s_waitcnt lgkmcnt(4)
    v_add_f32 v60, v60, v64
    v_smfmac_f32_16x16x64_bf16 v[18:21], v[10:13], v[136:143], v1
    v_add_f32 v61, v61, v65
    v_smfmac_f32_16x16x64_bf16 v[14:17], v[48:51], v[144:151], v1
    v_add_f32 v62, v62, v66
    v_smfmac_f32_16x16x64_bf16 v[18:21], v[48:51], v[152:159], v1
    v_add_f32 v63, v63, v67
    s_waitcnt lgkmcnt(0)
    v_smfmac_f32_16x16x64_bf16 v[14:17], v[52:55], v[160:167], v1
    v_add_f32 v22, v22, v23
    v_smfmac_f32_16x16x64_bf16 v[18:21], v[52:55], v[168:175], v1
    v_add_f32 v24, v24, v25
    v_add_f32 v22, v22, v24
    v_add_f32 v68, v68, v72
    v_add_f32 v69, v69, v73
    v_pk_add_f32 v[70:71], v[70:71], v[74:75]
    v_pk_add_f32 v[60:61], v[60:61], v[68:69]
    v_pk_add_f32 v[62:63], v[62:63], v[70:71]
    v_max3_f32 v24, v60, v61, v22
    v_max3_f32 v24, v24, v62, v63
    v_pk_add_f32 v[14:15], v[14:15], v[16:17]
    v_pk_add_f32 v[18:19], v[18:19], v[20:21]
    v_max_f32_dpp v25, v24, v24 row_ror:8 row_mask:0xf bank_mask:0xf
    v_max_f32_dpp v24, v24, v24 row_ror:8 row_mask:0xf bank_mask:0xf
    v_cvt_pk_bf16_f32 v29, v14, v15
    v_cvt_pk_bf16_f32 v35, v18, v19
    v_permlane16_swap_b32 v24, v25
    v_max_f32 v23, v24, v25
    v_max_f32 v24, v24, v25
    v_lshrrev_b32 v34, 16, v29
    v_lshrrev_b32 v40, 16, v35
    v_permlane32_swap_b32 v24, v23
    v_max_f32 v24, v24, v23
    v_sub_f32 v22, v22, v24
    v_pk_add_f32 v[60:61], v[60:61], v[24:25] op_sel_hi:[1,0] neg_lo:[0,1] neg_hi:[0,1]
    v_pk_add_f32 v[62:63], v[62:63], v[24:25] op_sel_hi:[1,0] neg_lo:[0,1] neg_hi:[0,1]
    v_mul_f32 v22, s40, v22
    v_pk_mul_f32 v[60:61], v[60:61], s[2:3]
    v_pk_mul_f32 v[62:63], v[62:63], s[2:3]
    v_exp_f32 v22, v22
    v_exp_f32 v60, v60
    v_exp_f32 v61, v61
    v_exp_f32 v62, v62
    v_exp_f32 v63, v63
    v_cvt_pk_bf16_f32 v46, v22, 0
    v_cvt_pk_bf16_f32 v44, v60, v61
    v_cvt_pk_bf16_f32 v45, v62, v63
    v_cvt_pk_bf16_f32 v43, v22, 0
    s_waitcnt vmcnt(2)
    v_mfma_f32_16x16x32_bf16 v[64:67], v[32:35], v[44:47], 0
    v_mov_b64 v[48:49], s[36:37]
    v_mov_b64 v[50:51], s[36:37]
    v_mfma_f32_16x16x32_bf16 v[60:63], v[28:31], v[42:45], 0
    v_min_u32 v76, -2, v29
    v_mov_b32 v78, v35
    v_mfma_f32_16x16x32_bf16 v[52:55], v[48:51], v[42:45], 0
    v_mov_b64 v[14:15], 0
    v_mov_b64 v[16:17], 0
    v_mfma_f32_16x16x32_bf16 v[68:71], v[34:37], v[42:45], 0
    v_add_f32_dpp v56, v64, v60 row_ror:8 row_mask:0xf bank_mask:0x3
    v_add_f32_dpp v57, v65, v61 row_ror:8 row_mask:0xf bank_mask:0x3
    v_mfma_f32_16x16x32_bf16 v[72:75], v[38:41], v[44:47], 0
    v_add_f32_dpp v50, v52, v52 row_ror:8 row_mask:0xf bank_mask:0xf
    v_add_f32_dpp v58, v66, v62 row_ror:8 row_mask:0xf bank_mask:0x3
    v_add_f32_dpp v59, v67, v63 row_ror:8 row_mask:0xf bank_mask:0x3
    v_rcp_f32 v50, v50
    v_and_b32 v10, 0xffffffdf, v0
    v_lshrrev_b32 v11, 2, v0
    v_mov_b64 v[18:19], 0
    v_mov_b64 v[20:21], 0
    v_add_f32_dpp v56, v68, v72 row_ror:8 row_mask:0xf bank_mask:0xc
    v_add_f32_dpp v57, v69, v73 row_ror:8 row_mask:0xf bank_mask:0xc
    v_add_f32_dpp v58, v70, v74 row_ror:8 row_mask:0xf bank_mask:0xc
    v_add_f32_dpp v59, v71, v75 row_ror:8 row_mask:0xf bank_mask:0xc
    v_pk_mul_f32 v[56:57], v[56:57], v[50:51] op_sel_hi:[1,0]
    v_pk_mul_f32 v[58:59], v[58:59], v[50:51] op_sel_hi:[1,0]
    v_cvt_pk_bf16_f32 v56, v56, v57
    v_cvt_pk_bf16_f32 v57, v58, v59
    ds_write_b64 v6, v[56:57] offset:512
    v_mfma_f32_16x16x32_bf16 v[22:25], v[14:17], v[14:17], 0
    ds_read_b128 v[60:63], v4 offset:20480
    ds_read_b128 v[64:67], v4 offset:21504
    ds_read_b128 v[68:71], v4 offset:24576
    ds_read_b128 v[72:75], v4 offset:25600
    v_mfma_f32_16x16x32_bf16 v[26:29], v[14:17], v[14:17], 0
    s_waitcnt lgkmcnt(4)
    s_barrier
    ds_read_b128 v[42:45], v10 offset:0
    ds_read_b128 v[50:53], v10 offset:1024
    v_mfma_f32_16x16x32_bf16 v[30:33], v[14:17], v[14:17], 0
    ds_read_b128 v[34:37], v0 offset:0
    ds_read_b128 v[46:49], v10 offset:32
    s_waitcnt lgkmcnt(3)
    v_smfmac_f32_16x16x64_bf16 v[18:21], v[42:45], v[176:183], v1
    ds_read_b128 v[38:41], v0 offset:1024
    v_smfmac_f32_16x16x64_bf16 v[22:25], v[42:45], v[192:199], v1
    ds_read_b128 v[54:57], v10 offset:1056
    s_waitcnt lgkmcnt(4)
    v_smfmac_f32_16x16x64_bf16 v[18:21], v[50:53], v[60:67], v1
    ds_read_b128 v[60:63], v4 offset:22528
    v_smfmac_f32_16x16x64_bf16 v[22:25], v[50:53], v[68:75], v1
    ds_read_b128 v[64:67], v4 offset:23552
    s_waitcnt lgkmcnt(4)
    v_smfmac_f32_16x16x64_bf16 v[14:17], v[34:37], v[240:247], v1
    ds_read_b128 v[68:71], v4 offset:26624
    v_smfmac_f32_16x16x64_bf16 v[18:21], v[46:49], v[184:191], v1
    ds_read_b128 v[72:75], v4 offset:27648
    s_waitcnt lgkmcnt(4)
    v_smfmac_f32_16x16x64_bf16 v[14:17], v[38:41], v[248:255], v1
    ds_read_b128 v[34:37], v4 offset:28672
    v_smfmac_f32_16x16x64_bf16 v[22:25], v[46:49], v[200:207], v1
    ds_read_b128 v[38:41], v4 offset:29696
    s_waitcnt lgkmcnt(4)
    v_smfmac_f32_16x16x64_bf16 v[18:21], v[54:57], v[60:67], v1
    ds_read_b128 v[60:63], v4 offset:30720
    v_add_f32 v14, v14, v16
    v_add_f32 v15, v15, v17
    s_waitcnt lgkmcnt(3)
    v_smfmac_f32_16x16x64_bf16 v[22:25], v[54:57], v[68:75], v1
    ds_read_b128 v[64:67], v4 offset:31744
    v_cvt_pk_bf16_f32 v58, v14, v15
    v_and_or_b32 v58, v58, -2, s46
    buffer_store_dword v58, v11, s[4:7], s20 offen
    v_smfmac_f32_16x16x64_bf16 v[26:29], v[42:45], v[208:215], v1
    ds_read_b128 v[68:71], v4 offset:32768
    v_cvt_pk_bf16_f32 v18, v18, v19
    v_cvt_pk_bf16_f32 v19, v20, v21
    v_and_or_b32 v18, v18, -2, s46
    v_smfmac_f32_16x16x64_bf16 v[26:29], v[46:49], v[216:223], v1
    ds_read_b128 v[72:75], v4 offset:33792
    v_cvt_pk_bf16_f32 v20, v22, v23
    v_cvt_pk_bf16_f32 v21, v24, v25
    buffer_store_dwordx4 v[18:21], v0, s[4:7], s18 offen
    s_waitcnt lgkmcnt(4)
    v_smfmac_f32_16x16x64_bf16 v[26:29], v[50:53], v[34:41], v1
    ds_read_b128 v[34:37], v4 offset:34816
    v_smfmac_f32_16x16x64_bf16 v[30:33], v[42:45], v[224:231], v1
    ds_read_b128 v[38:41], v4 offset:35840
    s_waitcnt lgkmcnt(4)
    v_smfmac_f32_16x16x64_bf16 v[26:29], v[54:57], v[60:67], v1
    s_waitcnt lgkmcnt(2)
    v_smfmac_f32_16x16x64_bf16 v[30:33], v[50:53], v[68:75], v1
    v_smfmac_f32_16x16x64_bf16 v[30:33], v[46:49], v[232:239], v1
    v_cvt_pk_bf16_f32 v26, v26, v27
    v_cvt_pk_bf16_f32 v27, v28, v29
    s_waitcnt lgkmcnt(0)
    v_smfmac_f32_16x16x64_bf16 v[30:33], v[54:57], v[34:41], v1
    v_and_or_b32 v26, v26, -2, s46
    s_nop 6
    v_cvt_pk_bf16_f32 v28, v30, v31
    v_cvt_pk_bf16_f32 v29, v32, v33
    buffer_store_dwordx4 v[26:29], v0, s[4:7], s19 offen
    v_bfe_u32 v58, v0, 6, 1
    v_lshlrev_b32 v58, 4, v58
    v_mov_b32 v59, 0x3f80
    v_lshlrev_b32 v58, v58, v59
    v_cndmask_b32 v10, 0, v58, s[30:31]
    s_lshl_b64 vcc, s[30:31], 1
    v_cndmask_b32 v11, 0, v58, vcc
    s_lshl_b64 vcc, s[30:31], 2
    v_cndmask_b32 v12, 0, v58, vcc
    s_lshl_b64 vcc, s[30:31], 3
    v_cndmask_b32 v13, 0, v58, vcc
    v_mov_b64 v[54:55], -1
    s_mov_b32 s41, 0
    s_xor_b32 s18, s18, 0x100000
    s_xor_b32 s19, s19, 0x100000
    s_xor_b32 s20, s20, 0x100000
    s_add_u32 s17, s17, 0x4000
    s_and_b32 s17, s17, 0xfffeffff
    s_add_u32 s21, s21, 262144
    s_add_u32 s22, s22, 262144
    s_add_u32 s23, s23, 131072
    s_waitcnt vmcnt(0)
    buffer_load_dwordx4 v[34:37], v7, s[4:7], s24 offen sc1
    buffer_load_dwordx4 v[38:41], v7, s[4:7], s25 offen sc1
    buffer_load_dwordx4 v[42:45], v7, s[4:7], s26 offen sc1
    buffer_load_dwordx4 v[46:49], v7, s[4:7], s27 offen sc1
    s_waitcnt vmcnt(3)
    v_mfma_f32_16x16x32_bf16 v[50:53], v[10:13], v[34:37], 0
    s_waitcnt vmcnt(2)
    v_mfma_f32_16x16x32_bf16 v[50:53], v[10:13], v[38:41], v[50:53]
    v_bitop3_b32 v58, v34, v38, s46 bitop3:0x7e
    s_waitcnt vmcnt(1)
    v_mfma_f32_16x16x32_bf16 v[50:53], v[10:13], v[42:45], v[50:53]
    s_waitcnt vmcnt(0)
    v_mfma_f32_16x16x32_bf16 v[50:53], v[10:13], v[46:49], v[50:53]
    v_bitop3_b32 v59, v42, v46, s46 bitop3:0x7e
    v_or_b32 v58, v58, v59
    v_and_b32 v58, 1, v58
    v_cmp_ne_u32 vcc, 0, v58
    s_cbranch_vccnz pp_41
ok_42:
    s_nop 2
    v_add_f32_dpp v50, v50, v50 row_ror:8 row_mask:0xf bank_mask:0xf
    v_add_f32_dpp v51, v51, v51 row_ror:8 row_mask:0xf bank_mask:0xf
    v_add_f32_dpp v52, v52, v52 row_ror:8 row_mask:0xf bank_mask:0xf
    v_add_f32_dpp v53, v53, v53 row_ror:8 row_mask:0xf bank_mask:0xf
    s_mov_b64 exec, s[28:29]
    v_cvt_pk_bf16_f32 v58, v50, v51
    v_cvt_pk_bf16_f32 v59, v52, v53
    v_min_u32 v58, -2, v58
    buffer_store_dwordx2 v[58:59], v8, s[4:7], s17 offen
    buffer_store_dwordx2 v[54:55], v8, s[4:7], s47 offen
    s_mov_b64 exec, -1
    s_xor_b32 s24, s24, 0x100000
    s_xor_b32 s25, s25, 0x100000
    s_xor_b32 s26, s26, 0x100000
    s_xor_b32 s27, s27, 0x100000
    s_add_u32 s47, s47, 0x4000
    s_and_b32 s47, s47, 0xfffeffff
    s_and_b32 s42, s16, 1
    s_xor_b32 s46, s46, s42
    s_add_u32 s16, s16, 1
    s_cmp_lt_u32 s16, 63
    s_cbranch_scc1 step_37
step_43:
    s_mov_b32 s41, 0
    s_add_u32 s86, s17, 6144
    s_mov_b32 m0, 6144
    s_mov_b32 s72, s23
    s_mov_b32 s76, 0
    v_mov_b64 v[14:15], 0
    v_mov_b64 v[16:17], 0
    v_mov_b64 v[18:19], 0
    v_mov_b64 v[20:21], 0
    v_mov_b64 v[22:23], 0
    v_mov_b64 v[24:25], 0
    v_mov_b64 v[26:27], 0
    v_mov_b64 v[28:29], 0
redo_44:
    s_waitcnt lgkmcnt(0)
    s_barrier
    ds_read_b128 v[48:51], v0 offset:0
    s_mov_b32 m0, 6144
    s_nop 0
    buffer_load_dwordx4 v0, s[4:7], s86 offen offset:0 sc1 lds
    ds_read_b128 v[52:55], v0 offset:1024
    ds_read_b128 v[56:59], v0 offset:2048
    s_mov_b32 m0, 15616
    ds_read_b128 v[60:63], v4 offset:0
    ds_read_b128 v[64:67], v4 offset:1024
    s_waitcnt lgkmcnt(4)
    v_smfmac_f32_16x16x64_bf16 v[14:17], v[48:51], a[224:231], v1
    ds_read_b128 v[68:71], v4 offset:2048
    ds_read_b128 v[72:75], v4 offset:3072
    ds_read_b128 v[10:13], v0 offset:3072
    v_smfmac_f32_16x16x64_bf16 v[22:25], v[48:51], a[232:239], v1
    buffer_store_dwordx4 v[76:79], v0, s[4:7], s72 offen sc1
    v_smfmac_f32_16x16x64_bf16 v[18:21], v[48:51], a[144:151], v1
    v_smfmac_f32_16x16x64_bf16 v[26:29], v[48:51], a[152:159], v1
    s_waitcnt lgkmcnt(3)
    v_smfmac_f32_16x16x64_bf16 v[14:17], v[52:55], a[240:247], v1
    v_smfmac_f32_16x16x64_bf16 v[22:25], v[52:55], a[248:255], v1
    v_smfmac_f32_16x16x64_bf16 v[18:21], v[52:55], v[60:67], v1
    ds_read_b128 v[60:63], v4 offset:4096
    s_waitcnt lgkmcnt(1)
    v_smfmac_f32_16x16x64_bf16 v[26:29], v[52:55], v[68:75], v1
    ds_read_b128 v[64:67], v4 offset:5120
    v_smfmac_f32_16x16x64_bf16 v[18:21], v[56:59], a[160:167], v1
    ds_read_b128 v[68:71], v4 offset:6144
    v_smfmac_f32_16x16x64_bf16 v[26:29], v[56:59], a[168:175], v1
    ds_read_b128 v[72:75], v4 offset:7168
    s_waitcnt vmcnt(1)
    s_barrier
    ds_read_b128 v[48:51], v0 offset:4096
    v_smfmac_f32_16x16x64_bf16 v[14:17], v[10:13], v[80:87], v1
    ds_read_b128 v[52:55], v0 offset:5120
    v_smfmac_f32_16x16x64_bf16 v[22:25], v[10:13], v[88:95], v1
    ds_read_b128 v[56:59], v0 offset:6144
    s_waitcnt lgkmcnt(5)
    v_smfmac_f32_16x16x64_bf16 v[18:21], v[10:13], v[60:67], v1
    ds_read_b128 v[60:63], v4 offset:8192
    s_waitcnt lgkmcnt(4)
    v_smfmac_f32_16x16x64_bf16 v[26:29], v[10:13], v[68:75], v1
    ds_read_b128 v[64:67], v4 offset:9216
    s_waitcnt lgkmcnt(4)
    v_smfmac_f32_16x16x64_bf16 v[14:17], v[48:51], v[96:103], v1
    ds_read_b128 v[10:13], v0 offset:7168
    v_smfmac_f32_16x16x64_bf16 v[22:25], v[48:51], v[104:111], v1
    ds_read_b128 v[68:71], v4 offset:10240
    v_smfmac_f32_16x16x64_bf16 v[18:21], v[48:51], a[176:183], v1
    ds_read_b128 v[72:75], v4 offset:11264
    v_smfmac_f32_16x16x64_bf16 v[26:29], v[48:51], a[184:191], v1
    s_waitcnt lgkmcnt(3)
    v_smfmac_f32_16x16x64_bf16 v[14:17], v[52:55], v[112:119], v1
    ds_read_b128 v[48:51], v0 offset:8192
    v_smfmac_f32_16x16x64_bf16 v[22:25], v[52:55], v[120:127], v1
    v_smfmac_f32_16x16x64_bf16 v[18:21], v[52:55], v[60:67], v1
    ds_read_b128 v[60:63], v4 offset:12288
    s_waitcnt lgkmcnt(2)
    v_smfmac_f32_16x16x64_bf16 v[26:29], v[52:55], v[68:75], v1
    ds_read_b128 v[64:67], v4 offset:13312
    v_smfmac_f32_16x16x64_bf16 v[14:17], v[56:59], v[128:135], v1
    ds_read_b128 v[68:71], v4 offset:14336
    v_smfmac_f32_16x16x64_bf16 v[22:25], v[56:59], v[136:143], v1
    ds_read_b128 v[72:75], v4 offset:15360
    v_smfmac_f32_16x16x64_bf16 v[18:21], v[56:59], a[192:199], v1
    v_smfmac_f32_16x16x64_bf16 v[26:29], v[56:59], a[200:207], v1
    v_smfmac_f32_16x16x64_bf16 v[14:17], v[10:13], v[144:151], v1
    v_smfmac_f32_16x16x64_bf16 v[22:25], v[10:13], v[152:159], v1
    s_waitcnt lgkmcnt(0)
    v_smfmac_f32_16x16x64_bf16 v[18:21], v[10:13], v[60:67], v1
    ds_read_b128 v[60:63], v4 offset:16384
    v_smfmac_f32_16x16x64_bf16 v[26:29], v[10:13], v[68:75], v1
    ds_read_b128 v[64:67], v4 offset:17408
    v_smfmac_f32_16x16x64_bf16 v[14:17], v[48:51], v[160:167], v1
    ds_read_b128 v[10:13], v0 offset:2048
    v_smfmac_f32_16x16x64_bf16 v[22:25], v[48:51], v[168:175], v1
    ds_read_b128 v[68:71], v4 offset:18432
    v_smfmac_f32_16x16x64_bf16 v[18:21], v[48:51], a[208:215], v1
    ds_read_b128 v[72:75], v4 offset:19456
    v_smfmac_f32_16x16x64_bf16 v[26:29], v[48:51], a[216:223], v1
    s_waitcnt lgkmcnt(2)
    v_smfmac_f32_16x16x64_bf16 v[14:17], v[10:13], v[60:67], v1
    s_waitcnt lgkmcnt(0)
    v_smfmac_f32_16x16x64_bf16 v[22:25], v[10:13], v[68:75], v1
    v_add_f32 v18, v18, v20
    v_add_f32 v19, v19, v21
    v_cvt_pk_bf16_f32 v77, v18, v19
    v_add_f32 v26, v26, v28
    v_add_f32 v27, v27, v29
    v_cvt_pk_bf16_f32 v79, v26, v27
    v_add_f32 v14, v14, v16
    v_add_f32 v15, v15, v17
    v_cvt_pk_bf16_f32 v76, v14, v15
    v_add_f32 v22, v22, v24
    v_add_f32 v23, v23, v25
    v_cvt_pk_bf16_f32 v78, v22, v23
    v_cmp_u_f32 s[74:75], v26, v27
    v_min_u32 v76, -2, v76
    s_cmp_lg_u64 s[74:75], 0
    s_cbranch_scc1 nan_45
back_46:
    s_add_u32 s23, s23, 131072
    buffer_store_dwordx4 v[76:79], v0, s[4:7], s23 offen sc1
    s_branch done
nan_45:
    v_mov_b32 v34, 0
    ds_read_b32 v35, v0 offset:4096
    s_waitcnt lgkmcnt(0)
    v_max_u32 v34, v34, v35
    ds_read_b32 v35, v0 offset:4104
    s_waitcnt lgkmcnt(0)
    v_max_u32 v34, v34, v35
    ds_read_b32 v35, v0 offset:5120
    s_waitcnt lgkmcnt(0)
    v_max_u32 v34, v34, v35
    ds_read_b32 v35, v0 offset:5128
    s_waitcnt lgkmcnt(0)
    v_max_u32 v34, v34, v35
    ds_read_b32 v35, v0 offset:6144
    s_waitcnt lgkmcnt(0)
    v_max_u32 v34, v34, v35
    ds_read_b32 v35, v0 offset:6152
    s_waitcnt lgkmcnt(0)
    v_max_u32 v34, v34, v35
    ds_read_b32 v35, v0 offset:7168
    s_waitcnt lgkmcnt(0)
    v_max_u32 v34, v34, v35
    ds_read_b32 v35, v0 offset:7176
    s_waitcnt lgkmcnt(0)
    v_max_u32 v34, v34, v35
    ds_read_b32 v35, v0 offset:8192
    s_waitcnt lgkmcnt(0)
    v_max_u32 v34, v34, v35
    ds_read_b32 v35, v0 offset:8200
    s_waitcnt lgkmcnt(0)
    v_max_u32 v34, v34, v35
    v_cmp_eq_u32 s[74:75], -1, v34
    s_nop 0
    s_cmp_eq_u64 s[74:75], 0
    s_cbranch_scc1 back_46
    s_add_u32 s76, s76, 1
    s_cmp_gt_u32 s76, 2000000
    s_cbranch_scc1 fin1
    s_mov_b32 s72, 100662272
    v_mov_b64 v[14:15], 0
    v_mov_b64 v[16:17], 0
    v_mov_b64 v[18:19], 0
    v_mov_b64 v[20:21], 0
    v_mov_b64 v[22:23], 0
    v_mov_b64 v[24:25], 0
    v_mov_b64 v[26:27], 0
    v_mov_b64 v[28:29], 0
    s_waitcnt vmcnt(0)
    s_barrier
    s_branch redo_44
nan_39:
    v_mov_b32 v34, 0
    ds_read_b32 v35, v0 offset:4096
    s_waitcnt lgkmcnt(0)
    v_max_u32 v34, v34, v35
    ds_read_b32 v35, v0 offset:4104
    s_waitcnt lgkmcnt(0)
    v_max_u32 v34, v34, v35
    ds_read_b32 v35, v0 offset:5120
    s_waitcnt lgkmcnt(0)
    v_max_u32 v34, v34, v35
    ds_read_b32 v35, v0 offset:5128
    s_waitcnt lgkmcnt(0)
    v_max_u32 v34, v34, v35
    ds_read_b32 v35, v0 offset:6144
    s_waitcnt lgkmcnt(0)
    v_max_u32 v34, v34, v35
    ds_read_b32 v35, v0 offset:6152
    s_waitcnt lgkmcnt(0)
    v_max_u32 v34, v34, v35
    ds_read_b32 v35, v0 offset:7168
    s_waitcnt lgkmcnt(0)
    v_max_u32 v34, v34, v35
    ds_read_b32 v35, v0 offset:7176
    s_waitcnt lgkmcnt(0)
    v_max_u32 v34, v34, v35
    ds_read_b32 v35, v0 offset:8192
    s_waitcnt lgkmcnt(0)
    v_max_u32 v34, v34, v35
    ds_read_b32 v35, v0 offset:8200
    s_waitcnt lgkmcnt(0)
    v_max_u32 v34, v34, v35
    v_cmp_eq_u32 s[74:75], -1, v34
    s_nop 0
    s_cmp_eq_u64 s[74:75], 0
    s_cbranch_scc1 back_40
    s_add_u32 s76, s76, 1
    s_cmp_gt_u32 s76, 2000000
    s_cbranch_scc1 fin1
    s_mov_b32 s72, 100662272
    v_mov_b64 v[14:15], 0
    v_mov_b64 v[16:17], 0
    v_mov_b64 v[18:19], 0
    v_mov_b64 v[20:21], 0
    v_mov_b64 v[22:23], 0
    v_mov_b64 v[24:25], 0
    v_mov_b64 v[26:27], 0
    v_mov_b64 v[28:29], 0
    s_waitcnt vmcnt(0)
    s_barrier
    s_branch redo_38
pp_41:
    buffer_load_dwordx4 v[34:37], v7, s[4:7], s24 offen sc1
    buffer_load_dwordx4 v[38:41], v7, s[4:7], s25 offen sc1
    buffer_load_dwordx4 v[42:45], v7, s[4:7], s26 offen sc1
    buffer_load_dwordx4 v[46:49], v7, s[4:7], s27 offen sc1
    s_add_u32 s41, s41, 1
    s_cmp_gt_u32 s41, 2000000
    s_cbranch_scc1 fin1
    s_waitcnt vmcnt(3)
    v_mfma_f32_16x16x32_bf16 v[50:53], v[10:13], v[34:37], 0
    s_waitcnt vmcnt(2)
    v_mfma_f32_16x16x32_bf16 v[50:53], v[10:13], v[38:41], v[50:53]
    v_bitop3_b32 v58, v34, v38, s46 bitop3:0x7e
    s_waitcnt vmcnt(1)
    v_mfma_f32_16x16x32_bf16 v[50:53], v[10:13], v[42:45], v[50:53]
    s_waitcnt vmcnt(0)
    v_mfma_f32_16x16x32_bf16 v[50:53], v[10:13], v[46:49], v[50:53]
    v_bitop3_b32 v59, v42, v46, s46 bitop3:0x7e
    v_or_b32 v58, v58, v59
    v_and_b32 v58, 1, v58
    v_cmp_ne_u32 vcc, 0, v58
    s_cbranch_vccnz pp_41
    s_branch ok_42
role_21:
.p2align 6
step_47:
    s_mov_b32 s41, 0
    s_add_u32 s38, s17, 4096
    s_add_u32 s86, s17, 7168
    s_mov_b32 m0, 7168
    s_mov_b32 s72, s23
    s_mov_b32 s76, 0
    v_mov_b64 v[14:15], 0
    v_mov_b64 v[16:17], 0
    v_mov_b64 v[18:19], 0
    v_mov_b64 v[20:21], 0
    v_mov_b64 v[22:23], 0
    v_mov_b64 v[24:25], 0
    v_mov_b64 v[26:27], 0
    v_mov_b64 v[28:29], 0
    s_nop 9
    buffer_load_dwordx4 v[40:43], v0, s[4:7], s38 offen offset:0 sc1
    s_nop 15
    s_nop 7
    buffer_load_dwordx4 v[60:63], v0, s[4:7], s38 offen offset:0 sc1
    s_waitcnt vmcnt(1)
    ds_write_b128 v0, v[40:43] offset:4096
    v_max_u32 v34, v40, v42
    v_cmp_eq_u32 vcc, -1, v34
    s_cbranch_vccnz pp_48
ok_49:
redo_50:
    s_waitcnt lgkmcnt(0)
    s_barrier
    ds_read_b128 v[48:51], v0 offset:0
    s_mov_b32 m0, 7168
    s_nop 0
    buffer_load_dwordx4 v0, s[4:7], s86 offen offset:0 sc1 lds
    ds_read_b128 v[52:55], v0 offset:1024
    ds_read_b128 v[56:59], v0 offset:2048
    s_mov_b32 m0, 15872
    s_waitcnt lgkmcnt(2)
    v_smfmac_f32_16x16x64_bf16 v[14:17], v[48:51], a[0:7], v1
    s_waitcnt vmcnt(1)
    ds_read_b128 v[60:63], v4 offset:0
    ds_read_b128 v[64:67], v4 offset:1024
    v_smfmac_f32_16x16x64_bf16 v[22:25], v[48:51], a[8:15], v1
    ds_read_b128 v[68:71], v4 offset:2048
    ds_read_b128 v[72:75], v4 offset:3072
    v_smfmac_f32_16x16x64_bf16 v[18:21], v[48:51], a[144:151], v1
    ds_read_b128 v[10:13], v0 offset:3072
    v_smfmac_f32_16x16x64_bf16 v[26:29], v[48:51], a[152:159], v1
    ds_read_b128 v[48:51], v0 offset:4096
    s_waitcnt lgkmcnt(6)
    v_smfmac_f32_16x16x64_bf16 v[14:17], v[52:55], a[16:23], v1
    buffer_load_dwordx4 v[40:43], v9, s[4:7], s21 offen sc1 nt
    v_smfmac_f32_16x16x64_bf16 v[22:25], v[52:55], a[24:31], v1
    buffer_load_dwordx4 v[44:47], v9, s[4:7], s21 offen offset:256 sc1 nt
    s_waitcnt lgkmcnt(2)
    v_smfmac_f32_16x16x64_bf16 v[18:21], v[52:55], v[60:67], v1
    ds_read_b128 v[60:63], v4 offset:4096
    v_smfmac_f32_16x16x64_bf16 v[26:29], v[52:55], v[68:75], v1
    ds_read_b128 v[64:67], v4 offset:5120
    v_smfmac_f32_16x16x64_bf16 v[14:17], v[56:59], a[32:39], v1
    ds_read_b128 v[68:71], v4 offset:6144
    v_smfmac_f32_16x16x64_bf16 v[22:25], v[56:59], a[40:47], v1
    ds_read_b128 v[72:75], v4 offset:7168
    v_smfmac_f32_16x16x64_bf16 v[18:21], v[56:59], a[160:167], v1
    buffer_load_dwordx4 v[30:33], v9, s[4:7], s22 offen sc1 nt
    v_smfmac_f32_16x16x64_bf16 v[26:29], v[56:59], a[168:175], v1
    buffer_load_dwordx4 v[36:39], v9, s[4:7], s22 offen offset:256 sc1 nt
    s_waitcnt lgkmcnt(2)
    v_smfmac_f32_16x16x64_bf16 v[14:17], v[10:13], a[48:55], v1
    v_smfmac_f32_16x16x64_bf16 v[22:25], v[10:13], a[56:63], v1
    v_smfmac_f32_16x16x64_bf16 v[18:21], v[10:13], v[60:67], v1
    ds_read_b128 v[60:63], v4 offset:8192
    s_waitcnt lgkmcnt(1)
    v_smfmac_f32_16x16x64_bf16 v[26:29], v[10:13], v[68:75], v1
    ds_read_b128 v[64:67], v4 offset:9216
    v_lshlrev_b32 v35, 3, v0
    v_smfmac_f32_16x16x64_bf16 v[14:17], v[48:51], a[64:71], v1
    ds_read_b128 v[68:71], v4 offset:10240
    s_waitcnt vmcnt(4)
    s_barrier
    ds_read_b128 v[52:55], v0 offset:5120
    v_smfmac_f32_16x16x64_bf16 v[22:25], v[48:51], a[72:79], v1
    ds_read_b128 v[56:59], v0 offset:6144
    v_smfmac_f32_16x16x64_bf16 v[18:21], v[48:51], a[176:183], v1
    ds_read_b128 v[10:13], v0 offset:7168
    v_smfmac_f32_16x16x64_bf16 v[26:29], v[48:51], a[184:191], v1
    ds_read_b128 v[72:75], v4 offset:11264
    s_waitcnt lgkmcnt(3)
    v_smfmac_f32_16x16x64_bf16 v[14:17], v[52:55], a[80:87], v1
    ds_read_b128 v[48:51], v0 offset:8192
    v_smfmac_f32_16x16x64_bf16 v[22:25], v[52:55], a[88:95], v1
    buffer_store_dwordx4 v[76:79], v0, s[4:7], s72 offen sc1
    v_smfmac_f32_16x16x64_bf16 v[18:21], v[52:55], v[60:67], v1
    ds_read_b128 v[60:63], v4 offset:12288
    s_waitcnt lgkmcnt(2)
    v_smfmac_f32_16x16x64_bf16 v[26:29], v[52:55], v[68:75], v1
    ds_read_b128 v[64:67], v4 offset:13312
    v_smfmac_f32_16x16x64_bf16 v[14:17], v[56:59], a[96:103], v1
    ds_read_b128 v[68:71], v4 offset:14336
    v_smfmac_f32_16x16x64_bf16 v[22:25], v[56:59], a[104:111], v1
    ds_read_b128 v[72:75], v4 offset:15360
    v_smfmac_f32_16x16x64_bf16 v[18:21], v[56:59], a[192:199], v1
    ds_read_b128 v[52:55], v0 offset:0
    v_smfmac_f32_16x16x64_bf16 v[26:29], v[56:59], a[200:207], v1
    ds_read_b128 v[56:59], v0 offset:1024
    s_mov_b64 vcc, s[34:35]
    v_smfmac_f32_16x16x64_bf16 v[14:17], v[10:13], a[112:119], v1
    s_add_u32 s42, s22, 520192
    buffer_load_dword v35, s[4:7], s42 offen sc1 lds
    s_waitcnt lgkmcnt(3)
    v_smfmac_f32_16x16x64_bf16 v[14:17], v[48:51], a[128:135], v1
    v_smfmac_f32_16x16x64_bf16 v[18:21], v[48:51], a[208:215], v1
    v_smfmac_f32_16x16x64_bf16 v[18:21], v[10:13], v[60:67], v1
    ds_read_b128 v[60:63], v4 offset:16384
    v_add_f32 v14, v14, v16
    v_smfmac_f32_16x16x64_bf16 v[22:25], v[48:51], a[136:143], v1
    ds_read_b128 v[64:67], v4 offset:17408
    v_add_f32 v15, v15, v17
    v_cvt_pk_bf16_f32 v76, v14, v15
    v_smfmac_f32_16x16x64_bf16 v[22:25], v[10:13], a[120:127], v1
    v_add_f32 v18, v18, v20
    v_add_f32 v19, v19, v21
    v_smfmac_f32_16x16x64_bf16 v[26:29], v[48:51], a[216:223], v1
    v_cvt_pk_bf16_f32 v77, v18, v19
    v_mov_b64 v[14:15], 0
    s_waitcnt lgkmcnt(2)
    v_smfmac_f32_16x16x64_bf16 v[26:29], v[10:13], v[68:75], v1
    ds_read_b128 v[68:71], v4 offset:18432
    v_mov_b64 v[16:17], 0
    v_mfma_f32_16x16x16_bf16 v[18:21], v[76:77], v[2:3], 0
    v_add_f32 v22, v22, v24
    v_add_f32 v23, v23, v25
    v_cvt_pk_bf16_f32 v78, v22, v23
    ds_read_b128 v[72:75], v4 offset:19456
    v_add_f32 v26, v26, v28
    v_add_f32 v27, v27, v29
    v_cvt_pk_bf16_f32 v79, v26, v27
    v_cmp_u_f32 s[74:75], v22, v23
    v_cvt_pk_bf16_f32 v22, v18, v19
    v_mfma_f32_16x16x16_bf16 v[26:29], v[78:79], v[2:3], 0
    v_cvt_pk_bf16_f32 v23, v20, v21
    v_mov_b64 v[18:19], 0
    v_smfmac_f32_16x16x64_bf16 v[14:17], v[52:55], a[224:231], v1
    ds_read_b128 v[10:13], v0 offset:2048
    v_mov_b64 v[20:21], 0
    v_smfmac_f32_16x16x64_bf16 v[14:17], v[56:59], a[240:247], v1
    ds_read_b128 v[48:51], v0 offset:3072
    v_cvt_pk_bf16_f32 v24, v26, v27
    v_cvt_pk_bf16_f32 v25, v28, v29
    s_waitcnt vmcnt(4)
    s_nop 0
    v_mfma_f32_16x16x32_bf16 v[40:43], v[40:43], v[22:25], 0
    v_mfma_f32_16x16x32_bf16 v[44:47], v[44:47], v[22:25], 0
    s_cmp_lg_u64 s[74:75], 0
    v_mfma_f32_16x16x32_bf16 v[26:29], v[22:25], v[22:25], 0
    s_cbranch_scc1 nan_51
back_52:
    v_smfmac_f32_16x16x64_bf16 v[18:21], v[52:55], a[232:239], v1
    ds_read_b128 v[52:55], v0 offset:4096
    v_cndmask_b32_dpp v40, v44, v40, vcc quad_perm:[0,1,0,1] row_mask:0xf bank_mask:0xf
    v_cndmask_b32_dpp v41, v45, v41, vcc quad_perm:[0,1,0,1] row_mask:0xf bank_mask:0xf
    v_cndmask_b32_dpp v42, v46, v42, vcc quad_perm:[0,1,0,1] row_mask:0xf bank_mask:0xf
    v_cndmask_b32_dpp v43, v47, v43, vcc quad_perm:[0,1,0,1] row_mask:0xf bank_mask:0xf
    ds_write_b128 v5, v[40:43] offset:11264
    v_cndmask_b32_dpp v28, v29, v28, vcc quad_perm:[0,1,0,1] row_mask:0xf bank_mask:0xf
    ds_write_b32 v5, v28 offset:13320
    v_smfmac_f32_16x16x64_bf16 v[18:21], v[56:59], a[248:255], v1
    ds_read_b128 v[56:59], v0 offset:5120
    v_mov_b32 v42, 0
    s_waitcnt lgkmcnt(4)
    v_smfmac_f32_16x16x64_bf16 v[14:17], v[10:13], v[60:67], v1
    v_mov_b32 v47, 0
    v_smfmac_f32_16x16x64_bf16 v[18:21], v[10:13], v[68:75], v1
    ds_read_b128 v[10:13], v0 offset:6144
    v_mov_b32 v28, 0
    v_smfmac_f32_16x16x64_bf16 v[14:17], v[48:51], v[80:87], v1
    v_mov_b32 v41, 0
    v_smfmac_f32_16x16x64_bf16 v[18:21], v[48:51], v[88:95], v1
    ds_read_b128 v[48:51], v0 offset:7168
    s_waitcnt lgkmcnt(3)
    s_barrier
    ds_read_b128 v[60:63], v0 offset:9216
    v_smfmac_f32_16x16x64_bf16 v[14:17], v[52:55], v[96:103], v1
    ds_read_b128 v[64:67], v0 offset:10240
    v_smfmac_f32_16x16x64_bf16 v[18:21], v[52:55], v[104:111], v1
    ds_read_b128 v[68:71], v0 offset:11264
    s_waitcnt lgkmcnt(4)
    v_smfmac_f32_16x16x64_bf16 v[14:17], v[56:59], v[112:119], v1
    ds_read_b128 v[72:75], v0 offset:12288
    v_smfmac_f32_16x16x64_bf16 v[18:21], v[56:59], v[120:127], v1
    ds_read_b128 v[22:25], v0 offset:13312
    v_smfmac_f32_16x16x64_bf16 v[14:17], v[10:13], v[128:135], v1
    ds_read_b128 v[52:55], v0 offset:8192
    s_waitcnt lgkmcnt(4)
    v_add_f32 v60, v60, v64
    v_smfmac_f32_16x16x64_bf16 v[18:21], v[10:13], v[136:143], v1
    v_add_f32 v61, v61, v65
    v_smfmac_f32_16x16x64_bf16 v[14:17], v[48:51], v[144:151], v1
    v_add_f32 v62, v62, v66
    v_smfmac_f32_16x16x64_bf16 v[18:21], v[48:51], v[152:159], v1
    v_add_f32 v63, v63, v67
    s_waitcnt lgkmcnt(0)
    v_smfmac_f32_16x16x64_bf16 v[14:17], v[52:55], v[160:167], v1
    v_add_f32 v22, v22, v23
    v_smfmac_f32_16x16x64_bf16 v[18:21], v[52:55], v[168:175], v1
    v_add_f32 v24, v24, v25
    v_add_f32 v22, v22, v24
    v_add_f32 v68, v68, v72
    v_add_f32 v69, v69, v73
    v_pk_add_f32 v[70:71], v[70:71], v[74:75]
    v_pk_add_f32 v[60:61], v[60:61], v[68:69]
    v_pk_add_f32 v[62:63], v[62:63], v[70:71]
    v_max3_f32 v24, v60, v61, v22
    v_max3_f32 v24, v24, v62, v63
    v_pk_add_f32 v[14:15], v[14:15], v[16:17]
    v_pk_add_f32 v[18:19], v[18:19], v[20:21]
    v_max_f32_dpp v25, v24, v24 row_ror:8 row_mask:0xf bank_mask:0xf
    v_max_f32_dpp v24, v24, v24 row_ror:8 row_mask:0xf bank_mask:0xf
    v_cvt_pk_bf16_f32 v29, v14, v15
    v_cvt_pk_bf16_f32 v35, v18, v19
    v_permlane16_swap_b32 v24, v25
    v_max_f32 v23, v24, v25
    v_max_f32 v24, v24, v25
    v_lshrrev_b32 v34, 16, v29
    v_lshrrev_b32 v40, 16, v35
    v_permlane32_swap_b32 v24, v23
    v_max_f32 v24, v24, v23
    v_sub_f32 v22, v22, v24
    v_pk_add_f32 v[60:61], v[60:61], v[24:25] op_sel_hi:[1,0] neg_lo:[0,1] neg_hi:[0,1]
    v_pk_add_f32 v[62:63], v[62:63], v[24:25] op_sel_hi:[1,0] neg_lo:[0,1] neg_hi:[0,1]
    v_mul_f32 v22, s40, v22
    v_pk_mul_f32 v[60:61], v[60:61], s[2:3]
    v_pk_mul_f32 v[62:63], v[62:63], s[2:3]
    v_exp_f32 v22, v22
    v_exp_f32 v60, v60
    v_exp_f32 v61, v61
    v_exp_f32 v62, v62
    v_exp_f32 v63, v63
    v_cvt_pk_bf16_f32 v46, v22, 0
    v_cvt_pk_bf16_f32 v44, v60, v61
    v_cvt_pk_bf16_f32 v45, v62, v63
    v_cvt_pk_bf16_f32 v43, v22, 0
    s_waitcnt vmcnt(2)
    v_mfma_f32_16x16x32_bf16 v[64:67], v[32:35], v[44:47], 0
    v_mov_b64 v[48:49], s[36:37]
    v_mov_b64 v[50:51], s[36:37]
    v_mfma_f32_16x16x32_bf16 v[60:63], v[28:31], v[42:45], 0
    v_min_u32 v76, -2, v29
    v_mov_b32 v78, v35
    v_mfma_f32_16x16x32_bf16 v[52:55], v[48:51], v[42:45], 0
    v_mov_b64 v[14:15], 0
    v_mov_b64 v[16:17], 0
    v_mfma_f32_16x16x32_bf16 v[68:71], v[34:37], v[42:45], 0
    v_add_f32_dpp v56, v64, v60 row_ror:8 row_mask:0xf bank_mask:0x3
    v_add_f32_dpp v57, v65, v61 row_ror:8 row_mask:0xf bank_mask:0x3
    v_mfma_f32_16x16x32_bf16 v[72:75], v[38:41], v[44:47], 0
    v_add_f32_dpp v50, v52, v52 row_ror:8 row_mask:0xf bank_mask:0xf
    v_add_f32_dpp v58, v66, v62 row_ror:8 row_mask:0xf bank_mask:0x3
    v_add_f32_dpp v59, v67, v63 row_ror:8 row_mask:0xf bank_mask:0x3
    v_rcp_f32 v50, v50
    v_and_b32 v10, 0xffffffdf, v0
    v_lshrrev_b32 v11, 2, v0
    v_mov_b64 v[18:19], 0
    v_mov_b64 v[20:21], 0
    v_add_f32_dpp v56, v68, v72 row_ror:8 row_mask:0xf bank_mask:0xc
    v_add_f32_dpp v57, v69, v73 row_ror:8 row_mask:0xf bank_mask:0xc
    v_add_f32_dpp v58, v70, v74 row_ror:8 row_mask:0xf bank_mask:0xc
    v_add_f32_dpp v59, v71, v75 row_ror:8 row_mask:0xf bank_mask:0xc
    v_pk_mul_f32 v[56:57], v[56:57], v[50:51] op_sel_hi:[1,0]
    v_pk_mul_f32 v[58:59], v[58:59], v[50:51] op_sel_hi:[1,0]
    v_cvt_pk_bf16_f32 v56, v56, v57
    v_cvt_pk_bf16_f32 v57, v58, v59
    ds_write_b64 v6, v[56:57] offset:1024
    v_mfma_f32_16x16x32_bf16 v[22:25], v[14:17], v[14:17], 0
    ds_read_b128 v[60:63], v4 offset:20480
    ds_read_b128 v[64:67], v4 offset:21504
    ds_read_b128 v[68:71], v4 offset:24576
    ds_read_b128 v[72:75], v4 offset:25600
    v_mfma_f32_16x16x32_bf16 v[26:29], v[14:17], v[14:17], 0
    s_waitcnt lgkmcnt(4)
    s_barrier
    ds_read_b128 v[42:45], v10 offset:0
    ds_read_b128 v[50:53], v10 offset:1024
    v_mfma_f32_16x16x32_bf16 v[30:33], v[14:17], v[14:17], 0
    ds_read_b128 v[34:37], v0 offset:0
    ds_read_b128 v[46:49], v10 offset:32
    s_waitcnt lgkmcnt(3)
    v_smfmac_f32_16x16x64_bf16 v[18:21], v[42:45], v[176:183], v1
    ds_read_b128 v[38:41], v0 offset:1024
    v_smfmac_f32_16x16x64_bf16 v[22:25], v[42:45], v[192:199], v1
    ds_read_b128 v[54:57], v10 offset:1056
    s_waitcnt lgkmcnt(4)
    v_smfmac_f32_16x16x64_bf16 v[18:21], v[50:53], v[60:67], v1
    ds_read_b128 v[60:63], v4 offset:22528
    v_smfmac_f32_16x16x64_bf16 v[22:25], v[50:53], v[68:75], v1
    ds_read_b128 v[64:67], v4 offset:23552
    s_waitcnt lgkmcnt(4)
    v_smfmac_f32_16x16x64_bf16 v[14:17], v[34:37], v[240:247], v1
    ds_read_b128 v[68:71], v4 offset:26624
    v_smfmac_f32_16x16x64_bf16 v[18:21], v[46:49], v[184:191], v1
    ds_read_b128 v[72:75], v4 offset:27648
    s_waitcnt lgkmcnt(4)
    v_smfmac_f32_16x16x64_bf16 v[14:17], v[38:41], v[248:255], v1
    ds_read_b128 v[34:37], v4 offset:28672
    v_smfmac_f32_16x16x64_bf16 v[22:25], v[46:49], v[200:207], v1
    ds_read_b128 v[38:41], v4 offset:29696
    s_waitcnt lgkmcnt(4)
    v_smfmac_f32_16x16x64_bf16 v[18:21], v[54:57], v[60:67], v1
    ds_read_b128 v[60:63], v4 offset:30720
    v_add_f32 v14, v14, v16
    v_add_f32 v15, v15, v17
    s_waitcnt lgkmcnt(3)
    v_smfmac_f32_16x16x64_bf16 v[22:25], v[54:57], v[68:75], v1
    ds_read_b128 v[64:67], v4 offset:31744
    v_cvt_pk_bf16_f32 v58, v14, v15
    v_and_or_b32 v58, v58, -2, s46
    buffer_store_dword v58, v11, s[4:7], s20 offen
    v_smfmac_f32_16x16x64_bf16 v[26:29], v[42:45], v[208:215], v1
    ds_read_b128 v[68:71], v4 offset:32768
    v_cvt_pk_bf16_f32 v18, v18, v19
    v_cvt_pk_bf16_f32 v19, v20, v21
    v_and_or_b32 v18, v18, -2, s46
    v_smfmac_f32_16x16x64_bf16 v[26:29], v[46:49], v[216:223], v1
    ds_read_b128 v[72:75], v4 offset:33792
    v_cvt_pk_bf16_f32 v20, v22, v23
    v_cvt_pk_bf16_f32 v21, v24, v25
    buffer_store_dwordx4 v[18:21], v0, s[4:7], s18 offen
    s_waitcnt lgkmcnt(4)
    v_smfmac_f32_16x16x64_bf16 v[26:29], v[50:53], v[34:41], v1
    ds_read_b128 v[34:37], v4 offset:34816
    v_smfmac_f32_16x16x64_bf16 v[30:33], v[42:45], v[224:231], v1
    ds_read_b128 v[38:41], v4 offset:35840
    s_waitcnt lgkmcnt(4)
    v_smfmac_f32_16x16x64_bf16 v[26:29], v[54:57], v[60:67], v1
    s_waitcnt lgkmcnt(2)
    v_smfmac_f32_16x16x64_bf16 v[30:33], v[50:53], v[68:75], v1
    v_smfmac_f32_16x16x64_bf16 v[30:33], v[46:49], v[232:239], v1
    v_cvt_pk_bf16_f32 v26, v26, v27
    v_cvt_pk_bf16_f32 v27, v28, v29
    s_waitcnt lgkmcnt(0)
    v_smfmac_f32_16x16x64_bf16 v[30:33], v[54:57], v[34:41], v1
    v_and_or_b32 v26, v26, -2, s46
    s_nop 6
    v_cvt_pk_bf16_f32 v28, v30, v31
    v_cvt_pk_bf16_f32 v29, v32, v33
    buffer_store_dwordx4 v[26:29], v0, s[4:7], s19 offen
    v_bfe_u32 v58, v0, 6, 1
    v_lshlrev_b32 v58, 4, v58
    v_mov_b32 v59, 0x3f80
    v_lshlrev_b32 v58, v58, v59
    v_cndmask_b32 v10, 0, v58, s[30:31]
    s_lshl_b64 vcc, s[30:31], 1
    v_cndmask_b32 v11, 0, v58, vcc
    s_lshl_b64 vcc, s[30:31], 2
    v_cndmask_b32 v12, 0, v58, vcc
    s_lshl_b64 vcc, s[30:31], 3
    v_cndmask_b32 v13, 0, v58, vcc
    v_mov_b64 v[54:55], -1
    s_mov_b32 s41, 0
    s_xor_b32 s18, s18, 0x100000
    s_xor_b32 s19, s19, 0x100000
    s_xor_b32 s20, s20, 0x100000
    s_add_u32 s17, s17, 0x4000
    s_and_b32 s17, s17, 0xfffeffff
    s_add_u32 s21, s21, 262144
    s_add_u32 s22, s22, 262144
    s_add_u32 s23, s23, 131072
    s_waitcnt vmcnt(2)
    buffer_load_dwordx4 v[34:37], v7, s[4:7], s24 offen sc1
    s_waitcnt vmcnt(0)
    v_mfma_f32_16x16x32_bf16 v[50:53], v[10:13], v[34:37], 0
    v_bitop3_b32 v58, v34, v35, s46 bitop3:0x7e
    v_bitop3_b32 v59, v36, v37, s46 bitop3:0x7e
    v_or_b32 v58, v58, v59
    v_and_b32 v58, 1, v58
    v_cmp_ne_u32 vcc, 0, v58
    s_cbranch_vccnz pp_53
ok_54:
    s_nop 1
    v_add_f32_dpp v50, v50, v50 row_ror:8 row_mask:0xf bank_mask:0xf
    v_add_f32_dpp v51, v51, v51 row_ror:8 row_mask:0xf bank_mask:0xf
    v_add_f32_dpp v52, v52, v52 row_ror:8 row_mask:0xf bank_mask:0xf
    v_add_f32_dpp v53, v53, v53 row_ror:8 row_mask:0xf bank_mask:0xf
    v_add_f32_dpp v50, v50, v50 row_ror:4 row_mask:0xf bank_mask:0xf
    v_add_f32_dpp v51, v51, v51 row_ror:4 row_mask:0xf bank_mask:0xf
    v_add_f32_dpp v52, v52, v52 row_ror:4 row_mask:0xf bank_mask:0xf
    v_add_f32_dpp v53, v53, v53 row_ror:4 row_mask:0xf bank_mask:0xf
    v_add_f32_dpp v50, v50, v50 row_ror:2 row_mask:0xf bank_mask:0xf
    v_add_f32_dpp v51, v51, v51 row_ror:2 row_mask:0xf bank_mask:0xf
    v_add_f32_dpp v52, v52, v52 row_ror:2 row_mask:0xf bank_mask:0xf
    v_add_f32_dpp v53, v53, v53 row_ror:2 row_mask:0xf bank_mask:0xf
    s_mov_b64 exec, s[28:29]
    v_cvt_pk_bf16_f32 v58, v50, v51
    v_cvt_pk_bf16_f32 v59, v52, v53
    v_min_u32 v58, -2, v58
    buffer_store_dwordx2 v[58:59], v8, s[4:7], s17 offen
    buffer_store_dwordx2 v[54:55], v8, s[4:7], s47 offen
    s_mov_b64 exec, -1
    s_xor_b32 s24, s24, 0x100000
    s_add_u32 s47, s47, 0x4000
    s_and_b32 s47, s47, 0xfffeffff
    s_and_b32 s42, s16, 1
    s_xor_b32 s46, s46, s42
    s_add_u32 s16, s16, 1
    s_cmp_lt_u32 s16, 63
    s_cbranch_scc1 step_47
step_55:
    s_mov_b32 s41, 0
    s_add_u32 s38, s17, 4096
    s_add_u32 s86, s17, 7168
    s_mov_b32 m0, 7168
    s_mov_b32 s72, s23
    s_mov_b32 s76, 0
    v_mov_b64 v[14:15], 0
    v_mov_b64 v[16:17], 0
    v_mov_b64 v[18:19], 0
    v_mov_b64 v[20:21], 0
    v_mov_b64 v[22:23], 0
    v_mov_b64 v[24:25], 0
    v_mov_b64 v[26:27], 0
    v_mov_b64 v[28:29], 0
    s_nop 9
    buffer_load_dwordx4 v[40:43], v0, s[4:7], s38 offen offset:0 sc1
    s_nop 15
    s_nop 7
    buffer_load_dwordx4 v[60:63], v0, s[4:7], s38 offen offset:0 sc1
    s_waitcnt vmcnt(1)
    ds_write_b128 v0, v[40:43] offset:4096
    v_max_u32 v34, v40, v42
    v_cmp_eq_u32 vcc, -1, v34
    s_cbranch_vccnz pp_56
ok_57:
redo_58:
    s_waitcnt lgkmcnt(0)
    s_barrier
    ds_read_b128 v[48:51], v0 offset:0
    s_mov_b32 m0, 7168
    s_nop 0
    buffer_load_dwordx4 v0, s[4:7], s86 offen offset:0 sc1 lds
    ds_read_b128 v[52:55], v0 offset:1024
    ds_read_b128 v[56:59], v0 offset:2048
    s_mov_b32 m0, 15872
    s_waitcnt lgkmcnt(2)
    v_smfmac_f32_16x16x64_bf16 v[14:17], v[48:51], a[224:231], v1
    s_waitcnt vmcnt(1)
    ds_read_b128 v[60:63], v4 offset:0
    ds_read_b128 v[64:67], v4 offset:1024
    v_smfmac_f32_16x16x64_bf16 v[22:25], v[48:51], a[232:239], v1
    ds_read_b128 v[68:71], v4 offset:2048
    ds_read_b128 v[72:75], v4 offset:3072
    v_smfmac_f32_16x16x64_bf16 v[18:21], v[48:51], a[144:151], v1
    ds_read_b128 v[10:13], v0 offset:3072
    v_smfmac_f32_16x16x64_bf16 v[26:29], v[48:51], a[152:159], v1
    buffer_store_dwordx4 v[76:79], v0, s[4:7], s72 offen sc1
    s_waitcnt lgkmcnt(5)
    v_smfmac_f32_16x16x64_bf16 v[14:17], v[52:55], a[240:247], v1
    v_smfmac_f32_16x16x64_bf16 v[22:25], v[52:55], a[248:255], v1
    s_waitcnt lgkmcnt(1)
    v_smfmac_f32_16x16x64_bf16 v[18:21], v[52:55], v[60:67], v1
    ds_read_b128 v[60:63], v4 offset:4096
    v_smfmac_f32_16x16x64_bf16 v[26:29], v[52:55], v[68:75], v1
    ds_read_b128 v[64:67], v4 offset:5120
    v_smfmac_f32_16x16x64_bf16 v[18:21], v[56:59], a[160:167], v1
    ds_read_b128 v[68:71], v4 offset:6144
    v_smfmac_f32_16x16x64_bf16 v[26:29], v[56:59], a[168:175], v1
    ds_read_b128 v[72:75], v4 offset:7168
    s_waitcnt vmcnt(1)
    s_barrier
    ds_read_b128 v[48:51], v0 offset:4096
    s_waitcnt lgkmcnt(5)
    v_smfmac_f32_16x16x64_bf16 v[14:17], v[10:13], v[80:87], v1
    ds_read_b128 v[52:55], v0 offset:5120
    v_smfmac_f32_16x16x64_bf16 v[22:25], v[10:13], v[88:95], v1
    ds_read_b128 v[56:59], v0 offset:6144
    s_waitcnt lgkmcnt(5)
    v_smfmac_f32_16x16x64_bf16 v[18:21], v[10:13], v[60:67], v1
    ds_read_b128 v[60:63], v4 offset:8192
    s_waitcnt lgkmcnt(4)
    v_smfmac_f32_16x16x64_bf16 v[26:29], v[10:13], v[68:75], v1
    ds_read_b128 v[64:67], v4 offset:9216
    s_waitcnt lgkmcnt(4)
    v_smfmac_f32_16x16x64_bf16 v[14:17], v[48:51], v[96:103], v1
    ds_read_b128 v[10:13], v0 offset:7168
    v_smfmac_f32_16x16x64_bf16 v[22:25], v[48:51], v[104:111], v1
    ds_read_b128 v[68:71], v4 offset:10240
    v_smfmac_f32_16x16x64_bf16 v[18:21], v[48:51], a[176:183], v1
    ds_read_b128 v[72:75], v4 offset:11264
    v_smfmac_f32_16x16x64_bf16 v[26:29], v[48:51], a[184:191], v1
    s_waitcnt lgkmcnt(3)
    v_smfmac_f32_16x16x64_bf16 v[14:17], v[52:55], v[112:119], v1
    ds_read_b128 v[48:51], v0 offset:8192
    v_smfmac_f32_16x16x64_bf16 v[22:25], v[52:55], v[120:127], v1
    v_smfmac_f32_16x16x64_bf16 v[18:21], v[52:55], v[60:67], v1
    ds_read_b128 v[60:63], v4 offset:12288
    s_waitcnt lgkmcnt(2)
    v_smfmac_f32_16x16x64_bf16 v[26:29], v[52:55], v[68:75], v1
    ds_read_b128 v[64:67], v4 offset:13312
    v_smfmac_f32_16x16x64_bf16 v[14:17], v[56:59], v[128:135], v1
    ds_read_b128 v[68:71], v4 offset:14336
    v_smfmac_f32_16x16x64_bf16 v[22:25], v[56:59], v[136:143], v1
    ds_read_b128 v[72:75], v4 offset:15360
    v_smfmac_f32_16x16x64_bf16 v[18:21], v[56:59], a[192:199], v1
    v_smfmac_f32_16x16x64_bf16 v[26:29], v[56:59], a[200:207], v1
    v_smfmac_f32_16x16x64_bf16 v[14:17], v[10:13], v[144:151], v1
    v_smfmac_f32_16x16x64_bf16 v[22:25], v[10:13], v[152:159], v1
    s_waitcnt lgkmcnt(0)
    v_smfmac_f32_16x16x64_bf16 v[18:21], v[10:13], v[60:67], v1
    ds_read_b128 v[60:63], v4 offset:16384
    v_smfmac_f32_16x16x64_bf16 v[26:29], v[10:13], v[68:75], v1
    ds_read_b128 v[64:67], v4 offset:17408
    v_smfmac_f32_16x16x64_bf16 v[14:17], v[48:51], v[160:167], v1
    ds_read_b128 v[10:13], v0 offset:2048
    v_smfmac_f32_16x16x64_bf16 v[22:25], v[48:51], v[168:175], v1
    ds_read_b128 v[68:71], v4 offset:18432
    v_smfmac_f32_16x16x64_bf16 v[18:21], v[48:51], a[208:215], v1
    ds_read_b128 v[72:75], v4 offset:19456
    v_smfmac_f32_16x16x64_bf16 v[26:29], v[48:51], a[216:223], v1
    s_waitcnt lgkmcnt(2)
    v_smfmac_f32_16x16x64_bf16 v[14:17], v[10:13], v[60:67], v1
    s_waitcnt lgkmcnt(0)
    v_smfmac_f32_16x16x64_bf16 v[22:25], v[10:13], v[68:75], v1
    v_add_f32 v18, v18, v20
    v_add_f32 v19, v19, v21
    v_cvt_pk_bf16_f32 v77, v18, v19
    v_add_f32 v26, v26, v28
    v_add_f32 v27, v27, v29
    v_cvt_pk_bf16_f32 v79, v26, v27
    v_add_f32 v14, v14, v16
    v_add_f32 v15, v15, v17
    v_cvt_pk_bf16_f32 v76, v14, v15
    v_add_f32 v22, v22, v24
    v_add_f32 v23, v23, v25
    v_cvt_pk_bf16_f32 v78, v22, v23
    v_cmp_u_f32 s[74:75], v26, v27
    v_min_u32 v76, -2, v76
    s_cmp_lg_u64 s[74:75], 0
    s_cbranch_scc1 nan_59
back_60:
    s_add_u32 s23, s23, 131072
    buffer_store_dwordx4 v[76:79], v0, s[4:7], s23 offen sc1
    s_branch done
pp_56:
    buffer_load_dwordx4 v[40:43], v0, s[4:7], s38 offen offset:0 sc1
    s_add_u32 s41, s41, 1
    s_cmp_gt_u32 s41, 2000000
    s_cbranch_scc1 fin1
    s_waitcnt vmcnt(1)
    ds_write_b128 v0, v[60:63] offset:4096
    v_max_u32 v34, v60, v62
    v_cmp_eq_u32 vcc, -1, v34
    s_cbranch_vccz ok_57
    buffer_load_dwordx4 v[60:63], v0, s[4:7], s38 offen offset:0 sc1
    s_add_u32 s41, s41, 1
    s_waitcnt vmcnt(1)
    ds_write_b128 v0, v[40:43] offset:4096
    v_max_u32 v34, v40, v42
    v_cmp_eq_u32 vcc, -1, v34
    s_cbranch_vccnz pp_56
    s_branch ok_57
nan_59:
    v_mov_b32 v34, 0
    ds_read_b32 v35, v0 offset:4096
    s_waitcnt lgkmcnt(0)
    v_max_u32 v34, v34, v35
    ds_read_b32 v35, v0 offset:4104
    s_waitcnt lgkmcnt(0)
    v_max_u32 v34, v34, v35
    ds_read_b32 v35, v0 offset:5120
    s_waitcnt lgkmcnt(0)
    v_max_u32 v34, v34, v35
    ds_read_b32 v35, v0 offset:5128
    s_waitcnt lgkmcnt(0)
    v_max_u32 v34, v34, v35
    ds_read_b32 v35, v0 offset:6144
    s_waitcnt lgkmcnt(0)
    v_max_u32 v34, v34, v35
    ds_read_b32 v35, v0 offset:6152
    s_waitcnt lgkmcnt(0)
    v_max_u32 v34, v34, v35
    ds_read_b32 v35, v0 offset:7168
    s_waitcnt lgkmcnt(0)
    v_max_u32 v34, v34, v35
    ds_read_b32 v35, v0 offset:7176
    s_waitcnt lgkmcnt(0)
    v_max_u32 v34, v34, v35
    ds_read_b32 v35, v0 offset:8192
    s_waitcnt lgkmcnt(0)
    v_max_u32 v34, v34, v35
    ds_read_b32 v35, v0 offset:8200
    s_waitcnt lgkmcnt(0)
    v_max_u32 v34, v34, v35
    v_cmp_eq_u32 s[74:75], -1, v34
    s_nop 0
    s_cmp_eq_u64 s[74:75], 0
    s_cbranch_scc1 back_60
    s_add_u32 s76, s76, 1
    s_cmp_gt_u32 s76, 2000000
    s_cbranch_scc1 fin1
    s_mov_b32 s72, 100662272
    v_mov_b64 v[14:15], 0
    v_mov_b64 v[16:17], 0
    v_mov_b64 v[18:19], 0
    v_mov_b64 v[20:21], 0
    v_mov_b64 v[22:23], 0
    v_mov_b64 v[24:25], 0
    v_mov_b64 v[26:27], 0
    v_mov_b64 v[28:29], 0
    s_waitcnt vmcnt(0)
    s_barrier
    s_branch redo_58
pp_48:
    buffer_load_dwordx4 v[40:43], v0, s[4:7], s38 offen offset:0 sc1
    s_add_u32 s41, s41, 1
    s_cmp_gt_u32 s41, 2000000
    s_cbranch_scc1 fin1
    s_waitcnt vmcnt(1)
    ds_write_b128 v0, v[60:63] offset:4096
    v_max_u32 v34, v60, v62
    v_cmp_eq_u32 vcc, -1, v34
    s_cbranch_vccz ok_49
    buffer_load_dwordx4 v[60:63], v0, s[4:7], s38 offen offset:0 sc1
    s_add_u32 s41, s41, 1
    s_waitcnt vmcnt(1)
    ds_write_b128 v0, v[40:43] offset:4096
    v_max_u32 v34, v40, v42
    v_cmp_eq_u32 vcc, -1, v34
    s_cbranch_vccnz pp_48
    s_branch ok_49
nan_51:
    v_mov_b32 v34, 0
    ds_read_b32 v35, v0 offset:4096
    s_waitcnt lgkmcnt(0)
    v_max_u32 v34, v34, v35
    ds_read_b32 v35, v0 offset:4104
    s_waitcnt lgkmcnt(0)
    v_max_u32 v34, v34, v35
    ds_read_b32 v35, v0 offset:5120
    s_waitcnt lgkmcnt(0)
    v_max_u32 v34, v34, v35
    ds_read_b32 v35, v0 offset:5128
    s_waitcnt lgkmcnt(0)
    v_max_u32 v34, v34, v35
    ds_read_b32 v35, v0 offset:6144
    s_waitcnt lgkmcnt(0)
    v_max_u32 v34, v34, v35
    ds_read_b32 v35, v0 offset:6152
    s_waitcnt lgkmcnt(0)
    v_max_u32 v34, v34, v35
    ds_read_b32 v35, v0 offset:7168
    s_waitcnt lgkmcnt(0)
    v_max_u32 v34, v34, v35
    ds_read_b32 v35, v0 offset:7176
    s_waitcnt lgkmcnt(0)
    v_max_u32 v34, v34, v35
    ds_read_b32 v35, v0 offset:8192
    s_waitcnt lgkmcnt(0)
    v_max_u32 v34, v34, v35
    ds_read_b32 v35, v0 offset:8200
    s_waitcnt lgkmcnt(0)
    v_max_u32 v34, v34, v35
    v_cmp_eq_u32 s[74:75], -1, v34
    s_nop 0
    s_cmp_eq_u64 s[74:75], 0
    s_cbranch_scc1 back_52
    s_add_u32 s76, s76, 1
    s_cmp_gt_u32 s76, 2000000
    s_cbranch_scc1 fin1
    s_mov_b32 s72, 100662272
    v_mov_b64 v[14:15], 0
    v_mov_b64 v[16:17], 0
    v_mov_b64 v[18:19], 0
    v_mov_b64 v[20:21], 0
    v_mov_b64 v[22:23], 0
    v_mov_b64 v[24:25], 0
    v_mov_b64 v[26:27], 0
    v_mov_b64 v[28:29], 0
    s_waitcnt vmcnt(0)
    s_barrier
    s_branch redo_50
pp_53:
    buffer_load_dwordx4 v[34:37], v7, s[4:7], s24 offen sc1
    s_add_u32 s41, s41, 1
    s_cmp_gt_u32 s41, 2000000
    s_cbranch_scc1 fin1
    s_waitcnt vmcnt(0)
    v_mfma_f32_16x16x32_bf16 v[50:53], v[10:13], v[34:37], 0
    v_bitop3_b32 v58, v34, v35, s46 bitop3:0x7e
    v_bitop3_b32 v59, v36, v37, s46 bitop3:0x7e
    v_or_b32 v58, v58, v59
    v_and_b32 v58, 1, v58
    v_cmp_ne_u32 vcc, 0, v58
    s_cbranch_vccnz pp_53
    s_branch ok_54
role_22:
.p2align 6
step_61:
    s_mov_b32 s41, 0
    s_add_u32 s86, s17, 8192
    s_mov_b32 m0, 8192
    s_mov_b32 s72, s23
    s_mov_b32 s76, 0
    s_sub_u32 s44, s16, 1
    s_max_i32 s44, s44, 0
    v_mov_b64 v[14:15], 0
    v_mov_b64 v[16:17], 0
    v_mov_b64 v[18:19], 0
    v_mov_b64 v[20:21], 0
    v_mov_b64 v[22:23], 0
    v_mov_b64 v[24:25], 0
    v_mov_b64 v[26:27], 0
    v_mov_b64 v[28:29], 0
    s_nop 9
    buffer_load_dwordx4 v[40:43], v0, s[4:7], s17 offen offset:2048 sc1
    buffer_load_dwordx4 v[44:47], v0, s[4:7], s17 offen offset:3072 sc1
    s_nop 15
    s_nop 7
    buffer_load_dwordx4 v[60:63], v0, s[4:7], s17 offen offset:2048 sc1
    buffer_load_dwordx4 v[64:67], v0, s[4:7], s17 offen offset:3072 sc1
    s_waitcnt vmcnt(3)
    ds_write_b128 v0, v[40:43] offset:2048
    v_max_u32 v34, v40, v42
    s_waitcnt vmcnt(2)
    ds_write_b128 v0, v[44:47] offset:3072
    v_max3_u32 v34, v34, v44, v46
    v_cmp_eq_u32 vcc, -1, v34
    s_cbranch_vccnz pp_62
ok_63:
redo_64:
    v_mov_b32 v35, s44
    s_waitcnt lgkmcnt(0)
    s_barrier
    ds_read_b128 v[48:51], v0 offset:0
    buffer_load_dwordx4 v0, s[4:7], s86 offen offset:0 sc1 lds
    ds_read_b128 v[52:55], v0 offset:1024
    ds_read_b128 v[56:59], v0 offset:2048
    s_waitcnt lgkmcnt(2)
    v_smfmac_f32_16x16x64_bf16 v[14:17], v[48:51], a[0:7], v1
    s_waitcnt vmcnt(1)
    ds_read_b128 v[60:63], v4 offset:0
    ds_read_b128 v[64:67], v4 offset:1024
    v_smfmac_f32_16x16x64_bf16 v[22:25], v[48:51], a[8:15], v1
    ds_read_b128 v[68:71], v4 offset:2048
    ds_read_b128 v[72:75], v4 offset:3072
    v_smfmac_f32_16x16x64_bf16 v[18:21], v[48:51], a[144:151], v1
    ds_read_b128 v[10:13], v0 offset:3072
    v_smfmac_f32_16x16x64_bf16 v[26:29], v[48:51], a[152:159], v1
    ds_read_b128 v[48:51], v0 offset:4096
    s_waitcnt lgkmcnt(6)
    v_smfmac_f32_16x16x64_bf16 v[14:17], v[52:55], a[16:23], v1
    buffer_load_dwordx4 v[40:43], v9, s[4:7], s21 offen sc1 nt
    v_smfmac_f32_16x16x64_bf16 v[22:25], v[52:55], a[24:31], v1
    buffer_load_dwordx4 v[44:47], v9, s[4:7], s21 offen offset:256 sc1 nt
    s_waitcnt lgkmcnt(2)
    v_smfmac_f32_16x16x64_bf16 v[18:21], v[52:55], v[60:67], v1
    ds_read_b128 v[60:63], v4 offset:4096
    v_smfmac_f32_16x16x64_bf16 v[26:29], v[52:55], v[68:75], v1
    ds_read_b128 v[64:67], v4 offset:5120
    v_smfmac_f32_16x16x64_bf16 v[14:17], v[56:59], a[32:39], v1
    ds_read_b128 v[68:71], v4 offset:6144
    v_smfmac_f32_16x16x64_bf16 v[22:25], v[56:59], a[40:47], v1
    ds_read_b128 v[72:75], v4 offset:7168
    v_smfmac_f32_16x16x64_bf16 v[18:21], v[56:59], a[160:167], v1
    buffer_load_dwordx4 v[30:33], v9, s[4:7], s22 offen sc1 nt
    v_smfmac_f32_16x16x64_bf16 v[26:29], v[56:59], a[168:175], v1
    buffer_load_dwordx4 v[36:39], v9, s[4:7], s22 offen offset:256 sc1 nt
    s_waitcnt lgkmcnt(2)
    v_smfmac_f32_16x16x64_bf16 v[14:17], v[10:13], a[48:55], v1
    v_smfmac_f32_16x16x64_bf16 v[22:25], v[10:13], a[56:63], v1
    v_smfmac_f32_16x16x64_bf16 v[18:21], v[10:13], v[60:67], v1
    ds_read_b128 v[60:63], v4 offset:8192
    s_waitcnt lgkmcnt(1)
    v_smfmac_f32_16x16x64_bf16 v[26:29], v[10:13], v[68:75], v1
    ds_read_b128 v[64:67], v4 offset:9216
    v_smfmac_f32_16x16x64_bf16 v[14:17], v[48:51], a[64:71], v1
    ds_read_b128 v[68:71], v4 offset:10240
    s_waitcnt vmcnt(4)
    s_barrier
    ds_read_b128 v[52:55], v0 offset:5120
    v_smfmac_f32_16x16x64_bf16 v[22:25], v[48:51], a[72:79], v1
    ds_read_b128 v[56:59], v0 offset:6144
    v_smfmac_f32_16x16x64_bf16 v[18:21], v[48:51], a[176:183], v1
    ds_read_b128 v[10:13], v0 offset:7168
    v_smfmac_f32_16x16x64_bf16 v[26:29], v[48:51], a[184:191], v1
    ds_read_b128 v[72:75], v4 offset:11264
    s_waitcnt lgkmcnt(3)
    v_smfmac_f32_16x16x64_bf16 v[14:17], v[52:55], a[80:87], v1
    ds_read_b128 v[48:51], v0 offset:8192
    v_smfmac_f32_16x16x64_bf16 v[22:25], v[52:55], a[88:95], v1
    buffer_store_dwordx4 v[76:79], v0, s[4:7], s72 offen sc1
    v_smfmac_f32_16x16x64_bf16 v[18:21], v[52:55], v[60:67], v1
    ds_read_b128 v[60:63], v4 offset:12288
    s_waitcnt lgkmcnt(2)
    v_smfmac_f32_16x16x64_bf16 v[26:29], v[52:55], v[68:75], v1
    ds_read_b128 v[64:67], v4 offset:13312
    v_smfmac_f32_16x16x64_bf16 v[14:17], v[56:59], a[96:103], v1
    ds_read_b128 v[68:71], v4 offset:14336
    v_smfmac_f32_16x16x64_bf16 v[22:25], v[56:59], a[104:111], v1
    ds_read_b128 v[72:75], v4 offset:15360
    v_smfmac_f32_16x16x64_bf16 v[18:21], v[56:59], a[192:199], v1
    ds_read_b128 v[52:55], v0 offset:0
    v_smfmac_f32_16x16x64_bf16 v[26:29], v[56:59], a[200:207], v1
    ds_read_b128 v[56:59], v0 offset:1024
    s_mov_b64 vcc, s[34:35]
    v_smfmac_f32_16x16x64_bf16 v[14:17], v[10:13], a[112:119], v1
    buffer_load_dword v8, off, s[4:7], s32 sc1
    s_waitcnt lgkmcnt(3)
    v_smfmac_f32_16x16x64_bf16 v[14:17], v[48:51], a[128:135], v1
    buffer_store_dword v35, v7, s[4:7], s58 offen sc1
    v_smfmac_f32_16x16x64_bf16 v[18:21], v[48:51], a[208:215], v1
    v_smfmac_f32_16x16x64_bf16 v[18:21], v[10:13], v[60:67], v1
    ds_read_b128 v[60:63], v4 offset:16384
    v_add_f32 v14, v14, v16
    v_smfmac_f32_16x16x64_bf16 v[22:25], v[48:51], a[136:143], v1
    ds_read_b128 v[64:67], v4 offset:17408
    v_add_f32 v15, v15, v17
    v_cvt_pk_bf16_f32 v76, v14, v15
    v_smfmac_f32_16x16x64_bf16 v[22:25], v[10:13], a[120:127], v1
    v_add_f32 v18, v18, v20
    v_add_f32 v19, v19, v21
    v_smfmac_f32_16x16x64_bf16 v[26:29], v[48:51], a[216:223], v1
    v_cvt_pk_bf16_f32 v77, v18, v19
    v_mov_b64 v[14:15], 0
    s_waitcnt lgkmcnt(2)
    v_smfmac_f32_16x16x64_bf16 v[26:29], v[10:13], v[68:75], v1
    ds_read_b128 v[68:71], v4 offset:18432
    v_mov_b64 v[16:17], 0
    v_mfma_f32_16x16x16_bf16 v[18:21], v[76:77], v[2:3], 0
    v_add_f32 v22, v22, v24
    v_add_f32 v23, v23, v25
    v_cvt_pk_bf16_f32 v78, v22, v23
    ds_read_b128 v[72:75], v4 offset:19456
    v_add_f32 v26, v26, v28
    v_add_f32 v27, v27, v29
    v_cvt_pk_bf16_f32 v79, v26, v27
    v_cmp_u_f32 s[74:75], v22, v23
    v_cvt_pk_bf16_f32 v22, v18, v19
    v_mfma_f32_16x16x16_bf16 v[26:29], v[78:79], v[2:3], 0
    v_cvt_pk_bf16_f32 v23, v20, v21
    v_mov_b64 v[18:19], 0
    v_smfmac_f32_16x16x64_bf16 v[14:17], v[52:55], a[224:231], v1
    ds_read_b128 v[10:13], v0 offset:2048
    v_mov_b64 v[20:21], 0
    v_smfmac_f32_16x16x64_bf16 v[14:17], v[56:59], a[240:247], v1
    ds_read_b128 v[48:51], v0 offset:3072
    v_cvt_pk_bf16_f32 v24, v26, v27
    v_cvt_pk_bf16_f32 v25, v28, v29
    s_waitcnt vmcnt(5)
    s_nop 0
    v_mfma_f32_16x16x32_bf16 v[40:43], v[40:43], v[22:25], 0
    v_mfma_f32_16x16x32_bf16 v[44:47], v[44:47], v[22:25], 0
    s_cmp_lg_u64 s[74:75], 0
    v_mfma_f32_16x16x32_bf16 v[26:29], v[22:25], v[22:25], 0
    s_cbranch_scc1 nan_65
back_66:
    v_smfmac_f32_16x16x64_bf16 v[18:21], v[52:55], a[232:239], v1
    ds_read_b128 v[52:55], v0 offset:4096
    v_cndmask_b32_dpp v40, v44, v40, vcc quad_perm:[0,1,0,1] row_mask:0xf bank_mask:0xf
    v_cndmask_b32_dpp v41, v45, v41, vcc quad_perm:[0,1,0,1] row_mask:0xf bank_mask:0xf
    v_cndmask_b32_dpp v42, v46, v42, vcc quad_perm:[0,1,0,1] row_mask:0xf bank_mask:0xf
    v_cndmask_b32_dpp v43, v47, v43, vcc quad_perm:[0,1,0,1] row_mask:0xf bank_mask:0xf
    ds_write_b128 v5, v[40:43] offset:12288
    v_cndmask_b32_dpp v28, v29, v28, vcc quad_perm:[0,1,0,1] row_mask:0xf bank_mask:0xf
    ds_write_b32 v5, v28 offset:13324
    v_smfmac_f32_16x16x64_bf16 v[18:21], v[56:59], a[248:255], v1
    ds_read_b128 v[56:59], v0 offset:5120
    v_mov_b32 v42, 0
    s_waitcnt lgkmcnt(4)
    v_smfmac_f32_16x16x64_bf16 v[14:17], v[10:13], v[60:67], v1
    v_mov_b32 v47, 0
    v_smfmac_f32_16x16x64_bf16 v[18:21], v[10:13], v[68:75], v1
    ds_read_b128 v[10:13], v0 offset:6144
    v_mov_b32 v28, 0
    v_smfmac_f32_16x16x64_bf16 v[14:17], v[48:51], v[80:87], v1
    v_mov_b32 v41, 0
    v_smfmac_f32_16x16x64_bf16 v[18:21], v[48:51], v[88:95], v1
    ds_read_b128 v[48:51], v0 offset:7168
    s_waitcnt lgkmcnt(3)
    s_barrier
    ds_read_b128 v[60:63], v0 offset:9216
    v_smfmac_f32_16x16x64_bf16 v[14:17], v[52:55], v[96:103], v1
    ds_read_b128 v[64:67], v0 offset:10240
    v_smfmac_f32_16x16x64_bf16 v[18:21], v[52:55], v[104:111], v1
    ds_read_b128 v[68:71], v0 offset:11264
    s_waitcnt lgkmcnt(4)
    v_smfmac_f32_16x16x64_bf16 v[14:17], v[56:59], v[112:119], v1
    ds_read_b128 v[72:75], v0 offset:12288
    v_smfmac_f32_16x16x64_bf16 v[18:21], v[56:59], v[120:127], v1
    ds_read_b128 v[22:25], v0 offset:13312
    v_smfmac_f32_16x16x64_bf16 v[14:17], v[10:13], v[128:135], v1
    ds_read_b128 v[52:55], v0 offset:8192
    s_waitcnt lgkmcnt(4)
    v_add_f32 v60, v60, v64
    v_smfmac_f32_16x16x64_bf16 v[18:21], v[10:13], v[136:143], v1
    v_add_f32 v61, v61, v65
    v_smfmac_f32_16x16x64_bf16 v[14:17], v[48:51], v[144:151], v1
    v_add_f32 v62, v62, v66
    v_smfmac_f32_16x16x64_bf16 v[18:21], v[48:51], v[152:159], v1
    v_add_f32 v63, v63, v67
    s_waitcnt lgkmcnt(0)
    v_smfmac_f32_16x16x64_bf16 v[14:17], v[52:55], v[160:167], v1
    v_add_f32 v22, v22, v23
    v_smfmac_f32_16x16x64_bf16 v[18:21], v[52:55], v[168:175], v1
    v_add_f32 v24, v24, v25
    v_add_f32 v22, v22, v24
    v_add_f32 v68, v68, v72
    v_add_f32 v69, v69, v73
    v_pk_add_f32 v[70:71], v[70:71], v[74:75]
    v_pk_add_f32 v[60:61], v[60:61], v[68:69]
    v_pk_add_f32 v[62:63], v[62:63], v[70:71]
    v_max3_f32 v24, v60, v61, v22
    v_max3_f32 v24, v24, v62, v63
    v_pk_add_f32 v[14:15], v[14:15], v[16:17]
    v_pk_add_f32 v[18:19], v[18:19], v[20:21]
    v_max_f32_dpp v25, v24, v24 row_ror:8 row_mask:0xf bank_mask:0xf
    v_max_f32_dpp v24, v24, v24 row_ror:8 row_mask:0xf bank_mask:0xf
    v_cvt_pk_bf16_f32 v29, v14, v15
    v_cvt_pk_bf16_f32 v35, v18, v19
    v_permlane16_swap_b32 v24, v25
    v_max_f32 v23, v24, v25
    v_max_f32 v24, v24, v25
    v_lshrrev_b32 v34, 16, v29
    v_lshrrev_b32 v40, 16, v35
    v_permlane32_swap_b32 v24, v23
    v_max_f32 v24, v24, v23
    v_sub_f32 v22, v22, v24
    v_pk_add_f32 v[60:61], v[60:61], v[24:25] op_sel_hi:[1,0] neg_lo:[0,1] neg_hi:[0,1]
    v_pk_add_f32 v[62:63], v[62:63], v[24:25] op_sel_hi:[1,0] neg_lo:[0,1] neg_hi:[0,1]
    v_mul_f32 v22, s40, v22
    v_pk_mul_f32 v[60:61], v[60:61], s[2:3]
    v_pk_mul_f32 v[62:63], v[62:63], s[2:3]
    v_exp_f32 v22, v22
    v_exp_f32 v60, v60
    v_exp_f32 v61, v61
    v_exp_f32 v62, v62
    v_exp_f32 v63, v63
    v_cvt_pk_bf16_f32 v46, v22, 0
    v_cvt_pk_bf16_f32 v44, v60, v61
    v_cvt_pk_bf16_f32 v45, v62, v63
    v_cvt_pk_bf16_f32 v43, v22, 0
    s_waitcnt vmcnt(3)
    v_mfma_f32_16x16x32_bf16 v[64:67], v[32:35], v[44:47], 0
    v_mov_b64 v[48:49], s[36:37]
    v_mov_b64 v[50:51], s[36:37]
    v_mfma_f32_16x16x32_bf16 v[60:63], v[28:31], v[42:45], 0
    v_min_u32 v76, -2, v29
    v_mov_b32 v78, v35
    v_mfma_f32_16x16x32_bf16 v[52:55], v[48:51], v[42:45], 0
    v_mov_b64 v[14:15], 0
    v_mov_b64 v[16:17], 0
    v_mfma_f32_16x16x32_bf16 v[68:71], v[34:37], v[42:45], 0
    v_add_f32_dpp v56, v64, v60 row_ror:8 row_mask:0xf bank_mask:0x3
    v_add_f32_dpp v57, v65, v61 row_ror:8 row_mask:0xf bank_mask:0x3
    v_mfma_f32_16x16x32_bf16 v[72:75], v[38:41], v[44:47], 0
    v_add_f32_dpp v50, v52, v52 row_ror:8 row_mask:0xf bank_mask:0xf
    v_add_f32_dpp v58, v66, v62 row_ror:8 row_mask:0xf bank_mask:0x3
    v_add_f32_dpp v59, v67, v63 row_ror:8 row_mask:0xf bank_mask:0x3
    v_rcp_f32 v50, v50
    v_and_b32 v10, 0xffffffdf, v0
    v_lshrrev_b32 v11, 2, v0
    v_mov_b64 v[18:19], 0
    v_mov_b64 v[20:21], 0
    v_add_f32_dpp v56, v68, v72 row_ror:8 row_mask:0xf bank_mask:0xc
    v_add_f32_dpp v57, v69, v73 row_ror:8 row_mask:0xf bank_mask:0xc
    v_add_f32_dpp v58, v70, v74 row_ror:8 row_mask:0xf bank_mask:0xc
    v_add_f32_dpp v59, v71, v75 row_ror:8 row_mask:0xf bank_mask:0xc
    v_pk_mul_f32 v[56:57], v[56:57], v[50:51] op_sel_hi:[1,0]
    v_pk_mul_f32 v[58:59], v[58:59], v[50:51] op_sel_hi:[1,0]
    v_cvt_pk_bf16_f32 v56, v56, v57
    v_cvt_pk_bf16_f32 v57, v58, v59
    ds_write_b64 v6, v[56:57] offset:1536
    v_mfma_f32_16x16x32_bf16 v[22:25], v[14:17], v[14:17], 0
    ds_read_b128 v[60:63], v4 offset:20480
    ds_read_b128 v[64:67], v4 offset:21504
    ds_read_b128 v[68:71], v4 offset:24576
    ds_read_b128 v[72:75], v4 offset:25600
    v_mfma_f32_16x16x32_bf16 v[26:29], v[14:17], v[14:17], 0
    s_waitcnt lgkmcnt(4)
    s_barrier
    ds_read_b128 v[42:45], v10 offset:0
    ds_read_b128 v[50:53], v10 offset:1024
    v_mfma_f32_16x16x32_bf16 v[30:33], v[14:17], v[14:17], 0
    ds_read_b128 v[34:37], v0 offset:0
    ds_read_b128 v[46:49], v10 offset:32
    s_waitcnt lgkmcnt(3)
    v_smfmac_f32_16x16x64_bf16 v[18:21], v[42:45], v[176:183], v1
    ds_read_b128 v[38:41], v0 offset:1024
    v_smfmac_f32_16x16x64_bf16 v[22:25], v[42:45], v[192:199], v1
    ds_read_b128 v[54:57], v10 offset:1056
    s_waitcnt lgkmcnt(4)
    v_smfmac_f32_16x16x64_bf16 v[18:21], v[50:53], v[60:67], v1
    ds_read_b128 v[60:63], v4 offset:22528
    v_smfmac_f32_16x16x64_bf16 v[22:25], v[50:53], v[68:75], v1
    ds_read_b128 v[64:67], v4 offset:23552
    s_waitcnt lgkmcnt(4)
    v_smfmac_f32_16x16x64_bf16 v[14:17], v[34:37], v[240:247], v1
    ds_read_b128 v[68:71], v4 offset:26624
    v_smfmac_f32_16x16x64_bf16 v[18:21], v[46:49], v[184:191], v1
    ds_read_b128 v[72:75], v4 offset:27648
    s_waitcnt lgkmcnt(4)
    v_smfmac_f32_16x16x64_bf16 v[14:17], v[38:41], v[248:255], v1
    ds_read_b128 v[34:37], v4 offset:28672
    v_smfmac_f32_16x16x64_bf16 v[22:25], v[46:49], v[200:207], v1
    ds_read_b128 v[38:41], v4 offset:29696
    s_waitcnt lgkmcnt(4)
    v_smfmac_f32_16x16x64_bf16 v[18:21], v[54:57], v[60:67], v1
    ds_read_b128 v[60:63], v4 offset:30720
    v_add_f32 v14, v14, v16
    v_add_f32 v15, v15, v17
    s_waitcnt lgkmcnt(3)
    v_smfmac_f32_16x16x64_bf16 v[22:25], v[54:57], v[68:75], v1
    ds_read_b128 v[64:67], v4 offset:31744
    v_cvt_pk_bf16_f32 v58, v14, v15
    v_and_or_b32 v58, v58, -2, s46
    buffer_store_dword v58, v11, s[4:7], s20 offen
    v_smfmac_f32_16x16x64_bf16 v[26:29], v[42:45], v[208:215], v1
    ds_read_b128 v[68:71], v4 offset:32768
    v_cvt_pk_bf16_f32 v18, v18, v19
    v_cvt_pk_bf16_f32 v19, v20, v21
    v_and_or_b32 v18, v18, -2, s46
    v_smfmac_f32_16x16x64_bf16 v[26:29], v[46:49], v[216:223], v1
    ds_read_b128 v[72:75], v4 offset:33792
    v_cvt_pk_bf16_f32 v20, v22, v23
    v_cvt_pk_bf16_f32 v21, v24, v25
    buffer_store_dwordx4 v[18:21], v0, s[4:7], s18 offen
    s_waitcnt lgkmcnt(4)
    v_smfmac_f32_16x16x64_bf16 v[26:29], v[50:53], v[34:41], v1
    ds_read_b128 v[34:37], v4 offset:34816
    v_smfmac_f32_16x16x64_bf16 v[30:33], v[42:45], v[224:231], v1
    ds_read_b128 v[38:41], v4 offset:35840
    s_waitcnt lgkmcnt(4)
    v_smfmac_f32_16x16x64_bf16 v[26:29], v[54:57], v[60:67], v1
    s_waitcnt lgkmcnt(2)
    v_smfmac_f32_16x16x64_bf16 v[30:33], v[50:53], v[68:75], v1
    v_smfmac_f32_16x16x64_bf16 v[30:33], v[46:49], v[232:239], v1
    v_cvt_pk_bf16_f32 v26, v26, v27
    v_cvt_pk_bf16_f32 v27, v28, v29
    s_waitcnt lgkmcnt(0)
    v_smfmac_f32_16x16x64_bf16 v[30:33], v[54:57], v[34:41], v1
    v_and_or_b32 v26, v26, -2, s46
    s_nop 6
    v_cvt_pk_bf16_f32 v28, v30, v31
    v_cvt_pk_bf16_f32 v29, v32, v33
    buffer_store_dwordx4 v[26:29], v0, s[4:7], s19 offen
    s_xor_b32 s18, s18, 0x100000
    s_xor_b32 s19, s19, 0x100000
    s_xor_b32 s20, s20, 0x100000
    s_add_u32 s17, s17, 0x4000
    s_and_b32 s17, s17, 0xfffeffff
    s_add_u32 s21, s21, 262144
    s_add_u32 s22, s22, 262144
    s_add_u32 s23, s23, 131072
    s_waitcnt vmcnt(0)
    v_readfirstlane_b32 s42, v8
    s_cmp_ge_u32 s16, 61
    s_cselect_b32 s39, 0, s39
    s_cmp_lt_u32 s42, s39
    s_cbranch_scc1 nr_67
rk_68:
    s_add_u32 s32, s32, 16384
    s_add_u32 s33, s33, 1
    s_cmp_eq_u32 s33, 3
    s_cselect_b32 s42, 49152, 0
    s_cselect_b32 s43, 1, 0
    s_cselect_b32 s33, 0, s33
    s_sub_u32 s32, s32, s42
    s_add_u32 s39, s39, s43
    s_sleep 10
    s_and_b32 s42, s16, 1
    s_xor_b32 s46, s46, s42
    s_add_u32 s16, s16, 1
    s_cmp_lt_u32 s16, 63
    s_cbranch_scc1 step_61
step_69:
    s_mov_b32 s41, 0
    s_add_u32 s86, s17, 8192
    s_mov_b32 m0, 8192
    s_mov_b32 s72, s23
    s_mov_b32 s76, 0
    s_sub_u32 s44, s16, 1
    s_max_i32 s44, s44, 0
    v_mov_b64 v[14:15], 0
    v_mov_b64 v[16:17], 0
    v_mov_b64 v[18:19], 0
    v_mov_b64 v[20:21], 0
    v_mov_b64 v[22:23], 0
    v_mov_b64 v[24:25], 0
    v_mov_b64 v[26:27], 0
    v_mov_b64 v[28:29], 0
    s_nop 9
    buffer_load_dwordx4 v[40:43], v0, s[4:7], s17 offen offset:2048 sc1
    buffer_load_dwordx4 v[44:47], v0, s[4:7], s17 offen offset:3072 sc1
    s_nop 15
    s_nop 7
    buffer_load_dwordx4 v[60:63], v0, s[4:7], s17 offen offset:2048 sc1
    buffer_load_dwordx4 v[64:67], v0, s[4:7], s17 offen offset:3072 sc1
    s_waitcnt vmcnt(3)
    ds_write_b128 v0, v[40:43] offset:2048
    v_max_u32 v34, v40, v42
    s_waitcnt vmcnt(2)
    ds_write_b128 v0, v[44:47] offset:3072
    v_max3_u32 v34, v34, v44, v46
    v_cmp_eq_u32 vcc, -1, v34
    s_cbranch_vccnz pp_70
ok_71:
redo_72:
    v_mov_b32 v35, s44
    s_waitcnt lgkmcnt(0)
    s_barrier
    ds_read_b128 v[48:51], v0 offset:0
    buffer_load_dwordx4 v0, s[4:7], s86 offen offset:0 sc1 lds
    ds_read_b128 v[52:55], v0 offset:1024
    ds_read_b128 v[56:59], v0 offset:2048
    s_waitcnt lgkmcnt(2)
    v_smfmac_f32_16x16x64_bf16 v[14:17], v[48:51], a[224:231], v1
    s_waitcnt vmcnt(1)
    ds_read_b128 v[60:63], v4 offset:0
    ds_read_b128 v[64:67], v4 offset:1024
    v_smfmac_f32_16x16x64_bf16 v[22:25], v[48:51], a[232:239], v1
    ds_read_b128 v[68:71], v4 offset:2048
    ds_read_b128 v[72:75], v4 offset:3072
    v_smfmac_f32_16x16x64_bf16 v[18:21], v[48:51], a[144:151], v1
    ds_read_b128 v[10:13], v0 offset:3072
    v_smfmac_f32_16x16x64_bf16 v[26:29], v[48:51], a[152:159], v1
    buffer_store_dwordx4 v[76:79], v0, s[4:7], s72 offen sc1
    s_waitcnt lgkmcnt(5)
    v_smfmac_f32_16x16x64_bf16 v[14:17], v[52:55], a[240:247], v1
    v_smfmac_f32_16x16x64_bf16 v[22:25], v[52:55], a[248:255], v1
    s_waitcnt lgkmcnt(1)
    v_smfmac_f32_16x16x64_bf16 v[18:21], v[52:55], v[60:67], v1
    ds_read_b128 v[60:63], v4 offset:4096
    v_smfmac_f32_16x16x64_bf16 v[26:29], v[52:55], v[68:75], v1
    ds_read_b128 v[64:67], v4 offset:5120
    v_smfmac_f32_16x16x64_bf16 v[18:21], v[56:59], a[160:167], v1
    ds_read_b128 v[68:71], v4 offset:6144
    v_smfmac_f32_16x16x64_bf16 v[26:29], v[56:59], a[168:175], v1
    ds_read_b128 v[72:75], v4 offset:7168
    s_waitcnt vmcnt(1)
    s_barrier
    ds_read_b128 v[48:51], v0 offset:4096
    s_waitcnt lgkmcnt(5)
    v_smfmac_f32_16x16x64_bf16 v[14:17], v[10:13], v[80:87], v1
    ds_read_b128 v[52:55], v0 offset:5120
    v_smfmac_f32_16x16x64_bf16 v[22:25], v[10:13], v[88:95], v1
    ds_read_b128 v[56:59], v0 offset:6144
    s_waitcnt lgkmcnt(5)
    v_smfmac_f32_16x16x64_bf16 v[18:21], v[10:13], v[60:67], v1
    ds_read_b128 v[60:63], v4 offset:8192
    s_waitcnt lgkmcnt(4)
    v_smfmac_f32_16x16x64_bf16 v[26:29], v[10:13], v[68:75], v1
    ds_read_b128 v[64:67], v4 offset:9216
    s_waitcnt lgkmcnt(4)
    v_smfmac_f32_16x16x64_bf16 v[14:17], v[48:51], v[96:103], v1
    ds_read_b128 v[10:13], v0 offset:7168
    v_smfmac_f32_16x16x64_bf16 v[22:25], v[48:51], v[104:111], v1
    ds_read_b128 v[68:71], v4 offset:10240
    v_smfmac_f32_16x16x64_bf16 v[18:21], v[48:51], a[176:183], v1
    ds_read_b128 v[72:75], v4 offset:11264
    v_smfmac_f32_16x16x64_bf16 v[26:29], v[48:51], a[184:191], v1
    s_waitcnt lgkmcnt(3)
    v_smfmac_f32_16x16x64_bf16 v[14:17], v[52:55], v[112:119], v1
    ds_read_b128 v[48:51], v0 offset:8192
    v_smfmac_f32_16x16x64_bf16 v[22:25], v[52:55], v[120:127], v1
    v_smfmac_f32_16x16x64_bf16 v[18:21], v[52:55], v[60:67], v1
    ds_read_b128 v[60:63], v4 offset:12288
    s_waitcnt lgkmcnt(2)
    v_smfmac_f32_16x16x64_bf16 v[26:29], v[52:55], v[68:75], v1
    ds_read_b128 v[64:67], v4 offset:13312
    v_smfmac_f32_16x16x64_bf16 v[14:17], v[56:59], v[128:135], v1
    ds_read_b128 v[68:71], v4 offset:14336
    v_smfmac_f32_16x16x64_bf16 v[22:25], v[56:59], v[136:143], v1
    ds_read_b128 v[72:75], v4 offset:15360
    v_smfmac_f32_16x16x64_bf16 v[18:21], v[56:59], a[192:199], v1
    v_smfmac_f32_16x16x64_bf16 v[26:29], v[56:59], a[200:207], v1
    v_smfmac_f32_16x16x64_bf16 v[14:17], v[10:13], v[144:151], v1
    v_smfmac_f32_16x16x64_bf16 v[22:25], v[10:13], v[152:159], v1
    s_waitcnt lgkmcnt(0)
    v_smfmac_f32_16x16x64_bf16 v[18:21], v[10:13], v[60:67], v1
    ds_read_b128 v[60:63], v4 offset:16384
    v_smfmac_f32_16x16x64_bf16 v[26:29], v[10:13], v[68:75], v1
    ds_read_b128 v[64:67], v4 offset:17408
    v_smfmac_f32_16x16x64_bf16 v[14:17], v[48:51], v[160:167], v1
    ds_read_b128 v[10:13], v0 offset:2048
    v_smfmac_f32_16x16x64_bf16 v[22:25], v[48:51], v[168:175], v1
    ds_read_b128 v[68:71], v4 offset:18432
    v_smfmac_f32_16x16x64_bf16 v[18:21], v[48:51], a[208:215], v1
    ds_read_b128 v[72:75], v4 offset:19456
    v_smfmac_f32_16x16x64_bf16 v[26:29], v[48:51], a[216:223], v1
    s_waitcnt lgkmcnt(2)
    v_smfmac_f32_16x16x64_bf16 v[14:17], v[10:13], v[60:67], v1
    s_waitcnt lgkmcnt(0)
    v_smfmac_f32_16x16x64_bf16 v[22:25], v[10:13], v[68:75], v1
    v_add_f32 v18, v18, v20
    v_add_f32 v19, v19, v21
    v_cvt_pk_bf16_f32 v77, v18, v19
    v_add_f32 v26, v26, v28
    v_add_f32 v27, v27, v29
    v_cvt_pk_bf16_f32 v79, v26, v27
    v_add_f32 v14, v14, v16
    v_add_f32 v15, v15, v17
    v_cvt_pk_bf16_f32 v76, v14, v15
    v_add_f32 v22, v22, v24
    v_add_f32 v23, v23, v25
    v_cvt_pk_bf16_f32 v78, v22, v23
    v_cmp_u_f32 s[74:75], v26, v27
    v_min_u32 v76, -2, v76
    s_cmp_lg_u64 s[74:75], 0
    s_cbranch_scc1 nan_73
back_74:
    s_add_u32 s23, s23, 131072
    buffer_store_dwordx4 v[76:79], v0, s[4:7], s23 offen sc1
    s_branch done
pp_70:
    buffer_load_dwordx4 v[40:43], v0, s[4:7], s17 offen offset:2048 sc1
    buffer_load_dwordx4 v[44:47], v0, s[4:7], s17 offen offset:3072 sc1
    s_add_u32 s41, s41, 1
    s_cmp_gt_u32 s41, 2000000
    s_cbranch_scc1 fin1
    s_waitcnt vmcnt(3)
    ds_write_b128 v0, v[60:63] offset:2048
    v_max_u32 v34, v60, v62
    s_waitcnt vmcnt(2)
    ds_write_b128 v0, v[64:67] offset:3072
    v_max3_u32 v34, v34, v64, v66
    v_cmp_eq_u32 vcc, -1, v34
    s_cbranch_vccz ok_71
    buffer_load_dwordx4 v[60:63], v0, s[4:7], s17 offen offset:2048 sc1
    buffer_load_dwordx4 v[64:67], v0, s[4:7], s17 offen offset:3072 sc1
    s_add_u32 s41, s41, 1
    s_waitcnt vmcnt(3)
    ds_write_b128 v0, v[40:43] offset:2048
    v_max_u32 v34, v40, v42
    s_waitcnt vmcnt(2)
    ds_write_b128 v0, v[44:47] offset:3072
    v_max3_u32 v34, v34, v44, v46
    v_cmp_eq_u32 vcc, -1, v34
    s_cbranch_vccnz pp_70
    s_branch ok_71
nan_73:
    v_mov_b32 v34, 0
    ds_read_b32 v35, v0 offset:4096
    s_waitcnt lgkmcnt(0)
    v_max_u32 v34, v34, v35
    ds_read_b32 v35, v0 offset:4104
    s_waitcnt lgkmcnt(0)
    v_max_u32 v34, v34, v35
    ds_read_b32 v35, v0 offset:5120
    s_waitcnt lgkmcnt(0)
    v_max_u32 v34, v34, v35
    ds_read_b32 v35, v0 offset:5128
    s_waitcnt lgkmcnt(0)
    v_max_u32 v34, v34, v35
    ds_read_b32 v35, v0 offset:6144
    s_waitcnt lgkmcnt(0)
    v_max_u32 v34, v34, v35
    ds_read_b32 v35, v0 offset:6152
    s_waitcnt lgkmcnt(0)
    v_max_u32 v34, v34, v35
    ds_read_b32 v35, v0 offset:7168
    s_waitcnt lgkmcnt(0)
    v_max_u32 v34, v34, v35
    ds_read_b32 v35, v0 offset:7176
    s_waitcnt lgkmcnt(0)
    v_max_u32 v34, v34, v35
    ds_read_b32 v35, v0 offset:8192
    s_waitcnt lgkmcnt(0)
    v_max_u32 v34, v34, v35
    ds_read_b32 v35, v0 offset:8200
    s_waitcnt lgkmcnt(0)
    v_max_u32 v34, v34, v35
    v_cmp_eq_u32 s[74:75], -1, v34
    s_nop 0
    s_cmp_eq_u64 s[74:75], 0
    s_cbranch_scc1 back_74
    s_add_u32 s76, s76, 1
    s_cmp_gt_u32 s76, 2000000
    s_cbranch_scc1 fin1
    s_mov_b32 s72, 100662272
    v_mov_b64 v[14:15], 0
    v_mov_b64 v[16:17], 0
    v_mov_b64 v[18:19], 0
    v_mov_b64 v[20:21], 0
    v_mov_b64 v[22:23], 0
    v_mov_b64 v[24:25], 0
    v_mov_b64 v[26:27], 0
    v_mov_b64 v[28:29], 0
    s_waitcnt vmcnt(0)
    s_barrier
    s_branch redo_72
pp_62:
    buffer_load_dwordx4 v[40:43], v0, s[4:7], s17 offen offset:2048 sc1
    buffer_load_dwordx4 v[44:47], v0, s[4:7], s17 offen offset:3072 sc1
    s_add_u32 s41, s41, 1
    s_cmp_gt_u32 s41, 2000000
    s_cbranch_scc1 fin1
    s_waitcnt vmcnt(3)
    ds_write_b128 v0, v[60:63] offset:2048
    v_max_u32 v34, v60, v62
    s_waitcnt vmcnt(2)
    ds_write_b128 v0, v[64:67] offset:3072
    v_max3_u32 v34, v34, v64, v66
    v_cmp_eq_u32 vcc, -1, v34
    s_cbranch_vccz ok_63
    buffer_load_dwordx4 v[60:63], v0, s[4:7], s17 offen offset:2048 sc1
    buffer_load_dwordx4 v[64:67], v0, s[4:7], s17 offen offset:3072 sc1
    s_add_u32 s41, s41, 1
    s_waitcnt vmcnt(3)
    ds_write_b128 v0, v[40:43] offset:2048
    v_max_u32 v34, v40, v42
    s_waitcnt vmcnt(2)
    ds_write_b128 v0, v[44:47] offset:3072
    v_max3_u32 v34, v34, v44, v46
    v_cmp_eq_u32 vcc, -1, v34
    s_cbranch_vccnz pp_62
    s_branch ok_63
nan_65:
    v_mov_b32 v34, 0
    ds_read_b32 v35, v0 offset:4096
    s_waitcnt lgkmcnt(0)
    v_max_u32 v34, v34, v35
    ds_read_b32 v35, v0 offset:4104
    s_waitcnt lgkmcnt(0)
    v_max_u32 v34, v34, v35
    ds_read_b32 v35, v0 offset:5120
    s_waitcnt lgkmcnt(0)
    v_max_u32 v34, v34, v35
    ds_read_b32 v35, v0 offset:5128
    s_waitcnt lgkmcnt(0)
    v_max_u32 v34, v34, v35
    ds_read_b32 v35, v0 offset:6144
    s_waitcnt lgkmcnt(0)
    v_max_u32 v34, v34, v35
    ds_read_b32 v35, v0 offset:6152
    s_waitcnt lgkmcnt(0)
    v_max_u32 v34, v34, v35
    ds_read_b32 v35, v0 offset:7168
    s_waitcnt lgkmcnt(0)
    v_max_u32 v34, v34, v35
    ds_read_b32 v35, v0 offset:7176
    s_waitcnt lgkmcnt(0)
    v_max_u32 v34, v34, v35
    ds_read_b32 v35, v0 offset:8192
    s_waitcnt lgkmcnt(0)
    v_max_u32 v34, v34, v35
    ds_read_b32 v35, v0 offset:8200
    s_waitcnt lgkmcnt(0)
    v_max_u32 v34, v34, v35
    v_cmp_eq_u32 s[74:75], -1, v34
    s_nop 0
    s_cmp_eq_u64 s[74:75], 0
    s_cbranch_scc1 back_66
    s_add_u32 s76, s76, 1
    s_cmp_gt_u32 s76, 2000000
    s_cbranch_scc1 fin1
    s_mov_b32 s72, 100662272
    v_mov_b64 v[14:15], 0
    v_mov_b64 v[16:17], 0
    v_mov_b64 v[18:19], 0
    v_mov_b64 v[20:21], 0
    v_mov_b64 v[22:23], 0
    v_mov_b64 v[24:25], 0
    v_mov_b64 v[26:27], 0
    v_mov_b64 v[28:29], 0
    s_waitcnt vmcnt(0)
    s_barrier
    s_branch redo_64
nr_67:
    s_mov_b32 s41, 0
rd_75:
    buffer_load_dword v8, off, s[4:7], s32 sc1
    s_waitcnt vmcnt(0)
    v_readfirstlane_b32 s42, v8
    s_nop 0
    s_cmp_ge_u32 s42, s39
    s_cbranch_scc1 rd_76
    s_sleep 4
    s_add_u32 s41, s41, 1
    s_cmp_lt_u32 s41, 2000000
    s_cbranch_scc1 rd_75
    s_branch fin1
rd_76:
    s_branch rk_68
slow_18:
    s_cmp_eq_u32 s14, 1
    s_cbranch_scc1 role_78
    s_cmp_eq_u32 s14, 2
    s_cbranch_scc1 role_79
    s_cmp_eq_u32 s14, 3
    s_cbranch_scc1 role_80
role_77:
.p2align 6
step_81:
    s_mov_b32 s41, 0
    s_add_u32 s86, s17, 5120
    s_mov_b32 m0, 5120
    s_mov_b32 s72, s23
    s_mov_b32 s76, 0
    v_mov_b64 v[14:15], 0
    v_mov_b64 v[16:17], 0
    v_mov_b64 v[18:19], 0
    v_mov_b64 v[20:21], 0
    v_mov_b64 v[22:23], 0
    v_mov_b64 v[24:25], 0
    v_mov_b64 v[26:27], 0
    v_mov_b64 v[28:29], 0
    s_nop 9
    buffer_load_dwordx4 v[40:43], v0, s[4:7], s17 offen offset:0 sc1
    buffer_load_dwordx4 v[44:47], v0, s[4:7], s17 offen offset:1024 sc1
    s_nop 15
    s_nop 7
    buffer_load_dwordx4 v[60:63], v0, s[4:7], s17 offen offset:0 sc1
    buffer_load_dwordx4 v[64:67], v0, s[4:7], s17 offen offset:1024 sc1
    s_waitcnt vmcnt(3)
    ds_write_b128 v0, v[40:43] offset:0
    v_max_u32 v34, v40, v42
    s_waitcnt vmcnt(2)
    ds_write_b128 v0, v[44:47] offset:1024
    v_max3_u32 v34, v34, v44, v46
    v_cmp_eq_u32 vcc, -1, v34
    s_cbranch_vccnz pp_82
ok_83:
redo_84:
    s_waitcnt lgkmcnt(0)
    s_barrier
    ds_read_b128 v[48:51], v0 offset:0
    buffer_load_dwordx4 v0, s[4:7], s86 offen offset:0 sc1 lds
    ds_read_b128 v[52:55], v0 offset:1024
    ds_read_b128 v[56:59], v0 offset:2048
    s_waitcnt lgkmcnt(2)
    v_smfmac_f32_16x16x64_bf16 v[14:17], v[48:51], a[0:7], v1
    s_waitcnt vmcnt(1)
    ds_read_b128 v[60:63], v4 offset:0
    ds_read_b128 v[64:67], v4 offset:1024
    v_smfmac_f32_16x16x64_bf16 v[22:25], v[48:51], a[8:15], v1
    ds_read_b128 v[68:71], v4 offset:2048
    ds_read_b128 v[72:75], v4 offset:3072
    v_smfmac_f32_16x16x64_bf16 v[18:21], v[48:51], a[144:151], v1
    ds_read_b128 v[10:13], v0 offset:3072
    v_smfmac_f32_16x16x64_bf16 v[26:29], v[48:51], a[152:159], v1
    ds_read_b128 v[48:51], v0 offset:4096
    s_waitcnt lgkmcnt(6)
    v_smfmac_f32_16x16x64_bf16 v[14:17], v[52:55], a[16:23], v1
    buffer_load_dwordx4 v[40:43], v9, s[4:7], s21 offen sc1 nt
    v_smfmac_f32_16x16x64_bf16 v[22:25], v[52:55], a[24:31], v1
    buffer_load_dwordx4 v[44:47], v9, s[4:7], s21 offen offset:256 sc1 nt
    s_waitcnt lgkmcnt(2)
    v_smfmac_f32_16x16x64_bf16 v[18:21], v[52:55], v[60:67], v1
    ds_read_b128 v[60:63], v4 offset:4096
    v_smfmac_f32_16x16x64_bf16 v[26:29], v[52:55], v[68:75], v1
    ds_read_b128 v[64:67], v4 offset:5120
    v_smfmac_f32_16x16x64_bf16 v[14:17], v[56:59], a[32:39], v1
    ds_read_b128 v[68:71], v4 offset:6144
    v_smfmac_f32_16x16x64_bf16 v[22:25], v[56:59], a[40:47], v1
    ds_read_b128 v[72:75], v4 offset:7168
    v_smfmac_f32_16x16x64_bf16 v[18:21], v[56:59], a[160:167], v1
    buffer_load_dwordx4 v[30:33], v9, s[4:7], s22 offen sc1 nt
    v_smfmac_f32_16x16x64_bf16 v[26:29], v[56:59], a[168:175], v1
    buffer_load_dwordx4 v[36:39], v9, s[4:7], s22 offen offset:256 sc1 nt
    s_waitcnt lgkmcnt(2)
    v_smfmac_f32_16x16x64_bf16 v[14:17], v[10:13], a[48:55], v1
    v_smfmac_f32_16x16x64_bf16 v[22:25], v[10:13], a[56:63], v1
    v_smfmac_f32_16x16x64_bf16 v[18:21], v[10:13], v[60:67], v1
    ds_read_b128 v[60:63], v4 offset:8192
    s_waitcnt lgkmcnt(1)
    v_smfmac_f32_16x16x64_bf16 v[26:29], v[10:13], v[68:75], v1
    ds_read_b128 v[64:67], v4 offset:9216
    v_smfmac_f32_16x16x64_bf16 v[14:17], v[48:51], a[64:71], v1
    ds_read_b128 v[68:71], v4 offset:10240
    s_waitcnt vmcnt(4)
    s_barrier
    ds_read_b128 v[52:55], v0 offset:5120
    v_smfmac_f32_16x16x64_bf16 v[22:25], v[48:51], a[72:79], v1
    ds_read_b128 v[56:59], v0 offset:6144
    v_smfmac_f32_16x16x64_bf16 v[18:21], v[48:51], a[176:183], v1
    ds_read_b128 v[10:13], v0 offset:7168
    v_smfmac_f32_16x16x64_bf16 v[26:29], v[48:51], a[184:191], v1
    ds_read_b128 v[72:75], v4 offset:11264
    s_waitcnt lgkmcnt(3)
    v_smfmac_f32_16x16x64_bf16 v[14:17], v[52:55], a[80:87], v1
    ds_read_b128 v[48:51], v0 offset:8192
    v_smfmac_f32_16x16x64_bf16 v[22:25], v[52:55], a[88:95], v1
    buffer_store_dwordx4 v[76:79], v0, s[4:7], s72 offen sc1
    v_smfmac_f32_16x16x64_bf16 v[18:21], v[52:55], v[60:67], v1
    ds_read_b128 v[60:63], v4 offset:12288
    s_waitcnt lgkmcnt(2)
    v_smfmac_f32_16x16x64_bf16 v[26:29], v[52:55], v[68:75], v1
    ds_read_b128 v[64:67], v4 offset:13312
    v_smfmac_f32_16x16x64_bf16 v[14:17], v[56:59], a[96:103], v1
    ds_read_b128 v[68:71], v4 offset:14336
    v_smfmac_f32_16x16x64_bf16 v[22:25], v[56:59], a[104:111], v1
    ds_read_b128 v[72:75], v4 offset:15360
    v_smfmac_f32_16x16x64_bf16 v[18:21], v[56:59], a[192:199], v1
    ds_read_b128 v[52:55], v0 offset:0
    v_smfmac_f32_16x16x64_bf16 v[26:29], v[56:59], a[200:207], v1
    ds_read_b128 v[56:59], v0 offset:1024
    s_mov_b64 vcc, s[34:35]
    v_smfmac_f32_16x16x64_bf16 v[14:17], v[10:13], a[112:119], v1
    s_waitcnt lgkmcnt(3)
    v_smfmac_f32_16x16x64_bf16 v[14:17], v[48:51], a[128:135], v1
    v_smfmac_f32_16x16x64_bf16 v[18:21], v[48:51], a[208:215], v1
    v_smfmac_f32_16x16x64_bf16 v[18:21], v[10:13], v[60:67], v1
    ds_read_b128 v[60:63], v4 offset:16384
    v_add_f32 v14, v14, v16
    v_smfmac_f32_16x16x64_bf16 v[22:25], v[48:51], a[136:143], v1
    ds_read_b128 v[64:67], v4 offset:17408
    v_add_f32 v15, v15, v17
    v_cvt_pk_bf16_f32 v76, v14, v15
    v_smfmac_f32_16x16x64_bf16 v[22:25], v[10:13], a[120:127], v1
    v_add_f32 v18, v18, v20
    v_add_f32 v19, v19, v21
    v_smfmac_f32_16x16x64_bf16 v[26:29], v[48:51], a[216:223], v1
    v_cvt_pk_bf16_f32 v77, v18, v19
    v_mov_b64 v[14:15], 0
    s_waitcnt lgkmcnt(2)
    v_smfmac_f32_16x16x64_bf16 v[26:29], v[10:13], v[68:75], v1
    ds_read_b128 v[68:71], v4 offset:18432
    v_mov_b64 v[16:17], 0
    v_mfma_f32_16x16x16_bf16 v[18:21], v[76:77], v[2:3], 0
    v_add_f32 v22, v22, v24
    v_add_f32 v23, v23, v25
    v_cvt_pk_bf16_f32 v78, v22, v23
    ds_read_b128 v[72:75], v4 offset:19456
    v_add_f32 v26, v26, v28
    v_add_f32 v27, v27, v29
    v_cvt_pk_bf16_f32 v79, v26, v27
    v_cmp_u_f32 s[74:75], v22, v23
    v_cvt_pk_bf16_f32 v22, v18, v19
    v_mfma_f32_16x16x16_bf16 v[26:29], v[78:79], v[2:3], 0
    v_cvt_pk_bf16_f32 v23, v20, v21
    v_mov_b64 v[18:19], 0
    v_smfmac_f32_16x16x64_bf16 v[14:17], v[52:55], a[224:231], v1
    ds_read_b128 v[10:13], v0 offset:2048
    v_mov_b64 v[20:21], 0
    v_smfmac_f32_16x16x64_bf16 v[14:17], v[56:59], a[240:247], v1
    ds_read_b128 v[48:51], v0 offset:3072
    v_cvt_pk_bf16_f32 v24, v26, v27
    v_cvt_pk_bf16_f32 v25, v28, v29
    s_waitcnt vmcnt(3)
    s_nop 0
    v_mfma_f32_16x16x32_bf16 v[40:43], v[40:43], v[22:25], 0
    v_mfma_f32_16x16x32_bf16 v[44:47], v[44:47], v[22:25], 0
    s_cmp_lg_u64 s[74:75], 0
    v_mfma_f32_16x16x32_bf16 v[26:29], v[22:25], v[22:25], 0
    s_cbranch_scc1 nan_85
back_86:
    v_smfmac_f32_16x16x64_bf16 v[18:21], v[52:55], a[232:239], v1
    ds_read_b128 v[52:55], v0 offset:4096
    v_cndmask_b32_dpp v40, v44, v40, vcc quad_perm:[0,1,0,1] row_mask:0xf bank_mask:0xf
    v_cndmask_b32_dpp v41, v45, v41, vcc quad_perm:[0,1,0,1] row_mask:0xf bank_mask:0xf
    v_cndmask_b32_dpp v42, v46, v42, vcc quad_perm:[0,1,0,1] row_mask:0xf bank_mask:0xf
    v_cndmask_b32_dpp v43, v47, v43, vcc quad_perm:[0,1,0,1] row_mask:0xf bank_mask:0xf
    ds_write_b128 v5, v[40:43] offset:9216
    v_cndmask_b32_dpp v28, v29, v28, vcc quad_perm:[0,1,0,1] row_mask:0xf bank_mask:0xf
    ds_write_b32 v5, v28 offset:13312
    v_smfmac_f32_16x16x64_bf16 v[18:21], v[56:59], a[248:255], v1
    ds_read_b128 v[56:59], v0 offset:5120
    v_mov_b32 v42, 0
    s_waitcnt lgkmcnt(4)
    v_smfmac_f32_16x16x64_bf16 v[14:17], v[10:13], v[60:67], v1
    v_mov_b32 v47, 0
    v_smfmac_f32_16x16x64_bf16 v[18:21], v[10:13], v[68:75], v1
    ds_read_b128 v[10:13], v0 offset:6144
    v_mov_b32 v28, 0
    v_smfmac_f32_16x16x64_bf16 v[14:17], v[48:51], v[80:87], v1
    v_mov_b32 v41, 0
    v_smfmac_f32_16x16x64_bf16 v[18:21], v[48:51], v[88:95], v1
    ds_read_b128 v[48:51], v0 offset:7168
    s_waitcnt lgkmcnt(3)
    s_barrier
    ds_read_b128 v[60:63], v0 offset:9216
    v_smfmac_f32_16x16x64_bf16 v[14:17], v[52:55], v[96:103], v1
    ds_read_b128 v[64:67], v0 offset:10240
    v_smfmac_f32_16x16x64_bf16 v[18:21], v[52:55], v[104:111], v1
    ds_read_b128 v[68:71], v0 offset:11264
    s_waitcnt lgkmcnt(4)
    v_smfmac_f32_16x16x64_bf16 v[14:17], v[56:59], v[112:119], v1
    ds_read_b128 v[72:75], v0 offset:12288
    v_smfmac_f32_16x16x64_bf16 v[18:21], v[56:59], v[120:127], v1
    ds_read_b128 v[22:25], v0 offset:13312
    v_smfmac_f32_16x16x64_bf16 v[14:17], v[10:13], v[128:135], v1
    ds_read_b128 v[52:55], v0 offset:8192
    s_waitcnt lgkmcnt(4)
    v_add_f32 v60, v60, v64
    v_smfmac_f32_16x16x64_bf16 v[18:21], v[10:13], v[136:143], v1
    v_add_f32 v61, v61, v65
    v_smfmac_f32_16x16x64_bf16 v[14:17], v[48:51], v[144:151], v1
    v_add_f32 v62, v62, v66
    v_smfmac_f32_16x16x64_bf16 v[18:21], v[48:51], v[152:159], v1
    v_add_f32 v63, v63, v67
    s_waitcnt lgkmcnt(0)
    v_smfmac_f32_16x16x64_bf16 v[14:17], v[52:55], v[160:167], v1
    v_add_f32 v22, v22, v23
    v_smfmac_f32_16x16x64_bf16 v[18:21], v[52:55], v[168:175], v1
    v_add_f32 v24, v24, v25
    v_add_f32 v22, v22, v24
    v_add_f32 v68, v68, v72
    v_add_f32 v69, v69, v73
    v_pk_add_f32 v[70:71], v[70:71], v[74:75]
    v_pk_add_f32 v[60:61], v[60:61], v[68:69]
    v_pk_add_f32 v[62:63], v[62:63], v[70:71]
    v_max3_f32 v24, v60, v61, v22
    v_max3_f32 v24, v24, v62, v63
    v_pk_add_f32 v[14:15], v[14:15], v[16:17]
    v_pk_add_f32 v[18:19], v[18:19], v[20:21]
    v_max_f32_dpp v25, v24, v24 row_ror:8 row_mask:0xf bank_mask:0xf
    v_max_f32_dpp v24, v24, v24 row_ror:8 row_mask:0xf bank_mask:0xf
    v_cvt_pk_bf16_f32 v29, v14, v15
    v_cvt_pk_bf16_f32 v35, v18, v19
    v_permlane16_swap_b32 v24, v25
    v_max_f32 v23, v24, v25
    v_max_f32 v24, v24, v25
    v_lshrrev_b32 v34, 16, v29
    v_lshrrev_b32 v40, 16, v35
    v_permlane32_swap_b32 v24, v23
    v_max_f32 v24, v24, v23
    v_sub_f32 v22, v22, v24
    v_pk_add_f32 v[60:61], v[60:61], v[24:25] op_sel_hi:[1,0] neg_lo:[0,1] neg_hi:[0,1]
    v_pk_add_f32 v[62:63], v[62:63], v[24:25] op_sel_hi:[1,0] neg_lo:[0,1] neg_hi:[0,1]
    v_mul_f32 v22, s40, v22
    v_pk_mul_f32 v[60:61], v[60:61], s[2:3]
    v_pk_mul_f32 v[62:63], v[62:63], s[2:3]
    v_exp_f32 v22, v22
    v_exp_f32 v60, v60
    v_exp_f32 v61, v61
    v_exp_f32 v62, v62
    v_exp_f32 v63, v63
    v_cvt_pk_bf16_f32 v46, v22, 0
    v_cvt_pk_bf16_f32 v44, v60, v61
    v_cvt_pk_bf16_f32 v45, v62, v63
    v_cvt_pk_bf16_f32 v43, v22, 0
    s_waitcnt vmcnt(1)
    v_mfma_f32_16x16x32_bf16 v[64:67], v[32:35], v[44:47], 0
    v_mov_b64 v[48:49], s[36:37]
    v_mov_b64 v[50:51], s[36:37]
    v_mfma_f32_16x16x32_bf16 v[60:63], v[28:31], v[42:45], 0
    v_min_u32 v76, -2, v29
    v_mov_b32 v78, v35
    v_mfma_f32_16x16x32_bf16 v[52:55], v[48:51], v[42:45], 0
    v_mov_b64 v[14:15], 0
    v_mov_b64 v[16:17], 0
    v_mfma_f32_16x16x32_bf16 v[68:71], v[34:37], v[42:45], 0
    v_add_f32_dpp v56, v64, v60 row_ror:8 row_mask:0xf bank_mask:0x3
    v_add_f32_dpp v57, v65, v61 row_ror:8 row_mask:0xf bank_mask:0x3
    v_mfma_f32_16x16x32_bf16 v[72:75], v[38:41], v[44:47], 0
    v_add_f32_dpp v50, v52, v52 row_ror:8 row_mask:0xf bank_mask:0xf
    v_add_f32_dpp v58, v66, v62 row_ror:8 row_mask:0xf bank_mask:0x3
    v_add_f32_dpp v59, v67, v63 row_ror:8 row_mask:0xf bank_mask:0x3
    v_rcp_f32 v50, v50
    v_and_b32 v10, 0xffffffdf, v0
    v_lshrrev_b32 v11, 2, v0
    v_mov_b64 v[18:19], 0
    v_mov_b64 v[20:21], 0
    v_add_f32_dpp v56, v68, v72 row_ror:8 row_mask:0xf bank_mask:0xc
    v_add_f32_dpp v57, v69, v73 row_ror:8 row_mask:0xf bank_mask:0xc
    v_add_f32_dpp v58, v70, v74 row_ror:8 row_mask:0xf bank_mask:0xc
    v_add_f32_dpp v59, v71, v75 row_ror:8 row_mask:0xf bank_mask:0xc
    v_pk_mul_f32 v[56:57], v[56:57], v[50:51] op_sel_hi:[1,0]
    v_pk_mul_f32 v[58:59], v[58:59], v[50:51] op_sel_hi:[1,0]
    v_cvt_pk_bf16_f32 v56, v56, v57
    v_cvt_pk_bf16_f32 v57, v58, v59
    ds_write_b64 v6, v[56:57] offset:0
    v_mfma_f32_16x16x32_bf16 v[22:25], v[14:17], v[14:17], 0
    ds_read_b128 v[60:63], v4 offset:20480
    ds_read_b128 v[64:67], v4 offset:21504
    ds_read_b128 v[68:71], v4 offset:24576
    ds_read_b128 v[72:75], v4 offset:25600
    v_mfma_f32_16x16x32_bf16 v[26:29], v[14:17], v[14:17], 0
    s_waitcnt lgkmcnt(4)
    s_barrier
    ds_read_b128 v[42:45], v10 offset:0
    ds_read_b128 v[50:53], v10 offset:1024
    v_mfma_f32_16x16x32_bf16 v[30:33], v[14:17], v[14:17], 0
    ds_read_b128 v[34:37], v0 offset:0
    ds_read_b128 v[46:49], v10 offset:32
    s_waitcnt lgkmcnt(3)
    v_smfmac_f32_16x16x64_bf16 v[18:21], v[42:45], v[176:183], v1
    ds_read_b128 v[38:41], v0 offset:1024
    v_smfmac_f32_16x16x64_bf16 v[22:25], v[42:45], v[192:199], v1
    ds_read_b128 v[54:57], v10 offset:1056
    s_waitcnt lgkmcnt(4)
    v_smfmac_f32_16x16x64_bf16 v[18:21], v[50:53], v[60:67], v1
    ds_read_b128 v[60:63], v4 offset:22528
    v_smfmac_f32_16x16x64_bf16 v[22:25], v[50:53], v[68:75], v1
    ds_read_b128 v[64:67], v4 offset:23552
    s_waitcnt lgkmcnt(4)
    v_smfmac_f32_16x16x64_bf16 v[14:17], v[34:37], v[240:247], v1
    ds_read_b128 v[68:71], v4 offset:26624
    v_smfmac_f32_16x16x64_bf16 v[18:21], v[46:49], v[184:191], v1
    ds_read_b128 v[72:75], v4 offset:27648
    s_waitcnt lgkmcnt(4)
    v_smfmac_f32_16x16x64_bf16 v[14:17], v[38:41], v[248:255], v1
    ds_read_b128 v[34:37], v4 offset:28672
    v_smfmac_f32_16x16x64_bf16 v[22:25], v[46:49], v[200:207], v1
    ds_read_b128 v[38:41], v4 offset:29696
    s_waitcnt lgkmcnt(4)
    v_smfmac_f32_16x16x64_bf16 v[18:21], v[54:57], v[60:67], v1
    ds_read_b128 v[60:63], v4 offset:30720
    v_add_f32 v14, v14, v16
    v_add_f32 v15, v15, v17
    s_waitcnt lgkmcnt(3)
    v_smfmac_f32_16x16x64_bf16 v[22:25], v[54:57], v[68:75], v1
    ds_read_b128 v[64:67], v4 offset:31744
    v_cvt_pk_bf16_f32 v58, v14, v15
    v_and_or_b32 v58, v58, -2, s46
    buffer_store_dword v58, v11, s[4:7], s20 offen sc1
    v_smfmac_f32_16x16x64_bf16 v[26:29], v[42:45], v[208:215], v1
    ds_read_b128 v[68:71], v4 offset:32768
    v_cvt_pk_bf16_f32 v18, v18, v19
    v_cvt_pk_bf16_f32 v19, v20, v21
    v_and_or_b32 v18, v18, -2, s46
    v_smfmac_f32_16x16x64_bf16 v[26:29], v[46:49], v[216:223], v1
    ds_read_b128 v[72:75], v4 offset:33792
    v_cvt_pk_bf16_f32 v20, v22, v23
    v_cvt_pk_bf16_f32 v21, v24, v25
    buffer_store_dwordx4 v[18:21], v0, s[4:7], s18 offen sc1
    s_waitcnt lgkmcnt(4)
    v_smfmac_f32_16x16x64_bf16 v[26:29], v[50:53], v[34:41], v1
    ds_read_b128 v[34:37], v4 offset:34816
    v_smfmac_f32_16x16x64_bf16 v[30:33], v[42:45], v[224:231], v1
    ds_read_b128 v[38:41], v4 offset:35840
    s_waitcnt lgkmcnt(4)
    v_smfmac_f32_16x16x64_bf16 v[26:29], v[54:57], v[60:67], v1
    s_waitcnt lgkmcnt(2)
    v_smfmac_f32_16x16x64_bf16 v[30:33], v[50:53], v[68:75], v1
    v_smfmac_f32_16x16x64_bf16 v[30:33], v[46:49], v[232:239], v1
    v_cvt_pk_bf16_f32 v26, v26, v27
    v_cvt_pk_bf16_f32 v27, v28, v29
    s_waitcnt lgkmcnt(0)
    v_smfmac_f32_16x16x64_bf16 v[30:33], v[54:57], v[34:41], v1
    v_and_or_b32 v26, v26, -2, s46
    s_nop 6
    v_cvt_pk_bf16_f32 v28, v30, v31
    v_cvt_pk_bf16_f32 v29, v32, v33
    buffer_store_dwordx4 v[26:29], v0, s[4:7], s19 offen sc1
    v_bfe_u32 v58, v0, 6, 1
    v_lshlrev_b32 v58, 4, v58
    v_mov_b32 v59, 0x3f80
    v_lshlrev_b32 v58, v58, v59
    v_cndmask_b32 v10, 0, v58, s[30:31]
    s_lshl_b64 vcc, s[30:31], 1
    v_cndmask_b32 v11, 0, v58, vcc
    s_lshl_b64 vcc, s[30:31], 2
    v_cndmask_b32 v12, 0, v58, vcc
    s_lshl_b64 vcc, s[30:31], 3
    v_cndmask_b32 v13, 0, v58, vcc
    v_mov_b64 v[54:55], -1
    s_mov_b32 s41, 0
    s_xor_b32 s18, s18, 0x100000
    s_xor_b32 s19, s19, 0x100000
    s_xor_b32 s20, s20, 0x100000
    s_add_u32 s17, s17, 0x4000
    s_and_b32 s17, s17, 0xfffeffff
    s_add_u32 s21, s21, 262144
    s_add_u32 s22, s22, 262144
    s_add_u32 s23, s23, 131072
    s_nop 15
    s_nop 15
    s_nop 15
    s_nop 1
    buffer_load_dwordx4 v[34:37], v7, s[4:7], s24 offen sc1
    buffer_load_dwordx4 v[38:41], v7, s[4:7], s25 offen sc1
    buffer_load_dwordx4 v[42:45], v7, s[4:7], s26 offen sc1
    buffer_load_dwordx4 v[46:49], v7, s[4:7], s27 offen sc1
    s_waitcnt vmcnt(3)
    v_mfma_f32_16x16x32_bf16 v[50:53], v[10:13], v[34:37], 0
    s_waitcnt vmcnt(2)
    v_mfma_f32_16x16x32_bf16 v[50:53], v[10:13], v[38:41], v[50:53]
    v_bitop3_b32 v58, v34, v38, s46 bitop3:0x7e
    s_waitcnt vmcnt(1)
    v_mfma_f32_16x16x32_bf16 v[50:53], v[10:13], v[42:45], v[50:53]
    s_waitcnt vmcnt(0)
    v_mfma_f32_16x16x32_bf16 v[50:53], v[10:13], v[46:49], v[50:53]
    v_bitop3_b32 v59, v42, v46, s46 bitop3:0x7e
    v_or_b32 v58, v58, v59
    v_and_b32 v58, 1, v58
    v_cmp_ne_u32 vcc, 0, v58
    s_cbranch_vccnz pp_87
ok_88:
    s_nop 2
    v_add_f32_dpp v50, v50, v50 row_ror:8 row_mask:0xf bank_mask:0xf
    v_add_f32_dpp v51, v51, v51 row_ror:8 row_mask:0xf bank_mask:0xf
    v_add_f32_dpp v52, v52, v52 row_ror:8 row_mask:0xf bank_mask:0xf
    v_add_f32_dpp v53, v53, v53 row_ror:8 row_mask:0xf bank_mask:0xf
    s_mov_b64 exec, s[28:29]
    v_cvt_pk_bf16_f32 v58, v50, v51
    v_cvt_pk_bf16_f32 v59, v52, v53
    v_min_u32 v58, -2, v58
    buffer_store_dwordx2 v[58:59], v8, s[4:7], s17 offen sc1
    buffer_store_dwordx2 v[54:55], v8, s[4:7], s47 offen sc1
    s_mov_b64 exec, -1
    s_wakeup
    s_xor_b32 s24, s24, 0x100000
    s_xor_b32 s25, s25, 0x100000
    s_xor_b32 s26, s26, 0x100000
    s_xor_b32 s27, s27, 0x100000
    s_add_u32 s47, s47, 0x4000
    s_and_b32 s47, s47, 0xfffeffff
    s_and_b32 s42, s16, 1
    s_xor_b32 s46, s46, s42
    s_add_u32 s16, s16, 1
    s_cmp_lt_u32 s16, 63
    s_cbranch_scc1 step_81
step_89:
    s_mov_b32 s41, 0
    s_add_u32 s86, s17, 5120
    s_mov_b32 m0, 5120
    s_mov_b32 s72, s23
    s_mov_b32 s76, 0
    v_mov_b64 v[14:15], 0
    v_mov_b64 v[16:17], 0
    v_mov_b64 v[18:19], 0
    v_mov_b64 v[20:21], 0
    v_mov_b64 v[22:23], 0
    v_mov_b64 v[24:25], 0
    v_mov_b64 v[26:27], 0
    v_mov_b64 v[28:29], 0
    s_nop 9
    buffer_load_dwordx4 v[40:43], v0, s[4:7], s17 offen offset:0 sc1
    buffer_load_dwordx4 v[44:47], v0, s[4:7], s17 offen offset:1024 sc1
    s_nop 15
    s_nop 7
    buffer_load_dwordx4 v[60:63], v0, s[4:7], s17 offen offset:0 sc1
    buffer_load_dwordx4 v[64:67], v0, s[4:7], s17 offen offset:1024 sc1
    s_waitcnt vmcnt(3)
    ds_write_b128 v0, v[40:43] offset:0
    v_max_u32 v34, v40, v42
    s_waitcnt vmcnt(2)
    ds_write_b128 v0, v[44:47] offset:1024
    v_max3_u32 v34, v34, v44, v46
    v_cmp_eq_u32 vcc, -1, v34
    s_cbranch_vccnz pp_90
ok_91:
redo_92:
    s_waitcnt lgkmcnt(0)
    s_barrier
    ds_read_b128 v[48:51], v0 offset:0
    buffer_load_dwordx4 v0, s[4:7], s86 offen offset:0 sc1 lds
    ds_read_b128 v[52:55], v0 offset:1024
    ds_read_b128 v[56:59], v0 offset:2048
    s_waitcnt lgkmcnt(2)
    v_smfmac_f32_16x16x64_bf16 v[14:17], v[48:51], a[224:231], v1
    s_waitcnt vmcnt(1)
    ds_read_b128 v[60:63], v4 offset:0
    ds_read_b128 v[64:67], v4 offset:1024
    v_smfmac_f32_16x16x64_bf16 v[22:25], v[48:51], a[232:239], v1
    ds_read_b128 v[68:71], v4 offset:2048
    ds_read_b128 v[72:75], v4 offset:3072
    v_smfmac_f32_16x16x64_bf16 v[18:21], v[48:51], a[144:151], v1
    ds_read_b128 v[10:13], v0 offset:3072
    v_smfmac_f32_16x16x64_bf16 v[26:29], v[48:51], a[152:159], v1
    buffer_store_dwordx4 v[76:79], v0, s[4:7], s72 offen sc1
    s_waitcnt lgkmcnt(5)
    v_smfmac_f32_16x16x64_bf16 v[14:17], v[52:55], a[240:247], v1
    v_smfmac_f32_16x16x64_bf16 v[22:25], v[52:55], a[248:255], v1
    s_waitcnt lgkmcnt(1)
    v_smfmac_f32_16x16x64_bf16 v[18:21], v[52:55], v[60:67], v1
    ds_read_b128 v[60:63], v4 offset:4096
    v_smfmac_f32_16x16x64_bf16 v[26:29], v[52:55], v[68:75], v1
    ds_read_b128 v[64:67], v4 offset:5120
    v_smfmac_f32_16x16x64_bf16 v[18:21], v[56:59], a[160:167], v1
    ds_read_b128 v[68:71], v4 offset:6144
    v_smfmac_f32_16x16x64_bf16 v[26:29], v[56:59], a[168:175], v1
    ds_read_b128 v[72:75], v4 offset:7168
    s_waitcnt vmcnt(1)
    s_barrier
    ds_read_b128 v[48:51], v0 offset:4096
    s_waitcnt lgkmcnt(5)
    v_smfmac_f32_16x16x64_bf16 v[14:17], v[10:13], v[80:87], v1
    ds_read_b128 v[52:55], v0 offset:5120
    v_smfmac_f32_16x16x64_bf16 v[22:25], v[10:13], v[88:95], v1
    ds_read_b128 v[56:59], v0 offset:6144
    s_waitcnt lgkmcnt(5)
    v_smfmac_f32_16x16x64_bf16 v[18:21], v[10:13], v[60:67], v1
    ds_read_b128 v[60:63], v4 offset:8192
    s_waitcnt lgkmcnt(4)
    v_smfmac_f32_16x16x64_bf16 v[26:29], v[10:13], v[68:75], v1
    ds_read_b128 v[64:67], v4 offset:9216
    s_waitcnt lgkmcnt(4)
    v_smfmac_f32_16x16x64_bf16 v[14:17], v[48:51], v[96:103], v1
    ds_read_b128 v[10:13], v0 offset:7168
    v_smfmac_f32_16x16x64_bf16 v[22:25], v[48:51], v[104:111], v1
    ds_read_b128 v[68:71], v4 offset:10240
    v_smfmac_f32_16x16x64_bf16 v[18:21], v[48:51], a[176:183], v1
    ds_read_b128 v[72:75], v4 offset:11264
    v_smfmac_f32_16x16x64_bf16 v[26:29], v[48:51], a[184:191], v1
    s_waitcnt lgkmcnt(3)
    v_smfmac_f32_16x16x64_bf16 v[14:17], v[52:55], v[112:119], v1
    ds_read_b128 v[48:51], v0 offset:8192
    v_smfmac_f32_16x16x64_bf16 v[22:25], v[52:55], v[120:127], v1
    v_smfmac_f32_16x16x64_bf16 v[18:21], v[52:55], v[60:67], v1
    ds_read_b128 v[60:63], v4 offset:12288
    s_waitcnt lgkmcnt(2)
    v_smfmac_f32_16x16x64_bf16 v[26:29], v[52:55], v[68:75], v1
    ds_read_b128 v[64:67], v4 offset:13312
    v_smfmac_f32_16x16x64_bf16 v[14:17], v[56:59], v[128:135], v1
    ds_read_b128 v[68:71], v4 offset:14336
    v_smfmac_f32_16x16x64_bf16 v[22:25], v[56:59], v[136:143], v1
    ds_read_b128 v[72:75], v4 offset:15360
    v_smfmac_f32_16x16x64_bf16 v[18:21], v[56:59], a[192:199], v1
    v_smfmac_f32_16x16x64_bf16 v[26:29], v[56:59], a[200:207], v1
    v_smfmac_f32_16x16x64_bf16 v[14:17], v[10:13], v[144:151], v1
    v_smfmac_f32_16x16x64_bf16 v[22:25], v[10:13], v[152:159], v1
    s_waitcnt lgkmcnt(0)
    v_smfmac_f32_16x16x64_bf16 v[18:21], v[10:13], v[60:67], v1
    ds_read_b128 v[60:63], v4 offset:16384
    v_smfmac_f32_16x16x64_bf16 v[26:29], v[10:13], v[68:75], v1
    ds_read_b128 v[64:67], v4 offset:17408
    v_smfmac_f32_16x16x64_bf16 v[14:17], v[48:51], v[160:167], v1
    ds_read_b128 v[10:13], v0 offset:2048
    v_smfmac_f32_16x16x64_bf16 v[22:25], v[48:51], v[168:175], v1
    ds_read_b128 v[68:71], v4 offset:18432
    v_smfmac_f32_16x16x64_bf16 v[18:21], v[48:51], a[208:215], v1
    ds_read_b128 v[72:75], v4 offset:19456
    v_smfmac_f32_16x16x64_bf16 v[26:29], v[48:51], a[216:223], v1
    s_waitcnt lgkmcnt(2)
    v_smfmac_f32_16x16x64_bf16 v[14:17], v[10:13], v[60:67], v1
    s_waitcnt lgkmcnt(0)
    v_smfmac_f32_16x16x64_bf16 v[22:25], v[10:13], v[68:75], v1
    v_add_f32 v18, v18, v20
    v_add_f32 v19, v19, v21
    v_cvt_pk_bf16_f32 v77, v18, v19
    v_add_f32 v26, v26, v28
    v_add_f32 v27, v27, v29
    v_cvt_pk_bf16_f32 v79, v26, v27
    v_add_f32 v14, v14, v16
    v_add_f32 v15, v15, v17
    v_cvt_pk_bf16_f32 v76, v14, v15
    v_add_f32 v22, v22, v24
    v_add_f32 v23, v23, v25
    v_cvt_pk_bf16_f32 v78, v22, v23
    v_cmp_u_f32 s[74:75], v26, v27
    v_min_u32 v76, -2, v76
    s_cmp_lg_u64 s[74:75], 0
    s_cbranch_scc1 nan_93
back_94:
    s_add_u32 s23, s23, 131072
    buffer_store_dwordx4 v[76:79], v0, s[4:7], s23 offen sc1
    s_branch done
pp_90:
    buffer_load_dwordx4 v[40:43], v0, s[4:7], s17 offen offset:0 sc1
    buffer_load_dwordx4 v[44:47], v0, s[4:7], s17 offen offset:1024 sc1
    s_add_u32 s41, s41, 1
    s_cmp_gt_u32 s41, 2000000
    s_cbranch_scc1 fin1
    s_waitcnt vmcnt(3)
    ds_write_b128 v0, v[60:63] offset:0
    v_max_u32 v34, v60, v62
    s_waitcnt vmcnt(2)
    ds_write_b128 v0, v[64:67] offset:1024
    v_max3_u32 v34, v34, v64, v66
    v_cmp_eq_u32 vcc, -1, v34
    s_cbranch_vccz ok_91
    buffer_load_dwordx4 v[60:63], v0, s[4:7], s17 offen offset:0 sc1
    buffer_load_dwordx4 v[64:67], v0, s[4:7], s17 offen offset:1024 sc1
    s_add_u32 s41, s41, 1
    s_waitcnt vmcnt(3)
    ds_write_b128 v0, v[40:43] offset:0
    v_max_u32 v34, v40, v42
    s_waitcnt vmcnt(2)
    ds_write_b128 v0, v[44:47] offset:1024
    v_max3_u32 v34, v34, v44, v46
    v_cmp_eq_u32 vcc, -1, v34
    s_cbranch_vccnz pp_90
    s_branch ok_91
nan_93:
    v_mov_b32 v34, 0
    ds_read_b32 v35, v0 offset:4096
    s_waitcnt lgkmcnt(0)
    v_max_u32 v34, v34, v35
    ds_read_b32 v35, v0 offset:4104
    s_waitcnt lgkmcnt(0)
    v_max_u32 v34, v34, v35
    ds_read_b32 v35, v0 offset:5120
    s_waitcnt lgkmcnt(0)
    v_max_u32 v34, v34, v35
    ds_read_b32 v35, v0 offset:5128
    s_waitcnt lgkmcnt(0)
    v_max_u32 v34, v34, v35
    ds_read_b32 v35, v0 offset:6144
    s_waitcnt lgkmcnt(0)
    v_max_u32 v34, v34, v35
    ds_read_b32 v35, v0 offset:6152
    s_waitcnt lgkmcnt(0)
    v_max_u32 v34, v34, v35
    ds_read_b32 v35, v0 offset:7168
    s_waitcnt lgkmcnt(0)
    v_max_u32 v34, v34, v35
    ds_read_b32 v35, v0 offset:7176
    s_waitcnt lgkmcnt(0)
    v_max_u32 v34, v34, v35
    ds_read_b32 v35, v0 offset:8192
    s_waitcnt lgkmcnt(0)
    v_max_u32 v34, v34, v35
    ds_read_b32 v35, v0 offset:8200
    s_waitcnt lgkmcnt(0)
    v_max_u32 v34, v34, v35
    v_cmp_eq_u32 s[74:75], -1, v34
    s_nop 0
    s_cmp_eq_u64 s[74:75], 0
    s_cbranch_scc1 back_94
    s_add_u32 s76, s76, 1
    s_cmp_gt_u32 s76, 2000000
    s_cbranch_scc1 fin1
    s_mov_b32 s72, 100662272
    v_mov_b64 v[14:15], 0
    v_mov_b64 v[16:17], 0
    v_mov_b64 v[18:19], 0
    v_mov_b64 v[20:21], 0
    v_mov_b64 v[22:23], 0
    v_mov_b64 v[24:25], 0
    v_mov_b64 v[26:27], 0
    v_mov_b64 v[28:29], 0
    s_waitcnt vmcnt(0)
    s_barrier
    s_branch redo_92
pp_82:
    buffer_load_dwordx4 v[40:43], v0, s[4:7], s17 offen offset:0 sc1
    buffer_load_dwordx4 v[44:47], v0, s[4:7], s17 offen offset:1024 sc1
    s_add_u32 s41, s41, 1
    s_cmp_gt_u32 s41, 2000000
    s_cbranch_scc1 fin1
    s_waitcnt vmcnt(3)
    ds_write_b128 v0, v[60:63] offset:0
    v_max_u32 v34, v60, v62
    s_waitcnt vmcnt(2)
    ds_write_b128 v0, v[64:67] offset:1024
    v_max3_u32 v34, v34, v64, v66
    v_cmp_eq_u32 vcc, -1, v34
    s_cbranch_vccz ok_83
    buffer_load_dwordx4 v[60:63], v0, s[4:7], s17 offen offset:0 sc1
    buffer_load_dwordx4 v[64:67], v0, s[4:7], s17 offen offset:1024 sc1
    s_add_u32 s41, s41, 1
    s_waitcnt vmcnt(3)
    ds_write_b128 v0, v[40:43] offset:0
    v_max_u32 v34, v40, v42
    s_waitcnt vmcnt(2)
    ds_write_b128 v0, v[44:47] offset:1024
    v_max3_u32 v34, v34, v44, v46
    v_cmp_eq_u32 vcc, -1, v34
    s_cbranch_vccnz pp_82
    s_branch ok_83
nan_85:
    v_mov_b32 v34, 0
    ds_read_b32 v35, v0 offset:4096
    s_waitcnt lgkmcnt(0)
    v_max_u32 v34, v34, v35
    ds_read_b32 v35, v0 offset:4104
    s_waitcnt lgkmcnt(0)
    v_max_u32 v34, v34, v35
    ds_read_b32 v35, v0 offset:5120
    s_waitcnt lgkmcnt(0)
    v_max_u32 v34, v34, v35
    ds_read_b32 v35, v0 offset:5128
    s_waitcnt lgkmcnt(0)
    v_max_u32 v34, v34, v35
    ds_read_b32 v35, v0 offset:6144
    s_waitcnt lgkmcnt(0)
    v_max_u32 v34, v34, v35
    ds_read_b32 v35, v0 offset:6152
    s_waitcnt lgkmcnt(0)
    v_max_u32 v34, v34, v35
    ds_read_b32 v35, v0 offset:7168
    s_waitcnt lgkmcnt(0)
    v_max_u32 v34, v34, v35
    ds_read_b32 v35, v0 offset:7176
    s_waitcnt lgkmcnt(0)
    v_max_u32 v34, v34, v35
    ds_read_b32 v35, v0 offset:8192
    s_waitcnt lgkmcnt(0)
    v_max_u32 v34, v34, v35
    ds_read_b32 v35, v0 offset:8200
    s_waitcnt lgkmcnt(0)
    v_max_u32 v34, v34, v35
    v_cmp_eq_u32 s[74:75], -1, v34
    s_nop 0
    s_cmp_eq_u64 s[74:75], 0
    s_cbranch_scc1 back_86
    s_add_u32 s76, s76, 1
    s_cmp_gt_u32 s76, 2000000
    s_cbranch_scc1 fin1
    s_mov_b32 s72, 100662272
    v_mov_b64 v[14:15], 0
    v_mov_b64 v[16:17], 0
    v_mov_b64 v[18:19], 0
    v_mov_b64 v[20:21], 0
    v_mov_b64 v[22:23], 0
    v_mov_b64 v[24:25], 0
    v_mov_b64 v[26:27], 0
    v_mov_b64 v[28:29], 0
    s_waitcnt vmcnt(0)
    s_barrier
    s_branch redo_84
pp_87:
    buffer_load_dwordx4 v[34:37], v7, s[4:7], s24 offen sc1
    buffer_load_dwordx4 v[38:41], v7, s[4:7], s25 offen sc1
    buffer_load_dwordx4 v[42:45], v7, s[4:7], s26 offen sc1
    buffer_load_dwordx4 v[46:49], v7, s[4:7], s27 offen sc1
    s_add_u32 s41, s41, 1
    s_cmp_gt_u32 s41, 2000000
    s_cbranch_scc1 fin1
    s_waitcnt vmcnt(3)
    v_mfma_f32_16x16x32_bf16 v[50:53], v[10:13], v[34:37], 0
    s_waitcnt vmcnt(2)
    v_mfma_f32_16x16x32_bf16 v[50:53], v[10:13], v[38:41], v[50:53]
    v_bitop3_b32 v58, v34, v38, s46 bitop3:0x7e
    s_waitcnt vmcnt(1)
    v_mfma_f32_16x16x32_bf16 v[50:53], v[10:13], v[42:45], v[50:53]
    s_waitcnt vmcnt(0)
    v_mfma_f32_16x16x32_bf16 v[50:53], v[10:13], v[46:49], v[50:53]
    v_bitop3_b32 v59, v42, v46, s46 bitop3:0x7e
    v_or_b32 v58, v58, v59
    v_and_b32 v58, 1, v58
    v_cmp_ne_u32 vcc, 0, v58
    s_cbranch_vccnz pp_87
    s_branch ok_88
role_78:
.p2align 6
step_95:
    s_mov_b32 s41, 0
    s_add_u32 s86, s17, 6144
    s_mov_b32 m0, 6144
    s_mov_b32 s72, s23
    s_mov_b32 s76, 0
    v_mov_b64 v[14:15], 0
    v_mov_b64 v[16:17], 0
    v_mov_b64 v[18:19], 0
    v_mov_b64 v[20:21], 0
    v_mov_b64 v[22:23], 0
    v_mov_b64 v[24:25], 0
    v_mov_b64 v[26:27], 0
    v_mov_b64 v[28:29], 0
redo_96:
    s_waitcnt lgkmcnt(0)
    s_barrier
    ds_read_b128 v[48:51], v0 offset:0
    s_mov_b32 m0, 6144
    s_nop 0
    buffer_load_dwordx4 v0, s[4:7], s86 offen offset:0 sc1 lds
    ds_read_b128 v[52:55], v0 offset:1024
    ds_read_b128 v[56:59], v0 offset:2048
    s_mov_b32 m0, 15616
    ds_read_b128 v[60:63], v4 offset:0
    ds_read_b128 v[64:67], v4 offset:1024
    s_waitcnt lgkmcnt(4)
    v_smfmac_f32_16x16x64_bf16 v[14:17], v[48:51], a[0:7], v1
    ds_read_b128 v[68:71], v4 offset:2048
    ds_read_b128 v[72:75], v4 offset:3072
    ds_read_b128 v[10:13], v0 offset:3072
    v_smfmac_f32_16x16x64_bf16 v[22:25], v[48:51], a[8:15], v1
    buffer_load_dwordx4 v[40:43], v9, s[4:7], s21 offen sc1 nt
    buffer_load_dwordx4 v[44:47], v9, s[4:7], s21 offen offset:256 sc1 nt
    v_smfmac_f32_16x16x64_bf16 v[18:21], v[48:51], a[144:151], v1
    buffer_load_dwordx4 v[30:33], v9, s[4:7], s22 offen sc1 nt
    v_smfmac_f32_16x16x64_bf16 v[26:29], v[48:51], a[152:159], v1
    ds_read_b128 v[48:51], v0 offset:4096
    s_waitcnt lgkmcnt(4)
    v_smfmac_f32_16x16x64_bf16 v[14:17], v[52:55], a[16:23], v1
    buffer_load_dwordx4 v[36:39], v9, s[4:7], s22 offen offset:256 sc1 nt
    v_smfmac_f32_16x16x64_bf16 v[22:25], v[52:55], a[24:31], v1
    v_smfmac_f32_16x16x64_bf16 v[18:21], v[52:55], v[60:67], v1
    ds_read_b128 v[60:63], v4 offset:4096
    s_waitcnt lgkmcnt(2)
    v_smfmac_f32_16x16x64_bf16 v[26:29], v[52:55], v[68:75], v1
    ds_read_b128 v[64:67], v4 offset:5120
    v_smfmac_f32_16x16x64_bf16 v[14:17], v[56:59], a[32:39], v1
    ds_read_b128 v[68:71], v4 offset:6144
    v_smfmac_f32_16x16x64_bf16 v[22:25], v[56:59], a[40:47], v1
    ds_read_b128 v[72:75], v4 offset:7168
    v_smfmac_f32_16x16x64_bf16 v[18:21], v[56:59], a[160:167], v1
    v_smfmac_f32_16x16x64_bf16 v[26:29], v[56:59], a[168:175], v1
    v_smfmac_f32_16x16x64_bf16 v[14:17], v[10:13], a[48:55], v1
    v_smfmac_f32_16x16x64_bf16 v[22:25], v[10:13], a[56:63], v1
    s_waitcnt lgkmcnt(0)
    v_smfmac_f32_16x16x64_bf16 v[18:21], v[10:13], v[60:67], v1
    ds_read_b128 v[60:63], v4 offset:8192
    v_smfmac_f32_16x16x64_bf16 v[26:29], v[10:13], v[68:75], v1
    ds_read_b128 v[64:67], v4 offset:9216
    v_lshlrev_b32 v35, 3, v0
    v_smfmac_f32_16x16x64_bf16 v[14:17], v[48:51], a[64:71], v1
    ds_read_b128 v[68:71], v4 offset:10240
    s_waitcnt vmcnt(4)
    s_barrier
    ds_read_b128 v[52:55], v0 offset:5120
    v_smfmac_f32_16x16x64_bf16 v[22:25], v[48:51], a[72:79], v1
    ds_read_b128 v[56:59], v0 offset:6144
    v_smfmac_f32_16x16x64_bf16 v[18:21], v[48:51], a[176:183], v1
    ds_read_b128 v[10:13], v0 offset:7168
    v_smfmac_f32_16x16x64_bf16 v[26:29], v[48:51], a[184:191], v1
    ds_read_b128 v[72:75], v4 offset:11264
    s_waitcnt lgkmcnt(3)
    v_smfmac_f32_16x16x64_bf16 v[14:17], v[52:55], a[80:87], v1
    ds_read_b128 v[48:51], v0 offset:8192
    v_smfmac_f32_16x16x64_bf16 v[22:25], v[52:55], a[88:95], v1
    buffer_store_dwordx4 v[76:79], v0, s[4:7], s72 offen sc1
    v_smfmac_f32_16x16x64_bf16 v[18:21], v[52:55], v[60:67], v1
    ds_read_b128 v[60:63], v4 offset:12288
    s_waitcnt lgkmcnt(2)
    v_smfmac_f32_16x16x64_bf16 v[26:29], v[52:55], v[68:75], v1
    ds_read_b128 v[64:67], v4 offset:13312
    v_smfmac_f32_16x16x64_bf16 v[14:17], v[56:59], a[96:103], v1
    ds_read_b128 v[68:71], v4 offset:14336
    v_smfmac_f32_16x16x64_bf16 v[22:25], v[56:59], a[104:111], v1
    ds_read_b128 v[72:75], v4 offset:15360
    v_smfmac_f32_16x16x64_bf16 v[18:21], v[56:59], a[192:199], v1
    ds_read_b128 v[52:55], v0 offset:0
    v_smfmac_f32_16x16x64_bf16 v[26:29], v[56:59], a[200:207], v1
    ds_read_b128 v[56:59], v0 offset:1024
    s_mov_b64 vcc, s[34:35]
    v_smfmac_f32_16x16x64_bf16 v[14:17], v[10:13], a[112:119], v1
    s_add_u32 s42, s21, 522240
    buffer_load_dword v35, s[4:7], s42 offen sc1 lds
    s_waitcnt lgkmcnt(3)
    v_smfmac_f32_16x16x64_bf16 v[14:17], v[48:51], a[128:135], v1
    v_smfmac_f32_16x16x64_bf16 v[18:21], v[48:51], a[208:215], v1
    v_smfmac_f32_16x16x64_bf16 v[18:21], v[10:13], v[60:67], v1
    ds_read_b128 v[60:63], v4 offset:16384
    v_add_f32 v14, v14, v16
    v_smfmac_f32_16x16x64_bf16 v[22:25], v[48:51], a[136:143], v1
    ds_read_b128 v[64:67], v4 offset:17408
    v_add_f32 v15, v15, v17
    v_cvt_pk_bf16_f32 v76, v14, v15
    v_smfmac_f32_16x16x64_bf16 v[22:25], v[10:13], a[120:127], v1
    v_add_f32 v18, v18, v20
    v_add_f32 v19, v19, v21
    v_smfmac_f32_16x16x64_bf16 v[26:29], v[48:51], a[216:223], v1
    v_cvt_pk_bf16_f32 v77, v18, v19
    v_mov_b64 v[14:15], 0
    s_waitcnt lgkmcnt(2)
    v_smfmac_f32_16x16x64_bf16 v[26:29], v[10:13], v[68:75], v1
    ds_read_b128 v[68:71], v4 offset:18432
    v_mov_b64 v[16:17], 0
    v_mfma_f32_16x16x16_bf16 v[18:21], v[76:77], v[2:3], 0
    v_add_f32 v22, v22, v24
    v_add_f32 v23, v23, v25
    v_cvt_pk_bf16_f32 v78, v22, v23
    ds_read_b128 v[72:75], v4 offset:19456
    v_add_f32 v26, v26, v28
    v_add_f32 v27, v27, v29
    v_cvt_pk_bf16_f32 v79, v26, v27
    v_cmp_u_f32 s[74:75], v22, v23
    v_cvt_pk_bf16_f32 v22, v18, v19
    v_mfma_f32_16x16x16_bf16 v[26:29], v[78:79], v[2:3], 0
    v_cvt_pk_bf16_f32 v23, v20, v21
    v_mov_b64 v[18:19], 0
    v_smfmac_f32_16x16x64_bf16 v[14:17], v[52:55], a[224:231], v1
    ds_read_b128 v[10:13], v0 offset:2048
    v_mov_b64 v[20:21], 0
    v_smfmac_f32_16x16x64_bf16 v[14:17], v[56:59], a[240:247], v1
    ds_read_b128 v[48:51], v0 offset:3072
    v_cvt_pk_bf16_f32 v24, v26, v27
    v_cvt_pk_bf16_f32 v25, v28, v29
    s_waitcnt vmcnt(4)
    s_nop 0
    v_mfma_f32_16x16x32_bf16 v[40:43], v[40:43], v[22:25], 0
    v_mfma_f32_16x16x32_bf16 v[44:47], v[44:47], v[22:25], 0
    s_cmp_lg_u64 s[74:75], 0
    v_mfma_f32_16x16x32_bf16 v[26:29], v[22:25], v[22:25], 0
    s_cbranch_scc1 nan_97
back_98:
    v_smfmac_f32_16x16x64_bf16 v[18:21], v[52:55], a[232:239], v1
    ds_read_b128 v[52:55], v0 offset:4096
    v_cndmask_b32_dpp v40, v44, v40, vcc quad_perm:[0,1,0,1] row_mask:0xf bank_mask:0xf
    v_cndmask_b32_dpp v41, v45, v41, vcc quad_perm:[0,1,0,1] row_mask:0xf bank_mask:0xf
    v_cndmask_b32_dpp v42, v46, v42, vcc quad_perm:[0,1,0,1] row_mask:0xf bank_mask:0xf
    v_cndmask_b32_dpp v43, v47, v43, vcc quad_perm:[0,1,0,1] row_mask:0xf bank_mask:0xf
    ds_write_b128 v5, v[40:43] offset:10240
    v_cndmask_b32_dpp v28, v29, v28, vcc quad_perm:[0,1,0,1] row_mask:0xf bank_mask:0xf
    ds_write_b32 v5, v28 offset:13316
    v_smfmac_f32_16x16x64_bf16 v[18:21], v[56:59], a[248:255], v1
    ds_read_b128 v[56:59], v0 offset:5120
    v_mov_b32 v42, 0
    s_waitcnt lgkmcnt(4)
    v_smfmac_f32_16x16x64_bf16 v[14:17], v[10:13], v[60:67], v1
    v_mov_b32 v47, 0
    v_smfmac_f32_16x16x64_bf16 v[18:21], v[10:13], v[68:75], v1
    ds_read_b128 v[10:13], v0 offset:6144
    v_mov_b32 v28, 0
    v_smfmac_f32_16x16x64_bf16 v[14:17], v[48:51], v[80:87], v1
    v_mov_b32 v41, 0
    v_smfmac_f32_16x16x64_bf16 v[18:21], v[48:51], v[88:95], v1
    ds_read_b128 v[48:51], v0 offset:7168
    s_waitcnt lgkmcnt(3)
    s_barrier
    ds_read_b128 v[60:63], v0 offset:9216
    v_smfmac_f32_16x16x64_bf16 v[14:17], v[52:55], v[96:103], v1
    ds_read_b128 v[64:67], v0 offset:10240
    v_smfmac_f32_16x16x64_bf16 v[18:21], v[52:55], v[104:111], v1
    ds_read_b128 v[68:71], v0 offset:11264
    s_waitcnt lgkmcnt(4)
    v_smfmac_f32_16x16x64_bf16 v[14:17], v[56:59], v[112:119], v1
    ds_read_b128 v[72:75], v0 offset:12288
    v_smfmac_f32_16x16x64_bf16 v[18:21], v[56:59], v[120:127], v1
    ds_read_b128 v[22:25], v0 offset:13312
    v_smfmac_f32_16x16x64_bf16 v[14:17], v[10:13], v[128:135], v1
    ds_read_b128 v[52:55], v0 offset:8192
    s_waitcnt lgkmcnt(4)
    v_add_f32 v60, v60, v64
    v_smfmac_f32_16x16x64_bf16 v[18:21], v[10:13], v[136:143], v1
    v_add_f32 v61, v61, v65
    v_smfmac_f32_16x16x64_bf16 v[14:17], v[48:51], v[144:151], v1
    v_add_f32 v62, v62, v66
    v_smfmac_f32_16x16x64_bf16 v[18:21], v[48:51], v[152:159], v1
    v_add_f32 v63, v63, v67
    s_waitcnt lgkmcnt(0)
    v_smfmac_f32_16x16x64_bf16 v[14:17], v[52:55], v[160:167], v1
    v_add_f32 v22, v22, v23
    v_smfmac_f32_16x16x64_bf16 v[18:21], v[52:55], v[168:175], v1
    v_add_f32 v24, v24, v25
    v_add_f32 v22, v22, v24
    v_add_f32 v68, v68, v72
    v_add_f32 v69, v69, v73
    v_pk_add_f32 v[70:71], v[70:71], v[74:75]
    v_pk_add_f32 v[60:61], v[60:61], v[68:69]
    v_pk_add_f32 v[62:63], v[62:63], v[70:71]
    v_max3_f32 v24, v60, v61, v22
    v_max3_f32 v24, v24, v62, v63
    v_pk_add_f32 v[14:15], v[14:15], v[16:17]
    v_pk_add_f32 v[18:19], v[18:19], v[20:21]
    v_max_f32_dpp v25, v24, v24 row_ror:8 row_mask:0xf bank_mask:0xf
    v_max_f32_dpp v24, v24, v24 row_ror:8 row_mask:0xf bank_mask:0xf
    v_cvt_pk_bf16_f32 v29, v14, v15
    v_cvt_pk_bf16_f32 v35, v18, v19
    v_permlane16_swap_b32 v24, v25
    v_max_f32 v23, v24, v25
    v_max_f32 v24, v24, v25
    v_lshrrev_b32 v34, 16, v29
    v_lshrrev_b32 v40, 16, v35
    v_permlane32_swap_b32 v24, v23
    v_max_f32 v24, v24, v23
    v_sub_f32 v22, v22, v24
    v_pk_add_f32 v[60:61], v[60:61], v[24:25] op_sel_hi:[1,0] neg_lo:[0,1] neg_hi:[0,1]
    v_pk_add_f32 v[62:63], v[62:63], v[24:25] op_sel_hi:[1,0] neg_lo:[0,1] neg_hi:[0,1]
    v_mul_f32 v22, s40, v22
    v_pk_mul_f32 v[60:61], v[60:61], s[2:3]
    v_pk_mul_f32 v[62:63], v[62:63], s[2:3]
    v_exp_f32 v22, v22
    v_exp_f32 v60, v60
    v_exp_f32 v61, v61
    v_exp_f32 v62, v62
    v_exp_f32 v63, v63
    v_cvt_pk_bf16_f32 v46, v22, 0
    v_cvt_pk_bf16_f32 v44, v60, v61
    v_cvt_pk_bf16_f32 v45, v62, v63
    v_cvt_pk_bf16_f32 v43, v22, 0
    s_waitcnt vmcnt(2)
    v_mfma_f32_16x16x32_bf16 v[64:67], v[32:35], v[44:47], 0
    v_mov_b64 v[48:49], s[36:37]
    v_mov_b64 v[50:51], s[36:37]
    v_mfma_f32_16x16x32_bf16 v[60:63], v[28:31], v[42:45], 0
    v_min_u32 v76, -2, v29
    v_mov_b32 v78, v35
    v_mfma_f32_16x16x32_bf16 v[52:55], v[48:51], v[42:45], 0
    v_mov_b64 v[14:15], 0
    v_mov_b64 v[16:17], 0
    v_mfma_f32_16x16x32_bf16 v[68:71], v[34:37], v[42:45], 0
    v_add_f32_dpp v56, v64, v60 row_ror:8 row_mask:0xf bank_mask:0x3
    v_add_f32_dpp v57, v65, v61 row_ror:8 row_mask:0xf bank_mask:0x3
    v_mfma_f32_16x16x32_bf16 v[72:75], v[38:41], v[44:47], 0
    v_add_f32_dpp v50, v52, v52 row_ror:8 row_mask:0xf bank_mask:0xf
    v_add_f32_dpp v58, v66, v62 row_ror:8 row_mask:0xf bank_mask:0x3
    v_add_f32_dpp v59, v67, v63 row_ror:8 row_mask:0xf bank_mask:0x3
    v_rcp_f32 v50, v50
    v_and_b32 v10, 0xffffffdf, v0
    v_lshrrev_b32 v11, 2, v0
    v_mov_b64 v[18:19], 0
    v_mov_b64 v[20:21], 0
    v_add_f32_dpp v56, v68, v72 row_ror:8 row_mask:0xf bank_mask:0xc
    v_add_f32_dpp v57, v69, v73 row_ror:8 row_mask:0xf bank_mask:0xc
    v_add_f32_dpp v58, v70, v74 row_ror:8 row_mask:0xf bank_mask:0xc
    v_add_f32_dpp v59, v71, v75 row_ror:8 row_mask:0xf bank_mask:0xc
    v_pk_mul_f32 v[56:57], v[56:57], v[50:51] op_sel_hi:[1,0]
    v_pk_mul_f32 v[58:59], v[58:59], v[50:51] op_sel_hi:[1,0]
    v_cvt_pk_bf16_f32 v56, v56, v57
    v_cvt_pk_bf16_f32 v57, v58, v59
    ds_write_b64 v6, v[56:57] offset:512
    v_mfma_f32_16x16x32_bf16 v[22:25], v[14:17], v[14:17], 0
    ds_read_b128 v[60:63], v4 offset:20480
    ds_read_b128 v[64:67], v4 offset:21504
    ds_read_b128 v[68:71], v4 offset:24576
    ds_read_b128 v[72:75], v4 offset:25600
    v_mfma_f32_16x16x32_bf16 v[26:29], v[14:17], v[14:17], 0
    s_waitcnt lgkmcnt(4)
    s_barrier
    ds_read_b128 v[42:45], v10 offset:0
    ds_read_b128 v[50:53], v10 offset:1024
    v_mfma_f32_16x16x32_bf16 v[30:33], v[14:17], v[14:17], 0
    ds_read_b128 v[34:37], v0 offset:0
    ds_read_b128 v[46:49], v10 offset:32
    s_waitcnt lgkmcnt(3)
    v_smfmac_f32_16x16x64_bf16 v[18:21], v[42:45], v[176:183], v1
    ds_read_b128 v[38:41], v0 offset:1024
    v_smfmac_f32_16x16x64_bf16 v[22:25], v[42:45], v[192:199], v1
    ds_read_b128 v[54:57], v10 offset:1056
    s_waitcnt lgkmcnt(4)
    v_smfmac_f32_16x16x64_bf16 v[18:21], v[50:53], v[60:67], v1
    ds_read_b128 v[60:63], v4 offset:22528
    v_smfmac_f32_16x16x64_bf16 v[22:25], v[50:53], v[68:75], v1
    ds_read_b128 v[64:67], v4 offset:23552
    s_waitcnt lgkmcnt(4)
    v_smfmac_f32_16x16x64_bf16 v[14:17], v[34:37], v[240:247], v1
    ds_read_b128 v[68:71], v4 offset:26624
    v_smfmac_f32_16x16x64_bf16 v[18:21], v[46:49], v[184:191], v1
    ds_read_b128 v[72:75], v4 offset:27648
    s_waitcnt lgkmcnt(4)
    v_smfmac_f32_16x16x64_bf16 v[14:17], v[38:41], v[248:255], v1
    ds_read_b128 v[34:37], v4 offset:28672
    v_smfmac_f32_16x16x64_bf16 v[22:25], v[46:49], v[200:207], v1
    ds_read_b128 v[38:41], v4 offset:29696
    s_waitcnt lgkmcnt(4)
    v_smfmac_f32_16x16x64_bf16 v[18:21], v[54:57], v[60:67], v1
    ds_read_b128 v[60:63], v4 offset:30720
    v_add_f32 v14, v14, v16
    v_add_f32 v15, v15, v17
    s_waitcnt lgkmcnt(3)
    v_smfmac_f32_16x16x64_bf16 v[22:25], v[54:57], v[68:75], v1
    ds_read_b128 v[64:67], v4 offset:31744
    v_cvt_pk_bf16_f32 v58, v14, v15
    v_and_or_b32 v58, v58, -2, s46
    buffer_store_dword v58, v11, s[4:7], s20 offen sc1
    v_smfmac_f32_16x16x64_bf16 v[26:29], v[42:45], v[208:215], v1
    ds_read_b128 v[68:71], v4 offset:32768
    v_cvt_pk_bf16_f32 v18, v18, v19
    v_cvt_pk_bf16_f32 v19, v20, v21
    v_and_or_b32 v18, v18, -2, s46
    v_smfmac_f32_16x16x64_bf16 v[26:29], v[46:49], v[216:223], v1
    ds_read_b128 v[72:75], v4 offset:33792
    v_cvt_pk_bf16_f32 v20, v22, v23
    v_cvt_pk_bf16_f32 v21, v24, v25
    buffer_store_dwordx4 v[18:21], v0, s[4:7], s18 offen sc1
    s_waitcnt lgkmcnt(4)
    v_smfmac_f32_16x16x64_bf16 v[26:29], v[50:53], v[34:41], v1
    ds_read_b128 v[34:37], v4 offset:34816
    v_smfmac_f32_16x16x64_bf16 v[30:33], v[42:45], v[224:231], v1
    ds_read_b128 v[38:41], v4 offset:35840
    s_waitcnt lgkmcnt(4)
    v_smfmac_f32_16x16x64_bf16 v[26:29], v[54:57], v[60:67], v1
    s_waitcnt lgkmcnt(2)
    v_smfmac_f32_16x16x64_bf16 v[30:33], v[50:53], v[68:75], v1
    v_smfmac_f32_16x16x64_bf16 v[30:33], v[46:49], v[232:239], v1
    v_cvt_pk_bf16_f32 v26, v26, v27
    v_cvt_pk_bf16_f32 v27, v28, v29
    s_waitcnt lgkmcnt(0)
    v_smfmac_f32_16x16x64_bf16 v[30:33], v[54:57], v[34:41], v1
    v_and_or_b32 v26, v26, -2, s46
    s_nop 6
    v_cvt_pk_bf16_f32 v28, v30, v31
    v_cvt_pk_bf16_f32 v29, v32, v33
    buffer_store_dwordx4 v[26:29], v0, s[4:7], s19 offen sc1
    v_bfe_u32 v58, v0, 6, 1
    v_lshlrev_b32 v58, 4, v58
    v_mov_b32 v59, 0x3f80
    v_lshlrev_b32 v58, v58, v59
    v_cndmask_b32 v10, 0, v58, s[30:31]
    s_lshl_b64 vcc, s[30:31], 1
    v_cndmask_b32 v11, 0, v58, vcc
    s_lshl_b64 vcc, s[30:31], 2
    v_cndmask_b32 v12, 0, v58, vcc
    s_lshl_b64 vcc, s[30:31], 3
    v_cndmask_b32 v13, 0, v58, vcc
    v_mov_b64 v[54:55], -1
    s_mov_b32 s41, 0
    s_xor_b32 s18, s18, 0x100000
    s_xor_b32 s19, s19, 0x100000
    s_xor_b32 s20, s20, 0x100000
    s_add_u32 s17, s17, 0x4000
    s_and_b32 s17, s17, 0xfffeffff
    s_add_u32 s21, s21, 262144
    s_add_u32 s22, s22, 262144
    s_add_u32 s23, s23, 131072
    s_waitcnt vmcnt(0)
    buffer_load_dwordx4 v[34:37], v7, s[4:7], s24 offen sc1
    buffer_load_dwordx4 v[38:41], v7, s[4:7], s25 offen sc1
    buffer_load_dwordx4 v[42:45], v7, s[4:7], s26 offen sc1
    buffer_load_dwordx4 v[46:49], v7, s[4:7], s27 offen sc1
    s_waitcnt vmcnt(3)
    v_mfma_f32_16x16x32_bf16 v[50:53], v[10:13], v[34:37], 0
    s_waitcnt vmcnt(2)
    v_mfma_f32_16x16x32_bf16 v[50:53], v[10:13], v[38:41], v[50:53]
    v_bitop3_b32 v58, v34, v38, s46 bitop3:0x7e
    s_waitcnt vmcnt(1)
    v_mfma_f32_16x16x32_bf16 v[50:53], v[10:13], v[42:45], v[50:53]
    s_waitcnt vmcnt(0)
    v_mfma_f32_16x16x32_bf16 v[50:53], v[10:13], v[46:49], v[50:53]
    v_bitop3_b32 v59, v42, v46, s46 bitop3:0x7e
    v_or_b32 v58, v58, v59
    v_and_b32 v58, 1, v58
    v_cmp_ne_u32 vcc, 0, v58
    s_cbranch_vccnz pp_99
ok_100:
    s_nop 2
    v_add_f32_dpp v50, v50, v50 row_ror:8 row_mask:0xf bank_mask:0xf
    v_add_f32_dpp v51, v51, v51 row_ror:8 row_mask:0xf bank_mask:0xf
    v_add_f32_dpp v52, v52, v52 row_ror:8 row_mask:0xf bank_mask:0xf
    v_add_f32_dpp v53, v53, v53 row_ror:8 row_mask:0xf bank_mask:0xf
    s_mov_b64 exec, s[28:29]
    v_cvt_pk_bf16_f32 v58, v50, v51
    v_cvt_pk_bf16_f32 v59, v52, v53
    v_min_u32 v58, -2, v58
    buffer_store_dwordx2 v[58:59], v8, s[4:7], s17 offen sc1
    buffer_store_dwordx2 v[54:55], v8, s[4:7], s47 offen sc1
    s_mov_b64 exec, -1
    s_xor_b32 s24, s24, 0x100000
    s_xor_b32 s25, s25, 0x100000
    s_xor_b32 s26, s26, 0x100000
    s_xor_b32 s27, s27, 0x100000
    s_add_u32 s47, s47, 0x4000
    s_and_b32 s47, s47, 0xfffeffff
    s_and_b32 s42, s16, 1
    s_xor_b32 s46, s46, s42
    s_add_u32 s16, s16, 1
    s_cmp_lt_u32 s16, 63
    s_cbranch_scc1 step_95
step_101:
    s_mov_b32 s41, 0
    s_add_u32 s86, s17, 6144
    s_mov_b32 m0, 6144
    s_mov_b32 s72, s23
    s_mov_b32 s76, 0
    v_mov_b64 v[14:15], 0
    v_mov_b64 v[16:17], 0
    v_mov_b64 v[18:19], 0
    v_mov_b64 v[20:21], 0
    v_mov_b64 v[22:23], 0
    v_mov_b64 v[24:25], 0
    v_mov_b64 v[26:27], 0
    v_mov_b64 v[28:29], 0
redo_102:
    s_waitcnt lgkmcnt(0)
    s_barrier
    ds_read_b128 v[48:51], v0 offset:0
    s_mov_b32 m0, 6144
    s_nop 0
    buffer_load_dwordx4 v0, s[4:7], s86 offen offset:0 sc1 lds
    ds_read_b128 v[52:55], v0 offset:1024
    ds_read_b128 v[56:59], v0 offset:2048
    s_mov_b32 m0, 15616
    ds_read_b128 v[60:63], v4 offset:0
    ds_read_b128 v[64:67], v4 offset:1024
    s_waitcnt lgkmcnt(4)
    v_smfmac_f32_16x16x64_bf16 v[14:17], v[48:51], a[224:231], v1
    ds_read_b128 v[68:71], v4 offset:2048
    ds_read_b128 v[72:75], v4 offset:3072
    ds_read_b128 v[10:13], v0 offset:3072
    v_smfmac_f32_16x16x64_bf16 v[22:25], v[48:51], a[232:239], v1
    buffer_store_dwordx4 v[76:79], v0, s[4:7], s72 offen sc1
    v_smfmac_f32_16x16x64_bf16 v[18:21], v[48:51], a[144:151], v1
    v_smfmac_f32_16x16x64_bf16 v[26:29], v[48:51], a[152:159], v1
    s_waitcnt lgkmcnt(3)
    v_smfmac_f32_16x16x64_bf16 v[14:17], v[52:55], a[240:247], v1
    v_smfmac_f32_16x16x64_bf16 v[22:25], v[52:55], a[248:255], v1
    v_smfmac_f32_16x16x64_bf16 v[18:21], v[52:55], v[60:67], v1
    ds_read_b128 v[60:63], v4 offset:4096
    s_waitcnt lgkmcnt(1)
    v_smfmac_f32_16x16x64_bf16 v[26:29], v[52:55], v[68:75], v1
    ds_read_b128 v[64:67], v4 offset:5120
    v_smfmac_f32_16x16x64_bf16 v[18:21], v[56:59], a[160:167], v1
    ds_read_b128 v[68:71], v4 offset:6144
    v_smfmac_f32_16x16x64_bf16 v[26:29], v[56:59], a[168:175], v1
    ds_read_b128 v[72:75], v4 offset:7168
    s_waitcnt vmcnt(1)
    s_barrier
    ds_read_b128 v[48:51], v0 offset:4096
    v_smfmac_f32_16x16x64_bf16 v[14:17], v[10:13], v[80:87], v1
    ds_read_b128 v[52:55], v0 offset:5120
    v_smfmac_f32_16x16x64_bf16 v[22:25], v[10:13], v[88:95], v1
    ds_read_b128 v[56:59], v0 offset:6144
    s_waitcnt lgkmcnt(5)
    v_smfmac_f32_16x16x64_bf16 v[18:21], v[10:13], v[60:67], v1
    ds_read_b128 v[60:63], v4 offset:8192
    s_waitcnt lgkmcnt(4)
    v_smfmac_f32_16x16x64_bf16 v[26:29], v[10:13], v[68:75], v1
    ds_read_b128 v[64:67], v4 offset:9216
    s_waitcnt lgkmcnt(4)
    v_smfmac_f32_16x16x64_bf16 v[14:17], v[48:51], v[96:103], v1
    ds_read_b128 v[10:13], v0 offset:7168
    v_smfmac_f32_16x16x64_bf16 v[22:25], v[48:51], v[104:111], v1
    ds_read_b128 v[68:71], v4 offset:10240
    v_smfmac_f32_16x16x64_bf16 v[18:21], v[48:51], a[176:183], v1
    ds_read_b128 v[72:75], v4 offset:11264
    v_smfmac_f32_16x16x64_bf16 v[26:29], v[48:51], a[184:191], v1
    s_waitcnt lgkmcnt(3)
    v_smfmac_f32_16x16x64_bf16 v[14:17], v[52:55], v[112:119], v1
    ds_read_b128 v[48:51], v0 offset:8192
    v_smfmac_f32_16x16x64_bf16 v[22:25], v[52:55], v[120:127], v1
    v_smfmac_f32_16x16x64_bf16 v[18:21], v[52:55], v[60:67], v1
    ds_read_b128 v[60:63], v4 offset:12288
    s_waitcnt lgkmcnt(2)
    v_smfmac_f32_16x16x64_bf16 v[26:29], v[52:55], v[68:75], v1
    ds_read_b128 v[64:67], v4 offset:13312
    v_smfmac_f32_16x16x64_bf16 v[14:17], v[56:59], v[128:135], v1
    ds_read_b128 v[68:71], v4 offset:14336
    v_smfmac_f32_16x16x64_bf16 v[22:25], v[56:59], v[136:143], v1
    ds_read_b128 v[72:75], v4 offset:15360
    v_smfmac_f32_16x16x64_bf16 v[18:21], v[56:59], a[192:199], v1
    v_smfmac_f32_16x16x64_bf16 v[26:29], v[56:59], a[200:207], v1
    v_smfmac_f32_16x16x64_bf16 v[14:17], v[10:13], v[144:151], v1
    v_smfmac_f32_16x16x64_bf16 v[22:25], v[10:13], v[152:159], v1
    s_waitcnt lgkmcnt(0)
    v_smfmac_f32_16x16x64_bf16 v[18:21], v[10:13], v[60:67], v1
    ds_read_b128 v[60:63], v4 offset:16384
    v_smfmac_f32_16x16x64_bf16 v[26:29], v[10:13], v[68:75], v1
    ds_read_b128 v[64:67], v4 offset:17408
    v_smfmac_f32_16x16x64_bf16 v[14:17], v[48:51], v[160:167], v1
    ds_read_b128 v[10:13], v0 offset:2048
    v_smfmac_f32_16x16x64_bf16 v[22:25], v[48:51], v[168:175], v1
    ds_read_b128 v[68:71], v4 offset:18432
    v_smfmac_f32_16x16x64_bf16 v[18:21], v[48:51], a[208:215], v1
    ds_read_b128 v[72:75], v4 offset:19456
    v_smfmac_f32_16x16x64_bf16 v[26:29], v[48:51], a[216:223], v1
    s_waitcnt lgkmcnt(2)
    v_smfmac_f32_16x16x64_bf16 v[14:17], v[10:13], v[60:67], v1
    s_waitcnt lgkmcnt(0)
    v_smfmac_f32_16x16x64_bf16 v[22:25], v[10:13], v[68:75], v1
    v_add_f32 v18, v18, v20
    v_add_f32 v19, v19, v21
    v_cvt_pk_bf16_f32 v77, v18, v19
    v_add_f32 v26, v26, v28
    v_add_f32 v27, v27, v29
    v_cvt_pk_bf16_f32 v79, v26, v27
    v_add_f32 v14, v14, v16
    v_add_f32 v15, v15, v17
    v_cvt_pk_bf16_f32 v76, v14, v15
    v_add_f32 v22, v22, v24
    v_add_f32 v23, v23, v25
    v_cvt_pk_bf16_f32 v78, v22, v23
    v_cmp_u_f32 s[74:75], v26, v27
    v_min_u32 v76, -2, v76
    s_cmp_lg_u64 s[74:75], 0
    s_cbranch_scc1 nan_103
back_104:
    s_add_u32 s23, s23, 131072
    buffer_store_dwordx4 v[76:79], v0, s[4:7], s23 offen sc1
    s_branch done
nan_103:
    v_mov_b32 v34, 0
    ds_read_b32 v35, v0 offset:4096
    s_waitcnt lgkmcnt(0)
    v_max_u32 v34, v34, v35
    ds_read_b32 v35, v0 offset:4104
    s_waitcnt lgkmcnt(0)
    v_max_u32 v34, v34, v35
    ds_read_b32 v35, v0 offset:5120
    s_waitcnt lgkmcnt(0)
    v_max_u32 v34, v34, v35
    ds_read_b32 v35, v0 offset:5128
    s_waitcnt lgkmcnt(0)
    v_max_u32 v34, v34, v35
    ds_read_b32 v35, v0 offset:6144
    s_waitcnt lgkmcnt(0)
    v_max_u32 v34, v34, v35
    ds_read_b32 v35, v0 offset:6152
    s_waitcnt lgkmcnt(0)
    v_max_u32 v34, v34, v35
    ds_read_b32 v35, v0 offset:7168
    s_waitcnt lgkmcnt(0)
    v_max_u32 v34, v34, v35
    ds_read_b32 v35, v0 offset:7176
    s_waitcnt lgkmcnt(0)
    v_max_u32 v34, v34, v35
    ds_read_b32 v35, v0 offset:8192
    s_waitcnt lgkmcnt(0)
    v_max_u32 v34, v34, v35
    ds_read_b32 v35, v0 offset:8200
    s_waitcnt lgkmcnt(0)
    v_max_u32 v34, v34, v35
    v_cmp_eq_u32 s[74:75], -1, v34
    s_nop 0
    s_cmp_eq_u64 s[74:75], 0
    s_cbranch_scc1 back_104
    s_add_u32 s76, s76, 1
    s_cmp_gt_u32 s76, 2000000
    s_cbranch_scc1 fin1
    s_mov_b32 s72, 100662272
    v_mov_b64 v[14:15], 0
    v_mov_b64 v[16:17], 0
    v_mov_b64 v[18:19], 0
    v_mov_b64 v[20:21], 0
    v_mov_b64 v[22:23], 0
    v_mov_b64 v[24:25], 0
    v_mov_b64 v[26:27], 0
    v_mov_b64 v[28:29], 0
    s_waitcnt vmcnt(0)
    s_barrier
    s_branch redo_102
nan_97:
    v_mov_b32 v34, 0
    ds_read_b32 v35, v0 offset:4096
    s_waitcnt lgkmcnt(0)
    v_max_u32 v34, v34, v35
    ds_read_b32 v35, v0 offset:4104
    s_waitcnt lgkmcnt(0)
    v_max_u32 v34, v34, v35
    ds_read_b32 v35, v0 offset:5120
    s_waitcnt lgkmcnt(0)
    v_max_u32 v34, v34, v35
    ds_read_b32 v35, v0 offset:5128
    s_waitcnt lgkmcnt(0)
    v_max_u32 v34, v34, v35
    ds_read_b32 v35, v0 offset:6144
    s_waitcnt lgkmcnt(0)
    v_max_u32 v34, v34, v35
    ds_read_b32 v35, v0 offset:6152
    s_waitcnt lgkmcnt(0)
    v_max_u32 v34, v34, v35
    ds_read_b32 v35, v0 offset:7168
    s_waitcnt lgkmcnt(0)
    v_max_u32 v34, v34, v35
    ds_read_b32 v35, v0 offset:7176
    s_waitcnt lgkmcnt(0)
    v_max_u32 v34, v34, v35
    ds_read_b32 v35, v0 offset:8192
    s_waitcnt lgkmcnt(0)
    v_max_u32 v34, v34, v35
    ds_read_b32 v35, v0 offset:8200
    s_waitcnt lgkmcnt(0)
    v_max_u32 v34, v34, v35
    v_cmp_eq_u32 s[74:75], -1, v34
    s_nop 0
    s_cmp_eq_u64 s[74:75], 0
    s_cbranch_scc1 back_98
    s_add_u32 s76, s76, 1
    s_cmp_gt_u32 s76, 2000000
    s_cbranch_scc1 fin1
    s_mov_b32 s72, 100662272
    v_mov_b64 v[14:15], 0
    v_mov_b64 v[16:17], 0
    v_mov_b64 v[18:19], 0
    v_mov_b64 v[20:21], 0
    v_mov_b64 v[22:23], 0
    v_mov_b64 v[24:25], 0
    v_mov_b64 v[26:27], 0
    v_mov_b64 v[28:29], 0
    s_waitcnt vmcnt(0)
    s_barrier
    s_branch redo_96
pp_99:
    buffer_load_dwordx4 v[34:37], v7, s[4:7], s24 offen sc1
    buffer_load_dwordx4 v[38:41], v7, s[4:7], s25 offen sc1
    buffer_load_dwordx4 v[42:45], v7, s[4:7], s26 offen sc1
    buffer_load_dwordx4 v[46:49], v7, s[4:7], s27 offen sc1
    s_add_u32 s41, s41, 1
    s_cmp_gt_u32 s41, 2000000
    s_cbranch_scc1 fin1
    s_waitcnt vmcnt(3)
    v_mfma_f32_16x16x32_bf16 v[50:53], v[10:13], v[34:37], 0
    s_waitcnt vmcnt(2)
    v_mfma_f32_16x16x32_bf16 v[50:53], v[10:13], v[38:41], v[50:53]
    v_bitop3_b32 v58, v34, v38, s46 bitop3:0x7e
    s_waitcnt vmcnt(1)
    v_mfma_f32_16x16x32_bf16 v[50:53], v[10:13], v[42:45], v[50:53]
    s_waitcnt vmcnt(0)
    v_mfma_f32_16x16x32_bf16 v[50:53], v[10:13], v[46:49], v[50:53]
    v_bitop3_b32 v59, v42, v46, s46 bitop3:0x7e
    v_or_b32 v58, v58, v59
    v_and_b32 v58, 1, v58
    v_cmp_ne_u32 vcc, 0, v58
    s_cbranch_vccnz pp_99
    s_branch ok_100
role_79:
.p2align 6
step_105:
    s_mov_b32 s41, 0
    s_add_u32 s38, s17, 4096
    s_add_u32 s86, s17, 7168
    s_mov_b32 m0, 7168
    s_mov_b32 s72, s23
    s_mov_b32 s76, 0
    v_mov_b64 v[14:15], 0
    v_mov_b64 v[16:17], 0
    v_mov_b64 v[18:19], 0
    v_mov_b64 v[20:21], 0
    v_mov_b64 v[22:23], 0
    v_mov_b64 v[24:25], 0
    v_mov_b64 v[26:27], 0
    v_mov_b64 v[28:29], 0
    s_nop 9
    buffer_load_dwordx4 v[40:43], v0, s[4:7], s38 offen offset:0 sc1
    s_nop 15
    s_nop 7
    buffer_load_dwordx4 v[60:63], v0, s[4:7], s38 offen offset:0 sc1
    s_waitcnt vmcnt(1)
    ds_write_b128 v0, v[40:43] offset:4096
    v_max_u32 v34, v40, v42
    v_cmp_eq_u32 vcc, -1, v34
    s_cbranch_vccnz pp_106
ok_107:
redo_108:
    s_waitcnt lgkmcnt(0)
    s_barrier
    ds_read_b128 v[48:51], v0 offset:0
    s_mov_b32 m0, 7168
    s_nop 0
    buffer_load_dwordx4 v0, s[4:7], s86 offen offset:0 sc1 lds
    ds_read_b128 v[52:55], v0 offset:1024
    ds_read_b128 v[56:59], v0 offset:2048
    s_mov_b32 m0, 15872
    s_waitcnt lgkmcnt(2)
    v_smfmac_f32_16x16x64_bf16 v[14:17], v[48:51], a[0:7], v1
    s_waitcnt vmcnt(1)
    ds_read_b128 v[60:63], v4 offset:0
    ds_read_b128 v[64:67], v4 offset:1024
    v_smfmac_f32_16x16x64_bf16 v[22:25], v[48:51], a[8:15], v1
    ds_read_b128 v[68:71], v4 offset:2048
    ds_read_b128 v[72:75], v4 offset:3072
    v_smfmac_f32_16x16x64_bf16 v[18:21], v[48:51], a[144:151], v1
    ds_read_b128 v[10:13], v0 offset:3072
    v_smfmac_f32_16x16x64_bf16 v[26:29], v[48:51], a[152:159], v1
    ds_read_b128 v[48:51], v0 offset:4096
    s_waitcnt lgkmcnt(6)
    v_smfmac_f32_16x16x64_bf16 v[14:17], v[52:55], a[16:23], v1
    buffer_load_dwordx4 v[40:43], v9, s[4:7], s21 offen sc1 nt
    v_smfmac_f32_16x16x64_bf16 v[22:25], v[52:55], a[24:31], v1
    buffer_load_dwordx4 v[44:47], v9, s[4:7], s21 offen offset:256 sc1 nt
    s_waitcnt lgkmcnt(2)
    v_smfmac_f32_16x16x64_bf16 v[18:21], v[52:55], v[60:67], v1
    ds_read_b128 v[60:63], v4 offset:4096
    v_smfmac_f32_16x16x64_bf16 v[26:29], v[52:55], v[68:75], v1
    ds_read_b128 v[64:67], v4 offset:5120
    v_smfmac_f32_16x16x64_bf16 v[14:17], v[56:59], a[32:39], v1
    ds_read_b128 v[68:71], v4 offset:6144
    v_smfmac_f32_16x16x64_bf16 v[22:25], v[56:59], a[40:47], v1
    ds_read_b128 v[72:75], v4 offset:7168
    v_smfmac_f32_16x16x64_bf16 v[18:21], v[56:59], a[160:167], v1
    buffer_load_dwordx4 v[30:33], v9, s[4:7], s22 offen sc1 nt
    v_smfmac_f32_16x16x64_bf16 v[26:29], v[56:59], a[168:175], v1
    buffer_load_dwordx4 v[36:39], v9, s[4:7], s22 offen offset:256 sc1 nt
    s_waitcnt lgkmcnt(2)
    v_smfmac_f32_16x16x64_bf16 v[14:17], v[10:13], a[48:55], v1
    v_smfmac_f32_16x16x64_bf16 v[22:25], v[10:13], a[56:63], v1
    v_smfmac_f32_16x16x64_bf16 v[18:21], v[10:13], v[60:67], v1
    ds_read_b128 v[60:63], v4 offset:8192
    s_waitcnt lgkmcnt(1)
    v_smfmac_f32_16x16x64_bf16 v[26:29], v[10:13], v[68:75], v1
    ds_read_b128 v[64:67], v4 offset:9216
    v_lshlrev_b32 v35, 3, v0
    v_smfmac_f32_16x16x64_bf16 v[14:17], v[48:51], a[64:71], v1
    ds_read_b128 v[68:71], v4 offset:10240
    s_waitcnt vmcnt(4)
    s_barrier
    ds_read_b128 v[52:55], v0 offset:5120
    v_smfmac_f32_16x16x64_bf16 v[22:25], v[48:51], a[72:79], v1
    ds_read_b128 v[56:59], v0 offset:6144
    v_smfmac_f32_16x16x64_bf16 v[18:21], v[48:51], a[176:183], v1
    ds_read_b128 v[10:13], v0 offset:7168
    v_smfmac_f32_16x16x64_bf16 v[26:29], v[48:51], a[184:191], v1
    ds_read_b128 v[72:75], v4 offset:11264
    s_waitcnt lgkmcnt(3)
    v_smfmac_f32_16x16x64_bf16 v[14:17], v[52:55], a[80:87], v1
    ds_read_b128 v[48:51], v0 offset:8192
    v_smfmac_f32_16x16x64_bf16 v[22:25], v[52:55], a[88:95], v1
    buffer_store_dwordx4 v[76:79], v0, s[4:7], s72 offen sc1
    v_smfmac_f32_16x16x64_bf16 v[18:21], v[52:55], v[60:67], v1
    ds_read_b128 v[60:63], v4 offset:12288
    s_waitcnt lgkmcnt(2)
    v_smfmac_f32_16x16x64_bf16 v[26:29], v[52:55], v[68:75], v1
    ds_read_b128 v[64:67], v4 offset:13312
    v_smfmac_f32_16x16x64_bf16 v[14:17], v[56:59], a[96:103], v1
    ds_read_b128 v[68:71], v4 offset:14336
    v_smfmac_f32_16x16x64_bf16 v[22:25], v[56:59], a[104:111], v1
    ds_read_b128 v[72:75], v4 offset:15360
    v_smfmac_f32_16x16x64_bf16 v[18:21], v[56:59], a[192:199], v1
    ds_read_b128 v[52:55], v0 offset:0
    v_smfmac_f32_16x16x64_bf16 v[26:29], v[56:59], a[200:207], v1
    ds_read_b128 v[56:59], v0 offset:1024
    s_mov_b64 vcc, s[34:35]
    v_smfmac_f32_16x16x64_bf16 v[14:17], v[10:13], a[112:119], v1
    s_add_u32 s42, s22, 520192
    buffer_load_dword v35, s[4:7], s42 offen sc1 lds
    s_waitcnt lgkmcnt(3)
    v_smfmac_f32_16x16x64_bf16 v[14:17], v[48:51], a[128:135], v1
    v_smfmac_f32_16x16x64_bf16 v[18:21], v[48:51], a[208:215], v1
    v_smfmac_f32_16x16x64_bf16 v[18:21], v[10:13], v[60:67], v1
    ds_read_b128 v[60:63], v4 offset:16384
    v_add_f32 v14, v14, v16
    v_smfmac_f32_16x16x64_bf16 v[22:25], v[48:51], a[136:143], v1
    ds_read_b128 v[64:67], v4 offset:17408
    v_add_f32 v15, v15, v17
    v_cvt_pk_bf16_f32 v76, v14, v15
    v_smfmac_f32_16x16x64_bf16 v[22:25], v[10:13], a[120:127], v1
    v_add_f32 v18, v18, v20
    v_add_f32 v19, v19, v21
    v_smfmac_f32_16x16x64_bf16 v[26:29], v[48:51], a[216:223], v1
    v_cvt_pk_bf16_f32 v77, v18, v19
    v_mov_b64 v[14:15], 0
    s_waitcnt lgkmcnt(2)
    v_smfmac_f32_16x16x64_bf16 v[26:29], v[10:13], v[68:75], v1
    ds_read_b128 v[68:71], v4 offset:18432
    v_mov_b64 v[16:17], 0
    v_mfma_f32_16x16x16_bf16 v[18:21], v[76:77], v[2:3], 0
    v_add_f32 v22, v22, v24
    v_add_f32 v23, v23, v25
    v_cvt_pk_bf16_f32 v78, v22, v23
    ds_read_b128 v[72:75], v4 offset:19456
    v_add_f32 v26, v26, v28
    v_add_f32 v27, v27, v29
    v_cvt_pk_bf16_f32 v79, v26, v27
    v_cmp_u_f32 s[74:75], v22, v23
    v_cvt_pk_bf16_f32 v22, v18, v19
    v_mfma_f32_16x16x16_bf16 v[26:29], v[78:79], v[2:3], 0
    v_cvt_pk_bf16_f32 v23, v20, v21
    v_mov_b64 v[18:19], 0
    v_smfmac_f32_16x16x64_bf16 v[14:17], v[52:55], a[224:231], v1
    ds_read_b128 v[10:13], v0 offset:2048
    v_mov_b64 v[20:21], 0
    v_smfmac_f32_16x16x64_bf16 v[14:17], v[56:59], a[240:247], v1
    ds_read_b128 v[48:51], v0 offset:3072
    v_cvt_pk_bf16_f32 v24, v26, v27
    v_cvt_pk_bf16_f32 v25, v28, v29
    s_waitcnt vmcnt(4)
    s_nop 0
    v_mfma_f32_16x16x32_bf16 v[40:43], v[40:43], v[22:25], 0
    v_mfma_f32_16x16x32_bf16 v[44:47], v[44:47], v[22:25], 0
    s_cmp_lg_u64 s[74:75], 0
    v_mfma_f32_16x16x32_bf16 v[26:29], v[22:25], v[22:25], 0
    s_cbranch_scc1 nan_109
back_110:
    v_smfmac_f32_16x16x64_bf16 v[18:21], v[52:55], a[232:239], v1
    ds_read_b128 v[52:55], v0 offset:4096
    v_cndmask_b32_dpp v40, v44, v40, vcc quad_perm:[0,1,0,1] row_mask:0xf bank_mask:0xf
    v_cndmask_b32_dpp v41, v45, v41, vcc quad_perm:[0,1,0,1] row_mask:0xf bank_mask:0xf
    v_cndmask_b32_dpp v42, v46, v42, vcc quad_perm:[0,1,0,1] row_mask:0xf bank_mask:0xf
    v_cndmask_b32_dpp v43, v47, v43, vcc quad_perm:[0,1,0,1] row_mask:0xf bank_mask:0xf
    ds_write_b128 v5, v[40:43] offset:11264
    v_cndmask_b32_dpp v28, v29, v28, vcc quad_perm:[0,1,0,1] row_mask:0xf bank_mask:0xf
    ds_write_b32 v5, v28 offset:13320
    v_smfmac_f32_16x16x64_bf16 v[18:21], v[56:59], a[248:255], v1
    ds_read_b128 v[56:59], v0 offset:5120
    v_mov_b32 v42, 0
    s_waitcnt lgkmcnt(4)
    v_smfmac_f32_16x16x64_bf16 v[14:17], v[10:13], v[60:67], v1
    v_mov_b32 v47, 0
    v_smfmac_f32_16x16x64_bf16 v[18:21], v[10:13], v[68:75], v1
    ds_read_b128 v[10:13], v0 offset:6144
    v_mov_b32 v28, 0
    v_smfmac_f32_16x16x64_bf16 v[14:17], v[48:51], v[80:87], v1
    v_mov_b32 v41, 0
    v_smfmac_f32_16x16x64_bf16 v[18:21], v[48:51], v[88:95], v1
    ds_read_b128 v[48:51], v0 offset:7168
    s_waitcnt lgkmcnt(3)
    s_barrier
    ds_read_b128 v[60:63], v0 offset:9216
    v_smfmac_f32_16x16x64_bf16 v[14:17], v[52:55], v[96:103], v1
    ds_read_b128 v[64:67], v0 offset:10240
    v_smfmac_f32_16x16x64_bf16 v[18:21], v[52:55], v[104:111], v1
    ds_read_b128 v[68:71], v0 offset:11264
    s_waitcnt lgkmcnt(4)
    v_smfmac_f32_16x16x64_bf16 v[14:17], v[56:59], v[112:119], v1
    ds_read_b128 v[72:75], v0 offset:12288
    v_smfmac_f32_16x16x64_bf16 v[18:21], v[56:59], v[120:127], v1
    ds_read_b128 v[22:25], v0 offset:13312
    v_smfmac_f32_16x16x64_bf16 v[14:17], v[10:13], v[128:135], v1
    ds_read_b128 v[52:55], v0 offset:8192
    s_waitcnt lgkmcnt(4)
    v_add_f32 v60, v60, v64
    v_smfmac_f32_16x16x64_bf16 v[18:21], v[10:13], v[136:143], v1
    v_add_f32 v61, v61, v65
    v_smfmac_f32_16x16x64_bf16 v[14:17], v[48:51], v[144:151], v1
    v_add_f32 v62, v62, v66
    v_smfmac_f32_16x16x64_bf16 v[18:21], v[48:51], v[152:159], v1
    v_add_f32 v63, v63, v67
    s_waitcnt lgkmcnt(0)
    v_smfmac_f32_16x16x64_bf16 v[14:17], v[52:55], v[160:167], v1
    v_add_f32 v22, v22, v23
    v_smfmac_f32_16x16x64_bf16 v[18:21], v[52:55], v[168:175], v1
    v_add_f32 v24, v24, v25
    v_add_f32 v22, v22, v24
    v_add_f32 v68, v68, v72
    v_add_f32 v69, v69, v73
    v_pk_add_f32 v[70:71], v[70:71], v[74:75]
    v_pk_add_f32 v[60:61], v[60:61], v[68:69]
    v_pk_add_f32 v[62:63], v[62:63], v[70:71]
    v_max3_f32 v24, v60, v61, v22
    v_max3_f32 v24, v24, v62, v63
    v_pk_add_f32 v[14:15], v[14:15], v[16:17]
    v_pk_add_f32 v[18:19], v[18:19], v[20:21]
    v_max_f32_dpp v25, v24, v24 row_ror:8 row_mask:0xf bank_mask:0xf
    v_max_f32_dpp v24, v24, v24 row_ror:8 row_mask:0xf bank_mask:0xf
    v_cvt_pk_bf16_f32 v29, v14, v15
    v_cvt_pk_bf16_f32 v35, v18, v19
    v_permlane16_swap_b32 v24, v25
    v_max_f32 v23, v24, v25
    v_max_f32 v24, v24, v25
    v_lshrrev_b32 v34, 16, v29
    v_lshrrev_b32 v40, 16, v35
    v_permlane32_swap_b32 v24, v23
    v_max_f32 v24, v24, v23
    v_sub_f32 v22, v22, v24
    v_pk_add_f32 v[60:61], v[60:61], v[24:25] op_sel_hi:[1,0] neg_lo:[0,1] neg_hi:[0,1]
    v_pk_add_f32 v[62:63], v[62:63], v[24:25] op_sel_hi:[1,0] neg_lo:[0,1] neg_hi:[0,1]
    v_mul_f32 v22, s40, v22
    v_pk_mul_f32 v[60:61], v[60:61], s[2:3]
    v_pk_mul_f32 v[62:63], v[62:63], s[2:3]
    v_exp_f32 v22, v22
    v_exp_f32 v60, v60
    v_exp_f32 v61, v61
    v_exp_f32 v62, v62
    v_exp_f32 v63, v63
    v_cvt_pk_bf16_f32 v46, v22, 0
    v_cvt_pk_bf16_f32 v44, v60, v61
    v_cvt_pk_bf16_f32 v45, v62, v63
    v_cvt_pk_bf16_f32 v43, v22, 0
    s_waitcnt vmcnt(2)
    v_mfma_f32_16x16x32_bf16 v[64:67], v[32:35], v[44:47], 0
    v_mov_b64 v[48:49], s[36:37]
    v_mov_b64 v[50:51], s[36:37]
    v_mfma_f32_16x16x32_bf16 v[60:63], v[28:31], v[42:45], 0
    v_min_u32 v76, -2, v29
    v_mov_b32 v78, v35
    v_mfma_f32_16x16x32_bf16 v[52:55], v[48:51], v[42:45], 0
    v_mov_b64 v[14:15], 0
    v_mov_b64 v[16:17], 0
    v_mfma_f32_16x16x32_bf16 v[68:71], v[34:37], v[42:45], 0
    v_add_f32_dpp v56, v64, v60 row_ror:8 row_mask:0xf bank_mask:0x3
    v_add_f32_dpp v57, v65, v61 row_ror:8 row_mask:0xf bank_mask:0x3
    v_mfma_f32_16x16x32_bf16 v[72:75], v[38:41], v[44:47], 0
    v_add_f32_dpp v50, v52, v52 row_ror:8 row_mask:0xf bank_mask:0xf
    v_add_f32_dpp v58, v66, v62 row_ror:8 row_mask:0xf bank_mask:0x3
    v_add_f32_dpp v59, v67, v63 row_ror:8 row_mask:0xf bank_mask:0x3
    v_rcp_f32 v50, v50
    v_and_b32 v10, 0xffffffdf, v0
    v_lshrrev_b32 v11, 2, v0
    v_mov_b64 v[18:19], 0
    v_mov_b64 v[20:21], 0
    v_add_f32_dpp v56, v68, v72 row_ror:8 row_mask:0xf bank_mask:0xc
    v_add_f32_dpp v57, v69, v73 row_ror:8 row_mask:0xf bank_mask:0xc
    v_add_f32_dpp v58, v70, v74 row_ror:8 row_mask:0xf bank_mask:0xc
    v_add_f32_dpp v59, v71, v75 row_ror:8 row_mask:0xf bank_mask:0xc
    v_pk_mul_f32 v[56:57], v[56:57], v[50:51] op_sel_hi:[1,0]
    v_pk_mul_f32 v[58:59], v[58:59], v[50:51] op_sel_hi:[1,0]
    v_cvt_pk_bf16_f32 v56, v56, v57
    v_cvt_pk_bf16_f32 v57, v58, v59
    ds_write_b64 v6, v[56:57] offset:1024
    v_mfma_f32_16x16x32_bf16 v[22:25], v[14:17], v[14:17], 0
    ds_read_b128 v[60:63], v4 offset:20480
    ds_read_b128 v[64:67], v4 offset:21504
    ds_read_b128 v[68:71], v4 offset:24576
    ds_read_b128 v[72:75], v4 offset:25600
    v_mfma_f32_16x16x32_bf16 v[26:29], v[14:17], v[14:17], 0
    s_waitcnt lgkmcnt(4)
    s_barrier
    ds_read_b128 v[42:45], v10 offset:0
    ds_read_b128 v[50:53], v10 offset:1024
    v_mfma_f32_16x16x32_bf16 v[30:33], v[14:17], v[14:17], 0
    ds_read_b128 v[34:37], v0 offset:0
    ds_read_b128 v[46:49], v10 offset:32
    s_waitcnt lgkmcnt(3)
    v_smfmac_f32_16x16x64_bf16 v[18:21], v[42:45], v[176:183], v1
    ds_read_b128 v[38:41], v0 offset:1024
    v_smfmac_f32_16x16x64_bf16 v[22:25], v[42:45], v[192:199], v1
    ds_read_b128 v[54:57], v10 offset:1056
    s_waitcnt lgkmcnt(4)
    v_smfmac_f32_16x16x64_bf16 v[18:21], v[50:53], v[60:67], v1
    ds_read_b128 v[60:63], v4 offset:22528
    v_smfmac_f32_16x16x64_bf16 v[22:25], v[50:53], v[68:75], v1
    ds_read_b128 v[64:67], v4 offset:23552
    s_waitcnt lgkmcnt(4)
    v_smfmac_f32_16x16x64_bf16 v[14:17], v[34:37], v[240:247], v1
    ds_read_b128 v[68:71], v4 offset:26624
    v_smfmac_f32_16x16x64_bf16 v[18:21], v[46:49], v[184:191], v1
    ds_read_b128 v[72:75], v4 offset:27648
    s_waitcnt lgkmcnt(4)
    v_smfmac_f32_16x16x64_bf16 v[14:17], v[38:41], v[248:255], v1
    ds_read_b128 v[34:37], v4 offset:28672
    v_smfmac_f32_16x16x64_bf16 v[22:25], v[46:49], v[200:207], v1
    ds_read_b128 v[38:41], v4 offset:29696
    s_waitcnt lgkmcnt(4)
    v_smfmac_f32_16x16x64_bf16 v[18:21], v[54:57], v[60:67], v1
    ds_read_b128 v[60:63], v4 offset:30720
    v_add_f32 v14, v14, v16
    v_add_f32 v15, v15, v17
    s_waitcnt lgkmcnt(3)
    v_smfmac_f32_16x16x64_bf16 v[22:25], v[54:57], v[68:75], v1
    ds_read_b128 v[64:67], v4 offset:31744
    v_cvt_pk_bf16_f32 v58, v14, v15
    v_and_or_b32 v58, v58, -2, s46
    buffer_store_dword v58, v11, s[4:7], s20 offen sc1
    v_smfmac_f32_16x16x64_bf16 v[26:29], v[42:45], v[208:215], v1
    ds_read_b128 v[68:71], v4 offset:32768
    v_cvt_pk_bf16_f32 v18, v18, v19
    v_cvt_pk_bf16_f32 v19, v20, v21
    v_and_or_b32 v18, v18, -2, s46
    v_smfmac_f32_16x16x64_bf16 v[26:29], v[46:49], v[216:223], v1
    ds_read_b128 v[72:75], v4 offset:33792
    v_cvt_pk_bf16_f32 v20, v22, v23
    v_cvt_pk_bf16_f32 v21, v24, v25
    buffer_store_dwordx4 v[18:21], v0, s[4:7], s18 offen sc1
    s_waitcnt lgkmcnt(4)
    v_smfmac_f32_16x16x64_bf16 v[26:29], v[50:53], v[34:41], v1
    ds_read_b128 v[34:37], v4 offset:34816
    v_smfmac_f32_16x16x64_bf16 v[30:33], v[42:45], v[224:231], v1
    ds_read_b128 v[38:41], v4 offset:35840
    s_waitcnt lgkmcnt(4)
    v_smfmac_f32_16x16x64_bf16 v[26:29], v[54:57], v[60:67], v1
    s_waitcnt lgkmcnt(2)
    v_smfmac_f32_16x16x64_bf16 v[30:33], v[50:53], v[68:75], v1
    v_smfmac_f32_16x16x64_bf16 v[30:33], v[46:49], v[232:239], v1
    v_cvt_pk_bf16_f32 v26, v26, v27
    v_cvt_pk_bf16_f32 v27, v28, v29
    s_waitcnt lgkmcnt(0)
    v_smfmac_f32_16x16x64_bf16 v[30:33], v[54:57], v[34:41], v1
    v_and_or_b32 v26, v26, -2, s46
    s_nop 6
    v_cvt_pk_bf16_f32 v28, v30, v31
    v_cvt_pk_bf16_f32 v29, v32, v33
    buffer_store_dwordx4 v[26:29], v0, s[4:7], s19 offen sc1
    v_bfe_u32 v58, v0, 6, 1
    v_lshlrev_b32 v58, 4, v58
    v_mov_b32 v59, 0x3f80
    v_lshlrev_b32 v58, v58, v59
    v_cndmask_b32 v10, 0, v58, s[30:31]
    s_lshl_b64 vcc, s[30:31], 1
    v_cndmask_b32 v11, 0, v58, vcc
    s_lshl_b64 vcc, s[30:31], 2
    v_cndmask_b32 v12, 0, v58, vcc
    s_lshl_b64 vcc, s[30:31], 3
    v_cndmask_b32 v13, 0, v58, vcc
    v_mov_b64 v[54:55], -1
    s_mov_b32 s41, 0
    s_xor_b32 s18, s18, 0x100000
    s_xor_b32 s19, s19, 0x100000
    s_xor_b32 s20, s20, 0x100000
    s_add_u32 s17, s17, 0x4000
    s_and_b32 s17, s17, 0xfffeffff
    s_add_u32 s21, s21, 262144
    s_add_u32 s22, s22, 262144
    s_add_u32 s23, s23, 131072
    s_waitcnt vmcnt(2)
    buffer_load_dwordx4 v[34:37], v7, s[4:7], s24 offen sc1
    s_waitcnt vmcnt(0)
    v_mfma_f32_16x16x32_bf16 v[50:53], v[10:13], v[34:37], 0
    v_bitop3_b32 v58, v34, v35, s46 bitop3:0x7e
    v_bitop3_b32 v59, v36, v37, s46 bitop3:0x7e
    v_or_b32 v58, v58, v59
    v_and_b32 v58, 1, v58
    v_cmp_ne_u32 vcc, 0, v58
    s_cbranch_vccnz pp_111
ok_112:
    s_nop 1
    v_add_f32_dpp v50, v50, v50 row_ror:8 row_mask:0xf bank_mask:0xf
    v_add_f32_dpp v51, v51, v51 row_ror:8 row_mask:0xf bank_mask:0xf
    v_add_f32_dpp v52, v52, v52 row_ror:8 row_mask:0xf bank_mask:0xf
    v_add_f32_dpp v53, v53, v53 row_ror:8 row_mask:0xf bank_mask:0xf
    v_add_f32_dpp v50, v50, v50 row_ror:4 row_mask:0xf bank_mask:0xf
    v_add_f32_dpp v51, v51, v51 row_ror:4 row_mask:0xf bank_mask:0xf
    v_add_f32_dpp v52, v52, v52 row_ror:4 row_mask:0xf bank_mask:0xf
    v_add_f32_dpp v53, v53, v53 row_ror:4 row_mask:0xf bank_mask:0xf
    v_add_f32_dpp v50, v50, v50 row_ror:2 row_mask:0xf bank_mask:0xf
    v_add_f32_dpp v51, v51, v51 row_ror:2 row_mask:0xf bank_mask:0xf
    v_add_f32_dpp v52, v52, v52 row_ror:2 row_mask:0xf bank_mask:0xf
    v_add_f32_dpp v53, v53, v53 row_ror:2 row_mask:0xf bank_mask:0xf
    s_mov_b64 exec, s[28:29]
    v_cvt_pk_bf16_f32 v58, v50, v51
    v_cvt_pk_bf16_f32 v59, v52, v53
    v_min_u32 v58, -2, v58
    buffer_store_dwordx2 v[58:59], v8, s[4:7], s17 offen sc1
    buffer_store_dwordx2 v[54:55], v8, s[4:7], s47 offen sc1
    s_mov_b64 exec, -1
    s_xor_b32 s24, s24, 0x100000
    s_add_u32 s47, s47, 0x4000
    s_and_b32 s47, s47, 0xfffeffff
    s_and_b32 s42, s16, 1
    s_xor_b32 s46, s46, s42
    s_add_u32 s16, s16, 1
    s_cmp_lt_u32 s16, 63
    s_cbranch_scc1 step_105
step_113:
    s_mov_b32 s41, 0
    s_add_u32 s38, s17, 4096
    s_add_u32 s86, s17, 7168
    s_mov_b32 m0, 7168
    s_mov_b32 s72, s23
    s_mov_b32 s76, 0
    v_mov_b64 v[14:15], 0
    v_mov_b64 v[16:17], 0
    v_mov_b64 v[18:19], 0
    v_mov_b64 v[20:21], 0
    v_mov_b64 v[22:23], 0
    v_mov_b64 v[24:25], 0
    v_mov_b64 v[26:27], 0
    v_mov_b64 v[28:29], 0
    s_nop 9
    buffer_load_dwordx4 v[40:43], v0, s[4:7], s38 offen offset:0 sc1
    s_nop 15
    s_nop 7
    buffer_load_dwordx4 v[60:63], v0, s[4:7], s38 offen offset:0 sc1
    s_waitcnt vmcnt(1)
    ds_write_b128 v0, v[40:43] offset:4096
    v_max_u32 v34, v40, v42
    v_cmp_eq_u32 vcc, -1, v34
    s_cbranch_vccnz pp_114
ok_115:
redo_116:
    s_waitcnt lgkmcnt(0)
    s_barrier
    ds_read_b128 v[48:51], v0 offset:0
    s_mov_b32 m0, 7168
    s_nop 0
    buffer_load_dwordx4 v0, s[4:7], s86 offen offset:0 sc1 lds
    ds_read_b128 v[52:55], v0 offset:1024
    ds_read_b128 v[56:59], v0 offset:2048
    s_mov_b32 m0, 15872
    s_waitcnt lgkmcnt(2)
    v_smfmac_f32_16x16x64_bf16 v[14:17], v[48:51], a[224:231], v1
    s_waitcnt vmcnt(1)
    ds_read_b128 v[60:63], v4 offset:0
    ds_read_b128 v[64:67], v4 offset:1024
    v_smfmac_f32_16x16x64_bf16 v[22:25], v[48:51], a[232:239], v1
    ds_read_b128 v[68:71], v4 offset:2048
    ds_read_b128 v[72:75], v4 offset:3072
    v_smfmac_f32_16x16x64_bf16 v[18:21], v[48:51], a[144:151], v1
    ds_read_b128 v[10:13], v0 offset:3072
    v_smfmac_f32_16x16x64_bf16 v[26:29], v[48:51], a[152:159], v1
    buffer_store_dwordx4 v[76:79], v0, s[4:7], s72 offen sc1
    s_waitcnt lgkmcnt(5)
    v_smfmac_f32_16x16x64_bf16 v[14:17], v[52:55], a[240:247], v1
    v_smfmac_f32_16x16x64_bf16 v[22:25], v[52:55], a[248:255], v1
    s_waitcnt lgkmcnt(1)
    v_smfmac_f32_16x16x64_bf16 v[18:21], v[52:55], v[60:67], v1
    ds_read_b128 v[60:63], v4 offset:4096
    v_smfmac_f32_16x16x64_bf16 v[26:29], v[52:55], v[68:75], v1
    ds_read_b128 v[64:67], v4 offset:5120
    v_smfmac_f32_16x16x64_bf16 v[18:21], v[56:59], a[160:167], v1
    ds_read_b128 v[68:71], v4 offset:6144
    v_smfmac_f32_16x16x64_bf16 v[26:29], v[56:59], a[168:175], v1
    ds_read_b128 v[72:75], v4 offset:7168
    s_waitcnt vmcnt(1)
    s_barrier
    ds_read_b128 v[48:51], v0 offset:4096
    s_waitcnt lgkmcnt(5)
    v_smfmac_f32_16x16x64_bf16 v[14:17], v[10:13], v[80:87], v1
    ds_read_b128 v[52:55], v0 offset:5120
    v_smfmac_f32_16x16x64_bf16 v[22:25], v[10:13], v[88:95], v1
    ds_read_b128 v[56:59], v0 offset:6144
    s_waitcnt lgkmcnt(5)
    v_smfmac_f32_16x16x64_bf16 v[18:21], v[10:13], v[60:67], v1
    ds_read_b128 v[60:63], v4 offset:8192
    s_waitcnt lgkmcnt(4)
    v_smfmac_f32_16x16x64_bf16 v[26:29], v[10:13], v[68:75], v1
    ds_read_b128 v[64:67], v4 offset:9216
    s_waitcnt lgkmcnt(4)
    v_smfmac_f32_16x16x64_bf16 v[14:17], v[48:51], v[96:103], v1
    ds_read_b128 v[10:13], v0 offset:7168
    v_smfmac_f32_16x16x64_bf16 v[22:25], v[48:51], v[104:111], v1
    ds_read_b128 v[68:71], v4 offset:10240
    v_smfmac_f32_16x16x64_bf16 v[18:21], v[48:51], a[176:183], v1
    ds_read_b128 v[72:75], v4 offset:11264
    v_smfmac_f32_16x16x64_bf16 v[26:29], v[48:51], a[184:191], v1
    s_waitcnt lgkmcnt(3)
    v_smfmac_f32_16x16x64_bf16 v[14:17], v[52:55], v[112:119], v1
    ds_read_b128 v[48:51], v0 offset:8192
    v_smfmac_f32_16x16x64_bf16 v[22:25], v[52:55], v[120:127], v1
    v_smfmac_f32_16x16x64_bf16 v[18:21], v[52:55], v[60:67], v1
    ds_read_b128 v[60:63], v4 offset:12288
    s_waitcnt lgkmcnt(2)
    v_smfmac_f32_16x16x64_bf16 v[26:29], v[52:55], v[68:75], v1
    ds_read_b128 v[64:67], v4 offset:13312
    v_smfmac_f32_16x16x64_bf16 v[14:17], v[56:59], v[128:135], v1
    ds_read_b128 v[68:71], v4 offset:14336
    v_smfmac_f32_16x16x64_bf16 v[22:25], v[56:59], v[136:143], v1
    ds_read_b128 v[72:75], v4 offset:15360
    v_smfmac_f32_16x16x64_bf16 v[18:21], v[56:59], a[192:199], v1
    v_smfmac_f32_16x16x64_bf16 v[26:29], v[56:59], a[200:207], v1
    v_smfmac_f32_16x16x64_bf16 v[14:17], v[10:13], v[144:151], v1
    v_smfmac_f32_16x16x64_bf16 v[22:25], v[10:13], v[152:159], v1
    s_waitcnt lgkmcnt(0)
    v_smfmac_f32_16x16x64_bf16 v[18:21], v[10:13], v[60:67], v1
    ds_read_b128 v[60:63], v4 offset:16384
    v_smfmac_f32_16x16x64_bf16 v[26:29], v[10:13], v[68:75], v1
    ds_read_b128 v[64:67], v4 offset:17408
    v_smfmac_f32_16x16x64_bf16 v[14:17], v[48:51], v[160:167], v1
    ds_read_b128 v[10:13], v0 offset:2048
    v_smfmac_f32_16x16x64_bf16 v[22:25], v[48:51], v[168:175], v1
    ds_read_b128 v[68:71], v4 offset:18432
    v_smfmac_f32_16x16x64_bf16 v[18:21], v[48:51], a[208:215], v1
    ds_read_b128 v[72:75], v4 offset:19456
    v_smfmac_f32_16x16x64_bf16 v[26:29], v[48:51], a[216:223], v1
    s_waitcnt lgkmcnt(2)
    v_smfmac_f32_16x16x64_bf16 v[14:17], v[10:13], v[60:67], v1
    s_waitcnt lgkmcnt(0)
    v_smfmac_f32_16x16x64_bf16 v[22:25], v[10:13], v[68:75], v1
    v_add_f32 v18, v18, v20
    v_add_f32 v19, v19, v21
    v_cvt_pk_bf16_f32 v77, v18, v19
    v_add_f32 v26, v26, v28
    v_add_f32 v27, v27, v29
    v_cvt_pk_bf16_f32 v79, v26, v27
    v_add_f32 v14, v14, v16
    v_add_f32 v15, v15, v17
    v_cvt_pk_bf16_f32 v76, v14, v15
    v_add_f32 v22, v22, v24
    v_add_f32 v23, v23, v25
    v_cvt_pk_bf16_f32 v78, v22, v23
    v_cmp_u_f32 s[74:75], v26, v27
    v_min_u32 v76, -2, v76
    s_cmp_lg_u64 s[74:75], 0
    s_cbranch_scc1 nan_117
back_118:
    s_add_u32 s23, s23, 131072
    buffer_store_dwordx4 v[76:79], v0, s[4:7], s23 offen sc1
    s_branch done
pp_114:
    buffer_load_dwordx4 v[40:43], v0, s[4:7], s38 offen offset:0 sc1
    s_add_u32 s41, s41, 1
    s_cmp_gt_u32 s41, 2000000
    s_cbranch_scc1 fin1
    s_waitcnt vmcnt(1)
    ds_write_b128 v0, v[60:63] offset:4096
    v_max_u32 v34, v60, v62
    v_cmp_eq_u32 vcc, -1, v34
    s_cbranch_vccz ok_115
    buffer_load_dwordx4 v[60:63], v0, s[4:7], s38 offen offset:0 sc1
    s_add_u32 s41, s41, 1
    s_waitcnt vmcnt(1)
    ds_write_b128 v0, v[40:43] offset:4096
    v_max_u32 v34, v40, v42
    v_cmp_eq_u32 vcc, -1, v34
    s_cbranch_vccnz pp_114
    s_branch ok_115
nan_117:
    v_mov_b32 v34, 0
    ds_read_b32 v35, v0 offset:4096
    s_waitcnt lgkmcnt(0)
    v_max_u32 v34, v34, v35
    ds_read_b32 v35, v0 offset:4104
    s_waitcnt lgkmcnt(0)
    v_max_u32 v34, v34, v35
    ds_read_b32 v35, v0 offset:5120
    s_waitcnt lgkmcnt(0)
    v_max_u32 v34, v34, v35
    ds_read_b32 v35, v0 offset:5128
    s_waitcnt lgkmcnt(0)
    v_max_u32 v34, v34, v35
    ds_read_b32 v35, v0 offset:6144
    s_waitcnt lgkmcnt(0)
    v_max_u32 v34, v34, v35
    ds_read_b32 v35, v0 offset:6152
    s_waitcnt lgkmcnt(0)
    v_max_u32 v34, v34, v35
    ds_read_b32 v35, v0 offset:7168
    s_waitcnt lgkmcnt(0)
    v_max_u32 v34, v34, v35
    ds_read_b32 v35, v0 offset:7176
    s_waitcnt lgkmcnt(0)
    v_max_u32 v34, v34, v35
    ds_read_b32 v35, v0 offset:8192
    s_waitcnt lgkmcnt(0)
    v_max_u32 v34, v34, v35
    ds_read_b32 v35, v0 offset:8200
    s_waitcnt lgkmcnt(0)
    v_max_u32 v34, v34, v35
    v_cmp_eq_u32 s[74:75], -1, v34
    s_nop 0
    s_cmp_eq_u64 s[74:75], 0
    s_cbranch_scc1 back_118
    s_add_u32 s76, s76, 1
    s_cmp_gt_u32 s76, 2000000
    s_cbranch_scc1 fin1
    s_mov_b32 s72, 100662272
    v_mov_b64 v[14:15], 0
    v_mov_b64 v[16:17], 0
    v_mov_b64 v[18:19], 0
    v_mov_b64 v[20:21], 0
    v_mov_b64 v[22:23], 0
    v_mov_b64 v[24:25], 0
    v_mov_b64 v[26:27], 0
    v_mov_b64 v[28:29], 0
    s_waitcnt vmcnt(0)
    s_barrier
    s_branch redo_116
pp_106:
    buffer_load_dwordx4 v[40:43], v0, s[4:7], s38 offen offset:0 sc1
    s_add_u32 s41, s41, 1
    s_cmp_gt_u32 s41, 2000000
    s_cbranch_scc1 fin1
    s_waitcnt vmcnt(1)
    ds_write_b128 v0, v[60:63] offset:4096
    v_max_u32 v34, v60, v62
    v_cmp_eq_u32 vcc, -1, v34
    s_cbranch_vccz ok_107
    buffer_load_dwordx4 v[60:63], v0, s[4:7], s38 offen offset:0 sc1
    s_add_u32 s41, s41, 1
    s_waitcnt vmcnt(1)
    ds_write_b128 v0, v[40:43] offset:4096
    v_max_u32 v34, v40, v42
    v_cmp_eq_u32 vcc, -1, v34
    s_cbranch_vccnz pp_106
    s_branch ok_107
nan_109:
    v_mov_b32 v34, 0
    ds_read_b32 v35, v0 offset:4096
    s_waitcnt lgkmcnt(0)
    v_max_u32 v34, v34, v35
    ds_read_b32 v35, v0 offset:4104
    s_waitcnt lgkmcnt(0)
    v_max_u32 v34, v34, v35
    ds_read_b32 v35, v0 offset:5120
    s_waitcnt lgkmcnt(0)
    v_max_u32 v34, v34, v35
    ds_read_b32 v35, v0 offset:5128
    s_waitcnt lgkmcnt(0)
    v_max_u32 v34, v34, v35
    ds_read_b32 v35, v0 offset:6144
    s_waitcnt lgkmcnt(0)
    v_max_u32 v34, v34, v35
    ds_read_b32 v35, v0 offset:6152
    s_waitcnt lgkmcnt(0)
    v_max_u32 v34, v34, v35
    ds_read_b32 v35, v0 offset:7168
    s_waitcnt lgkmcnt(0)
    v_max_u32 v34, v34, v35
    ds_read_b32 v35, v0 offset:7176
    s_waitcnt lgkmcnt(0)
    v_max_u32 v34, v34, v35
    ds_read_b32 v35, v0 offset:8192
    s_waitcnt lgkmcnt(0)
    v_max_u32 v34, v34, v35
    ds_read_b32 v35, v0 offset:8200
    s_waitcnt lgkmcnt(0)
    v_max_u32 v34, v34, v35
    v_cmp_eq_u32 s[74:75], -1, v34
    s_nop 0
    s_cmp_eq_u64 s[74:75], 0
    s_cbranch_scc1 back_110
    s_add_u32 s76, s76, 1
    s_cmp_gt_u32 s76, 2000000
    s_cbranch_scc1 fin1
    s_mov_b32 s72, 100662272
    v_mov_b64 v[14:15], 0
    v_mov_b64 v[16:17], 0
    v_mov_b64 v[18:19], 0
    v_mov_b64 v[20:21], 0
    v_mov_b64 v[22:23], 0
    v_mov_b64 v[24:25], 0
    v_mov_b64 v[26:27], 0
    v_mov_b64 v[28:29], 0
    s_waitcnt vmcnt(0)
    s_barrier
    s_branch redo_108
pp_111:
    buffer_load_dwordx4 v[34:37], v7, s[4:7], s24 offen sc1
    s_add_u32 s41, s41, 1
    s_cmp_gt_u32 s41, 2000000
    s_cbranch_scc1 fin1
    s_waitcnt vmcnt(0)
    v_mfma_f32_16x16x32_bf16 v[50:53], v[10:13], v[34:37], 0
    v_bitop3_b32 v58, v34, v35, s46 bitop3:0x7e
    v_bitop3_b32 v59, v36, v37, s46 bitop3:0x7e
    v_or_b32 v58, v58, v59
    v_and_b32 v58, 1, v58
    v_cmp_ne_u32 vcc, 0, v58
    s_cbranch_vccnz pp_111
    s_branch ok_112
role_80:
.p2align 6
step_119:
    s_mov_b32 s41, 0
    s_add_u32 s86, s17, 8192
    s_mov_b32 m0, 8192
    s_mov_b32 s72, s23
    s_mov_b32 s76, 0
    s_sub_u32 s44, s16, 1
    s_max_i32 s44, s44, 0
    v_mov_b64 v[14:15], 0
    v_mov_b64 v[16:17], 0
    v_mov_b64 v[18:19], 0
    v_mov_b64 v[20:21], 0
    v_mov_b64 v[22:23], 0
    v_mov_b64 v[24:25], 0
    v_mov_b64 v[26:27], 0
    v_mov_b64 v[28:29], 0
    s_nop 9
    buffer_load_dwordx4 v[40:43], v0, s[4:7], s17 offen offset:2048 sc1
    buffer_load_dwordx4 v[44:47], v0, s[4:7], s17 offen offset:3072 sc1
    s_nop 15
    s_nop 7
    buffer_load_dwordx4 v[60:63], v0, s[4:7], s17 offen offset:2048 sc1
    buffer_load_dwordx4 v[64:67], v0, s[4:7], s17 offen offset:3072 sc1
    s_waitcnt vmcnt(3)
    ds_write_b128 v0, v[40:43] offset:2048
    v_max_u32 v34, v40, v42
    s_waitcnt vmcnt(2)
    ds_write_b128 v0, v[44:47] offset:3072
    v_max3_u32 v34, v34, v44, v46
    v_cmp_eq_u32 vcc, -1, v34
    s_cbranch_vccnz pp_120
ok_121:
redo_122:
    v_mov_b32 v35, s44
    s_waitcnt lgkmcnt(0)
    s_barrier
    ds_read_b128 v[48:51], v0 offset:0
    buffer_load_dwordx4 v0, s[4:7], s86 offen offset:0 sc1 lds
    ds_read_b128 v[52:55], v0 offset:1024
    ds_read_b128 v[56:59], v0 offset:2048
    s_waitcnt lgkmcnt(2)
    v_smfmac_f32_16x16x64_bf16 v[14:17], v[48:51], a[0:7], v1
    s_waitcnt vmcnt(1)
    ds_read_b128 v[60:63], v4 offset:0
    ds_read_b128 v[64:67], v4 offset:1024
    v_smfmac_f32_16x16x64_bf16 v[22:25], v[48:51], a[8:15], v1
    ds_read_b128 v[68:71], v4 offset:2048
    ds_read_b128 v[72:75], v4 offset:3072
    v_smfmac_f32_16x16x64_bf16 v[18:21], v[48:51], a[144:151], v1
    ds_read_b128 v[10:13], v0 offset:3072
    v_smfmac_f32_16x16x64_bf16 v[26:29], v[48:51], a[152:159], v1
    ds_read_b128 v[48:51], v0 offset:4096
    s_waitcnt lgkmcnt(6)
    v_smfmac_f32_16x16x64_bf16 v[14:17], v[52:55], a[16:23], v1
    buffer_load_dwordx4 v[40:43], v9, s[4:7], s21 offen sc1 nt
    v_smfmac_f32_16x16x64_bf16 v[22:25], v[52:55], a[24:31], v1
    buffer_load_dwordx4 v[44:47], v9, s[4:7], s21 offen offset:256 sc1 nt
    s_waitcnt lgkmcnt(2)
    v_smfmac_f32_16x16x64_bf16 v[18:21], v[52:55], v[60:67], v1
    ds_read_b128 v[60:63], v4 offset:4096
    v_smfmac_f32_16x16x64_bf16 v[26:29], v[52:55], v[68:75], v1
    ds_read_b128 v[64:67], v4 offset:5120
    v_smfmac_f32_16x16x64_bf16 v[14:17], v[56:59], a[32:39], v1
    ds_read_b128 v[68:71], v4 offset:6144
    v_smfmac_f32_16x16x64_bf16 v[22:25], v[56:59], a[40:47], v1
    ds_read_b128 v[72:75], v4 offset:7168
    v_smfmac_f32_16x16x64_bf16 v[18:21], v[56:59], a[160:167], v1
    buffer_load_dwordx4 v[30:33], v9, s[4:7], s22 offen sc1 nt
    v_smfmac_f32_16x16x64_bf16 v[26:29], v[56:59], a[168:175], v1
    buffer_load_dwordx4 v[36:39], v9, s[4:7], s22 offen offset:256 sc1 nt
    s_waitcnt lgkmcnt(2)
    v_smfmac_f32_16x16x64_bf16 v[14:17], v[10:13], a[48:55], v1
    v_smfmac_f32_16x16x64_bf16 v[22:25], v[10:13], a[56:63], v1
    v_smfmac_f32_16x16x64_bf16 v[18:21], v[10:13], v[60:67], v1
    ds_read_b128 v[60:63], v4 offset:8192
    s_waitcnt lgkmcnt(1)
    v_smfmac_f32_16x16x64_bf16 v[26:29], v[10:13], v[68:75], v1
    ds_read_b128 v[64:67], v4 offset:9216
    v_smfmac_f32_16x16x64_bf16 v[14:17], v[48:51], a[64:71], v1
    ds_read_b128 v[68:71], v4 offset:10240
    s_waitcnt vmcnt(4)
    s_barrier
    ds_read_b128 v[52:55], v0 offset:5120
    v_smfmac_f32_16x16x64_bf16 v[22:25], v[48:51], a[72:79], v1
    ds_read_b128 v[56:59], v0 offset:6144
    v_smfmac_f32_16x16x64_bf16 v[18:21], v[48:51], a[176:183], v1
    ds_read_b128 v[10:13], v0 offset:7168
    v_smfmac_f32_16x16x64_bf16 v[26:29], v[48:51], a[184:191], v1
    ds_read_b128 v[72:75], v4 offset:11264
    s_waitcnt lgkmcnt(3)
    v_smfmac_f32_16x16x64_bf16 v[14:17], v[52:55], a[80:87], v1
    ds_read_b128 v[48:51], v0 offset:8192
    v_smfmac_f32_16x16x64_bf16 v[22:25], v[52:55], a[88:95], v1
    buffer_store_dwordx4 v[76:79], v0, s[4:7], s72 offen sc1
    v_smfmac_f32_16x16x64_bf16 v[18:21], v[52:55], v[60:67], v1
    ds_read_b128 v[60:63], v4 offset:12288
    s_waitcnt lgkmcnt(2)
    v_smfmac_f32_16x16x64_bf16 v[26:29], v[52:55], v[68:75], v1
    ds_read_b128 v[64:67], v4 offset:13312
    v_smfmac_f32_16x16x64_bf16 v[14:17], v[56:59], a[96:103], v1
    ds_read_b128 v[68:71], v4 offset:14336
    v_smfmac_f32_16x16x64_bf16 v[22:25], v[56:59], a[104:111], v1
    ds_read_b128 v[72:75], v4 offset:15360
    v_smfmac_f32_16x16x64_bf16 v[18:21], v[56:59], a[192:199], v1
    ds_read_b128 v[52:55], v0 offset:0
    v_smfmac_f32_16x16x64_bf16 v[26:29], v[56:59], a[200:207], v1
    ds_read_b128 v[56:59], v0 offset:1024
    s_mov_b64 vcc, s[34:35]
    v_smfmac_f32_16x16x64_bf16 v[14:17], v[10:13], a[112:119], v1
    buffer_load_dword v8, off, s[4:7], s32 sc1
    s_waitcnt lgkmcnt(3)
    v_smfmac_f32_16x16x64_bf16 v[14:17], v[48:51], a[128:135], v1
    buffer_store_dword v35, v7, s[4:7], s58 offen sc1
    v_smfmac_f32_16x16x64_bf16 v[18:21], v[48:51], a[208:215], v1
    v_smfmac_f32_16x16x64_bf16 v[18:21], v[10:13], v[60:67], v1
    ds_read_b128 v[60:63], v4 offset:16384
    v_add_f32 v14, v14, v16
    v_smfmac_f32_16x16x64_bf16 v[22:25], v[48:51], a[136:143], v1
    ds_read_b128 v[64:67], v4 offset:17408
    v_add_f32 v15, v15, v17
    v_cvt_pk_bf16_f32 v76, v14, v15
    v_smfmac_f32_16x16x64_bf16 v[22:25], v[10:13], a[120:127], v1
    v_add_f32 v18, v18, v20
    v_add_f32 v19, v19, v21
    v_smfmac_f32_16x16x64_bf16 v[26:29], v[48:51], a[216:223], v1
    v_cvt_pk_bf16_f32 v77, v18, v19
    v_mov_b64 v[14:15], 0
    s_waitcnt lgkmcnt(2)
    v_smfmac_f32_16x16x64_bf16 v[26:29], v[10:13], v[68:75], v1
    ds_read_b128 v[68:71], v4 offset:18432
    v_mov_b64 v[16:17], 0
    v_mfma_f32_16x16x16_bf16 v[18:21], v[76:77], v[2:3], 0
    v_add_f32 v22, v22, v24
    v_add_f32 v23, v23, v25
    v_cvt_pk_bf16_f32 v78, v22, v23
    ds_read_b128 v[72:75], v4 offset:19456
    v_add_f32 v26, v26, v28
    v_add_f32 v27, v27, v29
    v_cvt_pk_bf16_f32 v79, v26, v27
    v_cmp_u_f32 s[74:75], v22, v23
    v_cvt_pk_bf16_f32 v22, v18, v19
    v_mfma_f32_16x16x16_bf16 v[26:29], v[78:79], v[2:3], 0
    v_cvt_pk_bf16_f32 v23, v20, v21
    v_mov_b64 v[18:19], 0
    v_smfmac_f32_16x16x64_bf16 v[14:17], v[52:55], a[224:231], v1
    ds_read_b128 v[10:13], v0 offset:2048
    v_mov_b64 v[20:21], 0
    v_smfmac_f32_16x16x64_bf16 v[14:17], v[56:59], a[240:247], v1
    ds_read_b128 v[48:51], v0 offset:3072
    v_cvt_pk_bf16_f32 v24, v26, v27
    v_cvt_pk_bf16_f32 v25, v28, v29
    s_waitcnt vmcnt(5)
    s_nop 0
    v_mfma_f32_16x16x32_bf16 v[40:43], v[40:43], v[22:25], 0
    v_mfma_f32_16x16x32_bf16 v[44:47], v[44:47], v[22:25], 0
    s_cmp_lg_u64 s[74:75], 0
    v_mfma_f32_16x16x32_bf16 v[26:29], v[22:25], v[22:25], 0
    s_cbranch_scc1 nan_123
back_124:
    v_smfmac_f32_16x16x64_bf16 v[18:21], v[52:55], a[232:239], v1
    ds_read_b128 v[52:55], v0 offset:4096
    v_cndmask_b32_dpp v40, v44, v40, vcc quad_perm:[0,1,0,1] row_mask:0xf bank_mask:0xf
    v_cndmask_b32_dpp v41, v45, v41, vcc quad_perm:[0,1,0,1] row_mask:0xf bank_mask:0xf
    v_cndmask_b32_dpp v42, v46, v42, vcc quad_perm:[0,1,0,1] row_mask:0xf bank_mask:0xf
    v_cndmask_b32_dpp v43, v47, v43, vcc quad_perm:[0,1,0,1] row_mask:0xf bank_mask:0xf
    ds_write_b128 v5, v[40:43] offset:12288
    v_cndmask_b32_dpp v28, v29, v28, vcc quad_perm:[0,1,0,1] row_mask:0xf bank_mask:0xf
    ds_write_b32 v5, v28 offset:13324
    v_smfmac_f32_16x16x64_bf16 v[18:21], v[56:59], a[248:255], v1
    ds_read_b128 v[56:59], v0 offset:5120
    v_mov_b32 v42, 0
    s_waitcnt lgkmcnt(4)
    v_smfmac_f32_16x16x64_bf16 v[14:17], v[10:13], v[60:67], v1
    v_mov_b32 v47, 0
    v_smfmac_f32_16x16x64_bf16 v[18:21], v[10:13], v[68:75], v1
    ds_read_b128 v[10:13], v0 offset:6144
    v_mov_b32 v28, 0
    v_smfmac_f32_16x16x64_bf16 v[14:17], v[48:51], v[80:87], v1
    v_mov_b32 v41, 0
    v_smfmac_f32_16x16x64_bf16 v[18:21], v[48:51], v[88:95], v1
    ds_read_b128 v[48:51], v0 offset:7168
    s_waitcnt lgkmcnt(3)
    s_barrier
    ds_read_b128 v[60:63], v0 offset:9216
    v_smfmac_f32_16x16x64_bf16 v[14:17], v[52:55], v[96:103], v1
    ds_read_b128 v[64:67], v0 offset:10240
    v_smfmac_f32_16x16x64_bf16 v[18:21], v[52:55], v[104:111], v1
    ds_read_b128 v[68:71], v0 offset:11264
    s_waitcnt lgkmcnt(4)
    v_smfmac_f32_16x16x64_bf16 v[14:17], v[56:59], v[112:119], v1
    ds_read_b128 v[72:75], v0 offset:12288
    v_smfmac_f32_16x16x64_bf16 v[18:21], v[56:59], v[120:127], v1
    ds_read_b128 v[22:25], v0 offset:13312
    v_smfmac_f32_16x16x64_bf16 v[14:17], v[10:13], v[128:135], v1
    ds_read_b128 v[52:55], v0 offset:8192
    s_waitcnt lgkmcnt(4)
    v_add_f32 v60, v60, v64
    v_smfmac_f32_16x16x64_bf16 v[18:21], v[10:13], v[136:143], v1
    v_add_f32 v61, v61, v65
    v_smfmac_f32_16x16x64_bf16 v[14:17], v[48:51], v[144:151], v1
    v_add_f32 v62, v62, v66
    v_smfmac_f32_16x16x64_bf16 v[18:21], v[48:51], v[152:159], v1
    v_add_f32 v63, v63, v67
    s_waitcnt lgkmcnt(0)
    v_smfmac_f32_16x16x64_bf16 v[14:17], v[52:55], v[160:167], v1
    v_add_f32 v22, v22, v23
    v_smfmac_f32_16x16x64_bf16 v[18:21], v[52:55], v[168:175], v1
    v_add_f32 v24, v24, v25
    v_add_f32 v22, v22, v24
    v_add_f32 v68, v68, v72
    v_add_f32 v69, v69, v73
    v_pk_add_f32 v[70:71], v[70:71], v[74:75]
    v_pk_add_f32 v[60:61], v[60:61], v[68:69]
    v_pk_add_f32 v[62:63], v[62:63], v[70:71]
    v_max3_f32 v24, v60, v61, v22
    v_max3_f32 v24, v24, v62, v63
    v_pk_add_f32 v[14:15], v[14:15], v[16:17]
    v_pk_add_f32 v[18:19], v[18:19], v[20:21]
    v_max_f32_dpp v25, v24, v24 row_ror:8 row_mask:0xf bank_mask:0xf
    v_max_f32_dpp v24, v24, v24 row_ror:8 row_mask:0xf bank_mask:0xf
    v_cvt_pk_bf16_f32 v29, v14, v15
    v_cvt_pk_bf16_f32 v35, v18, v19
    v_permlane16_swap_b32 v24, v25
    v_max_f32 v23, v24, v25
    v_max_f32 v24, v24, v25
    v_lshrrev_b32 v34, 16, v29
    v_lshrrev_b32 v40, 16, v35
    v_permlane32_swap_b32 v24, v23
    v_max_f32 v24, v24, v23
    v_sub_f32 v22, v22, v24
    v_pk_add_f32 v[60:61], v[60:61], v[24:25] op_sel_hi:[1,0] neg_lo:[0,1] neg_hi:[0,1]
    v_pk_add_f32 v[62:63], v[62:63], v[24:25] op_sel_hi:[1,0] neg_lo:[0,1] neg_hi:[0,1]
    v_mul_f32 v22, s40, v22
    v_pk_mul_f32 v[60:61], v[60:61], s[2:3]
    v_pk_mul_f32 v[62:63], v[62:63], s[2:3]
    v_exp_f32 v22, v22
    v_exp_f32 v60, v60
    v_exp_f32 v61, v61
    v_exp_f32 v62, v62
    v_exp_f32 v63, v63
    v_cvt_pk_bf16_f32 v46, v22, 0
    v_cvt_pk_bf16_f32 v44, v60, v61
    v_cvt_pk_bf16_f32 v45, v62, v63
    v_cvt_pk_bf16_f32 v43, v22, 0
    s_waitcnt vmcnt(3)
    v_mfma_f32_16x16x32_bf16 v[64:67], v[32:35], v[44:47], 0
    v_mov_b64 v[48:49], s[36:37]
    v_mov_b64 v[50:51], s[36:37]
    v_mfma_f32_16x16x32_bf16 v[60:63], v[28:31], v[42:45], 0
    v_min_u32 v76, -2, v29
    v_mov_b32 v78, v35
    v_mfma_f32_16x16x32_bf16 v[52:55], v[48:51], v[42:45], 0
    v_mov_b64 v[14:15], 0
    v_mov_b64 v[16:17], 0
    v_mfma_f32_16x16x32_bf16 v[68:71], v[34:37], v[42:45], 0
    v_add_f32_dpp v56, v64, v60 row_ror:8 row_mask:0xf bank_mask:0x3
    v_add_f32_dpp v57, v65, v61 row_ror:8 row_mask:0xf bank_mask:0x3
    v_mfma_f32_16x16x32_bf16 v[72:75], v[38:41], v[44:47], 0
    v_add_f32_dpp v50, v52, v52 row_ror:8 row_mask:0xf bank_mask:0xf
    v_add_f32_dpp v58, v66, v62 row_ror:8 row_mask:0xf bank_mask:0x3
    v_add_f32_dpp v59, v67, v63 row_ror:8 row_mask:0xf bank_mask:0x3
    v_rcp_f32 v50, v50
    v_and_b32 v10, 0xffffffdf, v0
    v_lshrrev_b32 v11, 2, v0
    v_mov_b64 v[18:19], 0
    v_mov_b64 v[20:21], 0
    v_add_f32_dpp v56, v68, v72 row_ror:8 row_mask:0xf bank_mask:0xc
    v_add_f32_dpp v57, v69, v73 row_ror:8 row_mask:0xf bank_mask:0xc
    v_add_f32_dpp v58, v70, v74 row_ror:8 row_mask:0xf bank_mask:0xc
    v_add_f32_dpp v59, v71, v75 row_ror:8 row_mask:0xf bank_mask:0xc
    v_pk_mul_f32 v[56:57], v[56:57], v[50:51] op_sel_hi:[1,0]
    v_pk_mul_f32 v[58:59], v[58:59], v[50:51] op_sel_hi:[1,0]
    v_cvt_pk_bf16_f32 v56, v56, v57
    v_cvt_pk_bf16_f32 v57, v58, v59
    ds_write_b64 v6, v[56:57] offset:1536
    v_mfma_f32_16x16x32_bf16 v[22:25], v[14:17], v[14:17], 0
    ds_read_b128 v[60:63], v4 offset:20480
    ds_read_b128 v[64:67], v4 offset:21504
    ds_read_b128 v[68:71], v4 offset:24576
    ds_read_b128 v[72:75], v4 offset:25600
    v_mfma_f32_16x16x32_bf16 v[26:29], v[14:17], v[14:17], 0
    s_waitcnt lgkmcnt(4)
    s_barrier
    ds_read_b128 v[42:45], v10 offset:0
    ds_read_b128 v[50:53], v10 offset:1024
    v_mfma_f32_16x16x32_bf16 v[30:33], v[14:17], v[14:17], 0
    ds_read_b128 v[34:37], v0 offset:0
    ds_read_b128 v[46:49], v10 offset:32
    s_waitcnt lgkmcnt(3)
    v_smfmac_f32_16x16x64_bf16 v[18:21], v[42:45], v[176:183], v1
    ds_read_b128 v[38:41], v0 offset:1024
    v_smfmac_f32_16x16x64_bf16 v[22:25], v[42:45], v[192:199], v1
    ds_read_b128 v[54:57], v10 offset:1056
    s_waitcnt lgkmcnt(4)
    v_smfmac_f32_16x16x64_bf16 v[18:21], v[50:53], v[60:67], v1
    ds_read_b128 v[60:63], v4 offset:22528
    v_smfmac_f32_16x16x64_bf16 v[22:25], v[50:53], v[68:75], v1
    ds_read_b128 v[64:67], v4 offset:23552
    s_waitcnt lgkmcnt(4)
    v_smfmac_f32_16x16x64_bf16 v[14:17], v[34:37], v[240:247], v1
    ds_read_b128 v[68:71], v4 offset:26624
    v_smfmac_f32_16x16x64_bf16 v[18:21], v[46:49], v[184:191], v1
    ds_read_b128 v[72:75], v4 offset:27648
    s_waitcnt lgkmcnt(4)
    v_smfmac_f32_16x16x64_bf16 v[14:17], v[38:41], v[248:255], v1
    ds_read_b128 v[34:37], v4 offset:28672
    v_smfmac_f32_16x16x64_bf16 v[22:25], v[46:49], v[200:207], v1
    ds_read_b128 v[38:41], v4 offset:29696
    s_waitcnt lgkmcnt(4)
    v_smfmac_f32_16x16x64_bf16 v[18:21], v[54:57], v[60:67], v1
    ds_read_b128 v[60:63], v4 offset:30720
    v_add_f32 v14, v14, v16
    v_add_f32 v15, v15, v17
    s_waitcnt lgkmcnt(3)
    v_smfmac_f32_16x16x64_bf16 v[22:25], v[54:57], v[68:75], v1
    ds_read_b128 v[64:67], v4 offset:31744
    v_cvt_pk_bf16_f32 v58, v14, v15
    v_and_or_b32 v58, v58, -2, s46
    buffer_store_dword v58, v11, s[4:7], s20 offen sc1
    v_smfmac_f32_16x16x64_bf16 v[26:29], v[42:45], v[208:215], v1
    ds_read_b128 v[68:71], v4 offset:32768
    v_cvt_pk_bf16_f32 v18, v18, v19
    v_cvt_pk_bf16_f32 v19, v20, v21
    v_and_or_b32 v18, v18, -2, s46
    v_smfmac_f32_16x16x64_bf16 v[26:29], v[46:49], v[216:223], v1
    ds_read_b128 v[72:75], v4 offset:33792
    v_cvt_pk_bf16_f32 v20, v22, v23
    v_cvt_pk_bf16_f32 v21, v24, v25
    buffer_store_dwordx4 v[18:21], v0, s[4:7], s18 offen sc1
    s_waitcnt lgkmcnt(4)
    v_smfmac_f32_16x16x64_bf16 v[26:29], v[50:53], v[34:41], v1
    ds_read_b128 v[34:37], v4 offset:34816
    v_smfmac_f32_16x16x64_bf16 v[30:33], v[42:45], v[224:231], v1
    ds_read_b128 v[38:41], v4 offset:35840
    s_waitcnt lgkmcnt(4)
    v_smfmac_f32_16x16x64_bf16 v[26:29], v[54:57], v[60:67], v1
    s_waitcnt lgkmcnt(2)
    v_smfmac_f32_16x16x64_bf16 v[30:33], v[50:53], v[68:75], v1
    v_smfmac_f32_16x16x64_bf16 v[30:33], v[46:49], v[232:239], v1
    v_cvt_pk_bf16_f32 v26, v26, v27
    v_cvt_pk_bf16_f32 v27, v28, v29
    s_waitcnt lgkmcnt(0)
    v_smfmac_f32_16x16x64_bf16 v[30:33], v[54:57], v[34:41], v1
    v_and_or_b32 v26, v26, -2, s46
    s_nop 6
    v_cvt_pk_bf16_f32 v28, v30, v31
    v_cvt_pk_bf16_f32 v29, v32, v33
    buffer_store_dwordx4 v[26:29], v0, s[4:7], s19 offen sc1
    s_xor_b32 s18, s18, 0x100000
    s_xor_b32 s19, s19, 0x100000
    s_xor_b32 s20, s20, 0x100000
    s_add_u32 s17, s17, 0x4000
    s_and_b32 s17, s17, 0xfffeffff
    s_add_u32 s21, s21, 262144
    s_add_u32 s22, s22, 262144
    s_add_u32 s23, s23, 131072
    s_waitcnt vmcnt(0)
    v_readfirstlane_b32 s42, v8
    s_cmp_ge_u32 s16, 61
    s_cselect_b32 s39, 0, s39
    s_cmp_lt_u32 s42, s39
    s_cbranch_scc1 nr_125
rk_126:
    s_add_u32 s32, s32, 16384
    s_add_u32 s33, s33, 1
    s_cmp_eq_u32 s33, 3
    s_cselect_b32 s42, 49152, 0
    s_cselect_b32 s43, 1, 0
    s_cselect_b32 s33, 0, s33
    s_sub_u32 s32, s32, s42
    s_add_u32 s39, s39, s43
    s_sleep 10
    s_and_b32 s42, s16, 1
    s_xor_b32 s46, s46, s42
    s_add_u32 s16, s16, 1
    s_cmp_lt_u32 s16, 63
    s_cbranch_scc1 step_119
step_127:
    s_mov_b32 s41, 0
    s_add_u32 s86, s17, 8192
    s_mov_b32 m0, 8192
    s_mov_b32 s72, s23
    s_mov_b32 s76, 0
    s_sub_u32 s44, s16, 1
    s_max_i32 s44, s44, 0
    v_mov_b64 v[14:15], 0
    v_mov_b64 v[16:17], 0
    v_mov_b64 v[18:19], 0
    v_mov_b64 v[20:21], 0
    v_mov_b64 v[22:23], 0
    v_mov_b64 v[24:25], 0
    v_mov_b64 v[26:27], 0
    v_mov_b64 v[28:29], 0
    s_nop 9
    buffer_load_dwordx4 v[40:43], v0, s[4:7], s17 offen offset:2048 sc1
    buffer_load_dwordx4 v[44:47], v0, s[4:7], s17 offen offset:3072 sc1
    s_nop 15
    s_nop 7
    buffer_load_dwordx4 v[60:63], v0, s[4:7], s17 offen offset:2048 sc1
    buffer_load_dwordx4 v[64:67], v0, s[4:7], s17 offen offset:3072 sc1
    s_waitcnt vmcnt(3)
    ds_write_b128 v0, v[40:43] offset:2048
    v_max_u32 v34, v40, v42
    s_waitcnt vmcnt(2)
    ds_write_b128 v0, v[44:47] offset:3072
    v_max3_u32 v34, v34, v44, v46
    v_cmp_eq_u32 vcc, -1, v34
    s_cbranch_vccnz pp_128
ok_129:
redo_130:
    v_mov_b32 v35, s44
    s_waitcnt lgkmcnt(0)
    s_barrier
    ds_read_b128 v[48:51], v0 offset:0
    buffer_load_dwordx4 v0, s[4:7], s86 offen offset:0 sc1 lds
    ds_read_b128 v[52:55], v0 offset:1024
    ds_read_b128 v[56:59], v0 offset:2048
    s_waitcnt lgkmcnt(2)
    v_smfmac_f32_16x16x64_bf16 v[14:17], v[48:51], a[224:231], v1
    s_waitcnt vmcnt(1)
    ds_read_b128 v[60:63], v4 offset:0
    ds_read_b128 v[64:67], v4 offset:1024
    v_smfmac_f32_16x16x64_bf16 v[22:25], v[48:51], a[232:239], v1
    ds_read_b128 v[68:71], v4 offset:2048
    ds_read_b128 v[72:75], v4 offset:3072
    v_smfmac_f32_16x16x64_bf16 v[18:21], v[48:51], a[144:151], v1
    ds_read_b128 v[10:13], v0 offset:3072
    v_smfmac_f32_16x16x64_bf16 v[26:29], v[48:51], a[152:159], v1
    buffer_store_dwordx4 v[76:79], v0, s[4:7], s72 offen sc1
    s_waitcnt lgkmcnt(5)
    v_smfmac_f32_16x16x64_bf16 v[14:17], v[52:55], a[240:247], v1
    v_smfmac_f32_16x16x64_bf16 v[22:25], v[52:55], a[248:255], v1
    s_waitcnt lgkmcnt(1)
    v_smfmac_f32_16x16x64_bf16 v[18:21], v[52:55], v[60:67], v1
    ds_read_b128 v[60:63], v4 offset:4096
    v_smfmac_f32_16x16x64_bf16 v[26:29], v[52:55], v[68:75], v1
    ds_read_b128 v[64:67], v4 offset:5120
    v_smfmac_f32_16x16x64_bf16 v[18:21], v[56:59], a[160:167], v1
    ds_read_b128 v[68:71], v4 offset:6144
    v_smfmac_f32_16x16x64_bf16 v[26:29], v[56:59], a[168:175], v1
    ds_read_b128 v[72:75], v4 offset:7168
    s_waitcnt vmcnt(1)
    s_barrier
    ds_read_b128 v[48:51], v0 offset:4096
    s_waitcnt lgkmcnt(5)
    v_smfmac_f32_16x16x64_bf16 v[14:17], v[10:13], v[80:87], v1
    ds_read_b128 v[52:55], v0 offset:5120
    v_smfmac_f32_16x16x64_bf16 v[22:25], v[10:13], v[88:95], v1
    ds_read_b128 v[56:59], v0 offset:6144
    s_waitcnt lgkmcnt(5)
    v_smfmac_f32_16x16x64_bf16 v[18:21], v[10:13], v[60:67], v1
    ds_read_b128 v[60:63], v4 offset:8192
    s_waitcnt lgkmcnt(4)
    v_smfmac_f32_16x16x64_bf16 v[26:29], v[10:13], v[68:75], v1
    ds_read_b128 v[64:67], v4 offset:9216
    s_waitcnt lgkmcnt(4)
    v_smfmac_f32_16x16x64_bf16 v[14:17], v[48:51], v[96:103], v1
    ds_read_b128 v[10:13], v0 offset:7168
    v_smfmac_f32_16x16x64_bf16 v[22:25], v[48:51], v[104:111], v1
    ds_read_b128 v[68:71], v4 offset:10240
    v_smfmac_f32_16x16x64_bf16 v[18:21], v[48:51], a[176:183], v1
    ds_read_b128 v[72:75], v4 offset:11264
    v_smfmac_f32_16x16x64_bf16 v[26:29], v[48:51], a[184:191], v1
    s_waitcnt lgkmcnt(3)
    v_smfmac_f32_16x16x64_bf16 v[14:17], v[52:55], v[112:119], v1
    ds_read_b128 v[48:51], v0 offset:8192
    v_smfmac_f32_16x16x64_bf16 v[22:25], v[52:55], v[120:127], v1
    v_smfmac_f32_16x16x64_bf16 v[18:21], v[52:55], v[60:67], v1
    ds_read_b128 v[60:63], v4 offset:12288
    s_waitcnt lgkmcnt(2)
    v_smfmac_f32_16x16x64_bf16 v[26:29], v[52:55], v[68:75], v1
    ds_read_b128 v[64:67], v4 offset:13312
    v_smfmac_f32_16x16x64_bf16 v[14:17], v[56:59], v[128:135], v1
    ds_read_b128 v[68:71], v4 offset:14336
    v_smfmac_f32_16x16x64_bf16 v[22:25], v[56:59], v[136:143], v1
    ds_read_b128 v[72:75], v4 offset:15360
    v_smfmac_f32_16x16x64_bf16 v[18:21], v[56:59], a[192:199], v1
    v_smfmac_f32_16x16x64_bf16 v[26:29], v[56:59], a[200:207], v1
    v_smfmac_f32_16x16x64_bf16 v[14:17], v[10:13], v[144:151], v1
    v_smfmac_f32_16x16x64_bf16 v[22:25], v[10:13], v[152:159], v1
    s_waitcnt lgkmcnt(0)
    v_smfmac_f32_16x16x64_bf16 v[18:21], v[10:13], v[60:67], v1
    ds_read_b128 v[60:63], v4 offset:16384
    v_smfmac_f32_16x16x64_bf16 v[26:29], v[10:13], v[68:75], v1
    ds_read_b128 v[64:67], v4 offset:17408
    v_smfmac_f32_16x16x64_bf16 v[14:17], v[48:51], v[160:167], v1
    ds_read_b128 v[10:13], v0 offset:2048
    v_smfmac_f32_16x16x64_bf16 v[22:25], v[48:51], v[168:175], v1
    ds_read_b128 v[68:71], v4 offset:18432
    v_smfmac_f32_16x16x64_bf16 v[18:21], v[48:51], a[208:215], v1
    ds_read_b128 v[72:75], v4 offset:19456
    v_smfmac_f32_16x16x64_bf16 v[26:29], v[48:51], a[216:223], v1
    s_waitcnt lgkmcnt(2)
    v_smfmac_f32_16x16x64_bf16 v[14:17], v[10:13], v[60:67], v1
    s_waitcnt lgkmcnt(0)
    v_smfmac_f32_16x16x64_bf16 v[22:25], v[10:13], v[68:75], v1
    v_add_f32 v18, v18, v20
    v_add_f32 v19, v19, v21
    v_cvt_pk_bf16_f32 v77, v18, v19
    v_add_f32 v26, v26, v28
    v_add_f32 v27, v27, v29
    v_cvt_pk_bf16_f32 v79, v26, v27
    v_add_f32 v14, v14, v16
    v_add_f32 v15, v15, v17
    v_cvt_pk_bf16_f32 v76, v14, v15
    v_add_f32 v22, v22, v24
    v_add_f32 v23, v23, v25
    v_cvt_pk_bf16_f32 v78, v22, v23
    v_cmp_u_f32 s[74:75], v26, v27
    v_min_u32 v76, -2, v76
    s_cmp_lg_u64 s[74:75], 0
    s_cbranch_scc1 nan_131
back_132:
    s_add_u32 s23, s23, 131072
    buffer_store_dwordx4 v[76:79], v0, s[4:7], s23 offen sc1
    s_branch done
pp_128:
    buffer_load_dwordx4 v[40:43], v0, s[4:7], s17 offen offset:2048 sc1
    buffer_load_dwordx4 v[44:47], v0, s[4:7], s17 offen offset:3072 sc1
    s_add_u32 s41, s41, 1
    s_cmp_gt_u32 s41, 2000000
    s_cbranch_scc1 fin1
    s_waitcnt vmcnt(3)
    ds_write_b128 v0, v[60:63] offset:2048
    v_max_u32 v34, v60, v62
    s_waitcnt vmcnt(2)
    ds_write_b128 v0, v[64:67] offset:3072
    v_max3_u32 v34, v34, v64, v66
    v_cmp_eq_u32 vcc, -1, v34
    s_cbranch_vccz ok_129
    buffer_load_dwordx4 v[60:63], v0, s[4:7], s17 offen offset:2048 sc1
    buffer_load_dwordx4 v[64:67], v0, s[4:7], s17 offen offset:3072 sc1
    s_add_u32 s41, s41, 1
    s_waitcnt vmcnt(3)
    ds_write_b128 v0, v[40:43] offset:2048
    v_max_u32 v34, v40, v42
    s_waitcnt vmcnt(2)
    ds_write_b128 v0, v[44:47] offset:3072
    v_max3_u32 v34, v34, v44, v46
    v_cmp_eq_u32 vcc, -1, v34
    s_cbranch_vccnz pp_128
    s_branch ok_129
nan_131:
    v_mov_b32 v34, 0
    ds_read_b32 v35, v0 offset:4096
    s_waitcnt lgkmcnt(0)
    v_max_u32 v34, v34, v35
    ds_read_b32 v35, v0 offset:4104
    s_waitcnt lgkmcnt(0)
    v_max_u32 v34, v34, v35
    ds_read_b32 v35, v0 offset:5120
    s_waitcnt lgkmcnt(0)
    v_max_u32 v34, v34, v35
    ds_read_b32 v35, v0 offset:5128
    s_waitcnt lgkmcnt(0)
    v_max_u32 v34, v34, v35
    ds_read_b32 v35, v0 offset:6144
    s_waitcnt lgkmcnt(0)
    v_max_u32 v34, v34, v35
    ds_read_b32 v35, v0 offset:6152
    s_waitcnt lgkmcnt(0)
    v_max_u32 v34, v34, v35
    ds_read_b32 v35, v0 offset:7168
    s_waitcnt lgkmcnt(0)
    v_max_u32 v34, v34, v35
    ds_read_b32 v35, v0 offset:7176
    s_waitcnt lgkmcnt(0)
    v_max_u32 v34, v34, v35
    ds_read_b32 v35, v0 offset:8192
    s_waitcnt lgkmcnt(0)
    v_max_u32 v34, v34, v35
    ds_read_b32 v35, v0 offset:8200
    s_waitcnt lgkmcnt(0)
    v_max_u32 v34, v34, v35
    v_cmp_eq_u32 s[74:75], -1, v34
    s_nop 0
    s_cmp_eq_u64 s[74:75], 0
    s_cbranch_scc1 back_132
    s_add_u32 s76, s76, 1
    s_cmp_gt_u32 s76, 2000000
    s_cbranch_scc1 fin1
    s_mov_b32 s72, 100662272
    v_mov_b64 v[14:15], 0
    v_mov_b64 v[16:17], 0
    v_mov_b64 v[18:19], 0
    v_mov_b64 v[20:21], 0
    v_mov_b64 v[22:23], 0
    v_mov_b64 v[24:25], 0
    v_mov_b64 v[26:27], 0
    v_mov_b64 v[28:29], 0
    s_waitcnt vmcnt(0)
    s_barrier
    s_branch redo_130
pp_120:
    buffer_load_dwordx4 v[40:43], v0, s[4:7], s17 offen offset:2048 sc1
    buffer_load_dwordx4 v[44:47], v0, s[4:7], s17 offen offset:3072 sc1
    s_add_u32 s41, s41, 1
    s_cmp_gt_u32 s41, 2000000
    s_cbranch_scc1 fin1
    s_waitcnt vmcnt(3)
    ds_write_b128 v0, v[60:63] offset:2048
    v_max_u32 v34, v60, v62
    s_waitcnt vmcnt(2)
    ds_write_b128 v0, v[64:67] offset:3072
    v_max3_u32 v34, v34, v64, v66
    v_cmp_eq_u32 vcc, -1, v34
    s_cbranch_vccz ok_121
    buffer_load_dwordx4 v[60:63], v0, s[4:7], s17 offen offset:2048 sc1
    buffer_load_dwordx4 v[64:67], v0, s[4:7], s17 offen offset:3072 sc1
    s_add_u32 s41, s41, 1
    s_waitcnt vmcnt(3)
    ds_write_b128 v0, v[40:43] offset:2048
    v_max_u32 v34, v40, v42
    s_waitcnt vmcnt(2)
    ds_write_b128 v0, v[44:47] offset:3072
    v_max3_u32 v34, v34, v44, v46
    v_cmp_eq_u32 vcc, -1, v34
    s_cbranch_vccnz pp_120
    s_branch ok_121
nan_123:
    v_mov_b32 v34, 0
    ds_read_b32 v35, v0 offset:4096
    s_waitcnt lgkmcnt(0)
    v_max_u32 v34, v34, v35
    ds_read_b32 v35, v0 offset:4104
    s_waitcnt lgkmcnt(0)
    v_max_u32 v34, v34, v35
    ds_read_b32 v35, v0 offset:5120
    s_waitcnt lgkmcnt(0)
    v_max_u32 v34, v34, v35
    ds_read_b32 v35, v0 offset:5128
    s_waitcnt lgkmcnt(0)
    v_max_u32 v34, v34, v35
    ds_read_b32 v35, v0 offset:6144
    s_waitcnt lgkmcnt(0)
    v_max_u32 v34, v34, v35
    ds_read_b32 v35, v0 offset:6152
    s_waitcnt lgkmcnt(0)
    v_max_u32 v34, v34, v35
    ds_read_b32 v35, v0 offset:7168
    s_waitcnt lgkmcnt(0)
    v_max_u32 v34, v34, v35
    ds_read_b32 v35, v0 offset:7176
    s_waitcnt lgkmcnt(0)
    v_max_u32 v34, v34, v35
    ds_read_b32 v35, v0 offset:8192
    s_waitcnt lgkmcnt(0)
    v_max_u32 v34, v34, v35
    ds_read_b32 v35, v0 offset:8200
    s_waitcnt lgkmcnt(0)
    v_max_u32 v34, v34, v35
    v_cmp_eq_u32 s[74:75], -1, v34
    s_nop 0
    s_cmp_eq_u64 s[74:75], 0
    s_cbranch_scc1 back_124
    s_add_u32 s76, s76, 1
    s_cmp_gt_u32 s76, 2000000
    s_cbranch_scc1 fin1
    s_mov_b32 s72, 100662272
    v_mov_b64 v[14:15], 0
    v_mov_b64 v[16:17], 0
    v_mov_b64 v[18:19], 0
    v_mov_b64 v[20:21], 0
    v_mov_b64 v[22:23], 0
    v_mov_b64 v[24:25], 0
    v_mov_b64 v[26:27], 0
    v_mov_b64 v[28:29], 0
    s_waitcnt vmcnt(0)
    s_barrier
    s_branch redo_122
nr_125:
    s_mov_b32 s41, 0
rd_133:
    buffer_load_dword v8, off, s[4:7], s32 sc1
    s_waitcnt vmcnt(0)
    v_readfirstlane_b32 s42, v8
    s_nop 0
    s_cmp_ge_u32 s42, s39
    s_cbranch_scc1 rd_134
    s_sleep 4
    s_add_u32 s41, s41, 1
    s_cmp_lt_u32 s41, 2000000
    s_cbranch_scc1 rd_133
    s_branch fin1
rd_134:
    s_branch rk_126
done:
    s_or_b32 s42, s15, s14
    s_cbranch_scc1 done3
    s_waitcnt vmcnt(0)
    buffer_wbl2 sc1
done3:
fin1:
    s_endpgm
bulk:
    v_lshlrev_b32 v1, 4, v0
    s_mov_b32 s68, s60
    s_mov_b32 s69, s61
    s_mov_b32 s70, 2359296
    s_mov_b32 s71, 0x20000
    s_mov_b32 s72, s66
    s_mov_b32 s73, s67
    s_mov_b32 s74, 2359296
    s_mov_b32 s75, 0x20000
    s_lshr_b32 s36, s15, 5
    s_sub_u32 s36, s36, 1
    s_and_b32 s37, s15, 31
    s_mov_b32 s38, 64
    s_cmp_lt_u32 s15, 32
    s_cselect_b32 s38, s15, s38
    s_cmp_ge_u32 s38, 64
    s_cbranch_scc1 proj
    v_and_b32 v10, 7, v0
    v_lshrrev_b32 v12, 3, v0
    v_mul_u32_u24 v2, 1152, v12
    v_lshl_add_u32 v2, v10, 4, v2
    s_lshl_b32 s20, s38, 2
    s_add_u32 s20, s20, s14
    s_mul_i32 s42, s20, 9216
    buffer_load_dwordx4 v[16:19], v2, s[68:71], s42 offen offset:0
    buffer_load_dwordx4 v[20:23], v2, s[68:71], s42 offen offset:128
    buffer_load_dwordx4 v[24:27], v2, s[68:71], s42 offen offset:256
    buffer_load_dwordx4 v[28:31], v2, s[68:71], s42 offen offset:384
    buffer_load_dwordx4 v[32:35], v2, s[68:71], s42 offen offset:512
    buffer_load_dwordx4 v[36:39], v2, s[68:71], s42 offen offset:640
    buffer_load_dwordx4 v[40:43], v2, s[68:71], s42 offen offset:768
    buffer_load_dwordx4 v[44:47], v2, s[68:71], s42 offen offset:896
    buffer_load_dwordx4 v[48:51], v2, s[68:71], s42 offen offset:1024
    s_add_u32 s42, s42, 1179648
    buffer_load_dwordx4 v[144:147], v2, s[68:71], s42 offen offset:0
    buffer_load_dwordx4 v[148:151], v2, s[68:71], s42 offen offset:128
    buffer_load_dwordx4 v[152:155], v2, s[68:71], s42 offen offset:256
    buffer_load_dwordx4 v[156:159], v2, s[68:71], s42 offen offset:384
    buffer_load_dwordx4 v[160:163], v2, s[68:71], s42 offen offset:512
    buffer_load_dwordx4 v[164:167], v2, s[68:71], s42 offen offset:640
    buffer_load_dwordx4 v[168:171], v2, s[68:71], s42 offen offset:768
    buffer_load_dwordx4 v[172:175], v2, s[68:71], s42 offen offset:896
    buffer_load_dwordx4 v[176:179], v2, s[68:71], s42 offen offset:1024
    v_lshlrev_b32 v3, 9, v10
    v_lshl_add_u32 v3, v12, 4, v3
ln2_135:
    v_mov_b32 v4, 0
    v_lshlrev_b32 v5, 2, v0
    s_lshl_b32 s42, s20, 8
    s_add_u32 s42, s42, 116391936
    buffer_store_dword v4, v5, s[4:7], s42 offen sc1
    v_mov_b32 v64, -1
    v_mov_b32 v65, -1
    v_mov_b32 v66, -1
    v_mov_b32 v67, -1
    s_lshl_b32 s42, s20, 11
    s_add_u32 s42, s42, 108527616
    buffer_store_dwordx4 v[64:67], v1, s[4:7], s42 offen sc1
    buffer_store_dwordx4 v[64:67], v1, s[4:7], s42 offen offset:1024 sc1
    s_add_u32 s42, s42, 4278190080
    buffer_store_dwordx4 v[64:67], v1, s[4:7], s42 offen sc1
    buffer_store_dwordx4 v[64:67], v1, s[4:7], s42 offen offset:1024 sc1
    s_lshl_b32 s42, s20, 9
    s_add_u32 s42, s42, 92274688
    v_lshlrev_b32 v5, 3, v0
    buffer_store_dwordx2 v[64:65], v5, s[4:7], s42 offen sc1
    s_waitcnt vmcnt(23)
    v_lshlrev_b32 v64, 16, v16
    v_and_b32 v65, 0xffff0000, v16
    v_lshlrev_b32 v66, 16, v17
    v_and_b32 v67, 0xffff0000, v17
    v_pk_add_f32 v[10:11], v[64:65], v[66:67]
    v_lshlrev_b32 v68, 16, v18
    v_and_b32 v69, 0xffff0000, v18
    v_pk_add_f32 v[10:11], v[10:11], v[68:69]
    v_lshlrev_b32 v70, 16, v19
    v_and_b32 v71, 0xffff0000, v19
    v_pk_add_f32 v[10:11], v[10:11], v[70:71]
    s_waitcnt vmcnt(22)
    v_lshlrev_b32 v72, 16, v20
    v_and_b32 v73, 0xffff0000, v20
    v_pk_add_f32 v[10:11], v[10:11], v[72:73]
    v_lshlrev_b32 v74, 16, v21
    v_and_b32 v75, 0xffff0000, v21
    v_pk_add_f32 v[10:11], v[10:11], v[74:75]
    v_lshlrev_b32 v76, 16, v22
    v_and_b32 v77, 0xffff0000, v22
    v_pk_add_f32 v[10:11], v[10:11], v[76:77]
    v_lshlrev_b32 v78, 16, v23
    v_and_b32 v79, 0xffff0000, v23
    v_pk_add_f32 v[10:11], v[10:11], v[78:79]
    s_waitcnt vmcnt(21)
    v_lshlrev_b32 v80, 16, v24
    v_and_b32 v81, 0xffff0000, v24
    v_pk_add_f32 v[10:11], v[10:11], v[80:81]
    v_lshlrev_b32 v82, 16, v25
    v_and_b32 v83, 0xffff0000, v25
    v_pk_add_f32 v[10:11], v[10:11], v[82:83]
    v_lshlrev_b32 v84, 16, v26
    v_and_b32 v85, 0xffff0000, v26
    v_pk_add_f32 v[10:11], v[10:11], v[84:85]
    v_lshlrev_b32 v86, 16, v27
    v_and_b32 v87, 0xffff0000, v27
    v_pk_add_f32 v[10:11], v[10:11], v[86:87]
    s_waitcnt vmcnt(20)
    v_lshlrev_b32 v88, 16, v28
    v_and_b32 v89, 0xffff0000, v28
    v_pk_add_f32 v[10:11], v[10:11], v[88:89]
    v_lshlrev_b32 v90, 16, v29
    v_and_b32 v91, 0xffff0000, v29
    v_pk_add_f32 v[10:11], v[10:11], v[90:91]
    v_lshlrev_b32 v92, 16, v30
    v_and_b32 v93, 0xffff0000, v30
    v_pk_add_f32 v[10:11], v[10:11], v[92:93]
    v_lshlrev_b32 v94, 16, v31
    v_and_b32 v95, 0xffff0000, v31
    v_pk_add_f32 v[10:11], v[10:11], v[94:95]
    s_waitcnt vmcnt(19)
    v_lshlrev_b32 v96, 16, v32
    v_and_b32 v97, 0xffff0000, v32
    v_pk_add_f32 v[10:11], v[10:11], v[96:97]
    v_lshlrev_b32 v98, 16, v33
    v_and_b32 v99, 0xffff0000, v33
    v_pk_add_f32 v[10:11], v[10:11], v[98:99]
    v_lshlrev_b32 v100, 16, v34
    v_and_b32 v101, 0xffff0000, v34
    v_pk_add_f32 v[10:11], v[10:11], v[100:101]
    v_lshlrev_b32 v102, 16, v35
    v_and_b32 v103, 0xffff0000, v35
    v_pk_add_f32 v[10:11], v[10:11], v[102:103]
    s_waitcnt vmcnt(18)
    v_lshlrev_b32 v104, 16, v36
    v_and_b32 v105, 0xffff0000, v36
    v_pk_add_f32 v[10:11], v[10:11], v[104:105]
    v_lshlrev_b32 v106, 16, v37
    v_and_b32 v107, 0xffff0000, v37
    v_pk_add_f32 v[10:11], v[10:11], v[106:107]
    v_lshlrev_b32 v108, 16, v38
    v_and_b32 v109, 0xffff0000, v38
    v_pk_add_f32 v[10:11], v[10:11], v[108:109]
    v_lshlrev_b32 v110, 16, v39
    v_and_b32 v111, 0xffff0000, v39
    v_pk_add_f32 v[10:11], v[10:11], v[110:111]
    s_waitcnt vmcnt(17)
    v_lshlrev_b32 v112, 16, v40
    v_and_b32 v113, 0xffff0000, v40
    v_pk_add_f32 v[10:11], v[10:11], v[112:113]
    v_lshlrev_b32 v114, 16, v41
    v_and_b32 v115, 0xffff0000, v41
    v_pk_add_f32 v[10:11], v[10:11], v[114:115]
    v_lshlrev_b32 v116, 16, v42
    v_and_b32 v117, 0xffff0000, v42
    v_pk_add_f32 v[10:11], v[10:11], v[116:117]
    v_lshlrev_b32 v118, 16, v43
    v_and_b32 v119, 0xffff0000, v43
    v_pk_add_f32 v[10:11], v[10:11], v[118:119]
    s_waitcnt vmcnt(16)
    v_lshlrev_b32 v120, 16, v44
    v_and_b32 v121, 0xffff0000, v44
    v_pk_add_f32 v[10:11], v[10:11], v[120:121]
    v_lshlrev_b32 v122, 16, v45
    v_and_b32 v123, 0xffff0000, v45
    v_pk_add_f32 v[10:11], v[10:11], v[122:123]
    v_lshlrev_b32 v124, 16, v46
    v_and_b32 v125, 0xffff0000, v46
    v_pk_add_f32 v[10:11], v[10:11], v[124:125]
    v_lshlrev_b32 v126, 16, v47
    v_and_b32 v127, 0xffff0000, v47
    v_pk_add_f32 v[10:11], v[10:11], v[126:127]
    s_waitcnt vmcnt(15)
    v_lshlrev_b32 v128, 16, v48
    v_and_b32 v129, 0xffff0000, v48
    v_pk_add_f32 v[10:11], v[10:11], v[128:129]
    v_lshlrev_b32 v130, 16, v49
    v_and_b32 v131, 0xffff0000, v49
    v_pk_add_f32 v[10:11], v[10:11], v[130:131]
    v_lshlrev_b32 v132, 16, v50
    v_and_b32 v133, 0xffff0000, v50
    v_pk_add_f32 v[10:11], v[10:11], v[132:133]
    v_lshlrev_b32 v134, 16, v51
    v_and_b32 v135, 0xffff0000, v51
    v_pk_add_f32 v[10:11], v[10:11], v[134:135]
    v_add_f32 v4, v10, v11
    s_nop 1
    v_add_f32_dpp v4, v4, v4 quad_perm:[1,0,3,2] row_mask:0xf bank_mask:0xf
    s_nop 1
    v_add_f32_dpp v4, v4, v4 quad_perm:[2,3,0,1] row_mask:0xf bank_mask:0xf
    s_nop 1
    v_add_f32_dpp v4, v4, v4 row_half_mirror row_mask:0xf bank_mask:0xf
    v_mul_f32 v6, 0x3ae38e39, v4
    v_pk_add_f32 v[12:13], v[64:65], v[6:7] op_sel_hi:[1,0] neg_lo:[0,1] neg_hi:[0,1]
    v_pk_mul_f32 v[10:11], v[12:13], v[12:13]
    v_pk_add_f32 v[12:13], v[66:67], v[6:7] op_sel_hi:[1,0] neg_lo:[0,1] neg_hi:[0,1]
    v_pk_fma_f32 v[10:11], v[12:13], v[12:13], v[10:11]
    v_pk_add_f32 v[12:13], v[68:69], v[6:7] op_sel_hi:[1,0] neg_lo:[0,1] neg_hi:[0,1]
    v_pk_fma_f32 v[10:11], v[12:13], v[12:13], v[10:11]
    v_pk_add_f32 v[12:13], v[70:71], v[6:7] op_sel_hi:[1,0] neg_lo:[0,1] neg_hi:[0,1]
    v_pk_fma_f32 v[10:11], v[12:13], v[12:13], v[10:11]
    v_pk_add_f32 v[12:13], v[72:73], v[6:7] op_sel_hi:[1,0] neg_lo:[0,1] neg_hi:[0,1]
    v_pk_fma_f32 v[10:11], v[12:13], v[12:13], v[10:11]
    v_pk_add_f32 v[12:13], v[74:75], v[6:7] op_sel_hi:[1,0] neg_lo:[0,1] neg_hi:[0,1]
    v_pk_fma_f32 v[10:11], v[12:13], v[12:13], v[10:11]
    v_pk_add_f32 v[12:13], v[76:77], v[6:7] op_sel_hi:[1,0] neg_lo:[0,1] neg_hi:[0,1]
    v_pk_fma_f32 v[10:11], v[12:13], v[12:13], v[10:11]
    v_pk_add_f32 v[12:13], v[78:79], v[6:7] op_sel_hi:[1,0] neg_lo:[0,1] neg_hi:[0,1]
    v_pk_fma_f32 v[10:11], v[12:13], v[12:13], v[10:11]
    v_pk_add_f32 v[12:13], v[80:81], v[6:7] op_sel_hi:[1,0] neg_lo:[0,1] neg_hi:[0,1]
    v_pk_fma_f32 v[10:11], v[12:13], v[12:13], v[10:11]
    v_pk_add_f32 v[12:13], v[82:83], v[6:7] op_sel_hi:[1,0] neg_lo:[0,1] neg_hi:[0,1]
    v_pk_fma_f32 v[10:11], v[12:13], v[12:13], v[10:11]
    v_pk_add_f32 v[12:13], v[84:85], v[6:7] op_sel_hi:[1,0] neg_lo:[0,1] neg_hi:[0,1]
    v_pk_fma_f32 v[10:11], v[12:13], v[12:13], v[10:11]
    v_pk_add_f32 v[12:13], v[86:87], v[6:7] op_sel_hi:[1,0] neg_lo:[0,1] neg_hi:[0,1]
    v_pk_fma_f32 v[10:11], v[12:13], v[12:13], v[10:11]
    v_pk_add_f32 v[12:13], v[88:89], v[6:7] op_sel_hi:[1,0] neg_lo:[0,1] neg_hi:[0,1]
    v_pk_fma_f32 v[10:11], v[12:13], v[12:13], v[10:11]
    v_pk_add_f32 v[12:13], v[90:91], v[6:7] op_sel_hi:[1,0] neg_lo:[0,1] neg_hi:[0,1]
    v_pk_fma_f32 v[10:11], v[12:13], v[12:13], v[10:11]
    v_pk_add_f32 v[12:13], v[92:93], v[6:7] op_sel_hi:[1,0] neg_lo:[0,1] neg_hi:[0,1]
    v_pk_fma_f32 v[10:11], v[12:13], v[12:13], v[10:11]
    v_pk_add_f32 v[12:13], v[94:95], v[6:7] op_sel_hi:[1,0] neg_lo:[0,1] neg_hi:[0,1]
    v_pk_fma_f32 v[10:11], v[12:13], v[12:13], v[10:11]
    v_pk_add_f32 v[12:13], v[96:97], v[6:7] op_sel_hi:[1,0] neg_lo:[0,1] neg_hi:[0,1]
    v_pk_fma_f32 v[10:11], v[12:13], v[12:13], v[10:11]
    v_pk_add_f32 v[12:13], v[98:99], v[6:7] op_sel_hi:[1,0] neg_lo:[0,1] neg_hi:[0,1]
    v_pk_fma_f32 v[10:11], v[12:13], v[12:13], v[10:11]
    v_pk_add_f32 v[12:13], v[100:101], v[6:7] op_sel_hi:[1,0] neg_lo:[0,1] neg_hi:[0,1]
    v_pk_fma_f32 v[10:11], v[12:13], v[12:13], v[10:11]
    v_pk_add_f32 v[12:13], v[102:103], v[6:7] op_sel_hi:[1,0] neg_lo:[0,1] neg_hi:[0,1]
    v_pk_fma_f32 v[10:11], v[12:13], v[12:13], v[10:11]
    v_pk_add_f32 v[12:13], v[104:105], v[6:7] op_sel_hi:[1,0] neg_lo:[0,1] neg_hi:[0,1]
    v_pk_fma_f32 v[10:11], v[12:13], v[12:13], v[10:11]
    v_pk_add_f32 v[12:13], v[106:107], v[6:7] op_sel_hi:[1,0] neg_lo:[0,1] neg_hi:[0,1]
    v_pk_fma_f32 v[10:11], v[12:13], v[12:13], v[10:11]
    v_pk_add_f32 v[12:13], v[108:109], v[6:7] op_sel_hi:[1,0] neg_lo:[0,1] neg_hi:[0,1]
    v_pk_fma_f32 v[10:11], v[12:13], v[12:13], v[10:11]
    v_pk_add_f32 v[12:13], v[110:111], v[6:7] op_sel_hi:[1,0] neg_lo:[0,1] neg_hi:[0,1]
    v_pk_fma_f32 v[10:11], v[12:13], v[12:13], v[10:11]
    v_pk_add_f32 v[12:13], v[112:113], v[6:7] op_sel_hi:[1,0] neg_lo:[0,1] neg_hi:[0,1]
    v_pk_fma_f32 v[10:11], v[12:13], v[12:13], v[10:11]
    v_pk_add_f32 v[12:13], v[114:115], v[6:7] op_sel_hi:[1,0] neg_lo:[0,1] neg_hi:[0,1]
    v_pk_fma_f32 v[10:11], v[12:13], v[12:13], v[10:11]
    v_pk_add_f32 v[12:13], v[116:117], v[6:7] op_sel_hi:[1,0] neg_lo:[0,1] neg_hi:[0,1]
    v_pk_fma_f32 v[10:11], v[12:13], v[12:13], v[10:11]
    v_pk_add_f32 v[12:13], v[118:119], v[6:7] op_sel_hi:[1,0] neg_lo:[0,1] neg_hi:[0,1]
    v_pk_fma_f32 v[10:11], v[12:13], v[12:13], v[10:11]
    v_pk_add_f32 v[12:13], v[120:121], v[6:7] op_sel_hi:[1,0] neg_lo:[0,1] neg_hi:[0,1]
    v_pk_fma_f32 v[10:11], v[12:13], v[12:13], v[10:11]
    v_pk_add_f32 v[12:13], v[122:123], v[6:7] op_sel_hi:[1,0] neg_lo:[0,1] neg_hi:[0,1]
    v_pk_fma_f32 v[10:11], v[12:13], v[12:13], v[10:11]
    v_pk_add_f32 v[12:13], v[124:125], v[6:7] op_sel_hi:[1,0] neg_lo:[0,1] neg_hi:[0,1]
    v_pk_fma_f32 v[10:11], v[12:13], v[12:13], v[10:11]
    v_pk_add_f32 v[12:13], v[126:127], v[6:7] op_sel_hi:[1,0] neg_lo:[0,1] neg_hi:[0,1]
    v_pk_fma_f32 v[10:11], v[12:13], v[12:13], v[10:11]
    v_pk_add_f32 v[12:13], v[128:129], v[6:7] op_sel_hi:[1,0] neg_lo:[0,1] neg_hi:[0,1]
    v_pk_fma_f32 v[10:11], v[12:13], v[12:13], v[10:11]
    v_pk_add_f32 v[12:13], v[130:131], v[6:7] op_sel_hi:[1,0] neg_lo:[0,1] neg_hi:[0,1]
    v_pk_fma_f32 v[10:11], v[12:13], v[12:13], v[10:11]
    v_pk_add_f32 v[12:13], v[132:133], v[6:7] op_sel_hi:[1,0] neg_lo:[0,1] neg_hi:[0,1]
    v_pk_fma_f32 v[10:11], v[12:13], v[12:13], v[10:11]
    v_pk_add_f32 v[12:13], v[134:135], v[6:7] op_sel_hi:[1,0] neg_lo:[0,1] neg_hi:[0,1]
    v_pk_fma_f32 v[10:11], v[12:13], v[12:13], v[10:11]
    v_add_f32 v5, v10, v11
    s_nop 1
    v_add_f32_dpp v5, v5, v5 quad_perm:[1,0,3,2] row_mask:0xf bank_mask:0xf
    s_nop 1
    v_add_f32_dpp v5, v5, v5 quad_perm:[2,3,0,1] row_mask:0xf bank_mask:0xf
    s_nop 1
    v_add_f32_dpp v5, v5, v5 row_half_mirror row_mask:0xf bank_mask:0xf
    v_mul_f32 v5, 0x3ae38e39, v5
    v_cvt_pk_bf16_f32 v5, v5, v5
    v_and_b32 v5, 0xffff0000, v5
    v_add_f32 v5, 0x3727c5ac, v5
    v_cvt_pk_bf16_f32 v5, v5, v5
    v_and_b32 v5, 0xffff0000, v5
    v_sqrt_f32 v5, v5
    s_nop 0
    v_cvt_pk_bf16_f32 v5, v5, v5
    v_and_b32 v5, 0xffff0000, v5
    v_rcp_f32 v8, v5
    v_cvt_pk_bf16_f32 v6, v6, v6
    v_and_b32 v6, 0xffff0000, v6
    s_mul_i32 s42, s38, 36864
    s_lshl_b32 s43, s14, 7
    s_add_u32 s42, s42, s43
    v_pk_add_f32 v[64:65], v[64:65], v[6:7] op_sel_hi:[1,0] neg_lo:[0,1] neg_hi:[0,1]
    v_cvt_pk_bf16_f32 v16, v64, v65
    v_lshlrev_b32 v64, 16, v16
    v_and_b32 v65, 0xffff0000, v16
    v_pk_mul_f32 v[64:65], v[64:65], v[8:9] op_sel_hi:[1,0]
    v_cvt_pk_bf16_f32 v16, v64, v65
    v_pk_add_f32 v[66:67], v[66:67], v[6:7] op_sel_hi:[1,0] neg_lo:[0,1] neg_hi:[0,1]
    v_cvt_pk_bf16_f32 v17, v66, v67
    v_lshlrev_b32 v66, 16, v17
    v_and_b32 v67, 0xffff0000, v17
    v_pk_mul_f32 v[66:67], v[66:67], v[8:9] op_sel_hi:[1,0]
    v_cvt_pk_bf16_f32 v17, v66, v67
    v_pk_add_f32 v[68:69], v[68:69], v[6:7] op_sel_hi:[1,0] neg_lo:[0,1] neg_hi:[0,1]
    v_cvt_pk_bf16_f32 v18, v68, v69
    v_lshlrev_b32 v68, 16, v18
    v_and_b32 v69, 0xffff0000, v18
    v_pk_mul_f32 v[68:69], v[68:69], v[8:9] op_sel_hi:[1,0]
    v_cvt_pk_bf16_f32 v18, v68, v69
    v_pk_add_f32 v[70:71], v[70:71], v[6:7] op_sel_hi:[1,0] neg_lo:[0,1] neg_hi:[0,1]
    v_cvt_pk_bf16_f32 v19, v70, v71
    v_lshlrev_b32 v70, 16, v19
    v_and_b32 v71, 0xffff0000, v19
    v_pk_mul_f32 v[70:71], v[70:71], v[8:9] op_sel_hi:[1,0]
    v_cvt_pk_bf16_f32 v19, v70, v71
    s_add_u32 s43, s42, 0
    buffer_store_dwordx4 v[16:19], v3, s[4:7], s43 offen sc1
    v_pk_add_f32 v[72:73], v[72:73], v[6:7] op_sel_hi:[1,0] neg_lo:[0,1] neg_hi:[0,1]
    v_cvt_pk_bf16_f32 v20, v72, v73
    v_lshlrev_b32 v72, 16, v20
    v_and_b32 v73, 0xffff0000, v20
    v_pk_mul_f32 v[72:73], v[72:73], v[8:9] op_sel_hi:[1,0]
    v_cvt_pk_bf16_f32 v20, v72, v73
    v_pk_add_f32 v[74:75], v[74:75], v[6:7] op_sel_hi:[1,0] neg_lo:[0,1] neg_hi:[0,1]
    v_cvt_pk_bf16_f32 v21, v74, v75
    v_lshlrev_b32 v74, 16, v21
    v_and_b32 v75, 0xffff0000, v21
    v_pk_mul_f32 v[74:75], v[74:75], v[8:9] op_sel_hi:[1,0]
    v_cvt_pk_bf16_f32 v21, v74, v75
    v_pk_add_f32 v[76:77], v[76:77], v[6:7] op_sel_hi:[1,0] neg_lo:[0,1] neg_hi:[0,1]
    v_cvt_pk_bf16_f32 v22, v76, v77
    v_lshlrev_b32 v76, 16, v22
    v_and_b32 v77, 0xffff0000, v22
    v_pk_mul_f32 v[76:77], v[76:77], v[8:9] op_sel_hi:[1,0]
    v_cvt_pk_bf16_f32 v22, v76, v77
    v_pk_add_f32 v[78:79], v[78:79], v[6:7] op_sel_hi:[1,0] neg_lo:[0,1] neg_hi:[0,1]
    v_cvt_pk_bf16_f32 v23, v78, v79
    v_lshlrev_b32 v78, 16, v23
    v_and_b32 v79, 0xffff0000, v23
    v_pk_mul_f32 v[78:79], v[78:79], v[8:9] op_sel_hi:[1,0]
    v_cvt_pk_bf16_f32 v23, v78, v79
    s_add_u32 s43, s42, 4096
    buffer_store_dwordx4 v[20:23], v3, s[4:7], s43 offen sc1
    v_pk_add_f32 v[80:81], v[80:81], v[6:7] op_sel_hi:[1,0] neg_lo:[0,1] neg_hi:[0,1]
    v_cvt_pk_bf16_f32 v24, v80, v81
    v_lshlrev_b32 v80, 16, v24
    v_and_b32 v81, 0xffff0000, v24
    v_pk_mul_f32 v[80:81], v[80:81], v[8:9] op_sel_hi:[1,0]
    v_cvt_pk_bf16_f32 v24, v80, v81
    v_pk_add_f32 v[82:83], v[82:83], v[6:7] op_sel_hi:[1,0] neg_lo:[0,1] neg_hi:[0,1]
    v_cvt_pk_bf16_f32 v25, v82, v83
    v_lshlrev_b32 v82, 16, v25
    v_and_b32 v83, 0xffff0000, v25
    v_pk_mul_f32 v[82:83], v[82:83], v[8:9] op_sel_hi:[1,0]
    v_cvt_pk_bf16_f32 v25, v82, v83
    v_pk_add_f32 v[84:85], v[84:85], v[6:7] op_sel_hi:[1,0] neg_lo:[0,1] neg_hi:[0,1]
    v_cvt_pk_bf16_f32 v26, v84, v85
    v_lshlrev_b32 v84, 16, v26
    v_and_b32 v85, 0xffff0000, v26
    v_pk_mul_f32 v[84:85], v[84:85], v[8:9] op_sel_hi:[1,0]
    v_cvt_pk_bf16_f32 v26, v84, v85
    v_pk_add_f32 v[86:87], v[86:87], v[6:7] op_sel_hi:[1,0] neg_lo:[0,1] neg_hi:[0,1]
    v_cvt_pk_bf16_f32 v27, v86, v87
    v_lshlrev_b32 v86, 16, v27
    v_and_b32 v87, 0xffff0000, v27
    v_pk_mul_f32 v[86:87], v[86:87], v[8:9] op_sel_hi:[1,0]
    v_cvt_pk_bf16_f32 v27, v86, v87
    s_add_u32 s43, s42, 8192
    buffer_store_dwordx4 v[24:27], v3, s[4:7], s43 offen sc1
    v_pk_add_f32 v[88:89], v[88:89], v[6:7] op_sel_hi:[1,0] neg_lo:[0,1] neg_hi:[0,1]
    v_cvt_pk_bf16_f32 v28, v88, v89
    v_lshlrev_b32 v88, 16, v28
    v_and_b32 v89, 0xffff0000, v28
    v_pk_mul_f32 v[88:89], v[88:89], v[8:9] op_sel_hi:[1,0]
    v_cvt_pk_bf16_f32 v28, v88, v89
    v_pk_add_f32 v[90:91], v[90:91], v[6:7] op_sel_hi:[1,0] neg_lo:[0,1] neg_hi:[0,1]
    v_cvt_pk_bf16_f32 v29, v90, v91
    v_lshlrev_b32 v90, 16, v29
    v_and_b32 v91, 0xffff0000, v29
    v_pk_mul_f32 v[90:91], v[90:91], v[8:9] op_sel_hi:[1,0]
    v_cvt_pk_bf16_f32 v29, v90, v91
    v_pk_add_f32 v[92:93], v[92:93], v[6:7] op_sel_hi:[1,0] neg_lo:[0,1] neg_hi:[0,1]
    v_cvt_pk_bf16_f32 v30, v92, v93
    v_lshlrev_b32 v92, 16, v30
    v_and_b32 v93, 0xffff0000, v30
    v_pk_mul_f32 v[92:93], v[92:93], v[8:9] op_sel_hi:[1,0]
    v_cvt_pk_bf16_f32 v30, v92, v93
    v_pk_add_f32 v[94:95], v[94:95], v[6:7] op_sel_hi:[1,0] neg_lo:[0,1] neg_hi:[0,1]
    v_cvt_pk_bf16_f32 v31, v94, v95
    v_lshlrev_b32 v94, 16, v31
    v_and_b32 v95, 0xffff0000, v31
    v_pk_mul_f32 v[94:95], v[94:95], v[8:9] op_sel_hi:[1,0]
    v_cvt_pk_bf16_f32 v31, v94, v95
    s_add_u32 s43, s42, 12288
    buffer_store_dwordx4 v[28:31], v3, s[4:7], s43 offen sc1
    v_pk_add_f32 v[96:97], v[96:97], v[6:7] op_sel_hi:[1,0] neg_lo:[0,1] neg_hi:[0,1]
    v_cvt_pk_bf16_f32 v32, v96, v97
    v_lshlrev_b32 v96, 16, v32
    v_and_b32 v97, 0xffff0000, v32
    v_pk_mul_f32 v[96:97], v[96:97], v[8:9] op_sel_hi:[1,0]
    v_cvt_pk_bf16_f32 v32, v96, v97
    v_pk_add_f32 v[98:99], v[98:99], v[6:7] op_sel_hi:[1,0] neg_lo:[0,1] neg_hi:[0,1]
    v_cvt_pk_bf16_f32 v33, v98, v99
    v_lshlrev_b32 v98, 16, v33
    v_and_b32 v99, 0xffff0000, v33
    v_pk_mul_f32 v[98:99], v[98:99], v[8:9] op_sel_hi:[1,0]
    v_cvt_pk_bf16_f32 v33, v98, v99
    v_pk_add_f32 v[100:101], v[100:101], v[6:7] op_sel_hi:[1,0] neg_lo:[0,1] neg_hi:[0,1]
    v_cvt_pk_bf16_f32 v34, v100, v101
    v_lshlrev_b32 v100, 16, v34
    v_and_b32 v101, 0xffff0000, v34
    v_pk_mul_f32 v[100:101], v[100:101], v[8:9] op_sel_hi:[1,0]
    v_cvt_pk_bf16_f32 v34, v100, v101
    v_pk_add_f32 v[102:103], v[102:103], v[6:7] op_sel_hi:[1,0] neg_lo:[0,1] neg_hi:[0,1]
    v_cvt_pk_bf16_f32 v35, v102, v103
    v_lshlrev_b32 v102, 16, v35
    v_and_b32 v103, 0xffff0000, v35
    v_pk_mul_f32 v[102:103], v[102:103], v[8:9] op_sel_hi:[1,0]
    v_cvt_pk_bf16_f32 v35, v102, v103
    s_add_u32 s43, s42, 16384
    buffer_store_dwordx4 v[32:35], v3, s[4:7], s43 offen sc1
    v_pk_add_f32 v[104:105], v[104:105], v[6:7] op_sel_hi:[1,0] neg_lo:[0,1] neg_hi:[0,1]
    v_cvt_pk_bf16_f32 v36, v104, v105
    v_lshlrev_b32 v104, 16, v36
    v_and_b32 v105, 0xffff0000, v36
    v_pk_mul_f32 v[104:105], v[104:105], v[8:9] op_sel_hi:[1,0]
    v_cvt_pk_bf16_f32 v36, v104, v105
    v_pk_add_f32 v[106:107], v[106:107], v[6:7] op_sel_hi:[1,0] neg_lo:[0,1] neg_hi:[0,1]
    v_cvt_pk_bf16_f32 v37, v106, v107
    v_lshlrev_b32 v106, 16, v37
    v_and_b32 v107, 0xffff0000, v37
    v_pk_mul_f32 v[106:107], v[106:107], v[8:9] op_sel_hi:[1,0]
    v_cvt_pk_bf16_f32 v37, v106, v107
    v_pk_add_f32 v[108:109], v[108:109], v[6:7] op_sel_hi:[1,0] neg_lo:[0,1] neg_hi:[0,1]
    v_cvt_pk_bf16_f32 v38, v108, v109
    v_lshlrev_b32 v108, 16, v38
    v_and_b32 v109, 0xffff0000, v38
    v_pk_mul_f32 v[108:109], v[108:109], v[8:9] op_sel_hi:[1,0]
    v_cvt_pk_bf16_f32 v38, v108, v109
    v_pk_add_f32 v[110:111], v[110:111], v[6:7] op_sel_hi:[1,0] neg_lo:[0,1] neg_hi:[0,1]
    v_cvt_pk_bf16_f32 v39, v110, v111
    v_lshlrev_b32 v110, 16, v39
    v_and_b32 v111, 0xffff0000, v39
    v_pk_mul_f32 v[110:111], v[110:111], v[8:9] op_sel_hi:[1,0]
    v_cvt_pk_bf16_f32 v39, v110, v111
    s_add_u32 s43, s42, 20480
    buffer_store_dwordx4 v[36:39], v3, s[4:7], s43 offen sc1
    v_pk_add_f32 v[112:113], v[112:113], v[6:7] op_sel_hi:[1,0] neg_lo:[0,1] neg_hi:[0,1]
    v_cvt_pk_bf16_f32 v40, v112, v113
    v_lshlrev_b32 v112, 16, v40
    v_and_b32 v113, 0xffff0000, v40
    v_pk_mul_f32 v[112:113], v[112:113], v[8:9] op_sel_hi:[1,0]
    v_cvt_pk_bf16_f32 v40, v112, v113
    v_pk_add_f32 v[114:115], v[114:115], v[6:7] op_sel_hi:[1,0] neg_lo:[0,1] neg_hi:[0,1]
    v_cvt_pk_bf16_f32 v41, v114, v115
    v_lshlrev_b32 v114, 16, v41
    v_and_b32 v115, 0xffff0000, v41
    v_pk_mul_f32 v[114:115], v[114:115], v[8:9] op_sel_hi:[1,0]
    v_cvt_pk_bf16_f32 v41, v114, v115
    v_pk_add_f32 v[116:117], v[116:117], v[6:7] op_sel_hi:[1,0] neg_lo:[0,1] neg_hi:[0,1]
    v_cvt_pk_bf16_f32 v42, v116, v117
    v_lshlrev_b32 v116, 16, v42
    v_and_b32 v117, 0xffff0000, v42
    v_pk_mul_f32 v[116:117], v[116:117], v[8:9] op_sel_hi:[1,0]
    v_cvt_pk_bf16_f32 v42, v116, v117
    v_pk_add_f32 v[118:119], v[118:119], v[6:7] op_sel_hi:[1,0] neg_lo:[0,1] neg_hi:[0,1]
    v_cvt_pk_bf16_f32 v43, v118, v119
    v_lshlrev_b32 v118, 16, v43
    v_and_b32 v119, 0xffff0000, v43
    v_pk_mul_f32 v[118:119], v[118:119], v[8:9] op_sel_hi:[1,0]
    v_cvt_pk_bf16_f32 v43, v118, v119
    s_add_u32 s43, s42, 24576
    buffer_store_dwordx4 v[40:43], v3, s[4:7], s43 offen sc1
    v_pk_add_f32 v[120:121], v[120:121], v[6:7] op_sel_hi:[1,0] neg_lo:[0,1] neg_hi:[0,1]
    v_cvt_pk_bf16_f32 v44, v120, v121
    v_lshlrev_b32 v120, 16, v44
    v_and_b32 v121, 0xffff0000, v44
    v_pk_mul_f32 v[120:121], v[120:121], v[8:9] op_sel_hi:[1,0]
    v_cvt_pk_bf16_f32 v44, v120, v121
    v_pk_add_f32 v[122:123], v[122:123], v[6:7] op_sel_hi:[1,0] neg_lo:[0,1] neg_hi:[0,1]
    v_cvt_pk_bf16_f32 v45, v122, v123
    v_lshlrev_b32 v122, 16, v45
    v_and_b32 v123, 0xffff0000, v45
    v_pk_mul_f32 v[122:123], v[122:123], v[8:9] op_sel_hi:[1,0]
    v_cvt_pk_bf16_f32 v45, v122, v123
    v_pk_add_f32 v[124:125], v[124:125], v[6:7] op_sel_hi:[1,0] neg_lo:[0,1] neg_hi:[0,1]
    v_cvt_pk_bf16_f32 v46, v124, v125
    v_lshlrev_b32 v124, 16, v46
    v_and_b32 v125, 0xffff0000, v46
    v_pk_mul_f32 v[124:125], v[124:125], v[8:9] op_sel_hi:[1,0]
    v_cvt_pk_bf16_f32 v46, v124, v125
    v_pk_add_f32 v[126:127], v[126:127], v[6:7] op_sel_hi:[1,0] neg_lo:[0,1] neg_hi:[0,1]
    v_cvt_pk_bf16_f32 v47, v126, v127
    v_lshlrev_b32 v126, 16, v47
    v_and_b32 v127, 0xffff0000, v47
    v_pk_mul_f32 v[126:127], v[126:127], v[8:9] op_sel_hi:[1,0]
    v_cvt_pk_bf16_f32 v47, v126, v127
    s_add_u32 s43, s42, 28672
    buffer_store_dwordx4 v[44:47], v3, s[4:7], s43 offen sc1
    v_pk_add_f32 v[128:129], v[128:129], v[6:7] op_sel_hi:[1,0] neg_lo:[0,1] neg_hi:[0,1]
    v_cvt_pk_bf16_f32 v48, v128, v129
    v_lshlrev_b32 v128, 16, v48
    v_and_b32 v129, 0xffff0000, v48
    v_pk_mul_f32 v[128:129], v[128:129], v[8:9] op_sel_hi:[1,0]
    v_cvt_pk_bf16_f32 v48, v128, v129
    v_pk_add_f32 v[130:131], v[130:131], v[6:7] op_sel_hi:[1,0] neg_lo:[0,1] neg_hi:[0,1]
    v_cvt_pk_bf16_f32 v49, v130, v131
    v_lshlrev_b32 v130, 16, v49
    v_and_b32 v131, 0xffff0000, v49
    v_pk_mul_f32 v[130:131], v[130:131], v[8:9] op_sel_hi:[1,0]
    v_cvt_pk_bf16_f32 v49, v130, v131
    v_pk_add_f32 v[132:133], v[132:133], v[6:7] op_sel_hi:[1,0] neg_lo:[0,1] neg_hi:[0,1]
    v_cvt_pk_bf16_f32 v50, v132, v133
    v_lshlrev_b32 v132, 16, v50
    v_and_b32 v133, 0xffff0000, v50
    v_pk_mul_f32 v[132:133], v[132:133], v[8:9] op_sel_hi:[1,0]
    v_cvt_pk_bf16_f32 v50, v132, v133
    v_pk_add_f32 v[134:135], v[134:135], v[6:7] op_sel_hi:[1,0] neg_lo:[0,1] neg_hi:[0,1]
    v_cvt_pk_bf16_f32 v51, v134, v135
    v_lshlrev_b32 v134, 16, v51
    v_and_b32 v135, 0xffff0000, v51
    v_pk_mul_f32 v[134:135], v[134:135], v[8:9] op_sel_hi:[1,0]
    v_cvt_pk_bf16_f32 v51, v134, v135
    s_add_u32 s43, s42, 32768
    buffer_store_dwordx4 v[48:51], v3, s[4:7], s43 offen sc1
    s_cmp_ge_u32 s38, 32
    s_cbranch_scc1 ln2_136
    s_add_u32 s38, s38, 32
    s_add_u32 s20, s20, 128
    s_waitcnt vmcnt(15)
    v_mov_b64 v[16:17], v[144:145]
    v_mov_b64 v[18:19], v[146:147]
    v_mov_b64 v[20:21], v[148:149]
    v_mov_b64 v[22:23], v[150:151]
    v_mov_b64 v[24:25], v[152:153]
    v_mov_b64 v[26:27], v[154:155]
    v_mov_b64 v[28:29], v[156:157]
    v_mov_b64 v[30:31], v[158:159]
    v_mov_b64 v[32:33], v[160:161]
    v_mov_b64 v[34:35], v[162:163]
    v_mov_b64 v[36:37], v[164:165]
    v_mov_b64 v[38:39], v[166:167]
    v_mov_b64 v[40:41], v[168:169]
    v_mov_b64 v[42:43], v[170:171]
    v_mov_b64 v[44:45], v[172:173]
    v_mov_b64 v[46:47], v[174:175]
    v_mov_b64 v[48:49], v[176:177]
    v_mov_b64 v[50:51], v[178:179]
    s_branch ln2_135
ln2_136:
    s_waitcnt vmcnt(0)
    s_barrier
    s_cmp_lg_u32 s14, 0
    s_cbranch_scc1 lns_137
    s_mov_b64 exec, 1
    v_mov_b32 v2, 64
    v_mov_b32 v3, 1
    global_atomic_add v4, v2, v3, s[12:13] sc0
    v_mov_b32 v2, 224
    s_waitcnt vmcnt(0)
    v_readfirstlane_b32 s42, v4
    s_nop 0
    s_cmp_lg_u32 s42, 31
    s_cbranch_scc1 lns_138
    global_store_dword v2, v3, s[12:13] sc1
lns_138:
    s_mov_b64 exec, -1
lns_137:
    s_cmp_lt_u32 s15, 32
    s_cbranch_scc1 bend
proj:
    s_mov_b32 s29, 3
    s_cmp_lt_u32 s37, 25
    s_cselect_b32 s42, 9, 5
    s_cselect_b32 s43, 16, 25
    s_cselect_b32 s44, 48, 32
    s_cmp_lt_u32 s37, 16
    s_cselect_b32 s42, 16, s42
    s_cselect_b32 s43, 0, s43
    s_cselect_b32 s44, 0, s44
    s_mul_i32 s42, s42, s36
    s_add_u32 s42, s42, s37
    s_sub_u32 s42, s42, s43
    s_mul_hi_u32 s16, s42, 1431655766
    s_mul_i32 s43, s16, 3
    s_sub_u32 s17, s42, s43
    s_add_u32 s16, s16, s44
    s_cmp_lt_u32 s37, 30
    s_cbranch_scc1 pj_140
    s_and_b32 s17, s37, 1
    s_add_u32 s16, s36, 42
    s_mov_b32 s29, 2
pj_140:
    s_cmp_lt_u32 s37, 16
    s_cbranch_scc1 pj_139
    s_cmp_lg_u32 s14, 0
    s_cbranch_scc1 wl_141
    v_mov_b32 v3, 224
    s_mov_b32 s41, 0
    s_nop 0
sp_142:
    global_load_dword v2, v3, s[12:13] sc1
    s_waitcnt vmcnt(0)
    v_readfirstlane_b32 s45, v2
    s_nop 0
    s_cmp_lg_u32 s45, 0
    s_cbranch_scc1 sp_143
    s_sleep 8
    s_add_u32 s41, s41, 1
    s_cmp_lt_u32 s41, 2000000
    s_cbranch_scc1 sp_142
    s_branch fin2
sp_143:
wl_141:
    s_barrier
pj_139:
    v_mov_b32 v6, v1
    s_mov_b32 s19, 8192
    s_mov_b32 s21, 262144
    s_and_b32 s44, s14, 1
    s_cmp_ge_u32 s16, 48
    s_cbranch_scc1 pj_145
    s_cmp_ge_u32 s16, 32
    s_cbranch_scc1 pj_144
    s_lshl_b32 s18, s16, 8
    s_lshl_b32 s42, s44, 7
    s_add_u32 s18, s18, s42
    s_lshl_b32 s20, s16, 13
    s_lshl_b32 s42, s44, 12
    s_add_u32 s20, s20, s42
    s_cmp_ge_u32 s14, 2
    s_cbranch_scc1 pj_146
    s_mov_b32 s8, s52
    s_mov_b32 s9, s53
    s_mov_b32 s10, 4718592
    s_mov_b32 s11, 0x20000
    s_add_u32 s20, s20, 4194304
    v_and_b32 v6, 35, v0
    v_bfe_u32 v2, v0, 3, 2
    v_lshl_add_u32 v6, v2, 2, v6
    v_bfe_u32 v2, v0, 2, 1
    v_lshl_add_u32 v6, v2, 4, v6
    v_lshlrev_b32 v6, 4, v6
    s_mov_b32 s28, 0
    s_branch pj_147
pj_146:
    s_mov_b32 s8, s54
    s_mov_b32 s9, s55
    s_mov_b32 s10, 4718592
    s_mov_b32 s11, 0x20000
    s_add_u32 s20, s20, 20971520
    s_mov_b32 s28, 1
    s_branch pj_147
pj_144:
    s_sub_u32 s42, s16, 32
    s_lshl_b32 s42, s42, 2
    s_add_u32 s42, s42, s14
    s_lshl_b32 s18, s42, 7
    s_lshl_b32 s20, s42, 12
    s_add_u32 s20, s20, 37748736
    s_mov_b32 s8, s50
    s_mov_b32 s9, s51
    s_mov_b32 s10, 4718592
    s_mov_b32 s11, 0x20000
    s_mov_b32 s28, 0
    s_branch pj_147
pj_145:
    s_sub_u32 s42, s16, 48
    s_lshl_b32 s42, s42, 2
    s_add_u32 s42, s42, s14
    s_lshl_b32 s18, s42, 7
    s_lshl_b32 s20, s42, 12
    s_add_u32 s20, s20, 54525952
    s_mov_b32 s19, 9216
    s_mov_b32 s21, 294912
    s_mov_b32 s8, s62
    s_mov_b32 s9, s63
    s_mov_b32 s10, 5308416
    s_mov_b32 s11, 0x20000
    s_mov_b32 s28, 2
pj_147:
    v_lshrrev_b32 v4, 3, v0
    v_mul_lo_u32 v2, v4, s19
    v_and_b32 v4, 7, v0
    v_lshl_add_u32 v2, v4, 4, v2
    v_lshrrev_b32 v4, 5, v0
    v_bfe_u32 v5, v0, 2, 2
    v_lshl_add_u32 v4, v4, 3, v5
    v_mul_u32_u24 v3, 128, v4
    v_bfe_u32 v4, v0, 4, 1
    v_lshl_add_u32 v3, v4, 5, v3
    v_and_b32 v4, 3, v0
    v_lshl_add_u32 v3, v4, 3, v3
    s_mul_i32 s44, s14, 36864
    v_add_u32 v3, s44, v3
    s_mul_i32 s43, s19, 8
    s_mov_b32 s42, s18
    s_add_u32 m0, s44, 0
    s_nop 0
    buffer_load_dwordx4 v2, s[8:11], s42 offen  lds
    s_add_u32 s42, s42, s43
    s_add_u32 m0, s44, 1024
    s_nop 0
    buffer_load_dwordx4 v2, s[8:11], s42 offen  lds
    s_add_u32 s42, s42, s43
    s_add_u32 m0, s44, 2048
    s_nop 0
    buffer_load_dwordx4 v2, s[8:11], s42 offen  lds
    s_add_u32 s42, s42, s43
    s_add_u32 m0, s44, 3072
    s_nop 0
    buffer_load_dwordx4 v2, s[8:11], s42 offen  lds
    s_add_u32 s42, s42, s43
    s_add_u32 m0, s44, 4096
    s_nop 0
    buffer_load_dwordx4 v2, s[8:11], s42 offen  lds
    s_add_u32 s42, s42, s43
    s_add_u32 m0, s44, 5120
    s_nop 0
    buffer_load_dwordx4 v2, s[8:11], s42 offen  lds
    s_add_u32 s42, s42, s43
    s_add_u32 m0, s44, 6144
    s_nop 0
    buffer_load_dwordx4 v2, s[8:11], s42 offen  lds
    s_add_u32 s42, s42, s43
    s_add_u32 m0, s44, 7168
    s_nop 0
    buffer_load_dwordx4 v2, s[8:11], s42 offen  lds
    s_add_u32 s42, s42, s43
    s_add_u32 m0, s44, 8192
    s_nop 0
    buffer_load_dwordx4 v2, s[8:11], s42 offen  lds
    s_add_u32 s42, s42, s43
    s_add_u32 m0, s44, 9216
    s_nop 0
    buffer_load_dwordx4 v2, s[8:11], s42 offen  lds
    s_add_u32 s42, s42, s43
    s_add_u32 m0, s44, 10240
    s_nop 0
    buffer_load_dwordx4 v2, s[8:11], s42 offen  lds
    s_add_u32 s42, s42, s43
    s_add_u32 m0, s44, 11264
    s_nop 0
    buffer_load_dwordx4 v2, s[8:11], s42 offen  lds
    s_add_u32 s42, s42, s43
    s_add_u32 m0, s44, 12288
    s_nop 0
    buffer_load_dwordx4 v2, s[8:11], s42 offen  lds
    s_add_u32 s42, s42, s43
    s_add_u32 m0, s44, 13312
    s_nop 0
    buffer_load_dwordx4 v2, s[8:11], s42 offen  lds
    s_add_u32 s42, s42, s43
    s_add_u32 m0, s44, 14336
    s_nop 0
    buffer_load_dwordx4 v2, s[8:11], s42 offen  lds
    s_add_u32 s42, s42, s43
    s_add_u32 m0, s44, 15360
    s_nop 0
    buffer_load_dwordx4 v2, s[8:11], s42 offen  lds
    s_add_u32 s42, s42, s43
    s_add_u32 m0, s44, 16384
    s_nop 0
    buffer_load_dwordx4 v2, s[8:11], s42 offen  lds
    s_add_u32 s42, s42, s43
    s_add_u32 m0, s44, 17408
    s_nop 0
    buffer_load_dwordx4 v2, s[8:11], s42 offen  lds
    s_add_u32 s42, s42, s43
    s_add_u32 m0, s44, 18432
    s_nop 0
    buffer_load_dwordx4 v2, s[8:11], s42 offen  lds
    s_add_u32 s42, s42, s43
    s_add_u32 m0, s44, 19456
    s_nop 0
    buffer_load_dwordx4 v2, s[8:11], s42 offen  lds
    s_add_u32 s42, s42, s43
    s_add_u32 m0, s44, 20480
    s_nop 0
    buffer_load_dwordx4 v2, s[8:11], s42 offen  lds
    s_add_u32 s42, s42, s43
    s_add_u32 m0, s44, 21504
    s_nop 0
    buffer_load_dwordx4 v2, s[8:11], s42 offen  lds
    s_add_u32 s42, s42, s43
    s_add_u32 m0, s44, 22528
    s_nop 0
    buffer_load_dwordx4 v2, s[8:11], s42 offen  lds
    s_add_u32 s42, s42, s43
    s_add_u32 m0, s44, 23552
    s_nop 0
    buffer_load_dwordx4 v2, s[8:11], s42 offen  lds
    s_add_u32 s42, s42, s43
    s_add_u32 m0, s44, 24576
    s_nop 0
    buffer_load_dwordx4 v2, s[8:11], s42 offen  lds
    s_add_u32 s42, s42, s43
    s_add_u32 m0, s44, 25600
    s_nop 0
    buffer_load_dwordx4 v2, s[8:11], s42 offen  lds
    s_add_u32 s42, s42, s43
    s_add_u32 m0, s44, 26624
    s_nop 0
    buffer_load_dwordx4 v2, s[8:11], s42 offen  lds
    s_add_u32 s42, s42, s43
    s_add_u32 m0, s44, 27648
    s_nop 0
    buffer_load_dwordx4 v2, s[8:11], s42 offen  lds
    s_add_u32 s42, s42, s43
    s_add_u32 m0, s44, 28672
    s_nop 0
    buffer_load_dwordx4 v2, s[8:11], s42 offen  lds
    s_add_u32 s42, s42, s43
    s_add_u32 m0, s44, 29696
    s_nop 0
    buffer_load_dwordx4 v2, s[8:11], s42 offen  lds
    s_add_u32 s42, s42, s43
    s_add_u32 m0, s44, 30720
    s_nop 0
    buffer_load_dwordx4 v2, s[8:11], s42 offen  lds
    s_add_u32 s42, s42, s43
    s_add_u32 m0, s44, 31744
    s_nop 0
    buffer_load_dwordx4 v2, s[8:11], s42 offen  lds
    s_add_u32 s42, s42, s43
    s_add_u32 m0, s44, 32768
    s_nop 0
    buffer_load_dwordx4 v2, s[8:11], s42 offen  lds
    s_add_u32 s42, s42, s43
    s_add_u32 m0, s44, 33792
    s_nop 0
    buffer_load_dwordx4 v2, s[8:11], s42 offen  lds
    s_add_u32 s42, s42, s43
    s_add_u32 m0, s44, 34816
    s_nop 0
    buffer_load_dwordx4 v2, s[8:11], s42 offen  lds
    s_add_u32 s42, s42, s43
    s_add_u32 m0, s44, 35840
    s_nop 0
    buffer_load_dwordx4 v2, s[8:11], s42 offen  lds
    s_add_u32 s42, s42, s43
    s_waitcnt vmcnt(32)
    ds_read_b64_tr_b16 a[0:1], v3 offset:0
    ds_read_b64_tr_b16 a[2:3], v3 offset:512
    ds_read_b64_tr_b16 a[4:5], v3 offset:64
    ds_read_b64_tr_b16 a[6:7], v3 offset:576
    ds_read_b64_tr_b16 a[8:9], v3 offset:2048
    ds_read_b64_tr_b16 a[10:11], v3 offset:2560
    ds_read_b64_tr_b16 a[12:13], v3 offset:2112
    ds_read_b64_tr_b16 a[14:15], v3 offset:2624
    s_waitcnt lgkmcnt(0)
    s_add_u32 m0, s44, 0
    s_nop 0
    buffer_load_dwordx4 v2, s[8:11], s42 offen  lds
    s_add_u32 s42, s42, s43
    s_add_u32 m0, s44, 1024
    s_nop 0
    buffer_load_dwordx4 v2, s[8:11], s42 offen  lds
    s_add_u32 s42, s42, s43
    s_add_u32 m0, s44, 2048
    s_nop 0
    buffer_load_dwordx4 v2, s[8:11], s42 offen  lds
    s_add_u32 s42, s42, s43
    s_add_u32 m0, s44, 3072
    s_nop 0
    buffer_load_dwordx4 v2, s[8:11], s42 offen  lds
    s_add_u32 s42, s42, s43
    s_waitcnt vmcnt(32)
    ds_read_b64_tr_b16 a[16:17], v3 offset:4096
    ds_read_b64_tr_b16 a[18:19], v3 offset:4608
    ds_read_b64_tr_b16 a[20:21], v3 offset:4160
    ds_read_b64_tr_b16 a[22:23], v3 offset:4672
    ds_read_b64_tr_b16 a[24:25], v3 offset:6144
    ds_read_b64_tr_b16 a[26:27], v3 offset:6656
    ds_read_b64_tr_b16 a[28:29], v3 offset:6208
    ds_read_b64_tr_b16 a[30:31], v3 offset:6720
    s_waitcnt lgkmcnt(0)
    s_add_u32 m0, s44, 4096
    s_nop 0
    buffer_load_dwordx4 v2, s[8:11], s42 offen  lds
    s_add_u32 s42, s42, s43
    s_add_u32 m0, s44, 5120
    s_nop 0
    buffer_load_dwordx4 v2, s[8:11], s42 offen  lds
    s_add_u32 s42, s42, s43
    s_add_u32 m0, s44, 6144
    s_nop 0
    buffer_load_dwordx4 v2, s[8:11], s42 offen  lds
    s_add_u32 s42, s42, s43
    s_add_u32 m0, s44, 7168
    s_nop 0
    buffer_load_dwordx4 v2, s[8:11], s42 offen  lds
    s_add_u32 s42, s42, s43
    s_waitcnt vmcnt(32)
    ds_read_b64_tr_b16 a[32:33], v3 offset:8192
    ds_read_b64_tr_b16 a[34:35], v3 offset:8704
    ds_read_b64_tr_b16 a[36:37], v3 offset:8256
    ds_read_b64_tr_b16 a[38:39], v3 offset:8768
    ds_read_b64_tr_b16 a[40:41], v3 offset:10240
    ds_read_b64_tr_b16 a[42:43], v3 offset:10752
    ds_read_b64_tr_b16 a[44:45], v3 offset:10304
    ds_read_b64_tr_b16 a[46:47], v3 offset:10816
    s_waitcnt lgkmcnt(0)
    s_add_u32 m0, s44, 8192
    s_nop 0
    buffer_load_dwordx4 v2, s[8:11], s42 offen  lds
    s_add_u32 s42, s42, s43
    s_add_u32 m0, s44, 9216
    s_nop 0
    buffer_load_dwordx4 v2, s[8:11], s42 offen  lds
    s_add_u32 s42, s42, s43
    s_add_u32 m0, s44, 10240
    s_nop 0
    buffer_load_dwordx4 v2, s[8:11], s42 offen  lds
    s_add_u32 s42, s42, s43
    s_add_u32 m0, s44, 11264
    s_nop 0
    buffer_load_dwordx4 v2, s[8:11], s42 offen  lds
    s_add_u32 s42, s42, s43
    s_waitcnt vmcnt(32)
    ds_read_b64_tr_b16 a[48:49], v3 offset:12288
    ds_read_b64_tr_b16 a[50:51], v3 offset:12800
    ds_read_b64_tr_b16 a[52:53], v3 offset:12352
    ds_read_b64_tr_b16 a[54:55], v3 offset:12864
    ds_read_b64_tr_b16 a[56:57], v3 offset:14336
    ds_read_b64_tr_b16 a[58:59], v3 offset:14848
    ds_read_b64_tr_b16 a[60:61], v3 offset:14400
    ds_read_b64_tr_b16 a[62:63], v3 offset:14912
    s_waitcnt lgkmcnt(0)
    s_add_u32 m0, s44, 12288
    s_nop 0
    buffer_load_dwordx4 v2, s[8:11], s42 offen  lds
    s_add_u32 s42, s42, s43
    s_add_u32 m0, s44, 13312
    s_nop 0
    buffer_load_dwordx4 v2, s[8:11], s42 offen  lds
    s_add_u32 s42, s42, s43
    s_add_u32 m0, s44, 14336
    s_nop 0
    buffer_load_dwordx4 v2, s[8:11], s42 offen  lds
    s_add_u32 s42, s42, s43
    s_add_u32 m0, s44, 15360
    s_nop 0
    buffer_load_dwordx4 v2, s[8:11], s42 offen  lds
    s_add_u32 s42, s42, s43
    s_waitcnt vmcnt(32)
    ds_read_b64_tr_b16 a[64:65], v3 offset:16384
    ds_read_b64_tr_b16 a[66:67], v3 offset:16896
    ds_read_b64_tr_b16 a[68:69], v3 offset:16448
    ds_read_b64_tr_b16 a[70:71], v3 offset:16960
    ds_read_b64_tr_b16 a[72:73], v3 offset:18432
    ds_read_b64_tr_b16 a[74:75], v3 offset:18944
    ds_read_b64_tr_b16 a[76:77], v3 offset:18496
    ds_read_b64_tr_b16 a[78:79], v3 offset:19008
    s_waitcnt lgkmcnt(0)
    s_add_u32 m0, s44, 16384
    s_nop 0
    buffer_load_dwordx4 v2, s[8:11], s42 offen  lds
    s_add_u32 s42, s42, s43
    s_add_u32 m0, s44, 17408
    s_nop 0
    buffer_load_dwordx4 v2, s[8:11], s42 offen  lds
    s_add_u32 s42, s42, s43
    s_add_u32 m0, s44, 18432
    s_nop 0
    buffer_load_dwordx4 v2, s[8:11], s42 offen  lds
    s_add_u32 s42, s42, s43
    s_add_u32 m0, s44, 19456
    s_nop 0
    buffer_load_dwordx4 v2, s[8:11], s42 offen  lds
    s_add_u32 s42, s42, s43
    s_waitcnt vmcnt(32)
    ds_read_b64_tr_b16 a[80:81], v3 offset:20480
    ds_read_b64_tr_b16 a[82:83], v3 offset:20992
    ds_read_b64_tr_b16 a[84:85], v3 offset:20544
    ds_read_b64_tr_b16 a[86:87], v3 offset:21056
    ds_read_b64_tr_b16 a[88:89], v3 offset:22528
    ds_read_b64_tr_b16 a[90:91], v3 offset:23040
    ds_read_b64_tr_b16 a[92:93], v3 offset:22592
    ds_read_b64_tr_b16 a[94:95], v3 offset:23104
    s_waitcnt lgkmcnt(0)
    s_add_u32 m0, s44, 20480
    s_nop 0
    buffer_load_dwordx4 v2, s[8:11], s42 offen  lds
    s_add_u32 s42, s42, s43
    s_add_u32 m0, s44, 21504
    s_nop 0
    buffer_load_dwordx4 v2, s[8:11], s42 offen  lds
    s_add_u32 s42, s42, s43
    s_add_u32 m0, s44, 22528
    s_nop 0
    buffer_load_dwordx4 v2, s[8:11], s42 offen  lds
    s_add_u32 s42, s42, s43
    s_add_u32 m0, s44, 23552
    s_nop 0
    buffer_load_dwordx4 v2, s[8:11], s42 offen  lds
    s_add_u32 s42, s42, s43
    s_waitcnt vmcnt(32)
    ds_read_b64_tr_b16 a[96:97], v3 offset:24576
    ds_read_b64_tr_b16 a[98:99], v3 offset:25088
    ds_read_b64_tr_b16 a[100:101], v3 offset:24640
    ds_read_b64_tr_b16 a[102:103], v3 offset:25152
    ds_read_b64_tr_b16 a[104:105], v3 offset:26624
    ds_read_b64_tr_b16 a[106:107], v3 offset:27136
    ds_read_b64_tr_b16 a[108:109], v3 offset:26688
    ds_read_b64_tr_b16 a[110:111], v3 offset:27200
    s_waitcnt lgkmcnt(0)
    s_add_u32 m0, s44, 24576
    s_nop 0
    buffer_load_dwordx4 v2, s[8:11], s42 offen  lds
    s_add_u32 s42, s42, s43
    s_add_u32 m0, s44, 25600
    s_nop 0
    buffer_load_dwordx4 v2, s[8:11], s42 offen  lds
    s_add_u32 s42, s42, s43
    s_add_u32 m0, s44, 26624
    s_nop 0
    buffer_load_dwordx4 v2, s[8:11], s42 offen  lds
    s_add_u32 s42, s42, s43
    s_add_u32 m0, s44, 27648
    s_nop 0
    buffer_load_dwordx4 v2, s[8:11], s42 offen  lds
    s_add_u32 s42, s42, s43
    s_waitcnt vmcnt(32)
    ds_read_b64_tr_b16 a[112:113], v3 offset:28672
    ds_read_b64_tr_b16 a[114:115], v3 offset:29184
    ds_read_b64_tr_b16 a[116:117], v3 offset:28736
    ds_read_b64_tr_b16 a[118:119], v3 offset:29248
    ds_read_b64_tr_b16 a[120:121], v3 offset:30720
    ds_read_b64_tr_b16 a[122:123], v3 offset:31232
    ds_read_b64_tr_b16 a[124:125], v3 offset:30784
    ds_read_b64_tr_b16 a[126:127], v3 offset:31296
    s_waitcnt lgkmcnt(0)
    s_add_u32 m0, s44, 28672
    s_nop 0
    buffer_load_dwordx4 v2, s[8:11], s42 offen  lds
    s_add_u32 s42, s42, s43
    s_add_u32 m0, s44, 29696
    s_nop 0
    buffer_load_dwordx4 v2, s[8:11], s42 offen  lds
    s_add_u32 s42, s42, s43
    s_add_u32 m0, s44, 30720
    s_nop 0
    buffer_load_dwordx4 v2, s[8:11], s42 offen  lds
    s_add_u32 s42, s42, s43
    s_add_u32 m0, s44, 31744
    s_nop 0
    buffer_load_dwordx4 v2, s[8:11], s42 offen  lds
    s_add_u32 s42, s42, s43
    s_waitcnt vmcnt(32)
    ds_read_b64_tr_b16 a[128:129], v3 offset:32768
    ds_read_b64_tr_b16 a[130:131], v3 offset:33280
    ds_read_b64_tr_b16 a[132:133], v3 offset:32832
    ds_read_b64_tr_b16 a[134:135], v3 offset:33344
    ds_read_b64_tr_b16 a[136:137], v3 offset:34816
    ds_read_b64_tr_b16 a[138:139], v3 offset:35328
    ds_read_b64_tr_b16 a[140:141], v3 offset:34880
    ds_read_b64_tr_b16 a[142:143], v3 offset:35392
    s_waitcnt lgkmcnt(0)
    s_add_u32 m0, s44, 32768
    s_nop 0
    buffer_load_dwordx4 v2, s[8:11], s42 offen  lds
    s_add_u32 s42, s42, s43
    s_add_u32 m0, s44, 33792
    s_nop 0
    buffer_load_dwordx4 v2, s[8:11], s42 offen  lds
    s_add_u32 s42, s42, s43
    s_add_u32 m0, s44, 34816
    s_nop 0
    buffer_load_dwordx4 v2, s[8:11], s42 offen  lds
    s_add_u32 s42, s42, s43
    s_add_u32 m0, s44, 35840
    s_nop 0
    buffer_load_dwordx4 v2, s[8:11], s42 offen  lds
    s_add_u32 s42, s42, s43
    s_waitcnt vmcnt(32)
    ds_read_b64_tr_b16 a[144:145], v3 offset:0
    ds_read_b64_tr_b16 a[146:147], v3 offset:512
    ds_read_b64_tr_b16 a[148:149], v3 offset:64
    ds_read_b64_tr_b16 a[150:151], v3 offset:576
    ds_read_b64_tr_b16 a[152:153], v3 offset:2048
    ds_read_b64_tr_b16 a[154:155], v3 offset:2560
    ds_read_b64_tr_b16 a[156:157], v3 offset:2112
    ds_read_b64_tr_b16 a[158:159], v3 offset:2624
    s_waitcnt lgkmcnt(0)
    s_waitcnt vmcnt(28)
    ds_read_b64_tr_b16 a[160:161], v3 offset:4096
    ds_read_b64_tr_b16 a[162:163], v3 offset:4608
    ds_read_b64_tr_b16 a[164:165], v3 offset:4160
    ds_read_b64_tr_b16 a[166:167], v3 offset:4672
    ds_read_b64_tr_b16 a[168:169], v3 offset:6144
    ds_read_b64_tr_b16 a[170:171], v3 offset:6656
    ds_read_b64_tr_b16 a[172:173], v3 offset:6208
    ds_read_b64_tr_b16 a[174:175], v3 offset:6720
    s_waitcnt lgkmcnt(0)
    s_waitcnt vmcnt(24)
    ds_read_b64_tr_b16 a[176:177], v3 offset:8192
    ds_read_b64_tr_b16 a[178:179], v3 offset:8704
    ds_read_b64_tr_b16 a[180:181], v3 offset:8256
    ds_read_b64_tr_b16 a[182:183], v3 offset:8768
    ds_read_b64_tr_b16 a[184:185], v3 offset:10240
    ds_read_b64_tr_b16 a[186:187], v3 offset:10752
    ds_read_b64_tr_b16 a[188:189], v3 offset:10304
    ds_read_b64_tr_b16 a[190:191], v3 offset:10816
    s_waitcnt lgkmcnt(0)
    s_waitcnt vmcnt(20)
    ds_read_b64_tr_b16 a[192:193], v3 offset:12288
    ds_read_b64_tr_b16 a[194:195], v3 offset:12800
    ds_read_b64_tr_b16 a[196:197], v3 offset:12352
    ds_read_b64_tr_b16 a[198:199], v3 offset:12864
    ds_read_b64_tr_b16 a[200:201], v3 offset:14336
    ds_read_b64_tr_b16 a[202:203], v3 offset:14848
    ds_read_b64_tr_b16 a[204:205], v3 offset:14400
    ds_read_b64_tr_b16 a[206:207], v3 offset:14912
    s_waitcnt lgkmcnt(0)
    s_waitcnt vmcnt(16)
    ds_read_b64_tr_b16 a[208:209], v3 offset:16384
    ds_read_b64_tr_b16 a[210:211], v3 offset:16896
    ds_read_b64_tr_b16 a[212:213], v3 offset:16448
    ds_read_b64_tr_b16 a[214:215], v3 offset:16960
    ds_read_b64_tr_b16 a[216:217], v3 offset:18432
    ds_read_b64_tr_b16 a[218:219], v3 offset:18944
    ds_read_b64_tr_b16 a[220:221], v3 offset:18496
    ds_read_b64_tr_b16 a[222:223], v3 offset:19008
    s_waitcnt lgkmcnt(0)
    s_waitcnt vmcnt(12)
    ds_read_b64_tr_b16 a[224:225], v3 offset:20480
    ds_read_b64_tr_b16 a[226:227], v3 offset:20992
    ds_read_b64_tr_b16 a[228:229], v3 offset:20544
    ds_read_b64_tr_b16 a[230:231], v3 offset:21056
    ds_read_b64_tr_b16 a[232:233], v3 offset:22528
    ds_read_b64_tr_b16 a[234:235], v3 offset:23040
    ds_read_b64_tr_b16 a[236:237], v3 offset:22592
    ds_read_b64_tr_b16 a[238:239], v3 offset:23104
    s_waitcnt lgkmcnt(0)
    s_waitcnt vmcnt(8)
    ds_read_b64_tr_b16 a[240:241], v3 offset:24576
    ds_read_b64_tr_b16 a[242:243], v3 offset:25088
    ds_read_b64_tr_b16 a[244:245], v3 offset:24640
    ds_read_b64_tr_b16 a[246:247], v3 offset:25152
    ds_read_b64_tr_b16 a[248:249], v3 offset:26624
    ds_read_b64_tr_b16 a[250:251], v3 offset:27136
    ds_read_b64_tr_b16 a[252:253], v3 offset:26688
    ds_read_b64_tr_b16 a[254:255], v3 offset:27200
    s_waitcnt lgkmcnt(0)
    s_waitcnt vmcnt(4)
    ds_read_b64_tr_b16 v[224:225], v3 offset:28672
    ds_read_b64_tr_b16 v[226:227], v3 offset:29184
    ds_read_b64_tr_b16 v[228:229], v3 offset:28736
    ds_read_b64_tr_b16 v[230:231], v3 offset:29248
    ds_read_b64_tr_b16 v[232:233], v3 offset:30720
    ds_read_b64_tr_b16 v[234:235], v3 offset:31232
    ds_read_b64_tr_b16 v[236:237], v3 offset:30784
    ds_read_b64_tr_b16 v[238:239], v3 offset:31296
    s_waitcnt lgkmcnt(0)
    s_waitcnt vmcnt(0)
    ds_read_b64_tr_b16 v[240:241], v3 offset:32768
    ds_read_b64_tr_b16 v[242:243], v3 offset:33280
    ds_read_b64_tr_b16 v[244:245], v3 offset:32832
    ds_read_b64_tr_b16 v[246:247], v3 offset:33344
    ds_read_b64_tr_b16 v[248:249], v3 offset:34816
    ds_read_b64_tr_b16 v[250:251], v3 offset:35328
    ds_read_b64_tr_b16 v[252:253], v3 offset:34880
    ds_read_b64_tr_b16 v[254:255], v3 offset:35392
    s_waitcnt lgkmcnt(0)
    s_mul_i32 s42, s21, s17
    s_add_u32 s20, s20, s42
    s_mul_i32 s21, s21, s29
    s_sub_u32 s20, s20, s21
    s_mul_i32 s22, s17, 36864
    s_mul_i32 s27, s14, 9216
    s_add_u32 s22, s22, s27
    s_cmp_eq_u32 s17, 0
    s_cselect_b32 s23, 22, 21
    s_cmp_eq_u32 s29, 2
    s_cselect_b32 s23, 32, s23
    s_mul_i32 s29, s29, 36864
    s_lshl_b32 s25, s17, 7
    s_add_u32 s25, s25, s16
    s_lshl_b32 s25, s25, 7
    s_add_u32 s25, s25, 116408320
    s_cmp_lg_u32 s14, 0
    s_cbranch_scc1 wl_148
    v_mov_b32 v3, 224
    s_mov_b32 s41, 0
    s_nop 0
sp_149:
    global_load_dword v2, v3, s[12:13] sc1
    s_waitcnt vmcnt(0)
    v_readfirstlane_b32 s45, v2
    s_nop 0
    s_cmp_lg_u32 s45, 0
    s_cbranch_scc1 sp_150
    s_sleep 8
    s_add_u32 s41, s41, 1
    s_cmp_lt_u32 s41, 2000000
    s_cbranch_scc1 sp_149
    s_branch fin2
sp_150:
wl_148:
    s_barrier
    s_cmp_lt_u32 s37, 30
    s_cbranch_scc1 w2_151
    s_mov_b32 s44, 116420608
    s_mov_b32 s41, 0
sp_152:
    buffer_load_dword v2, off, s[4:7], s44 sc1
    s_waitcnt vmcnt(0)
    v_readfirstlane_b32 s45, v2
    s_nop 0
    s_cmp_ge_u32 s45, 1
    s_cbranch_scc1 sp_153
    s_sleep 40
    s_add_u32 s41, s41, 1
    s_cmp_lt_u32 s41, 2000000
    s_cbranch_scc1 sp_152
    s_branch fin2
sp_153:
    v_lshlrev_b32 v8, 7, v0
    s_mov_b32 s8, s64
    s_mov_b32 s9, s65
    s_mov_b32 s10, 5308416
    s_mov_b32 s11, 0x20000
    s_lshl_b32 s42, s36, 1
    s_add_u32 s42, s42, s37
    s_sub_u32 s42, s42, 30
    s_lshl_b32 s42, s42, 2
    s_add_u32 s42, s42, s14
    s_lshl_b32 s42, s42, 13
    buffer_load_dword v9, v8, s[8:11], s42 offen
    s_add_u32 s42, s42, 393216
    buffer_load_dword v9, v8, s[8:11], s42 offen
    s_add_u32 s42, s42, 393216
    buffer_load_dword v9, v8, s[8:11], s42 offen
    s_add_u32 s42, s42, 393216
    buffer_load_dword v9, v8, s[8:11], s42 offen
    s_add_u32 s42, s42, 393216
    buffer_load_dword v9, v8, s[8:11], s42 offen
    s_add_u32 s42, s42, 393216
    buffer_load_dword v9, v8, s[8:11], s42 offen
    s_add_u32 s42, s42, 393216
    buffer_load_dword v9, v8, s[8:11], s42 offen
    s_add_u32 s42, s42, 393216
    buffer_load_dword v9, v8, s[8:11], s42 offen
    s_add_u32 s42, s42, 393216
    buffer_load_dword v9, v8, s[8:11], s42 offen
    s_add_u32 s42, s42, 393216
    buffer_load_dword v9, v8, s[8:11], s42 offen
    s_add_u32 s42, s42, 393216
    buffer_load_dword v9, v8, s[8:11], s42 offen
    s_add_u32 s42, s42, 393216
    buffer_load_dword v9, v8, s[8:11], s42 offen
    s_add_u32 s42, s42, 393216
    buffer_load_dword v9, v8, s[8:11], s42 offen
    s_add_u32 s42, s42, 393216
    buffer_load_dword v9, v8, s[8:11], s42 offen
    s_add_u32 s42, s42, 393216
    s_waitcnt vmcnt(0)
w2_151:
    s_add_u32 s43, s27, 0
    s_add_u32 m0, s43, 0
    s_add_u32 s42, s22, 0
    buffer_load_dwordx4 v1, s[4:7], s42 offen offset:0 sc1 lds
    buffer_load_dwordx4 v1, s[4:7], s42 offen offset:1024 sc1 lds
    buffer_load_dwordx4 v1, s[4:7], s42 offen offset:2048 sc1 lds
    s_add_u32 m0, s43, 3072
    s_add_u32 s42, s22, 3072
    buffer_load_dwordx4 v1, s[4:7], s42 offen offset:0 sc1 lds
    buffer_load_dwordx4 v1, s[4:7], s42 offen offset:1024 sc1 lds
    buffer_load_dwordx4 v1, s[4:7], s42 offen offset:2048 sc1 lds
    s_add_u32 m0, s43, 6144
    s_add_u32 s42, s22, 6144
    buffer_load_dwordx4 v1, s[4:7], s42 offen offset:0 sc1 lds
    buffer_load_dwordx4 v1, s[4:7], s42 offen offset:1024 sc1 lds
    buffer_load_dwordx4 v1, s[4:7], s42 offen offset:2048 sc1 lds
    s_add_u32 s22, s22, s29
    s_add_u32 s43, s27, 36864
    s_add_u32 m0, s43, 0
    s_add_u32 s42, s22, 0
    buffer_load_dwordx4 v1, s[4:7], s42 offen offset:0 sc1 lds
    buffer_load_dwordx4 v1, s[4:7], s42 offen offset:1024 sc1 lds
    buffer_load_dwordx4 v1, s[4:7], s42 offen offset:2048 sc1 lds
    s_add_u32 m0, s43, 3072
    s_add_u32 s42, s22, 3072
    buffer_load_dwordx4 v1, s[4:7], s42 offen offset:0 sc1 lds
    buffer_load_dwordx4 v1, s[4:7], s42 offen offset:1024 sc1 lds
    buffer_load_dwordx4 v1, s[4:7], s42 offen offset:2048 sc1 lds
    s_add_u32 m0, s43, 6144
    s_add_u32 s42, s22, 6144
    buffer_load_dwordx4 v1, s[4:7], s42 offen offset:0 sc1 lds
    buffer_load_dwordx4 v1, s[4:7], s42 offen offset:1024 sc1 lds
    buffer_load_dwordx4 v1, s[4:7], s42 offen offset:2048 sc1 lds
    s_add_u32 s22, s22, s29
    s_mov_b32 s24, 0
    s_mov_b32 s26, 0
    s_cmp_eq_u32 s28, 1
    s_cbranch_scc1 pv_155
    s_cmp_eq_u32 s28, 2
    s_cbranch_scc1 pv_156
pv_154:
    s_waitcnt vmcnt(9)
    s_barrier
    v_add_u32 v2, s26, v1
    ds_read_b128 v[64:67], v2 offset:0
    ds_read_b128 v[68:71], v2 offset:1024
    ds_read_b128 v[72:75], v2 offset:2048
    ds_read_b128 v[76:79], v2 offset:3072
    ds_read_b128 v[80:83], v2 offset:4096
    s_waitcnt lgkmcnt(4)
    v_mfma_f32_32x32x16_bf16 v[16:31], a[0:3], v[64:67], 0
    ds_read_b128 v[84:87], v2 offset:5120
    v_mfma_f32_32x32x16_bf16 v[32:47], a[4:7], v[64:67], 0
    s_sub_u32 s44, s24, 1
    s_max_i32 s44, s44, 0
    s_cmp_lg_u32 s14, 0
    s_cbranch_scc1 pp_160
    v_mov_b32 v3, s44
    s_mov_b64 exec, 1
    buffer_store_dword v3, off, s[4:7], s25 sc1
    s_mov_b64 exec, -1
pp_160:
    s_waitcnt lgkmcnt(4)
    v_mfma_f32_32x32x16_bf16 v[16:31], a[8:11], v[68:71], v[16:31]
    ds_read_b128 v[64:67], v2 offset:6144
    v_mfma_f32_32x32x16_bf16 v[32:47], a[12:15], v[68:71], v[32:47]
    s_sub_u32 s43, s26, 36864
    s_cmp_eq_u32 s26, 0
    s_cselect_b32 s43, 73728, s43
    s_add_u32 s43, s43, s27
    s_waitcnt lgkmcnt(4)
    v_mfma_f32_32x32x16_bf16 v[16:31], a[16:19], v[72:75], v[16:31]
    ds_read_b128 v[68:71], v2 offset:7168
    v_mfma_f32_32x32x16_bf16 v[32:47], a[20:23], v[72:75], v[32:47]
    s_add_u32 m0, s43, 0
    s_add_u32 s42, s22, 0
    buffer_load_dwordx4 v1, s[4:7], s42 offen offset:0 sc1 lds
    s_waitcnt lgkmcnt(4)
    v_mfma_f32_32x32x16_bf16 v[16:31], a[24:27], v[76:79], v[16:31]
    ds_read_b128 v[72:75], v2 offset:8192
    v_mfma_f32_32x32x16_bf16 v[32:47], a[28:31], v[76:79], v[32:47]
    buffer_load_dwordx4 v1, s[4:7], s42 offen offset:1024 sc1 lds
    s_waitcnt lgkmcnt(4)
    v_mfma_f32_32x32x16_bf16 v[16:31], a[32:35], v[80:83], v[16:31]
    ds_read_b128 v[76:79], v2 offset:9216
    v_mfma_f32_32x32x16_bf16 v[32:47], a[36:39], v[80:83], v[32:47]
    buffer_load_dwordx4 v1, s[4:7], s42 offen offset:2048 sc1 lds
    s_waitcnt lgkmcnt(4)
    v_mfma_f32_32x32x16_bf16 v[16:31], a[40:43], v[84:87], v[16:31]
    ds_read_b128 v[80:83], v2 offset:10240
    v_mfma_f32_32x32x16_bf16 v[32:47], a[44:47], v[84:87], v[32:47]
    s_add_u32 m0, s43, 3072
    s_add_u32 s42, s22, 3072
    buffer_load_dwordx4 v1, s[4:7], s42 offen offset:0 sc1 lds
    s_waitcnt lgkmcnt(4)
    v_mfma_f32_32x32x16_bf16 v[16:31], a[48:51], v[64:67], v[16:31]
    ds_read_b128 v[84:87], v2 offset:11264
    v_mfma_f32_32x32x16_bf16 v[32:47], a[52:55], v[64:67], v[32:47]
    buffer_load_dwordx4 v1, s[4:7], s42 offen offset:1024 sc1 lds
    s_waitcnt lgkmcnt(4)
    v_mfma_f32_32x32x16_bf16 v[16:31], a[56:59], v[68:71], v[16:31]
    ds_read_b128 v[64:67], v2 offset:12288
    v_mfma_f32_32x32x16_bf16 v[32:47], a[60:63], v[68:71], v[32:47]
    buffer_load_dwordx4 v1, s[4:7], s42 offen offset:2048 sc1 lds
    s_waitcnt lgkmcnt(4)
    v_mfma_f32_32x32x16_bf16 v[16:31], a[64:67], v[72:75], v[16:31]
    ds_read_b128 v[68:71], v2 offset:13312
    v_mfma_f32_32x32x16_bf16 v[32:47], a[68:71], v[72:75], v[32:47]
    s_add_u32 m0, s43, 6144
    s_add_u32 s42, s22, 6144
    buffer_load_dwordx4 v1, s[4:7], s42 offen offset:0 sc1 lds
    s_waitcnt lgkmcnt(4)
    v_mfma_f32_32x32x16_bf16 v[16:31], a[72:75], v[76:79], v[16:31]
    ds_read_b128 v[72:75], v2 offset:14336
    v_mfma_f32_32x32x16_bf16 v[32:47], a[76:79], v[76:79], v[32:47]
    buffer_load_dwordx4 v1, s[4:7], s42 offen offset:1024 sc1 lds
    s_waitcnt lgkmcnt(4)
    v_mfma_f32_32x32x16_bf16 v[16:31], a[80:83], v[80:83], v[16:31]
    ds_read_b128 v[76:79], v2 offset:15360
    v_mfma_f32_32x32x16_bf16 v[32:47], a[84:87], v[80:83], v[32:47]
    buffer_load_dwordx4 v1, s[4:7], s42 offen offset:2048 sc1 lds
    s_waitcnt lgkmcnt(4)
    v_mfma_f32_32x32x16_bf16 v[16:31], a[88:91], v[84:87], v[16:31]
    ds_read_b128 v[80:83], v2 offset:16384
    v_mfma_f32_32x32x16_bf16 v[32:47], a[92:95], v[84:87], v[32:47]
    s_add_u32 s22, s22, s29
    s_waitcnt lgkmcnt(4)
    v_mfma_f32_32x32x16_bf16 v[16:31], a[96:99], v[64:67], v[16:31]
    ds_read_b128 v[84:87], v2 offset:17408
    v_mfma_f32_32x32x16_bf16 v[32:47], a[100:103], v[64:67], v[32:47]
    s_add_u32 s26, s26, 36864
    s_cmp_eq_u32 s26, 110592
    s_cselect_b32 s26, 0, s26
    s_add_u32 s24, s24, 1
    s_waitcnt lgkmcnt(4)
    v_mfma_f32_32x32x16_bf16 v[16:31], a[104:107], v[68:71], v[16:31]
    ds_read_b128 v[64:67], v2 offset:18432
    v_mfma_f32_32x32x16_bf16 v[32:47], a[108:111], v[68:71], v[32:47]
    s_waitcnt lgkmcnt(4)
    v_mfma_f32_32x32x16_bf16 v[16:31], a[112:115], v[72:75], v[16:31]
    ds_read_b128 v[68:71], v2 offset:19456
    v_mfma_f32_32x32x16_bf16 v[32:47], a[116:119], v[72:75], v[32:47]
    s_waitcnt lgkmcnt(4)
    v_mfma_f32_32x32x16_bf16 v[16:31], a[120:123], v[76:79], v[16:31]
    ds_read_b128 v[72:75], v2 offset:20480
    v_mfma_f32_32x32x16_bf16 v[32:47], a[124:127], v[76:79], v[32:47]
    s_waitcnt lgkmcnt(4)
    v_mfma_f32_32x32x16_bf16 v[16:31], a[128:131], v[80:83], v[16:31]
    ds_read_b128 v[76:79], v2 offset:21504
    v_mfma_f32_32x32x16_bf16 v[32:47], a[132:135], v[80:83], v[32:47]
    s_waitcnt lgkmcnt(4)
    v_mfma_f32_32x32x16_bf16 v[16:31], a[136:139], v[84:87], v[16:31]
    ds_read_b128 v[80:83], v2 offset:22528
    v_mfma_f32_32x32x16_bf16 v[32:47], a[140:143], v[84:87], v[32:47]
    s_waitcnt lgkmcnt(4)
    v_mfma_f32_32x32x16_bf16 v[16:31], a[144:147], v[64:67], v[16:31]
    ds_read_b128 v[84:87], v2 offset:23552
    v_mfma_f32_32x32x16_bf16 v[32:47], a[148:151], v[64:67], v[32:47]
    s_waitcnt lgkmcnt(4)
    v_mfma_f32_32x32x16_bf16 v[16:31], a[152:155], v[68:71], v[16:31]
    ds_read_b128 v[64:67], v2 offset:24576
    v_mfma_f32_32x32x16_bf16 v[32:47], a[156:159], v[68:71], v[32:47]
    s_waitcnt lgkmcnt(4)
    v_mfma_f32_32x32x16_bf16 v[16:31], a[160:163], v[72:75], v[16:31]
    ds_read_b128 v[68:71], v2 offset:25600
    v_mfma_f32_32x32x16_bf16 v[32:47], a[164:167], v[72:75], v[32:47]
    s_waitcnt lgkmcnt(4)
    v_mfma_f32_32x32x16_bf16 v[16:31], a[168:171], v[76:79], v[16:31]
    ds_read_b128 v[72:75], v2 offset:26624
    v_mfma_f32_32x32x16_bf16 v[32:47], a[172:175], v[76:79], v[32:47]
    s_waitcnt lgkmcnt(4)
    v_mfma_f32_32x32x16_bf16 v[16:31], a[176:179], v[80:83], v[16:31]
    ds_read_b128 v[76:79], v2 offset:27648
    v_mfma_f32_32x32x16_bf16 v[32:47], a[180:183], v[80:83], v[32:47]
    s_waitcnt lgkmcnt(4)
    v_mfma_f32_32x32x16_bf16 v[16:31], a[184:187], v[84:87], v[16:31]
    ds_read_b128 v[80:83], v2 offset:28672
    v_mfma_f32_32x32x16_bf16 v[32:47], a[188:191], v[84:87], v[32:47]
    s_waitcnt lgkmcnt(4)
    v_mfma_f32_32x32x16_bf16 v[16:31], a[192:195], v[64:67], v[16:31]
    ds_read_b128 v[84:87], v2 offset:29696
    v_mfma_f32_32x32x16_bf16 v[32:47], a[196:199], v[64:67], v[32:47]
    s_waitcnt lgkmcnt(4)
    v_mfma_f32_32x32x16_bf16 v[16:31], a[200:203], v[68:71], v[16:31]
    ds_read_b128 v[64:67], v2 offset:30720
    v_mfma_f32_32x32x16_bf16 v[32:47], a[204:207], v[68:71], v[32:47]
    s_waitcnt lgkmcnt(4)
    v_mfma_f32_32x32x16_bf16 v[16:31], a[208:211], v[72:75], v[16:31]
    ds_read_b128 v[68:71], v2 offset:31744
    v_mfma_f32_32x32x16_bf16 v[32:47], a[212:215], v[72:75], v[32:47]
    s_waitcnt lgkmcnt(4)
    v_mfma_f32_32x32x16_bf16 v[16:31], a[216:219], v[76:79], v[16:31]
    ds_read_b128 v[72:75], v2 offset:32768
    v_mfma_f32_32x32x16_bf16 v[32:47], a[220:223], v[76:79], v[32:47]
    s_waitcnt lgkmcnt(4)
    v_mfma_f32_32x32x16_bf16 v[16:31], a[224:227], v[80:83], v[16:31]
    ds_read_b128 v[76:79], v2 offset:33792
    v_mfma_f32_32x32x16_bf16 v[32:47], a[228:231], v[80:83], v[32:47]
    s_waitcnt lgkmcnt(4)
    v_mfma_f32_32x32x16_bf16 v[16:31], a[232:235], v[84:87], v[16:31]
    ds_read_b128 v[80:83], v2 offset:34816
    v_mfma_f32_32x32x16_bf16 v[32:47], a[236:239], v[84:87], v[32:47]
    s_waitcnt lgkmcnt(4)
    v_mfma_f32_32x32x16_bf16 v[16:31], a[240:243], v[64:67], v[16:31]
    ds_read_b128 v[84:87], v2 offset:35840
    v_mfma_f32_32x32x16_bf16 v[32:47], a[244:247], v[64:67], v[32:47]
    s_waitcnt lgkmcnt(4)
    v_mfma_f32_32x32x16_bf16 v[16:31], a[248:251], v[68:71], v[16:31]
    v_mfma_f32_32x32x16_bf16 v[32:47], a[252:255], v[68:71], v[32:47]
    s_waitcnt lgkmcnt(3)
    v_mfma_f32_32x32x16_bf16 v[16:31], v[224:227], v[72:75], v[16:31]
    v_mfma_f32_32x32x16_bf16 v[32:47], v[228:231], v[72:75], v[32:47]
    s_waitcnt lgkmcnt(2)
    v_mfma_f32_32x32x16_bf16 v[16:31], v[232:235], v[76:79], v[16:31]
    s_waitcnt lgkmcnt(1)
    v_mfma_f32_32x32x16_bf16 v[16:31], v[240:243], v[80:83], v[16:31]
    s_waitcnt lgkmcnt(0)
    v_mfma_f32_32x32x16_bf16 v[16:31], v[248:251], v[84:87], v[16:31]
    v_mfma_f32_32x32x16_bf16 v[32:47], v[236:239], v[76:79], v[32:47]
    v_mfma_f32_32x32x16_bf16 v[32:47], v[244:247], v[80:83], v[32:47]
    v_cvt_pk_bf16_f32 v48, v16, v17
    v_cvt_pk_bf16_f32 v49, v18, v19
    v_cvt_pk_bf16_f32 v50, v20, v21
    v_cvt_pk_bf16_f32 v51, v22, v23
    v_mfma_f32_32x32x16_bf16 v[32:47], v[252:255], v[84:87], v[32:47]
    v_cvt_pk_bf16_f32 v52, v24, v25
    v_cvt_pk_bf16_f32 v53, v26, v27
    v_cvt_pk_bf16_f32 v54, v28, v29
    v_cvt_pk_bf16_f32 v55, v30, v31
    s_add_u32 s20, s20, s21
    s_waitcnt vmcnt(9)
    s_barrier
    v_add_u32 v2, s26, v1
    ds_read_b128 v[64:67], v2 offset:0
    ds_read_b128 v[68:71], v2 offset:1024
    ds_read_b128 v[72:75], v2 offset:2048
    ds_read_b128 v[76:79], v2 offset:3072
    ds_read_b128 v[80:83], v2 offset:4096
    v_cvt_pk_bf16_f32 v56, v32, v33
    v_cvt_pk_bf16_f32 v57, v34, v35
    v_cvt_pk_bf16_f32 v58, v36, v37
    v_cvt_pk_bf16_f32 v59, v38, v39
    v_cvt_pk_bf16_f32 v60, v40, v41
    v_cvt_pk_bf16_f32 v61, v42, v43
    v_cvt_pk_bf16_f32 v62, v44, v45
    v_cvt_pk_bf16_f32 v63, v46, v47
    s_nop 1
pt_159:
    s_waitcnt lgkmcnt(4)
    v_mfma_f32_32x32x16_bf16 v[16:31], a[0:3], v[64:67], 0
    ds_read_b128 v[84:87], v2 offset:5120
    v_permlane32_swap_b32 v48, v50
    v_mfma_f32_32x32x16_bf16 v[32:47], a[4:7], v[64:67], 0
    s_sub_u32 s44, s24, 1
    s_max_i32 s44, s44, 0
    s_cmp_lg_u32 s14, 0
    s_cbranch_scc1 pp_161
    v_mov_b32 v3, s44
    s_mov_b64 exec, 1
    buffer_store_dword v3, off, s[4:7], s25 sc1
    s_mov_b64 exec, -1
pp_161:
    v_permlane32_swap_b32 v49, v51
    s_waitcnt lgkmcnt(4)
    v_mfma_f32_32x32x16_bf16 v[16:31], a[8:11], v[68:71], v[16:31]
    ds_read_b128 v[64:67], v2 offset:6144
    v_mfma_f32_32x32x16_bf16 v[32:47], a[12:15], v[68:71], v[32:47]
    s_sub_u32 s43, s26, 36864
    s_cmp_eq_u32 s26, 0
    s_cselect_b32 s43, 73728, s43
    s_add_u32 s43, s43, s27
    s_waitcnt lgkmcnt(4)
    v_mfma_f32_32x32x16_bf16 v[16:31], a[16:19], v[72:75], v[16:31]
    ds_read_b128 v[68:71], v2 offset:7168
    v_mfma_f32_32x32x16_bf16 v[32:47], a[20:23], v[72:75], v[32:47]
    s_add_u32 m0, s43, 0
    s_add_u32 s42, s22, 0
    buffer_load_dwordx4 v1, s[4:7], s42 offen offset:0 sc1 lds
    s_waitcnt lgkmcnt(4)
    v_mfma_f32_32x32x16_bf16 v[16:31], a[24:27], v[76:79], v[16:31]
    ds_read_b128 v[72:75], v2 offset:8192
    v_mfma_f32_32x32x16_bf16 v[32:47], a[28:31], v[76:79], v[32:47]
    buffer_load_dwordx4 v1, s[4:7], s42 offen offset:1024 sc1 lds
    s_waitcnt lgkmcnt(4)
    v_mfma_f32_32x32x16_bf16 v[16:31], a[32:35], v[80:83], v[16:31]
    ds_read_b128 v[76:79], v2 offset:9216
    v_mfma_f32_32x32x16_bf16 v[32:47], a[36:39], v[80:83], v[32:47]
    buffer_load_dwordx4 v1, s[4:7], s42 offen offset:2048 sc1 lds
    s_waitcnt lgkmcnt(4)
    v_mfma_f32_32x32x16_bf16 v[16:31], a[40:43], v[84:87], v[16:31]
    ds_read_b128 v[80:83], v2 offset:10240
    v_mfma_f32_32x32x16_bf16 v[32:47], a[44:47], v[84:87], v[32:47]
    s_add_u32 m0, s43, 3072
    s_add_u32 s42, s22, 3072
    buffer_load_dwordx4 v1, s[4:7], s42 offen offset:0 sc1 lds
    s_waitcnt lgkmcnt(4)
    v_mfma_f32_32x32x16_bf16 v[16:31], a[48:51], v[64:67], v[16:31]
    ds_read_b128 v[84:87], v2 offset:11264
    v_mfma_f32_32x32x16_bf16 v[32:47], a[52:55], v[64:67], v[32:47]
    buffer_load_dwordx4 v1, s[4:7], s42 offen offset:1024 sc1 lds
    s_waitcnt lgkmcnt(4)
    v_mfma_f32_32x32x16_bf16 v[16:31], a[56:59], v[68:71], v[16:31]
    ds_read_b128 v[64:67], v2 offset:12288
    v_mfma_f32_32x32x16_bf16 v[32:47], a[60:63], v[68:71], v[32:47]
    buffer_load_dwordx4 v1, s[4:7], s42 offen offset:2048 sc1 lds
    s_waitcnt lgkmcnt(4)
    v_mfma_f32_32x32x16_bf16 v[16:31], a[64:67], v[72:75], v[16:31]
    ds_read_b128 v[68:71], v2 offset:13312
    v_mfma_f32_32x32x16_bf16 v[32:47], a[68:71], v[72:75], v[32:47]
    s_add_u32 m0, s43, 6144
    s_add_u32 s42, s22, 6144
    buffer_load_dwordx4 v1, s[4:7], s42 offen offset:0 sc1 lds
    s_waitcnt lgkmcnt(4)
    v_mfma_f32_32x32x16_bf16 v[16:31], a[72:75], v[76:79], v[16:31]
    ds_read_b128 v[72:75], v2 offset:14336
    v_mfma_f32_32x32x16_bf16 v[32:47], a[76:79], v[76:79], v[32:47]
    buffer_load_dwordx4 v1, s[4:7], s42 offen offset:1024 sc1 lds
    s_waitcnt lgkmcnt(4)
    v_mfma_f32_32x32x16_bf16 v[16:31], a[80:83], v[80:83], v[16:31]
    ds_read_b128 v[76:79], v2 offset:15360
    v_mfma_f32_32x32x16_bf16 v[32:47], a[84:87], v[80:83], v[32:47]
    buffer_load_dwordx4 v1, s[4:7], s42 offen offset:2048 sc1 lds
    s_waitcnt lgkmcnt(4)
    v_mfma_f32_32x32x16_bf16 v[16:31], a[88:91], v[84:87], v[16:31]
    ds_read_b128 v[80:83], v2 offset:16384
    v_mfma_f32_32x32x16_bf16 v[32:47], a[92:95], v[84:87], v[32:47]
    s_add_u32 s22, s22, s29
    s_waitcnt lgkmcnt(4)
    v_mfma_f32_32x32x16_bf16 v[16:31], a[96:99], v[64:67], v[16:31]
    ds_read_b128 v[84:87], v2 offset:17408
    v_mfma_f32_32x32x16_bf16 v[32:47], a[100:103], v[64:67], v[32:47]
    s_add_u32 s26, s26, 36864
    s_cmp_eq_u32 s26, 110592
    s_cselect_b32 s26, 0, s26
    s_add_u32 s24, s24, 1
    buffer_store_dwordx4 v[48:51], v6, s[4:7], s20 offen offset:0 sc1
    s_waitcnt lgkmcnt(4)
    v_mfma_f32_32x32x16_bf16 v[16:31], a[104:107], v[68:71], v[16:31]
    ds_read_b128 v[64:67], v2 offset:18432
    v_permlane32_swap_b32 v52, v54
    v_mfma_f32_32x32x16_bf16 v[32:47], a[108:111], v[68:71], v[32:47]
    v_permlane32_swap_b32 v53, v55
    s_waitcnt lgkmcnt(4)
    v_mfma_f32_32x32x16_bf16 v[16:31], a[112:115], v[72:75], v[16:31]
    ds_read_b128 v[68:71], v2 offset:19456
    buffer_store_dwordx4 v[52:55], v6, s[4:7], s20 offen offset:1024 sc1
    v_mfma_f32_32x32x16_bf16 v[32:47], a[116:119], v[72:75], v[32:47]
    v_permlane32_swap_b32 v56, v58
    s_waitcnt lgkmcnt(4)
    v_mfma_f32_32x32x16_bf16 v[16:31], a[120:123], v[76:79], v[16:31]
    ds_read_b128 v[72:75], v2 offset:20480
    v_permlane32_swap_b32 v57, v59
    v_mfma_f32_32x32x16_bf16 v[32:47], a[124:127], v[76:79], v[32:47]
    buffer_store_dwordx4 v[56:59], v6, s[4:7], s20 offen offset:2048 sc1
    s_waitcnt lgkmcnt(4)
    v_mfma_f32_32x32x16_bf16 v[16:31], a[128:131], v[80:83], v[16:31]
    ds_read_b128 v[76:79], v2 offset:21504
    v_permlane32_swap_b32 v60, v62
    v_mfma_f32_32x32x16_bf16 v[32:47], a[132:135], v[80:83], v[32:47]
    v_permlane32_swap_b32 v61, v63
    s_waitcnt lgkmcnt(4)
    v_mfma_f32_32x32x16_bf16 v[16:31], a[136:139], v[84:87], v[16:31]
    ds_read_b128 v[80:83], v2 offset:22528
    buffer_store_dwordx4 v[60:63], v6, s[4:7], s20 offen offset:3072 sc1
    v_mfma_f32_32x32x16_bf16 v[32:47], a[140:143], v[84:87], v[32:47]
    s_waitcnt lgkmcnt(4)
    v_mfma_f32_32x32x16_bf16 v[16:31], a[144:147], v[64:67], v[16:31]
    ds_read_b128 v[84:87], v2 offset:23552
    v_mfma_f32_32x32x16_bf16 v[32:47], a[148:151], v[64:67], v[32:47]
    s_waitcnt lgkmcnt(4)
    v_mfma_f32_32x32x16_bf16 v[16:31], a[152:155], v[68:71], v[16:31]
    ds_read_b128 v[64:67], v2 offset:24576
    v_mfma_f32_32x32x16_bf16 v[32:47], a[156:159], v[68:71], v[32:47]
    s_waitcnt lgkmcnt(4)
    v_mfma_f32_32x32x16_bf16 v[16:31], a[160:163], v[72:75], v[16:31]
    ds_read_b128 v[68:71], v2 offset:25600
    v_mfma_f32_32x32x16_bf16 v[32:47], a[164:167], v[72:75], v[32:47]
    s_waitcnt lgkmcnt(4)
    v_mfma_f32_32x32x16_bf16 v[16:31], a[168:171], v[76:79], v[16:31]
    ds_read_b128 v[72:75], v2 offset:26624
    v_mfma_f32_32x32x16_bf16 v[32:47], a[172:175], v[76:79], v[32:47]
    s_waitcnt lgkmcnt(4)
    v_mfma_f32_32x32x16_bf16 v[16:31], a[176:179], v[80:83], v[16:31]
    ds_read_b128 v[76:79], v2 offset:27648
    v_mfma_f32_32x32x16_bf16 v[32:47], a[180:183], v[80:83], v[32:47]
    s_waitcnt lgkmcnt(4)
    v_mfma_f32_32x32x16_bf16 v[16:31], a[184:187], v[84:87], v[16:31]
    ds_read_b128 v[80:83], v2 offset:28672
    v_mfma_f32_32x32x16_bf16 v[32:47], a[188:191], v[84:87], v[32:47]
    s_waitcnt lgkmcnt(4)
    v_mfma_f32_32x32x16_bf16 v[16:31], a[192:195], v[64:67], v[16:31]
    ds_read_b128 v[84:87], v2 offset:29696
    v_mfma_f32_32x32x16_bf16 v[32:47], a[196:199], v[64:67], v[32:47]
    s_waitcnt lgkmcnt(4)
    v_mfma_f32_32x32x16_bf16 v[16:31], a[200:203], v[68:71], v[16:31]
    ds_read_b128 v[64:67], v2 offset:30720
    v_mfma_f32_32x32x16_bf16 v[32:47], a[204:207], v[68:71], v[32:47]
    s_waitcnt lgkmcnt(4)
    v_mfma_f32_32x32x16_bf16 v[16:31], a[208:211], v[72:75], v[16:31]
    ds_read_b128 v[68:71], v2 offset:31744
    v_mfma_f32_32x32x16_bf16 v[32:47], a[212:215], v[72:75], v[32:47]
    s_waitcnt lgkmcnt(4)
    v_mfma_f32_32x32x16_bf16 v[16:31], a[216:219], v[76:79], v[16:31]
    ds_read_b128 v[72:75], v2 offset:32768
    v_mfma_f32_32x32x16_bf16 v[32:47], a[220:223], v[76:79], v[32:47]
    s_waitcnt lgkmcnt(4)
    v_mfma_f32_32x32x16_bf16 v[16:31], a[224:227], v[80:83], v[16:31]
    ds_read_b128 v[76:79], v2 offset:33792
    v_mfma_f32_32x32x16_bf16 v[32:47], a[228:231], v[80:83], v[32:47]
    s_waitcnt lgkmcnt(4)
    v_mfma_f32_32x32x16_bf16 v[16:31], a[232:235], v[84:87], v[16:31]
    ds_read_b128 v[80:83], v2 offset:34816
    v_mfma_f32_32x32x16_bf16 v[32:47], a[236:239], v[84:87], v[32:47]
    s_waitcnt lgkmcnt(4)
    v_mfma_f32_32x32x16_bf16 v[16:31], a[240:243], v[64:67], v[16:31]
    ds_read_b128 v[84:87], v2 offset:35840
    v_mfma_f32_32x32x16_bf16 v[32:47], a[244:247], v[64:67], v[32:47]
    s_waitcnt lgkmcnt(4)
    v_mfma_f32_32x32x16_bf16 v[16:31], a[248:251], v[68:71], v[16:31]
    v_mfma_f32_32x32x16_bf16 v[32:47], a[252:255], v[68:71], v[32:47]
    s_waitcnt lgkmcnt(3)
    v_mfma_f32_32x32x16_bf16 v[16:31], v[224:227], v[72:75], v[16:31]
    v_mfma_f32_32x32x16_bf16 v[32:47], v[228:231], v[72:75], v[32:47]
    s_waitcnt lgkmcnt(2)
    v_mfma_f32_32x32x16_bf16 v[16:31], v[232:235], v[76:79], v[16:31]
    s_waitcnt lgkmcnt(1)
    v_mfma_f32_32x32x16_bf16 v[16:31], v[240:243], v[80:83], v[16:31]
    s_waitcnt lgkmcnt(0)
    v_mfma_f32_32x32x16_bf16 v[16:31], v[248:251], v[84:87], v[16:31]
    v_mfma_f32_32x32x16_bf16 v[32:47], v[236:239], v[76:79], v[32:47]
    v_mfma_f32_32x32x16_bf16 v[32:47], v[244:247], v[80:83], v[32:47]
    v_cvt_pk_bf16_f32 v48, v16, v17
    v_cvt_pk_bf16_f32 v49, v18, v19
    v_cvt_pk_bf16_f32 v50, v20, v21
    v_cvt_pk_bf16_f32 v51, v22, v23
    v_mfma_f32_32x32x16_bf16 v[32:47], v[252:255], v[84:87], v[32:47]
    v_cvt_pk_bf16_f32 v52, v24, v25
    v_cvt_pk_bf16_f32 v53, v26, v27
    v_cvt_pk_bf16_f32 v54, v28, v29
    v_cvt_pk_bf16_f32 v55, v30, v31
    s_add_u32 s20, s20, s21
    s_waitcnt vmcnt(0)
    s_barrier
    v_add_u32 v2, s26, v1
    ds_read_b128 v[64:67], v2 offset:0
    ds_read_b128 v[68:71], v2 offset:1024
    ds_read_b128 v[72:75], v2 offset:2048
    ds_read_b128 v[76:79], v2 offset:3072
    ds_read_b128 v[80:83], v2 offset:4096
    v_cvt_pk_bf16_f32 v56, v32, v33
    v_cvt_pk_bf16_f32 v57, v34, v35
    v_cvt_pk_bf16_f32 v58, v36, v37
    v_cvt_pk_bf16_f32 v59, v38, v39
    v_cvt_pk_bf16_f32 v60, v40, v41
    v_cvt_pk_bf16_f32 v61, v42, v43
    v_cvt_pk_bf16_f32 v62, v44, v45
    v_cvt_pk_bf16_f32 v63, v46, v47
    s_cmp_lt_u32 s24, s23
    s_nop 0
    s_cbranch_scc1 pt_159
    v_permlane32_swap_b32 v48, v50
    v_permlane32_swap_b32 v49, v51
    buffer_store_dwordx4 v[48:51], v6, s[4:7], s20 offen offset:0 sc1
    v_permlane32_swap_b32 v52, v54
    v_permlane32_swap_b32 v53, v55
    buffer_store_dwordx4 v[52:55], v6, s[4:7], s20 offen offset:1024 sc1
    v_permlane32_swap_b32 v56, v58
    v_permlane32_swap_b32 v57, v59
    buffer_store_dwordx4 v[56:59], v6, s[4:7], s20 offen offset:2048 sc1
    v_permlane32_swap_b32 v60, v62
    v_permlane32_swap_b32 v61, v63
    buffer_store_dwordx4 v[60:63], v6, s[4:7], s20 offen offset:3072 sc1
    s_branch pe_157
pv_155:
    s_waitcnt vmcnt(9)
    s_barrier
    v_add_u32 v2, s26, v1
    ds_read_b128 v[64:67], v2 offset:0
    ds_read_b128 v[68:71], v2 offset:1024
    ds_read_b128 v[72:75], v2 offset:2048
    ds_read_b128 v[76:79], v2 offset:3072
    ds_read_b128 v[80:83], v2 offset:4096
    s_waitcnt lgkmcnt(4)
    v_mfma_f32_32x32x16_bf16 v[16:31], v[64:67], a[0:3], 0
    ds_read_b128 v[84:87], v2 offset:5120
    v_mfma_f32_32x32x16_bf16 v[32:47], v[64:67], a[4:7], 0
    s_sub_u32 s44, s24, 1
    s_max_i32 s44, s44, 0
    s_cmp_lg_u32 s14, 0
    s_cbranch_scc1 pp_164
    v_mov_b32 v3, s44
    s_mov_b64 exec, 1
    buffer_store_dword v3, off, s[4:7], s25 sc1
    s_mov_b64 exec, -1
pp_164:
    s_waitcnt lgkmcnt(4)
    v_mfma_f32_32x32x16_bf16 v[16:31], v[68:71], a[8:11], v[16:31]
    ds_read_b128 v[64:67], v2 offset:6144
    v_mfma_f32_32x32x16_bf16 v[32:47], v[68:71], a[12:15], v[32:47]
    s_sub_u32 s43, s26, 36864
    s_cmp_eq_u32 s26, 0
    s_cselect_b32 s43, 73728, s43
    s_add_u32 s43, s43, s27
    s_waitcnt lgkmcnt(4)
    v_mfma_f32_32x32x16_bf16 v[16:31], v[72:75], a[16:19], v[16:31]
    ds_read_b128 v[68:71], v2 offset:7168
    v_mfma_f32_32x32x16_bf16 v[32:47], v[72:75], a[20:23], v[32:47]
    s_add_u32 m0, s43, 0
    s_add_u32 s42, s22, 0
    buffer_load_dwordx4 v1, s[4:7], s42 offen offset:0 sc1 lds
    s_waitcnt lgkmcnt(4)
    v_mfma_f32_32x32x16_bf16 v[16:31], v[76:79], a[24:27], v[16:31]
    ds_read_b128 v[72:75], v2 offset:8192
    v_mfma_f32_32x32x16_bf16 v[32:47], v[76:79], a[28:31], v[32:47]
    buffer_load_dwordx4 v1, s[4:7], s42 offen offset:1024 sc1 lds
    s_waitcnt lgkmcnt(4)
    v_mfma_f32_32x32x16_bf16 v[16:31], v[80:83], a[32:35], v[16:31]
    ds_read_b128 v[76:79], v2 offset:9216
    v_mfma_f32_32x32x16_bf16 v[32:47], v[80:83], a[36:39], v[32:47]
    buffer_load_dwordx4 v1, s[4:7], s42 offen offset:2048 sc1 lds
    s_waitcnt lgkmcnt(4)
    v_mfma_f32_32x32x16_bf16 v[16:31], v[84:87], a[40:43], v[16:31]
    ds_read_b128 v[80:83], v2 offset:10240
    v_mfma_f32_32x32x16_bf16 v[32:47], v[84:87], a[44:47], v[32:47]
    s_add_u32 m0, s43, 3072
    s_add_u32 s42, s22, 3072
    buffer_load_dwordx4 v1, s[4:7], s42 offen offset:0 sc1 lds
    s_waitcnt lgkmcnt(4)
    v_mfma_f32_32x32x16_bf16 v[16:31], v[64:67], a[48:51], v[16:31]
    ds_read_b128 v[84:87], v2 offset:11264
    v_mfma_f32_32x32x16_bf16 v[32:47], v[64:67], a[52:55], v[32:47]
    buffer_load_dwordx4 v1, s[4:7], s42 offen offset:1024 sc1 lds
    s_waitcnt lgkmcnt(4)
    v_mfma_f32_32x32x16_bf16 v[16:31], v[68:71], a[56:59], v[16:31]
    ds_read_b128 v[64:67], v2 offset:12288
    v_mfma_f32_32x32x16_bf16 v[32:47], v[68:71], a[60:63], v[32:47]
    buffer_load_dwordx4 v1, s[4:7], s42 offen offset:2048 sc1 lds
    s_waitcnt lgkmcnt(4)
    v_mfma_f32_32x32x16_bf16 v[16:31], v[72:75], a[64:67], v[16:31]
    ds_read_b128 v[68:71], v2 offset:13312
    v_mfma_f32_32x32x16_bf16 v[32:47], v[72:75], a[68:71], v[32:47]
    s_add_u32 m0, s43, 6144
    s_add_u32 s42, s22, 6144
    buffer_load_dwordx4 v1, s[4:7], s42 offen offset:0 sc1 lds
    s_waitcnt lgkmcnt(4)
    v_mfma_f32_32x32x16_bf16 v[16:31], v[76:79], a[72:75], v[16:31]
    ds_read_b128 v[72:75], v2 offset:14336
    v_mfma_f32_32x32x16_bf16 v[32:47], v[76:79], a[76:79], v[32:47]
    buffer_load_dwordx4 v1, s[4:7], s42 offen offset:1024 sc1 lds
    s_waitcnt lgkmcnt(4)
    v_mfma_f32_32x32x16_bf16 v[16:31], v[80:83], a[80:83], v[16:31]
    ds_read_b128 v[76:79], v2 offset:15360
    v_mfma_f32_32x32x16_bf16 v[32:47], v[80:83], a[84:87], v[32:47]
    buffer_load_dwordx4 v1, s[4:7], s42 offen offset:2048 sc1 lds
    s_waitcnt lgkmcnt(4)
    v_mfma_f32_32x32x16_bf16 v[16:31], v[84:87], a[88:91], v[16:31]
    ds_read_b128 v[80:83], v2 offset:16384
    v_mfma_f32_32x32x16_bf16 v[32:47], v[84:87], a[92:95], v[32:47]
    s_add_u32 s22, s22, s29
    s_waitcnt lgkmcnt(4)
    v_mfma_f32_32x32x16_bf16 v[16:31], v[64:67], a[96:99], v[16:31]
    ds_read_b128 v[84:87], v2 offset:17408
    v_mfma_f32_32x32x16_bf16 v[32:47], v[64:67], a[100:103], v[32:47]
    s_add_u32 s26, s26, 36864
    s_cmp_eq_u32 s26, 110592
    s_cselect_b32 s26, 0, s26
    s_add_u32 s24, s24, 1
    s_waitcnt lgkmcnt(4)
    v_mfma_f32_32x32x16_bf16 v[16:31], v[68:71], a[104:107], v[16:31]
    ds_read_b128 v[64:67], v2 offset:18432
    v_mfma_f32_32x32x16_bf16 v[32:47], v[68:71], a[108:111], v[32:47]
    s_waitcnt lgkmcnt(4)
    v_mfma_f32_32x32x16_bf16 v[16:31], v[72:75], a[112:115], v[16:31]
    ds_read_b128 v[68:71], v2 offset:19456
    v_mfma_f32_32x32x16_bf16 v[32:47], v[72:75], a[116:119], v[32:47]
    s_waitcnt lgkmcnt(4)
    v_mfma_f32_32x32x16_bf16 v[16:31], v[76:79], a[120:123], v[16:31]
    ds_read_b128 v[72:75], v2 offset:20480
    v_mfma_f32_32x32x16_bf16 v[32:47], v[76:79], a[124:127], v[32:47]
    s_waitcnt lgkmcnt(4)
    v_mfma_f32_32x32x16_bf16 v[16:31], v[80:83], a[128:131], v[16:31]
    ds_read_b128 v[76:79], v2 offset:21504
    v_mfma_f32_32x32x16_bf16 v[32:47], v[80:83], a[132:135], v[32:47]
    s_waitcnt lgkmcnt(4)
    v_mfma_f32_32x32x16_bf16 v[16:31], v[84:87], a[136:139], v[16:31]
    ds_read_b128 v[80:83], v2 offset:22528
    v_mfma_f32_32x32x16_bf16 v[32:47], v[84:87], a[140:143], v[32:47]
    s_waitcnt lgkmcnt(4)
    v_mfma_f32_32x32x16_bf16 v[16:31], v[64:67], a[144:147], v[16:31]
    ds_read_b128 v[84:87], v2 offset:23552
    v_mfma_f32_32x32x16_bf16 v[32:47], v[64:67], a[148:151], v[32:47]
    s_waitcnt lgkmcnt(4)
    v_mfma_f32_32x32x16_bf16 v[16:31], v[68:71], a[152:155], v[16:31]
    ds_read_b128 v[64:67], v2 offset:24576
    v_mfma_f32_32x32x16_bf16 v[32:47], v[68:71], a[156:159], v[32:47]
    s_waitcnt lgkmcnt(4)
    v_mfma_f32_32x32x16_bf16 v[16:31], v[72:75], a[160:163], v[16:31]
    ds_read_b128 v[68:71], v2 offset:25600
    v_mfma_f32_32x32x16_bf16 v[32:47], v[72:75], a[164:167], v[32:47]
    s_waitcnt lgkmcnt(4)
    v_mfma_f32_32x32x16_bf16 v[16:31], v[76:79], a[168:171], v[16:31]
    ds_read_b128 v[72:75], v2 offset:26624
    v_mfma_f32_32x32x16_bf16 v[32:47], v[76:79], a[172:175], v[32:47]
    s_waitcnt lgkmcnt(4)
    v_mfma_f32_32x32x16_bf16 v[16:31], v[80:83], a[176:179], v[16:31]
    ds_read_b128 v[76:79], v2 offset:27648
    v_mfma_f32_32x32x16_bf16 v[32:47], v[80:83], a[180:183], v[32:47]
    s_waitcnt lgkmcnt(4)
    v_mfma_f32_32x32x16_bf16 v[16:31], v[84:87], a[184:187], v[16:31]
    ds_read_b128 v[80:83], v2 offset:28672
    v_mfma_f32_32x32x16_bf16 v[32:47], v[84:87], a[188:191], v[32:47]
    s_waitcnt lgkmcnt(4)
    v_mfma_f32_32x32x16_bf16 v[16:31], v[64:67], a[192:195], v[16:31]
    ds_read_b128 v[84:87], v2 offset:29696
    v_mfma_f32_32x32x16_bf16 v[32:47], v[64:67], a[196:199], v[32:47]
    s_waitcnt lgkmcnt(4)
    v_mfma_f32_32x32x16_bf16 v[16:31], v[68:71], a[200:203], v[16:31]
    ds_read_b128 v[64:67], v2 offset:30720
    v_mfma_f32_32x32x16_bf16 v[32:47], v[68:71], a[204:207], v[32:47]
    s_waitcnt lgkmcnt(4)
    v_mfma_f32_32x32x16_bf16 v[16:31], v[72:75], a[208:211], v[16:31]
    ds_read_b128 v[68:71], v2 offset:31744
    v_mfma_f32_32x32x16_bf16 v[32:47], v[72:75], a[212:215], v[32:47]
    s_waitcnt lgkmcnt(4)
    v_mfma_f32_32x32x16_bf16 v[16:31], v[76:79], a[216:219], v[16:31]
    ds_read_b128 v[72:75], v2 offset:32768
    v_mfma_f32_32x32x16_bf16 v[32:47], v[76:79], a[220:223], v[32:47]
    s_waitcnt lgkmcnt(4)
    v_mfma_f32_32x32x16_bf16 v[16:31], v[80:83], a[224:227], v[16:31]
    ds_read_b128 v[76:79], v2 offset:33792
    v_mfma_f32_32x32x16_bf16 v[32:47], v[80:83], a[228:231], v[32:47]
    s_waitcnt lgkmcnt(4)
    v_mfma_f32_32x32x16_bf16 v[16:31], v[84:87], a[232:235], v[16:31]
    ds_read_b128 v[80:83], v2 offset:34816
    v_mfma_f32_32x32x16_bf16 v[32:47], v[84:87], a[236:239], v[32:47]
    s_waitcnt lgkmcnt(4)
    v_mfma_f32_32x32x16_bf16 v[16:31], v[64:67], a[240:243], v[16:31]
    ds_read_b128 v[84:87], v2 offset:35840
    v_mfma_f32_32x32x16_bf16 v[32:47], v[64:67], a[244:247], v[32:47]
    s_waitcnt lgkmcnt(4)
    v_mfma_f32_32x32x16_bf16 v[16:31], v[68:71], a[248:251], v[16:31]
    v_mfma_f32_32x32x16_bf16 v[32:47], v[68:71], a[252:255], v[32:47]
    s_waitcnt lgkmcnt(3)
    v_mfma_f32_32x32x16_bf16 v[16:31], v[72:75], v[224:227], v[16:31]
    v_mfma_f32_32x32x16_bf16 v[32:47], v[72:75], v[228:231], v[32:47]
    s_waitcnt lgkmcnt(2)
    v_mfma_f32_32x32x16_bf16 v[16:31], v[76:79], v[232:235], v[16:31]
    s_waitcnt lgkmcnt(1)
    v_mfma_f32_32x32x16_bf16 v[16:31], v[80:83], v[240:243], v[16:31]
    s_waitcnt lgkmcnt(0)
    v_mfma_f32_32x32x16_bf16 v[16:31], v[84:87], v[248:251], v[16:31]
    v_mfma_f32_32x32x16_bf16 v[32:47], v[76:79], v[236:239], v[32:47]
    v_mfma_f32_32x32x16_bf16 v[32:47], v[80:83], v[244:247], v[32:47]
    v_cvt_pk_bf16_f32 v48, v16, v17
    v_cvt_pk_bf16_f32 v49, v18, v19
    v_cvt_pk_bf16_f32 v50, v20, v21
    v_cvt_pk_bf16_f32 v51, v22, v23
    v_mfma_f32_32x32x16_bf16 v[32:47], v[84:87], v[252:255], v[32:47]
    v_cvt_pk_bf16_f32 v52, v24, v25
    v_cvt_pk_bf16_f32 v53, v26, v27
    v_cvt_pk_bf16_f32 v54, v28, v29
    v_cvt_pk_bf16_f32 v55, v30, v31
    s_add_u32 s20, s20, s21
    s_waitcnt vmcnt(9)
    s_barrier
    v_add_u32 v2, s26, v1
    ds_read_b128 v[64:67], v2 offset:0
    ds_read_b128 v[68:71], v2 offset:1024
    ds_read_b128 v[72:75], v2 offset:2048
    ds_read_b128 v[76:79], v2 offset:3072
    ds_read_b128 v[80:83], v2 offset:4096
    v_cvt_pk_bf16_f32 v56, v32, v33
    v_cvt_pk_bf16_f32 v57, v34, v35
    v_cvt_pk_bf16_f32 v58, v36, v37
    v_cvt_pk_bf16_f32 v59, v38, v39
    v_cvt_pk_bf16_f32 v60, v40, v41
    v_cvt_pk_bf16_f32 v61, v42, v43
    v_cvt_pk_bf16_f32 v62, v44, v45
    v_cvt_pk_bf16_f32 v63, v46, v47
    s_nop 1
pt_163:
    s_waitcnt lgkmcnt(4)
    v_mfma_f32_32x32x16_bf16 v[16:31], v[64:67], a[0:3], 0
    ds_read_b128 v[84:87], v2 offset:5120
    v_permlane32_swap_b32 v48, v50
    v_mfma_f32_32x32x16_bf16 v[32:47], v[64:67], a[4:7], 0
    s_sub_u32 s44, s24, 1
    s_max_i32 s44, s44, 0
    s_cmp_lg_u32 s14, 0
    s_cbranch_scc1 pp_165
    v_mov_b32 v3, s44
    s_mov_b64 exec, 1
    buffer_store_dword v3, off, s[4:7], s25 sc1
    s_mov_b64 exec, -1
pp_165:
    v_permlane32_swap_b32 v49, v51
    s_waitcnt lgkmcnt(4)
    v_mfma_f32_32x32x16_bf16 v[16:31], v[68:71], a[8:11], v[16:31]
    ds_read_b128 v[64:67], v2 offset:6144
    v_mfma_f32_32x32x16_bf16 v[32:47], v[68:71], a[12:15], v[32:47]
    s_sub_u32 s43, s26, 36864
    s_cmp_eq_u32 s26, 0
    s_cselect_b32 s43, 73728, s43
    s_add_u32 s43, s43, s27
    s_waitcnt lgkmcnt(4)
    v_mfma_f32_32x32x16_bf16 v[16:31], v[72:75], a[16:19], v[16:31]
    ds_read_b128 v[68:71], v2 offset:7168
    v_mfma_f32_32x32x16_bf16 v[32:47], v[72:75], a[20:23], v[32:47]
    s_add_u32 m0, s43, 0
    s_add_u32 s42, s22, 0
    buffer_load_dwordx4 v1, s[4:7], s42 offen offset:0 sc1 lds
    s_waitcnt lgkmcnt(4)
    v_mfma_f32_32x32x16_bf16 v[16:31], v[76:79], a[24:27], v[16:31]
    ds_read_b128 v[72:75], v2 offset:8192
    v_mfma_f32_32x32x16_bf16 v[32:47], v[76:79], a[28:31], v[32:47]
    buffer_load_dwordx4 v1, s[4:7], s42 offen offset:1024 sc1 lds
    s_waitcnt lgkmcnt(4)
    v_mfma_f32_32x32x16_bf16 v[16:31], v[80:83], a[32:35], v[16:31]
    ds_read_b128 v[76:79], v2 offset:9216
    v_mfma_f32_32x32x16_bf16 v[32:47], v[80:83], a[36:39], v[32:47]
    buffer_load_dwordx4 v1, s[4:7], s42 offen offset:2048 sc1 lds
    s_waitcnt lgkmcnt(4)
    v_mfma_f32_32x32x16_bf16 v[16:31], v[84:87], a[40:43], v[16:31]
    ds_read_b128 v[80:83], v2 offset:10240
    v_mfma_f32_32x32x16_bf16 v[32:47], v[84:87], a[44:47], v[32:47]
    s_add_u32 m0, s43, 3072
    s_add_u32 s42, s22, 3072
    buffer_load_dwordx4 v1, s[4:7], s42 offen offset:0 sc1 lds
    s_waitcnt lgkmcnt(4)
    v_mfma_f32_32x32x16_bf16 v[16:31], v[64:67], a[48:51], v[16:31]
    ds_read_b128 v[84:87], v2 offset:11264
    v_mfma_f32_32x32x16_bf16 v[32:47], v[64:67], a[52:55], v[32:47]
    buffer_load_dwordx4 v1, s[4:7], s42 offen offset:1024 sc1 lds
    s_waitcnt lgkmcnt(4)
    v_mfma_f32_32x32x16_bf16 v[16:31], v[68:71], a[56:59], v[16:31]
    ds_read_b128 v[64:67], v2 offset:12288
    v_mfma_f32_32x32x16_bf16 v[32:47], v[68:71], a[60:63], v[32:47]
    buffer_load_dwordx4 v1, s[4:7], s42 offen offset:2048 sc1 lds
    s_waitcnt lgkmcnt(4)
    v_mfma_f32_32x32x16_bf16 v[16:31], v[72:75], a[64:67], v[16:31]
    ds_read_b128 v[68:71], v2 offset:13312
    v_mfma_f32_32x32x16_bf16 v[32:47], v[72:75], a[68:71], v[32:47]
    s_add_u32 m0, s43, 6144
    s_add_u32 s42, s22, 6144
    buffer_load_dwordx4 v1, s[4:7], s42 offen offset:0 sc1 lds
    s_waitcnt lgkmcnt(4)
    v_mfma_f32_32x32x16_bf16 v[16:31], v[76:79], a[72:75], v[16:31]
    ds_read_b128 v[72:75], v2 offset:14336
    v_mfma_f32_32x32x16_bf16 v[32:47], v[76:79], a[76:79], v[32:47]
    buffer_load_dwordx4 v1, s[4:7], s42 offen offset:1024 sc1 lds
    s_waitcnt lgkmcnt(4)
    v_mfma_f32_32x32x16_bf16 v[16:31], v[80:83], a[80:83], v[16:31]
    ds_read_b128 v[76:79], v2 offset:15360
    v_mfma_f32_32x32x16_bf16 v[32:47], v[80:83], a[84:87], v[32:47]
    buffer_load_dwordx4 v1, s[4:7], s42 offen offset:2048 sc1 lds
    s_waitcnt lgkmcnt(4)
    v_mfma_f32_32x32x16_bf16 v[16:31], v[84:87], a[88:91], v[16:31]
    ds_read_b128 v[80:83], v2 offset:16384
    v_mfma_f32_32x32x16_bf16 v[32:47], v[84:87], a[92:95], v[32:47]
    s_add_u32 s22, s22, s29
    s_waitcnt lgkmcnt(4)
    v_mfma_f32_32x32x16_bf16 v[16:31], v[64:67], a[96:99], v[16:31]
    ds_read_b128 v[84:87], v2 offset:17408
    v_mfma_f32_32x32x16_bf16 v[32:47], v[64:67], a[100:103], v[32:47]
    s_add_u32 s26, s26, 36864
    s_cmp_eq_u32 s26, 110592
    s_cselect_b32 s26, 0, s26
    s_add_u32 s24, s24, 1
    buffer_store_dwordx4 v[48:51], v6, s[4:7], s20 offen offset:0 sc1
    s_waitcnt lgkmcnt(4)
    v_mfma_f32_32x32x16_bf16 v[16:31], v[68:71], a[104:107], v[16:31]
    ds_read_b128 v[64:67], v2 offset:18432
    v_permlane32_swap_b32 v52, v54
    v_mfma_f32_32x32x16_bf16 v[32:47], v[68:71], a[108:111], v[32:47]
    v_permlane32_swap_b32 v53, v55
    s_waitcnt lgkmcnt(4)
    v_mfma_f32_32x32x16_bf16 v[16:31], v[72:75], a[112:115], v[16:31]
    ds_read_b128 v[68:71], v2 offset:19456
    buffer_store_dwordx4 v[52:55], v6, s[4:7], s20 offen offset:1024 sc1
    v_mfma_f32_32x32x16_bf16 v[32:47], v[72:75], a[116:119], v[32:47]
    v_permlane32_swap_b32 v56, v58
    s_waitcnt lgkmcnt(4)
    v_mfma_f32_32x32x16_bf16 v[16:31], v[76:79], a[120:123], v[16:31]
    ds_read_b128 v[72:75], v2 offset:20480
    v_permlane32_swap_b32 v57, v59
    v_mfma_f32_32x32x16_bf16 v[32:47], v[76:79], a[124:127], v[32:47]
    buffer_store_dwordx4 v[56:59], v6, s[4:7], s20 offen offset:2048 sc1
    s_waitcnt lgkmcnt(4)
    v_mfma_f32_32x32x16_bf16 v[16:31], v[80:83], a[128:131], v[16:31]
    ds_read_b128 v[76:79], v2 offset:21504
    v_permlane32_swap_b32 v60, v62
    v_mfma_f32_32x32x16_bf16 v[32:47], v[80:83], a[132:135], v[32:47]
    v_permlane32_swap_b32 v61, v63
    s_waitcnt lgkmcnt(4)
    v_mfma_f32_32x32x16_bf16 v[16:31], v[84:87], a[136:139], v[16:31]
    ds_read_b128 v[80:83], v2 offset:22528
    buffer_store_dwordx4 v[60:63], v6, s[4:7], s20 offen offset:3072 sc1
    v_mfma_f32_32x32x16_bf16 v[32:47], v[84:87], a[140:143], v[32:47]
    s_waitcnt lgkmcnt(4)
    v_mfma_f32_32x32x16_bf16 v[16:31], v[64:67], a[144:147], v[16:31]
    ds_read_b128 v[84:87], v2 offset:23552
    v_mfma_f32_32x32x16_bf16 v[32:47], v[64:67], a[148:151], v[32:47]
    s_waitcnt lgkmcnt(4)
    v_mfma_f32_32x32x16_bf16 v[16:31], v[68:71], a[152:155], v[16:31]
    ds_read_b128 v[64:67], v2 offset:24576
    v_mfma_f32_32x32x16_bf16 v[32:47], v[68:71], a[156:159], v[32:47]
    s_waitcnt lgkmcnt(4)
    v_mfma_f32_32x32x16_bf16 v[16:31], v[72:75], a[160:163], v[16:31]
    ds_read_b128 v[68:71], v2 offset:25600
    v_mfma_f32_32x32x16_bf16 v[32:47], v[72:75], a[164:167], v[32:47]
    s_waitcnt lgkmcnt(4)
    v_mfma_f32_32x32x16_bf16 v[16:31], v[76:79], a[168:171], v[16:31]
    ds_read_b128 v[72:75], v2 offset:26624
    v_mfma_f32_32x32x16_bf16 v[32:47], v[76:79], a[172:175], v[32:47]
    s_waitcnt lgkmcnt(4)
    v_mfma_f32_32x32x16_bf16 v[16:31], v[80:83], a[176:179], v[16:31]
    ds_read_b128 v[76:79], v2 offset:27648
    v_mfma_f32_32x32x16_bf16 v[32:47], v[80:83], a[180:183], v[32:47]
    s_waitcnt lgkmcnt(4)
    v_mfma_f32_32x32x16_bf16 v[16:31], v[84:87], a[184:187], v[16:31]
    ds_read_b128 v[80:83], v2 offset:28672
    v_mfma_f32_32x32x16_bf16 v[32:47], v[84:87], a[188:191], v[32:47]
    s_waitcnt lgkmcnt(4)
    v_mfma_f32_32x32x16_bf16 v[16:31], v[64:67], a[192:195], v[16:31]
    ds_read_b128 v[84:87], v2 offset:29696
    v_mfma_f32_32x32x16_bf16 v[32:47], v[64:67], a[196:199], v[32:47]
    s_waitcnt lgkmcnt(4)
    v_mfma_f32_32x32x16_bf16 v[16:31], v[68:71], a[200:203], v[16:31]
    ds_read_b128 v[64:67], v2 offset:30720
    v_mfma_f32_32x32x16_bf16 v[32:47], v[68:71], a[204:207], v[32:47]
    s_waitcnt lgkmcnt(4)
    v_mfma_f32_32x32x16_bf16 v[16:31], v[72:75], a[208:211], v[16:31]
    ds_read_b128 v[68:71], v2 offset:31744
    v_mfma_f32_32x32x16_bf16 v[32:47], v[72:75], a[212:215], v[32:47]
    s_waitcnt lgkmcnt(4)
    v_mfma_f32_32x32x16_bf16 v[16:31], v[76:79], a[216:219], v[16:31]
    ds_read_b128 v[72:75], v2 offset:32768
    v_mfma_f32_32x32x16_bf16 v[32:47], v[76:79], a[220:223], v[32:47]
    s_waitcnt lgkmcnt(4)
    v_mfma_f32_32x32x16_bf16 v[16:31], v[80:83], a[224:227], v[16:31]
    ds_read_b128 v[76:79], v2 offset:33792
    v_mfma_f32_32x32x16_bf16 v[32:47], v[80:83], a[228:231], v[32:47]
    s_waitcnt lgkmcnt(4)
    v_mfma_f32_32x32x16_bf16 v[16:31], v[84:87], a[232:235], v[16:31]
    ds_read_b128 v[80:83], v2 offset:34816
    v_mfma_f32_32x32x16_bf16 v[32:47], v[84:87], a[236:239], v[32:47]
    s_waitcnt lgkmcnt(4)
    v_mfma_f32_32x32x16_bf16 v[16:31], v[64:67], a[240:243], v[16:31]
    ds_read_b128 v[84:87], v2 offset:35840
    v_mfma_f32_32x32x16_bf16 v[32:47], v[64:67], a[244:247], v[32:47]
    s_waitcnt lgkmcnt(4)
    v_mfma_f32_32x32x16_bf16 v[16:31], v[68:71], a[248:251], v[16:31]
    v_mfma_f32_32x32x16_bf16 v[32:47], v[68:71], a[252:255], v[32:47]
    s_waitcnt lgkmcnt(3)
    v_mfma_f32_32x32x16_bf16 v[16:31], v[72:75], v[224:227], v[16:31]
    v_mfma_f32_32x32x16_bf16 v[32:47], v[72:75], v[228:231], v[32:47]
    s_waitcnt lgkmcnt(2)
    v_mfma_f32_32x32x16_bf16 v[16:31], v[76:79], v[232:235], v[16:31]
    s_waitcnt lgkmcnt(1)
    v_mfma_f32_32x32x16_bf16 v[16:31], v[80:83], v[240:243], v[16:31]
    s_waitcnt lgkmcnt(0)
    v_mfma_f32_32x32x16_bf16 v[16:31], v[84:87], v[248:251], v[16:31]
    v_mfma_f32_32x32x16_bf16 v[32:47], v[76:79], v[236:239], v[32:47]
    v_mfma_f32_32x32x16_bf16 v[32:47], v[80:83], v[244:247], v[32:47]
    v_cvt_pk_bf16_f32 v48, v16, v17
    v_cvt_pk_bf16_f32 v49, v18, v19
    v_cvt_pk_bf16_f32 v50, v20, v21
    v_cvt_pk_bf16_f32 v51, v22, v23
    v_mfma_f32_32x32x16_bf16 v[32:47], v[84:87], v[252:255], v[32:47]
    v_cvt_pk_bf16_f32 v52, v24, v25
    v_cvt_pk_bf16_f32 v53, v26, v27
    v_cvt_pk_bf16_f32 v54, v28, v29
    v_cvt_pk_bf16_f32 v55, v30, v31
    s_add_u32 s20, s20, s21
    s_waitcnt vmcnt(0)
    s_barrier
    v_add_u32 v2, s26, v1
    ds_read_b128 v[64:67], v2 offset:0
    ds_read_b128 v[68:71], v2 offset:1024
    ds_read_b128 v[72:75], v2 offset:2048
    ds_read_b128 v[76:79], v2 offset:3072
    ds_read_b128 v[80:83], v2 offset:4096
    v_cvt_pk_bf16_f32 v56, v32, v33
    v_cvt_pk_bf16_f32 v57, v34, v35
    v_cvt_pk_bf16_f32 v58, v36, v37
    v_cvt_pk_bf16_f32 v59, v38, v39
    v_cvt_pk_bf16_f32 v60, v40, v41
    v_cvt_pk_bf16_f32 v61, v42, v43
    v_cvt_pk_bf16_f32 v62, v44, v45
    v_cvt_pk_bf16_f32 v63, v46, v47
    s_cmp_lt_u32 s24, s23
    s_nop 0
    s_cbranch_scc1 pt_163
    v_permlane32_swap_b32 v48, v50
    v_permlane32_swap_b32 v49, v51
    buffer_store_dwordx4 v[48:51], v6, s[4:7], s20 offen offset:0 sc1
    v_permlane32_swap_b32 v52, v54
    v_permlane32_swap_b32 v53, v55
    buffer_store_dwordx4 v[52:55], v6, s[4:7], s20 offen offset:1024 sc1
    v_permlane32_swap_b32 v56, v58
    v_permlane32_swap_b32 v57, v59
    buffer_store_dwordx4 v[56:59], v6, s[4:7], s20 offen offset:2048 sc1
    v_permlane32_swap_b32 v60, v62
    v_permlane32_swap_b32 v61, v63
    buffer_store_dwordx4 v[60:63], v6, s[4:7], s20 offen offset:3072 sc1
    s_branch pe_157
pv_156:
    s_waitcnt vmcnt(9)
    s_barrier
    v_add_u32 v2, s26, v1
    ds_read_b128 v[64:67], v2 offset:0
    ds_read_b128 v[68:71], v2 offset:1024
    ds_read_b128 v[72:75], v2 offset:2048
    ds_read_b128 v[76:79], v2 offset:3072
    ds_read_b128 v[80:83], v2 offset:4096
    s_waitcnt lgkmcnt(4)
    v_mfma_f32_32x32x16_bf16 v[16:31], a[0:3], v[64:67], 0
    ds_read_b128 v[84:87], v2 offset:5120
    v_mfma_f32_32x32x16_bf16 v[32:47], a[4:7], v[64:67], 0
    s_sub_u32 s44, s24, 2
    s_max_i32 s44, s44, 0
    s_cmp_lg_u32 s14, 0
    s_cbranch_scc1 pp_168
    v_mov_b32 v3, s44
    s_mov_b64 exec, 1
    buffer_store_dword v3, off, s[4:7], s25 sc1
    s_mov_b64 exec, -1
pp_168:
    s_waitcnt lgkmcnt(4)
    v_mfma_f32_32x32x16_bf16 v[16:31], a[8:11], v[68:71], v[16:31]
    ds_read_b128 v[64:67], v2 offset:6144
    v_mfma_f32_32x32x16_bf16 v[32:47], a[12:15], v[68:71], v[32:47]
    s_sub_u32 s43, s26, 36864
    s_cmp_eq_u32 s26, 0
    s_cselect_b32 s43, 73728, s43
    s_add_u32 s43, s43, s27
    s_waitcnt lgkmcnt(4)
    v_mfma_f32_32x32x16_bf16 v[16:31], a[16:19], v[72:75], v[16:31]
    ds_read_b128 v[68:71], v2 offset:7168
    v_mfma_f32_32x32x16_bf16 v[32:47], a[20:23], v[72:75], v[32:47]
    s_add_u32 m0, s43, 0
    s_add_u32 s42, s22, 0
    buffer_load_dwordx4 v1, s[4:7], s42 offen offset:0 sc1 lds
    s_waitcnt lgkmcnt(4)
    v_mfma_f32_32x32x16_bf16 v[16:31], a[24:27], v[76:79], v[16:31]
    ds_read_b128 v[72:75], v2 offset:8192
    v_mfma_f32_32x32x16_bf16 v[32:47], a[28:31], v[76:79], v[32:47]
    buffer_load_dwordx4 v1, s[4:7], s42 offen offset:1024 sc1 lds
    s_waitcnt lgkmcnt(4)
    v_mfma_f32_32x32x16_bf16 v[16:31], a[32:35], v[80:83], v[16:31]
    ds_read_b128 v[76:79], v2 offset:9216
    v_mfma_f32_32x32x16_bf16 v[32:47], a[36:39], v[80:83], v[32:47]
    buffer_load_dwordx4 v1, s[4:7], s42 offen offset:2048 sc1 lds
    s_waitcnt lgkmcnt(4)
    v_mfma_f32_32x32x16_bf16 v[16:31], a[40:43], v[84:87], v[16:31]
    ds_read_b128 v[80:83], v2 offset:10240
    v_mfma_f32_32x32x16_bf16 v[32:47], a[44:47], v[84:87], v[32:47]
    s_add_u32 m0, s43, 3072
    s_add_u32 s42, s22, 3072
    buffer_load_dwordx4 v1, s[4:7], s42 offen offset:0 sc1 lds
    s_waitcnt lgkmcnt(4)
    v_mfma_f32_32x32x16_bf16 v[16:31], a[48:51], v[64:67], v[16:31]
    ds_read_b128 v[84:87], v2 offset:11264
    v_mfma_f32_32x32x16_bf16 v[32:47], a[52:55], v[64:67], v[32:47]
    buffer_load_dwordx4 v1, s[4:7], s42 offen offset:1024 sc1 lds
    s_waitcnt lgkmcnt(4)
    v_mfma_f32_32x32x16_bf16 v[16:31], a[56:59], v[68:71], v[16:31]
    ds_read_b128 v[64:67], v2 offset:12288
    v_mfma_f32_32x32x16_bf16 v[32:47], a[60:63], v[68:71], v[32:47]
    buffer_load_dwordx4 v1, s[4:7], s42 offen offset:2048 sc1 lds
    s_waitcnt lgkmcnt(4)
    v_mfma_f32_32x32x16_bf16 v[16:31], a[64:67], v[72:75], v[16:31]
    ds_read_b128 v[68:71], v2 offset:13312
    v_mfma_f32_32x32x16_bf16 v[32:47], a[68:71], v[72:75], v[32:47]
    s_add_u32 m0, s43, 6144
    s_add_u32 s42, s22, 6144
    buffer_load_dwordx4 v1, s[4:7], s42 offen offset:0 sc1 lds
    s_waitcnt lgkmcnt(4)
    v_mfma_f32_32x32x16_bf16 v[16:31], a[72:75], v[76:79], v[16:31]
    ds_read_b128 v[72:75], v2 offset:14336
    v_mfma_f32_32x32x16_bf16 v[32:47], a[76:79], v[76:79], v[32:47]
    buffer_load_dwordx4 v1, s[4:7], s42 offen offset:1024 sc1 lds
    s_waitcnt lgkmcnt(4)
    v_mfma_f32_32x32x16_bf16 v[16:31], a[80:83], v[80:83], v[16:31]
    ds_read_b128 v[76:79], v2 offset:15360
    v_mfma_f32_32x32x16_bf16 v[32:47], a[84:87], v[80:83], v[32:47]
    buffer_load_dwordx4 v1, s[4:7], s42 offen offset:2048 sc1 lds
    s_waitcnt lgkmcnt(4)
    v_mfma_f32_32x32x16_bf16 v[16:31], a[88:91], v[84:87], v[16:31]
    ds_read_b128 v[80:83], v2 offset:16384
    v_mfma_f32_32x32x16_bf16 v[32:47], a[92:95], v[84:87], v[32:47]
    s_add_u32 s22, s22, s29
    s_waitcnt lgkmcnt(4)
    v_mfma_f32_32x32x16_bf16 v[16:31], a[96:99], v[64:67], v[16:31]
    ds_read_b128 v[84:87], v2 offset:17408
    v_mfma_f32_32x32x16_bf16 v[32:47], a[100:103], v[64:67], v[32:47]
    s_add_u32 s26, s26, 36864
    s_cmp_eq_u32 s26, 110592
    s_cselect_b32 s26, 0, s26
    s_add_u32 s24, s24, 1
    s_waitcnt lgkmcnt(4)
    v_mfma_f32_32x32x16_bf16 v[16:31], a[104:107], v[68:71], v[16:31]
    ds_read_b128 v[64:67], v2 offset:18432
    v_mfma_f32_32x32x16_bf16 v[32:47], a[108:111], v[68:71], v[32:47]
    s_waitcnt lgkmcnt(4)
    v_mfma_f32_32x32x16_bf16 v[16:31], a[112:115], v[72:75], v[16:31]
    ds_read_b128 v[68:71], v2 offset:19456
    v_mfma_f32_32x32x16_bf16 v[32:47], a[116:119], v[72:75], v[32:47]
    s_waitcnt lgkmcnt(4)
    v_mfma_f32_32x32x16_bf16 v[16:31], a[120:123], v[76:79], v[16:31]
    ds_read_b128 v[72:75], v2 offset:20480
    v_mfma_f32_32x32x16_bf16 v[32:47], a[124:127], v[76:79], v[32:47]
    s_waitcnt lgkmcnt(4)
    v_mfma_f32_32x32x16_bf16 v[16:31], a[128:131], v[80:83], v[16:31]
    ds_read_b128 v[76:79], v2 offset:21504
    v_mfma_f32_32x32x16_bf16 v[32:47], a[132:135], v[80:83], v[32:47]
    s_waitcnt lgkmcnt(4)
    v_mfma_f32_32x32x16_bf16 v[16:31], a[136:139], v[84:87], v[16:31]
    ds_read_b128 v[80:83], v2 offset:22528
    v_mfma_f32_32x32x16_bf16 v[32:47], a[140:143], v[84:87], v[32:47]
    s_waitcnt lgkmcnt(4)
    v_mfma_f32_32x32x16_bf16 v[16:31], a[144:147], v[64:67], v[16:31]
    ds_read_b128 v[84:87], v2 offset:23552
    v_mfma_f32_32x32x16_bf16 v[32:47], a[148:151], v[64:67], v[32:47]
    s_waitcnt lgkmcnt(4)
    v_mfma_f32_32x32x16_bf16 v[16:31], a[152:155], v[68:71], v[16:31]
    ds_read_b128 v[64:67], v2 offset:24576
    v_mfma_f32_32x32x16_bf16 v[32:47], a[156:159], v[68:71], v[32:47]
    s_waitcnt lgkmcnt(4)
    v_mfma_f32_32x32x16_bf16 v[16:31], a[160:163], v[72:75], v[16:31]
    ds_read_b128 v[68:71], v2 offset:25600
    v_mfma_f32_32x32x16_bf16 v[32:47], a[164:167], v[72:75], v[32:47]
    s_waitcnt lgkmcnt(4)
    v_mfma_f32_32x32x16_bf16 v[16:31], a[168:171], v[76:79], v[16:31]
    ds_read_b128 v[72:75], v2 offset:26624
    v_mfma_f32_32x32x16_bf16 v[32:47], a[172:175], v[76:79], v[32:47]
    s_waitcnt lgkmcnt(4)
    v_mfma_f32_32x32x16_bf16 v[16:31], a[176:179], v[80:83], v[16:31]
    ds_read_b128 v[76:79], v2 offset:27648
    v_mfma_f32_32x32x16_bf16 v[32:47], a[180:183], v[80:83], v[32:47]
    s_waitcnt lgkmcnt(4)
    v_mfma_f32_32x32x16_bf16 v[16:31], a[184:187], v[84:87], v[16:31]
    ds_read_b128 v[80:83], v2 offset:28672
    v_mfma_f32_32x32x16_bf16 v[32:47], a[188:191], v[84:87], v[32:47]
    s_waitcnt lgkmcnt(4)
    v_mfma_f32_32x32x16_bf16 v[16:31], a[192:195], v[64:67], v[16:31]
    ds_read_b128 v[84:87], v2 offset:29696
    v_mfma_f32_32x32x16_bf16 v[32:47], a[196:199], v[64:67], v[32:47]
    s_waitcnt lgkmcnt(4)
    v_mfma_f32_32x32x16_bf16 v[16:31], a[200:203], v[68:71], v[16:31]
    ds_read_b128 v[64:67], v2 offset:30720
    v_mfma_f32_32x32x16_bf16 v[32:47], a[204:207], v[68:71], v[32:47]
    s_waitcnt lgkmcnt(4)
    v_mfma_f32_32x32x16_bf16 v[16:31], a[208:211], v[72:75], v[16:31]
    ds_read_b128 v[68:71], v2 offset:31744
    v_mfma_f32_32x32x16_bf16 v[32:47], a[212:215], v[72:75], v[32:47]
    s_waitcnt lgkmcnt(4)
    v_mfma_f32_32x32x16_bf16 v[16:31], a[216:219], v[76:79], v[16:31]
    ds_read_b128 v[72:75], v2 offset:32768
    v_mfma_f32_32x32x16_bf16 v[32:47], a[220:223], v[76:79], v[32:47]
    s_waitcnt lgkmcnt(4)
    v_mfma_f32_32x32x16_bf16 v[16:31], a[224:227], v[80:83], v[16:31]
    ds_read_b128 v[76:79], v2 offset:33792
    v_mfma_f32_32x32x16_bf16 v[32:47], a[228:231], v[80:83], v[32:47]
    s_waitcnt lgkmcnt(4)
    v_mfma_f32_32x32x16_bf16 v[16:31], a[232:235], v[84:87], v[16:31]
    ds_read_b128 v[80:83], v2 offset:34816
    v_mfma_f32_32x32x16_bf16 v[32:47], a[236:239], v[84:87], v[32:47]
    s_waitcnt lgkmcnt(4)
    v_mfma_f32_32x32x16_bf16 v[16:31], a[240:243], v[64:67], v[16:31]
    ds_read_b128 v[84:87], v2 offset:35840
    v_mfma_f32_32x32x16_bf16 v[32:47], a[244:247], v[64:67], v[32:47]
    s_waitcnt lgkmcnt(4)
    v_mfma_f32_32x32x16_bf16 v[16:31], a[248:251], v[68:71], v[16:31]
    v_mfma_f32_32x32x16_bf16 v[32:47], a[252:255], v[68:71], v[32:47]
    s_waitcnt lgkmcnt(3)
    v_mfma_f32_32x32x16_bf16 v[16:31], v[224:227], v[72:75], v[16:31]
    v_mfma_f32_32x32x16_bf16 v[32:47], v[228:231], v[72:75], v[32:47]
    s_waitcnt lgkmcnt(2)
    v_mfma_f32_32x32x16_bf16 v[16:31], v[232:235], v[76:79], v[16:31]
    s_waitcnt lgkmcnt(1)
    v_mfma_f32_32x32x16_bf16 v[16:31], v[240:243], v[80:83], v[16:31]
    s_waitcnt lgkmcnt(0)
    v_mfma_f32_32x32x16_bf16 v[16:31], v[248:251], v[84:87], v[16:31]
    v_mfma_f32_32x32x16_bf16 v[32:47], v[236:239], v[76:79], v[32:47]
    v_mfma_f32_32x32x16_bf16 v[32:47], v[244:247], v[80:83], v[32:47]
    v_cvt_pk_bf16_f32 v48, v16, v17
    v_cvt_pk_bf16_f32 v49, v18, v19
    v_cvt_pk_bf16_f32 v50, v20, v21
    v_cvt_pk_bf16_f32 v51, v22, v23
    v_mfma_f32_32x32x16_bf16 v[32:47], v[252:255], v[84:87], v[32:47]
    v_cvt_pk_bf16_f32 v52, v24, v25
    v_cvt_pk_bf16_f32 v53, v26, v27
    v_cvt_pk_bf16_f32 v54, v28, v29
    v_cvt_pk_bf16_f32 v55, v30, v31
    s_add_u32 s20, s20, s21
    s_waitcnt vmcnt(9)
    s_barrier
    v_add_u32 v2, s26, v1
    ds_read_b128 v[64:67], v2 offset:0
    ds_read_b128 v[68:71], v2 offset:1024
    ds_read_b128 v[72:75], v2 offset:2048
    ds_read_b128 v[76:79], v2 offset:3072
    ds_read_b128 v[80:83], v2 offset:4096
    v_cvt_pk_bf16_f32 v56, v32, v33
    v_cvt_pk_bf16_f32 v57, v34, v35
    v_cvt_pk_bf16_f32 v58, v36, v37
    v_cvt_pk_bf16_f32 v59, v38, v39
    v_cvt_pk_bf16_f32 v60, v40, v41
    v_cvt_pk_bf16_f32 v61, v42, v43
    v_cvt_pk_bf16_f32 v62, v44, v45
    v_cvt_pk_bf16_f32 v63, v46, v47
    s_nop 1
pt_167:
    s_waitcnt lgkmcnt(4)
    v_mfma_f32_32x32x16_bf16 v[16:31], a[0:3], v[64:67], 0
    ds_read_b128 v[84:87], v2 offset:5120
    v_lshlrev_b32 v96, 16, v48
    v_lshlrev_b32 v100, 16, v49
    v_and_b32 v97, 0xffff0000, v48
    v_and_b32 v101, 0xffff0000, v49
    v_mfma_f32_32x32x16_bf16 v[32:47], a[4:7], v[64:67], 0
    s_sub_u32 s44, s24, 2
    s_max_i32 s44, s44, 0
    s_cmp_lg_u32 s14, 0
    s_cbranch_scc1 pp_169
    v_mov_b32 v3, s44
    s_mov_b64 exec, 1
    buffer_store_dword v3, off, s[4:7], s25 sc1
    s_mov_b64 exec, -1
pp_169:
    v_mul_f32 v98, 0xbfb8aa3b, v96
    v_mul_f32 v102, 0xbfb8aa3b, v100
    v_mul_f32 v99, 0xbfb8aa3b, v97
    v_mul_f32 v103, 0xbfb8aa3b, v101
    s_waitcnt lgkmcnt(4)
    v_mfma_f32_32x32x16_bf16 v[16:31], a[8:11], v[68:71], v[16:31]
    ds_read_b128 v[64:67], v2 offset:6144
    v_exp_f32 v98, v98
    v_exp_f32 v102, v102
    v_exp_f32 v99, v99
    v_exp_f32 v103, v103
    v_mfma_f32_32x32x16_bf16 v[32:47], a[12:15], v[68:71], v[32:47]
    s_sub_u32 s43, s26, 36864
    s_cmp_eq_u32 s26, 0
    s_cselect_b32 s43, 73728, s43
    s_add_u32 s43, s43, s27
    v_add_f32 v98, 1.0, v98
    v_add_f32 v102, 1.0, v102
    v_add_f32 v99, 1.0, v99
    v_add_f32 v103, 1.0, v103
    s_waitcnt lgkmcnt(4)
    v_mfma_f32_32x32x16_bf16 v[16:31], a[16:19], v[72:75], v[16:31]
    ds_read_b128 v[68:71], v2 offset:7168
    v_rcp_f32 v98, v98
    v_rcp_f32 v102, v102
    v_rcp_f32 v99, v99
    v_rcp_f32 v103, v103
    v_mfma_f32_32x32x16_bf16 v[32:47], a[20:23], v[72:75], v[32:47]
    s_add_u32 m0, s43, 0
    s_add_u32 s42, s22, 0
    buffer_load_dwordx4 v1, s[4:7], s42 offen offset:0 sc1 lds
    v_mul_f32 v96, v96, v98
    v_mul_f32 v100, v100, v102
    v_mul_f32 v97, v97, v99
    v_mul_f32 v101, v101, v103
    s_waitcnt lgkmcnt(4)
    v_mfma_f32_32x32x16_bf16 v[16:31], a[24:27], v[76:79], v[16:31]
    ds_read_b128 v[72:75], v2 offset:8192
    v_cvt_pk_bf16_f32 v48, v96, v97
    v_cvt_pk_bf16_f32 v49, v100, v101
    v_lshlrev_b32 v96, 16, v50
    v_lshlrev_b32 v100, 16, v51
    v_mfma_f32_32x32x16_bf16 v[32:47], a[28:31], v[76:79], v[32:47]
    buffer_load_dwordx4 v1, s[4:7], s42 offen offset:1024 sc1 lds
    v_and_b32 v97, 0xffff0000, v50
    v_and_b32 v101, 0xffff0000, v51
    v_mul_f32 v98, 0xbfb8aa3b, v96
    v_mul_f32 v102, 0xbfb8aa3b, v100
    s_waitcnt lgkmcnt(4)
    v_mfma_f32_32x32x16_bf16 v[16:31], a[32:35], v[80:83], v[16:31]
    ds_read_b128 v[76:79], v2 offset:9216
    v_mul_f32 v99, 0xbfb8aa3b, v97
    v_mul_f32 v103, 0xbfb8aa3b, v101
    v_exp_f32 v98, v98
    v_exp_f32 v102, v102
    v_mfma_f32_32x32x16_bf16 v[32:47], a[36:39], v[80:83], v[32:47]
    buffer_load_dwordx4 v1, s[4:7], s42 offen offset:2048 sc1 lds
    v_exp_f32 v99, v99
    v_exp_f32 v103, v103
    v_add_f32 v98, 1.0, v98
    v_add_f32 v102, 1.0, v102
    s_waitcnt lgkmcnt(4)
    v_mfma_f32_32x32x16_bf16 v[16:31], a[40:43], v[84:87], v[16:31]
    ds_read_b128 v[80:83], v2 offset:10240
    v_add_f32 v99, 1.0, v99
    v_add_f32 v103, 1.0, v103
    v_rcp_f32 v98, v98
    v_rcp_f32 v102, v102
    v_mfma_f32_32x32x16_bf16 v[32:47], a[44:47], v[84:87], v[32:47]
    s_add_u32 m0, s43, 3072
    s_add_u32 s42, s22, 3072
    buffer_load_dwordx4 v1, s[4:7], s42 offen offset:0 sc1 lds
    v_rcp_f32 v99, v99
    v_rcp_f32 v103, v103
    v_mul_f32 v96, v96, v98
    v_mul_f32 v100, v100, v102
    s_waitcnt lgkmcnt(4)
    v_mfma_f32_32x32x16_bf16 v[16:31], a[48:51], v[64:67], v[16:31]
    ds_read_b128 v[84:87], v2 offset:11264
    v_mul_f32 v97, v97, v99
    v_mul_f32 v101, v101, v103
    v_cvt_pk_bf16_f32 v50, v96, v97
    v_cvt_pk_bf16_f32 v51, v100, v101
    v_mfma_f32_32x32x16_bf16 v[32:47], a[52:55], v[64:67], v[32:47]
    buffer_load_dwordx4 v1, s[4:7], s42 offen offset:1024 sc1 lds
    v_lshlrev_b32 v96, 16, v52
    v_lshlrev_b32 v100, 16, v53
    v_and_b32 v97, 0xffff0000, v52
    v_and_b32 v101, 0xffff0000, v53
    s_waitcnt lgkmcnt(4)
    v_mfma_f32_32x32x16_bf16 v[16:31], a[56:59], v[68:71], v[16:31]
    ds_read_b128 v[64:67], v2 offset:12288
    v_mul_f32 v98, 0xbfb8aa3b, v96
    v_mul_f32 v102, 0xbfb8aa3b, v100
    v_mul_f32 v99, 0xbfb8aa3b, v97
    v_mul_f32 v103, 0xbfb8aa3b, v101
    v_mfma_f32_32x32x16_bf16 v[32:47], a[60:63], v[68:71], v[32:47]
    buffer_load_dwordx4 v1, s[4:7], s42 offen offset:2048 sc1 lds
    v_exp_f32 v98, v98
    v_exp_f32 v102, v102
    v_exp_f32 v99, v99
    v_exp_f32 v103, v103
    s_waitcnt lgkmcnt(4)
    v_mfma_f32_32x32x16_bf16 v[16:31], a[64:67], v[72:75], v[16:31]
    ds_read_b128 v[68:71], v2 offset:13312
    v_add_f32 v98, 1.0, v98
    v_add_f32 v102, 1.0, v102
    v_add_f32 v99, 1.0, v99
    v_add_f32 v103, 1.0, v103
    v_mfma_f32_32x32x16_bf16 v[32:47], a[68:71], v[72:75], v[32:47]
    s_add_u32 m0, s43, 6144
    s_add_u32 s42, s22, 6144
    buffer_load_dwordx4 v1, s[4:7], s42 offen offset:0 sc1 lds
    v_rcp_f32 v98, v98
    v_rcp_f32 v102, v102
    v_rcp_f32 v99, v99
    v_rcp_f32 v103, v103
    s_waitcnt lgkmcnt(4)
    v_mfma_f32_32x32x16_bf16 v[16:31], a[72:75], v[76:79], v[16:31]
    ds_read_b128 v[72:75], v2 offset:14336
    v_mul_f32 v96, v96, v98
    v_mul_f32 v100, v100, v102
    v_mul_f32 v97, v97, v99
    v_mul_f32 v101, v101, v103
    v_mfma_f32_32x32x16_bf16 v[32:47], a[76:79], v[76:79], v[32:47]
    buffer_load_dwordx4 v1, s[4:7], s42 offen offset:1024 sc1 lds
    v_cvt_pk_bf16_f32 v52, v96, v97
    v_cvt_pk_bf16_f32 v53, v100, v101
    v_lshlrev_b32 v96, 16, v54
    v_lshlrev_b32 v100, 16, v55
    s_waitcnt lgkmcnt(4)
    v_mfma_f32_32x32x16_bf16 v[16:31], a[80:83], v[80:83], v[16:31]
    ds_read_b128 v[76:79], v2 offset:15360
    v_and_b32 v97, 0xffff0000, v54
    v_and_b32 v101, 0xffff0000, v55
    v_mul_f32 v98, 0xbfb8aa3b, v96
    v_mul_f32 v102, 0xbfb8aa3b, v100
    v_mfma_f32_32x32x16_bf16 v[32:47], a[84:87], v[80:83], v[32:47]
    buffer_load_dwordx4 v1, s[4:7], s42 offen offset:2048 sc1 lds
    v_mul_f32 v99, 0xbfb8aa3b, v97
    v_mul_f32 v103, 0xbfb8aa3b, v101
    v_exp_f32 v98, v98
    v_exp_f32 v102, v102
    s_waitcnt lgkmcnt(4)
    v_mfma_f32_32x32x16_bf16 v[16:31], a[88:91], v[84:87], v[16:31]
    ds_read_b128 v[80:83], v2 offset:16384
    v_exp_f32 v99, v99
    v_exp_f32 v103, v103
    v_add_f32 v98, 1.0, v98
    v_add_f32 v102, 1.0, v102
    v_mfma_f32_32x32x16_bf16 v[32:47], a[92:95], v[84:87], v[32:47]
    s_add_u32 s22, s22, s29
    v_add_f32 v99, 1.0, v99
    v_add_f32 v103, 1.0, v103
    v_rcp_f32 v98, v98
    v_rcp_f32 v102, v102
    s_waitcnt lgkmcnt(4)
    v_mfma_f32_32x32x16_bf16 v[16:31], a[96:99], v[64:67], v[16:31]
    ds_read_b128 v[84:87], v2 offset:17408
    v_rcp_f32 v99, v99
    v_rcp_f32 v103, v103
    v_mul_f32 v96, v96, v98
    v_mul_f32 v100, v100, v102
    v_mfma_f32_32x32x16_bf16 v[32:47], a[100:103], v[64:67], v[32:47]
    s_add_u32 s26, s26, 36864
    s_cmp_eq_u32 s26, 110592
    s_cselect_b32 s26, 0, s26
    s_add_u32 s24, s24, 1
    v_mul_f32 v97, v97, v99
    v_mul_f32 v101, v101, v103
    v_cvt_pk_bf16_f32 v54, v96, v97
    v_cvt_pk_bf16_f32 v55, v100, v101
    s_waitcnt lgkmcnt(4)
    v_mfma_f32_32x32x16_bf16 v[16:31], a[104:107], v[68:71], v[16:31]
    ds_read_b128 v[64:67], v2 offset:18432
    v_lshlrev_b32 v96, 16, v56
    v_lshlrev_b32 v100, 16, v57
    v_and_b32 v97, 0xffff0000, v56
    v_and_b32 v101, 0xffff0000, v57
    v_mfma_f32_32x32x16_bf16 v[32:47], a[108:111], v[68:71], v[32:47]
    v_mul_f32 v98, 0xbfb8aa3b, v96
    v_mul_f32 v102, 0xbfb8aa3b, v100
    v_mul_f32 v99, 0xbfb8aa3b, v97
    v_mul_f32 v103, 0xbfb8aa3b, v101
    s_waitcnt lgkmcnt(4)
    v_mfma_f32_32x32x16_bf16 v[16:31], a[112:115], v[72:75], v[16:31]
    ds_read_b128 v[68:71], v2 offset:19456
    v_exp_f32 v98, v98
    v_exp_f32 v102, v102
    v_exp_f32 v99, v99
    v_exp_f32 v103, v103
    v_mfma_f32_32x32x16_bf16 v[32:47], a[116:119], v[72:75], v[32:47]
    v_add_f32 v98, 1.0, v98
    v_add_f32 v102, 1.0, v102
    v_add_f32 v99, 1.0, v99
    v_add_f32 v103, 1.0, v103
    s_waitcnt lgkmcnt(4)
    v_mfma_f32_32x32x16_bf16 v[16:31], a[120:123], v[76:79], v[16:31]
    ds_read_b128 v[72:75], v2 offset:20480
    v_rcp_f32 v98, v98
    v_rcp_f32 v102, v102
    v_rcp_f32 v99, v99
    v_rcp_f32 v103, v103
    v_mfma_f32_32x32x16_bf16 v[32:47], a[124:127], v[76:79], v[32:47]
    v_mul_f32 v96, v96, v98
    v_mul_f32 v100, v100, v102
    v_mul_f32 v97, v97, v99
    v_mul_f32 v101, v101, v103
    s_waitcnt lgkmcnt(4)
    v_mfma_f32_32x32x16_bf16 v[16:31], a[128:131], v[80:83], v[16:31]
    ds_read_b128 v[76:79], v2 offset:21504
    v_cvt_pk_bf16_f32 v56, v96, v97
    v_cvt_pk_bf16_f32 v57, v100, v101
    v_lshlrev_b32 v96, 16, v58
    v_lshlrev_b32 v100, 16, v59
    v_mfma_f32_32x32x16_bf16 v[32:47], a[132:135], v[80:83], v[32:47]
    v_and_b32 v97, 0xffff0000, v58
    v_and_b32 v101, 0xffff0000, v59
    v_mul_f32 v98, 0xbfb8aa3b, v96
    v_mul_f32 v102, 0xbfb8aa3b, v100
    s_waitcnt lgkmcnt(4)
    v_mfma_f32_32x32x16_bf16 v[16:31], a[136:139], v[84:87], v[16:31]
    ds_read_b128 v[80:83], v2 offset:22528
    v_mul_f32 v99, 0xbfb8aa3b, v97
    v_mul_f32 v103, 0xbfb8aa3b, v101
    v_exp_f32 v98, v98
    v_exp_f32 v102, v102
    v_mfma_f32_32x32x16_bf16 v[32:47], a[140:143], v[84:87], v[32:47]
    v_exp_f32 v99, v99
    v_exp_f32 v103, v103
    v_add_f32 v98, 1.0, v98
    v_add_f32 v102, 1.0, v102
    s_waitcnt lgkmcnt(4)
    v_mfma_f32_32x32x16_bf16 v[16:31], a[144:147], v[64:67], v[16:31]
    ds_read_b128 v[84:87], v2 offset:23552
    v_add_f32 v99, 1.0, v99
    v_add_f32 v103, 1.0, v103
    v_rcp_f32 v98, v98
    v_rcp_f32 v102, v102
    v_mfma_f32_32x32x16_bf16 v[32:47], a[148:151], v[64:67], v[32:47]
    v_rcp_f32 v99, v99
    v_rcp_f32 v103, v103
    v_mul_f32 v96, v96, v98
    v_mul_f32 v100, v100, v102
    s_waitcnt lgkmcnt(4)
    v_mfma_f32_32x32x16_bf16 v[16:31], a[152:155], v[68:71], v[16:31]
    ds_read_b128 v[64:67], v2 offset:24576
    v_mul_f32 v97, v97, v99
    v_mul_f32 v101, v101, v103
    v_cvt_pk_bf16_f32 v58, v96, v97
    v_cvt_pk_bf16_f32 v59, v100, v101
    v_mfma_f32_32x32x16_bf16 v[32:47], a[156:159], v[68:71], v[32:47]
    v_lshlrev_b32 v96, 16, v60
    v_lshlrev_b32 v100, 16, v61
    v_and_b32 v97, 0xffff0000, v60
    v_and_b32 v101, 0xffff0000, v61
    s_waitcnt lgkmcnt(4)
    v_mfma_f32_32x32x16_bf16 v[16:31], a[160:163], v[72:75], v[16:31]
    ds_read_b128 v[68:71], v2 offset:25600
    v_mul_f32 v98, 0xbfb8aa3b, v96
    v_mul_f32 v102, 0xbfb8aa3b, v100
    v_mul_f32 v99, 0xbfb8aa3b, v97
    v_mul_f32 v103, 0xbfb8aa3b, v101
    v_mfma_f32_32x32x16_bf16 v[32:47], a[164:167], v[72:75], v[32:47]
    v_exp_f32 v98, v98
    v_exp_f32 v102, v102
    v_exp_f32 v99, v99
    v_exp_f32 v103, v103
    s_waitcnt lgkmcnt(4)
    v_mfma_f32_32x32x16_bf16 v[16:31], a[168:171], v[76:79], v[16:31]
    ds_read_b128 v[72:75], v2 offset:26624
    v_add_f32 v98, 1.0, v98
    v_add_f32 v102, 1.0, v102
    v_add_f32 v99, 1.0, v99
    v_add_f32 v103, 1.0, v103
    v_mfma_f32_32x32x16_bf16 v[32:47], a[172:175], v[76:79], v[32:47]
    v_rcp_f32 v98, v98
    v_rcp_f32 v102, v102
    v_rcp_f32 v99, v99
    v_rcp_f32 v103, v103
    s_waitcnt lgkmcnt(4)
    v_mfma_f32_32x32x16_bf16 v[16:31], a[176:179], v[80:83], v[16:31]
    ds_read_b128 v[76:79], v2 offset:27648
    v_mul_f32 v96, v96, v98
    v_mul_f32 v100, v100, v102
    v_mul_f32 v97, v97, v99
    v_mul_f32 v101, v101, v103
    v_mfma_f32_32x32x16_bf16 v[32:47], a[180:183], v[80:83], v[32:47]
    v_cvt_pk_bf16_f32 v60, v96, v97
    v_cvt_pk_bf16_f32 v61, v100, v101
    v_lshlrev_b32 v96, 16, v62
    v_lshlrev_b32 v100, 16, v63
    s_waitcnt lgkmcnt(4)
    v_mfma_f32_32x32x16_bf16 v[16:31], a[184:187], v[84:87], v[16:31]
    ds_read_b128 v[80:83], v2 offset:28672
    v_and_b32 v97, 0xffff0000, v62
    v_and_b32 v101, 0xffff0000, v63
    v_mul_f32 v98, 0xbfb8aa3b, v96
    v_mul_f32 v102, 0xbfb8aa3b, v100
    v_mfma_f32_32x32x16_bf16 v[32:47], a[188:191], v[84:87], v[32:47]
    v_mul_f32 v99, 0xbfb8aa3b, v97
    v_mul_f32 v103, 0xbfb8aa3b, v101
    v_exp_f32 v98, v98
    v_exp_f32 v102, v102
    s_waitcnt lgkmcnt(4)
    v_mfma_f32_32x32x16_bf16 v[16:31], a[192:195], v[64:67], v[16:31]
    ds_read_b128 v[84:87], v2 offset:29696
    v_exp_f32 v99, v99
    v_exp_f32 v103, v103
    v_add_f32 v98, 1.0, v98
    v_add_f32 v102, 1.0, v102
    v_mfma_f32_32x32x16_bf16 v[32:47], a[196:199], v[64:67], v[32:47]
    v_add_f32 v99, 1.0, v99
    v_add_f32 v103, 1.0, v103
    v_rcp_f32 v98, v98
    v_rcp_f32 v102, v102
    s_waitcnt lgkmcnt(4)
    v_mfma_f32_32x32x16_bf16 v[16:31], a[200:203], v[68:71], v[16:31]
    ds_read_b128 v[64:67], v2 offset:30720
    v_rcp_f32 v99, v99
    v_rcp_f32 v103, v103
    v_mul_f32 v96, v96, v98
    v_mul_f32 v100, v100, v102
    v_mfma_f32_32x32x16_bf16 v[32:47], a[204:207], v[68:71], v[32:47]
    v_mul_f32 v97, v97, v99
    v_mul_f32 v101, v101, v103
    v_cvt_pk_bf16_f32 v62, v96, v97
    v_cvt_pk_bf16_f32 v63, v100, v101
    s_waitcnt lgkmcnt(4)
    v_mfma_f32_32x32x16_bf16 v[16:31], a[208:211], v[72:75], v[16:31]
    ds_read_b128 v[68:71], v2 offset:31744
    v_permlane32_swap_b32 v48, v50
    v_permlane32_swap_b32 v49, v51
    buffer_store_dwordx4 v[48:51], v6, s[4:7], s20 offen offset:0 sc1
    v_permlane32_swap_b32 v52, v54
    v_mfma_f32_32x32x16_bf16 v[32:47], a[212:215], v[72:75], v[32:47]
    v_permlane32_swap_b32 v53, v55
    buffer_store_dwordx4 v[52:55], v6, s[4:7], s20 offen offset:1024 sc1
    v_permlane32_swap_b32 v56, v58
    v_permlane32_swap_b32 v57, v59
    s_waitcnt lgkmcnt(4)
    v_mfma_f32_32x32x16_bf16 v[16:31], a[216:219], v[76:79], v[16:31]
    ds_read_b128 v[72:75], v2 offset:32768
    buffer_store_dwordx4 v[56:59], v6, s[4:7], s20 offen offset:2048 sc1
    v_permlane32_swap_b32 v60, v62
    v_permlane32_swap_b32 v61, v63
    buffer_store_dwordx4 v[60:63], v6, s[4:7], s20 offen offset:3072 sc1
    v_mfma_f32_32x32x16_bf16 v[32:47], a[220:223], v[76:79], v[32:47]
    s_waitcnt lgkmcnt(4)
    v_mfma_f32_32x32x16_bf16 v[16:31], a[224:227], v[80:83], v[16:31]
    ds_read_b128 v[76:79], v2 offset:33792
    v_mfma_f32_32x32x16_bf16 v[32:47], a[228:231], v[80:83], v[32:47]
    s_waitcnt lgkmcnt(4)
    v_mfma_f32_32x32x16_bf16 v[16:31], a[232:235], v[84:87], v[16:31]
    ds_read_b128 v[80:83], v2 offset:34816
    v_mfma_f32_32x32x16_bf16 v[32:47], a[236:239], v[84:87], v[32:47]
    s_waitcnt lgkmcnt(4)
    v_mfma_f32_32x32x16_bf16 v[16:31], a[240:243], v[64:67], v[16:31]
    ds_read_b128 v[84:87], v2 offset:35840
    v_mfma_f32_32x32x16_bf16 v[32:47], a[244:247], v[64:67], v[32:47]
    s_waitcnt lgkmcnt(4)
    v_mfma_f32_32x32x16_bf16 v[16:31], a[248:251], v[68:71], v[16:31]
    v_mfma_f32_32x32x16_bf16 v[32:47], a[252:255], v[68:71], v[32:47]
    s_waitcnt lgkmcnt(3)
    v_mfma_f32_32x32x16_bf16 v[16:31], v[224:227], v[72:75], v[16:31]
    v_mfma_f32_32x32x16_bf16 v[32:47], v[228:231], v[72:75], v[32:47]
    s_waitcnt lgkmcnt(2)
    v_mfma_f32_32x32x16_bf16 v[16:31], v[232:235], v[76:79], v[16:31]
    s_waitcnt lgkmcnt(1)
    v_mfma_f32_32x32x16_bf16 v[16:31], v[240:243], v[80:83], v[16:31]
    s_waitcnt lgkmcnt(0)
    v_mfma_f32_32x32x16_bf16 v[16:31], v[248:251], v[84:87], v[16:31]
    v_mfma_f32_32x32x16_bf16 v[32:47], v[236:239], v[76:79], v[32:47]
    v_mfma_f32_32x32x16_bf16 v[32:47], v[244:247], v[80:83], v[32:47]
    v_cvt_pk_bf16_f32 v48, v16, v17
    v_cvt_pk_bf16_f32 v49, v18, v19
    v_cvt_pk_bf16_f32 v50, v20, v21
    v_cvt_pk_bf16_f32 v51, v22, v23
    v_mfma_f32_32x32x16_bf16 v[32:47], v[252:255], v[84:87], v[32:47]
    v_cvt_pk_bf16_f32 v52, v24, v25
    v_cvt_pk_bf16_f32 v53, v26, v27
    v_cvt_pk_bf16_f32 v54, v28, v29
    v_cvt_pk_bf16_f32 v55, v30, v31
    s_add_u32 s20, s20, s21
    s_waitcnt vmcnt(13)
    s_barrier
    v_add_u32 v2, s26, v1
    ds_read_b128 v[64:67], v2 offset:0
    ds_read_b128 v[68:71], v2 offset:1024
    ds_read_b128 v[72:75], v2 offset:2048
    ds_read_b128 v[76:79], v2 offset:3072
    ds_read_b128 v[80:83], v2 offset:4096
    v_cvt_pk_bf16_f32 v56, v32, v33
    v_cvt_pk_bf16_f32 v57, v34, v35
    v_cvt_pk_bf16_f32 v58, v36, v37
    v_cvt_pk_bf16_f32 v59, v38, v39
    v_cvt_pk_bf16_f32 v60, v40, v41
    v_cvt_pk_bf16_f32 v61, v42, v43
    v_cvt_pk_bf16_f32 v62, v44, v45
    v_cvt_pk_bf16_f32 v63, v46, v47
    s_cmp_lt_u32 s24, s23
    s_nop 0
    s_cbranch_scc1 pt_167
    v_lshlrev_b32 v96, 16, v48
    v_lshlrev_b32 v100, 16, v49
    v_and_b32 v97, 0xffff0000, v48
    v_and_b32 v101, 0xffff0000, v49
    v_mul_f32 v98, 0xbfb8aa3b, v96
    v_mul_f32 v102, 0xbfb8aa3b, v100
    v_mul_f32 v99, 0xbfb8aa3b, v97
    v_mul_f32 v103, 0xbfb8aa3b, v101
    v_exp_f32 v98, v98
    v_exp_f32 v102, v102
    v_exp_f32 v99, v99
    v_exp_f32 v103, v103
    v_add_f32 v98, 1.0, v98
    v_add_f32 v102, 1.0, v102
    v_add_f32 v99, 1.0, v99
    v_add_f32 v103, 1.0, v103
    v_rcp_f32 v98, v98
    v_rcp_f32 v102, v102
    v_rcp_f32 v99, v99
    v_rcp_f32 v103, v103
    v_mul_f32 v96, v96, v98
    v_mul_f32 v100, v100, v102
    v_mul_f32 v97, v97, v99
    v_mul_f32 v101, v101, v103
    v_cvt_pk_bf16_f32 v48, v96, v97
    v_cvt_pk_bf16_f32 v49, v100, v101
    v_lshlrev_b32 v96, 16, v50
    v_lshlrev_b32 v100, 16, v51
    v_and_b32 v97, 0xffff0000, v50
    v_and_b32 v101, 0xffff0000, v51
    v_mul_f32 v98, 0xbfb8aa3b, v96
    v_mul_f32 v102, 0xbfb8aa3b, v100
    v_mul_f32 v99, 0xbfb8aa3b, v97
    v_mul_f32 v103, 0xbfb8aa3b, v101
    v_exp_f32 v98, v98
    v_exp_f32 v102, v102
    v_exp_f32 v99, v99
    v_exp_f32 v103, v103
    v_add_f32 v98, 1.0, v98
    v_add_f32 v102, 1.0, v102
    v_add_f32 v99, 1.0, v99
    v_add_f32 v103, 1.0, v103
    v_rcp_f32 v98, v98
    v_rcp_f32 v102, v102
    v_rcp_f32 v99, v99
    v_rcp_f32 v103, v103
    v_mul_f32 v96, v96, v98
    v_mul_f32 v100, v100, v102
    v_mul_f32 v97, v97, v99
    v_mul_f32 v101, v101, v103
    v_cvt_pk_bf16_f32 v50, v96, v97
    v_cvt_pk_bf16_f32 v51, v100, v101
    v_lshlrev_b32 v96, 16, v52
    v_lshlrev_b32 v100, 16, v53
    v_and_b32 v97, 0xffff0000, v52
    v_and_b32 v101, 0xffff0000, v53
    v_mul_f32 v98, 0xbfb8aa3b, v96
    v_mul_f32 v102, 0xbfb8aa3b, v100
    v_mul_f32 v99, 0xbfb8aa3b, v97
    v_mul_f32 v103, 0xbfb8aa3b, v101
    v_exp_f32 v98, v98
    v_exp_f32 v102, v102
    v_exp_f32 v99, v99
    v_exp_f32 v103, v103
    v_add_f32 v98, 1.0, v98
    v_add_f32 v102, 1.0, v102
    v_add_f32 v99, 1.0, v99
    v_add_f32 v103, 1.0, v103
    v_rcp_f32 v98, v98
    v_rcp_f32 v102, v102
    v_rcp_f32 v99, v99
    v_rcp_f32 v103, v103
    v_mul_f32 v96, v96, v98
    v_mul_f32 v100, v100, v102
    v_mul_f32 v97, v97, v99
    v_mul_f32 v101, v101, v103
    v_cvt_pk_bf16_f32 v52, v96, v97
    v_cvt_pk_bf16_f32 v53, v100, v101
    v_lshlrev_b32 v96, 16, v54
    v_lshlrev_b32 v100, 16, v55
    v_and_b32 v97, 0xffff0000, v54
    v_and_b32 v101, 0xffff0000, v55
    v_mul_f32 v98, 0xbfb8aa3b, v96
    v_mul_f32 v102, 0xbfb8aa3b, v100
    v_mul_f32 v99, 0xbfb8aa3b, v97
    v_mul_f32 v103, 0xbfb8aa3b, v101
    v_exp_f32 v98, v98
    v_exp_f32 v102, v102
    v_exp_f32 v99, v99
    v_exp_f32 v103, v103
    v_add_f32 v98, 1.0, v98
    v_add_f32 v102, 1.0, v102
    v_add_f32 v99, 1.0, v99
    v_add_f32 v103, 1.0, v103
    v_rcp_f32 v98, v98
    v_rcp_f32 v102, v102
    v_rcp_f32 v99, v99
    v_rcp_f32 v103, v103
    v_mul_f32 v96, v96, v98
    v_mul_f32 v100, v100, v102
    v_mul_f32 v97, v97, v99
    v_mul_f32 v101, v101, v103
    v_cvt_pk_bf16_f32 v54, v96, v97
    v_cvt_pk_bf16_f32 v55, v100, v101
    v_lshlrev_b32 v96, 16, v56
    v_lshlrev_b32 v100, 16, v57
    v_and_b32 v97, 0xffff0000, v56
    v_and_b32 v101, 0xffff0000, v57
    v_mul_f32 v98, 0xbfb8aa3b, v96
    v_mul_f32 v102, 0xbfb8aa3b, v100
    v_mul_f32 v99, 0xbfb8aa3b, v97
    v_mul_f32 v103, 0xbfb8aa3b, v101
    v_exp_f32 v98, v98
    v_exp_f32 v102, v102
    v_exp_f32 v99, v99
    v_exp_f32 v103, v103
    v_add_f32 v98, 1.0, v98
    v_add_f32 v102, 1.0, v102
    v_add_f32 v99, 1.0, v99
    v_add_f32 v103, 1.0, v103
    v_rcp_f32 v98, v98
    v_rcp_f32 v102, v102
    v_rcp_f32 v99, v99
    v_rcp_f32 v103, v103
    v_mul_f32 v96, v96, v98
    v_mul_f32 v100, v100, v102
    v_mul_f32 v97, v97, v99
    v_mul_f32 v101, v101, v103
    v_cvt_pk_bf16_f32 v56, v96, v97
    v_cvt_pk_bf16_f32 v57, v100, v101
    v_lshlrev_b32 v96, 16, v58
    v_lshlrev_b32 v100, 16, v59
    v_and_b32 v97, 0xffff0000, v58
    v_and_b32 v101, 0xffff0000, v59
    v_mul_f32 v98, 0xbfb8aa3b, v96
    v_mul_f32 v102, 0xbfb8aa3b, v100
    v_mul_f32 v99, 0xbfb8aa3b, v97
    v_mul_f32 v103, 0xbfb8aa3b, v101
    v_exp_f32 v98, v98
    v_exp_f32 v102, v102
    v_exp_f32 v99, v99
    v_exp_f32 v103, v103
    v_add_f32 v98, 1.0, v98
    v_add_f32 v102, 1.0, v102
    v_add_f32 v99, 1.0, v99
    v_add_f32 v103, 1.0, v103
    v_rcp_f32 v98, v98
    v_rcp_f32 v102, v102
    v_rcp_f32 v99, v99
    v_rcp_f32 v103, v103
    v_mul_f32 v96, v96, v98
    v_mul_f32 v100, v100, v102
    v_mul_f32 v97, v97, v99
    v_mul_f32 v101, v101, v103
    v_cvt_pk_bf16_f32 v58, v96, v97
    v_cvt_pk_bf16_f32 v59, v100, v101
    v_lshlrev_b32 v96, 16, v60
    v_lshlrev_b32 v100, 16, v61
    v_and_b32 v97, 0xffff0000, v60
    v_and_b32 v101, 0xffff0000, v61
    v_mul_f32 v98, 0xbfb8aa3b, v96
    v_mul_f32 v102, 0xbfb8aa3b, v100
    v_mul_f32 v99, 0xbfb8aa3b, v97
    v_mul_f32 v103, 0xbfb8aa3b, v101
    v_exp_f32 v98, v98
    v_exp_f32 v102, v102
    v_exp_f32 v99, v99
    v_exp_f32 v103, v103
    v_add_f32 v98, 1.0, v98
    v_add_f32 v102, 1.0, v102
    v_add_f32 v99, 1.0, v99
    v_add_f32 v103, 1.0, v103
    v_rcp_f32 v98, v98
    v_rcp_f32 v102, v102
    v_rcp_f32 v99, v99
    v_rcp_f32 v103, v103
    v_mul_f32 v96, v96, v98
    v_mul_f32 v100, v100, v102
    v_mul_f32 v97, v97, v99
    v_mul_f32 v101, v101, v103
    v_cvt_pk_bf16_f32 v60, v96, v97
    v_cvt_pk_bf16_f32 v61, v100, v101
    v_lshlrev_b32 v96, 16, v62
    v_lshlrev_b32 v100, 16, v63
    v_and_b32 v97, 0xffff0000, v62
    v_and_b32 v101, 0xffff0000, v63
    v_mul_f32 v98, 0xbfb8aa3b, v96
    v_mul_f32 v102, 0xbfb8aa3b, v100
    v_mul_f32 v99, 0xbfb8aa3b, v97
    v_mul_f32 v103, 0xbfb8aa3b, v101
    v_exp_f32 v98, v98
    v_exp_f32 v102, v102
    v_exp_f32 v99, v99
    v_exp_f32 v103, v103
    v_add_f32 v98, 1.0, v98
    v_add_f32 v102, 1.0, v102
    v_add_f32 v99, 1.0, v99
    v_add_f32 v103, 1.0, v103
    v_rcp_f32 v98, v98
    v_rcp_f32 v102, v102
    v_rcp_f32 v99, v99
    v_rcp_f32 v103, v103
    v_mul_f32 v96, v96, v98
    v_mul_f32 v100, v100, v102
    v_mul_f32 v97, v97, v99
    v_mul_f32 v101, v101, v103
    v_cvt_pk_bf16_f32 v62, v96, v97
    v_cvt_pk_bf16_f32 v63, v100, v101
    v_permlane32_swap_b32 v48, v50
    v_permlane32_swap_b32 v49, v51
    buffer_store_dwordx4 v[48:51], v6, s[4:7], s20 offen offset:0 sc1
    v_permlane32_swap_b32 v52, v54
    v_permlane32_swap_b32 v53, v55
    buffer_store_dwordx4 v[52:55], v6, s[4:7], s20 offen offset:1024 sc1
    v_permlane32_swap_b32 v56, v58
    v_permlane32_swap_b32 v57, v59
    buffer_store_dwordx4 v[56:59], v6, s[4:7], s20 offen offset:2048 sc1
    v_permlane32_swap_b32 v60, v62
    v_permlane32_swap_b32 v61, v63
    buffer_store_dwordx4 v[60:63], v6, s[4:7], s20 offen offset:3072 sc1
    s_branch pe_157
pe_157:
    s_waitcnt vmcnt(0) lgkmcnt(0)
    s_barrier
    s_cmp_lg_u32 s14, 0
    s_cbranch_scc1 pp_170
    v_mov_b32 v3, s23
    s_mov_b64 exec, 1
    buffer_store_dword v3, off, s[4:7], s25 sc1
    s_mov_b64 exec, -1
pp_170:
    s_cmp_ge_u32 s37, 30
    s_cbranch_scc1 bend
    s_cmp_lt_u32 s37, 6
    s_cbranch_scc1 attn
    s_cmp_ge_u32 s36, 3
    s_cselect_b32 s42, 7, 6
    s_cselect_b32 s43, 42, 24
    s_mul_i32 s44, s36, 6
    s_sub_u32 s43, s43, s44
    s_cmp_lt_u32 s37, 24
    s_cselect_b32 s17, s36, s42
    s_cselect_b32 s43, 6, s43
    s_sub_u32 s16, s37, s43
    s_mov_b32 s8, s64
    s_mov_b32 s9, s65
    s_mov_b32 s10, 5308416
    s_mov_b32 s11, 0x20000
    s_mov_b32 s19, 1152
    s_mul_i32 s18, s14, 1327104
    s_lshl_b32 s42, s16, 6
    s_add_u32 s18, s18, s42
    s_barrier
    v_lshrrev_b32 v4, 2, v0
    v_mul_lo_u32 v2, v4, s19
    v_and_b32 v4, 3, v0
    v_lshl_add_u32 v2, v4, 4, v2
    v_lshrrev_b32 v4, 5, v0
    v_bfe_u32 v5, v0, 2, 2
    v_lshl_add_u32 v4, v4, 3, v5
    v_mul_u32_u24 v3, 64, v4
    v_bfe_u32 v4, v0, 4, 1
    v_lshl_add_u32 v3, v4, 5, v3
    v_and_b32 v4, 3, v0
    v_lshl_add_u32 v3, v4, 3, v3
    s_mul_i32 s44, s14, 32768
    v_add_u32 v3, s44, v3
    s_mul_i32 s43, s19, 16
    s_mov_b32 s42, s18
    s_add_u32 m0, s44, 0
    s_nop 0
    buffer_load_dwordx4 v2, s[8:11], s42 offen  lds
    s_add_u32 s42, s42, s43
    s_add_u32 m0, s44, 1024
    s_nop 0
    buffer_load_dwordx4 v2, s[8:11], s42 offen  lds
    s_add_u32 s42, s42, s43
    s_add_u32 m0, s44, 2048
    s_nop 0
    buffer_load_dwordx4 v2, s[8:11], s42 offen  lds
    s_add_u32 s42, s42, s43
    s_add_u32 m0, s44, 3072
    s_nop 0
    buffer_load_dwordx4 v2, s[8:11], s42 offen  lds
    s_add_u32 s42, s42, s43
    s_add_u32 m0, s44, 4096
    s_nop 0
    buffer_load_dwordx4 v2, s[8:11], s42 offen  lds
    s_add_u32 s42, s42, s43
    s_add_u32 m0, s44, 5120
    s_nop 0
    buffer_load_dwordx4 v2, s[8:11], s42 offen  lds
    s_add_u32 s42, s42, s43
    s_add_u32 m0, s44, 6144
    s_nop 0
    buffer_load_dwordx4 v2, s[8:11], s42 offen  lds
    s_add_u32 s42, s42, s43
    s_add_u32 m0, s44, 7168
    s_nop 0
    buffer_load_dwordx4 v2, s[8:11], s42 offen  lds
    s_add_u32 s42, s42, s43
    s_add_u32 m0, s44, 8192
    s_nop 0
    buffer_load_dwordx4 v2, s[8:11], s42 offen  lds
    s_add_u32 s42, s42, s43
    s_add_u32 m0, s44, 9216
    s_nop 0
    buffer_load_dwordx4 v2, s[8:11], s42 offen  lds
    s_add_u32 s42, s42, s43
    s_add_u32 m0, s44, 10240
    s_nop 0
    buffer_load_dwordx4 v2, s[8:11], s42 offen  lds
    s_add_u32 s42, s42, s43
    s_add_u32 m0, s44, 11264
    s_nop 0
    buffer_load_dwordx4 v2, s[8:11], s42 offen  lds
    s_add_u32 s42, s42, s43
    s_add_u32 m0, s44, 12288
    s_nop 0
    buffer_load_dwordx4 v2, s[8:11], s42 offen  lds
    s_add_u32 s42, s42, s43
    s_add_u32 m0, s44, 13312
    s_nop 0
    buffer_load_dwordx4 v2, s[8:11], s42 offen  lds
    s_add_u32 s42, s42, s43
    s_add_u32 m0, s44, 14336
    s_nop 0
    buffer_load_dwordx4 v2, s[8:11], s42 offen  lds
    s_add_u32 s42, s42, s43
    s_add_u32 m0, s44, 15360
    s_nop 0
    buffer_load_dwordx4 v2, s[8:11], s42 offen  lds
    s_add_u32 s42, s42, s43
    s_add_u32 m0, s44, 16384
    s_nop 0
    buffer_load_dwordx4 v2, s[8:11], s42 offen  lds
    s_add_u32 s42, s42, s43
    s_add_u32 m0, s44, 17408
    s_nop 0
    buffer_load_dwordx4 v2, s[8:11], s42 offen  lds
    s_add_u32 s42, s42, s43
    s_add_u32 m0, s44, 18432
    s_nop 0
    buffer_load_dwordx4 v2, s[8:11], s42 offen  lds
    s_add_u32 s42, s42, s43
    s_add_u32 m0, s44, 19456
    s_nop 0
    buffer_load_dwordx4 v2, s[8:11], s42 offen  lds
    s_add_u32 s42, s42, s43
    s_add_u32 m0, s44, 20480
    s_nop 0
    buffer_load_dwordx4 v2, s[8:11], s42 offen  lds
    s_add_u32 s42, s42, s43
    s_add_u32 m0, s44, 21504
    s_nop 0
    buffer_load_dwordx4 v2, s[8:11], s42 offen  lds
    s_add_u32 s42, s42, s43
    s_add_u32 m0, s44, 22528
    s_nop 0
    buffer_load_dwordx4 v2, s[8:11], s42 offen  lds
    s_add_u32 s42, s42, s43
    s_add_u32 m0, s44, 23552
    s_nop 0
    buffer_load_dwordx4 v2, s[8:11], s42 offen  lds
    s_add_u32 s42, s42, s43
    s_add_u32 m0, s44, 24576
    s_nop 0
    buffer_load_dwordx4 v2, s[8:11], s42 offen  lds
    s_add_u32 s42, s42, s43
    s_add_u32 m0, s44, 25600
    s_nop 0
    buffer_load_dwordx4 v2, s[8:11], s42 offen  lds
    s_add_u32 s42, s42, s43
    s_add_u32 m0, s44, 26624
    s_nop 0
    buffer_load_dwordx4 v2, s[8:11], s42 offen  lds
    s_add_u32 s42, s42, s43
    s_add_u32 m0, s44, 27648
    s_nop 0
    buffer_load_dwordx4 v2, s[8:11], s42 offen  lds
    s_add_u32 s42, s42, s43
    s_add_u32 m0, s44, 28672
    s_nop 0
    buffer_load_dwordx4 v2, s[8:11], s42 offen  lds
    s_add_u32 s42, s42, s43
    s_add_u32 m0, s44, 29696
    s_nop 0
    buffer_load_dwordx4 v2, s[8:11], s42 offen  lds
    s_add_u32 s42, s42, s43
    s_add_u32 m0, s44, 30720
    s_nop 0
    buffer_load_dwordx4 v2, s[8:11], s42 offen  lds
    s_add_u32 s42, s42, s43
    s_add_u32 m0, s44, 31744
    s_nop 0
    buffer_load_dwordx4 v2, s[8:11], s42 offen  lds
    s_add_u32 s42, s42, s43
    s_waitcnt vmcnt(28)
    ds_read_b64_tr_b16 a[0:1], v3 offset:0
    ds_read_b64_tr_b16 a[2:3], v3 offset:256
    ds_read_b64_tr_b16 a[4:5], v3 offset:1024
    ds_read_b64_tr_b16 a[6:7], v3 offset:1280
    ds_read_b64_tr_b16 a[8:9], v3 offset:2048
    ds_read_b64_tr_b16 a[10:11], v3 offset:2304
    ds_read_b64_tr_b16 a[12:13], v3 offset:3072
    ds_read_b64_tr_b16 a[14:15], v3 offset:3328
    s_waitcnt lgkmcnt(0)
    s_add_u32 m0, s44, 0
    s_nop 0
    buffer_load_dwordx4 v2, s[8:11], s42 offen  lds
    s_add_u32 s42, s42, s43
    s_add_u32 m0, s44, 1024
    s_nop 0
    buffer_load_dwordx4 v2, s[8:11], s42 offen  lds
    s_add_u32 s42, s42, s43
    s_add_u32 m0, s44, 2048
    s_nop 0
    buffer_load_dwordx4 v2, s[8:11], s42 offen  lds
    s_add_u32 s42, s42, s43
    s_add_u32 m0, s44, 3072
    s_nop 0
    buffer_load_dwordx4 v2, s[8:11], s42 offen  lds
    s_add_u32 s42, s42, s43
    s_waitcnt vmcnt(28)
    ds_read_b64_tr_b16 a[16:17], v3 offset:4096
    ds_read_b64_tr_b16 a[18:19], v3 offset:4352
    ds_read_b64_tr_b16 a[20:21], v3 offset:5120
    ds_read_b64_tr_b16 a[22:23], v3 offset:5376
    ds_read_b64_tr_b16 a[24:25], v3 offset:6144
    ds_read_b64_tr_b16 a[26:27], v3 offset:6400
    ds_read_b64_tr_b16 a[28:29], v3 offset:7168
    ds_read_b64_tr_b16 a[30:31], v3 offset:7424
    s_waitcnt lgkmcnt(0)
    s_add_u32 m0, s44, 4096
    s_nop 0
    buffer_load_dwordx4 v2, s[8:11], s42 offen  lds
    s_add_u32 s42, s42, s43
    s_add_u32 m0, s44, 5120
    s_nop 0
    buffer_load_dwordx4 v2, s[8:11], s42 offen  lds
    s_add_u32 s42, s42, s43
    s_add_u32 m0, s44, 6144
    s_nop 0
    buffer_load_dwordx4 v2, s[8:11], s42 offen  lds
    s_add_u32 s42, s42, s43
    s_add_u32 m0, s44, 7168
    s_nop 0
    buffer_load_dwordx4 v2, s[8:11], s42 offen  lds
    s_add_u32 s42, s42, s43
    s_waitcnt vmcnt(28)
    ds_read_b64_tr_b16 a[32:33], v3 offset:8192
    ds_read_b64_tr_b16 a[34:35], v3 offset:8448
    ds_read_b64_tr_b16 a[36:37], v3 offset:9216
    ds_read_b64_tr_b16 a[38:39], v3 offset:9472
    ds_read_b64_tr_b16 a[40:41], v3 offset:10240
    ds_read_b64_tr_b16 a[42:43], v3 offset:10496
    ds_read_b64_tr_b16 a[44:45], v3 offset:11264
    ds_read_b64_tr_b16 a[46:47], v3 offset:11520
    s_waitcnt lgkmcnt(0)
    s_add_u32 m0, s44, 8192
    s_nop 0
    buffer_load_dwordx4 v2, s[8:11], s42 offen  lds
    s_add_u32 s42, s42, s43
    s_add_u32 m0, s44, 9216
    s_nop 0
    buffer_load_dwordx4 v2, s[8:11], s42 offen  lds
    s_add_u32 s42, s42, s43
    s_add_u32 m0, s44, 10240
    s_nop 0
    buffer_load_dwordx4 v2, s[8:11], s42 offen  lds
    s_add_u32 s42, s42, s43
    s_add_u32 m0, s44, 11264
    s_nop 0
    buffer_load_dwordx4 v2, s[8:11], s42 offen  lds
    s_add_u32 s42, s42, s43
    s_waitcnt vmcnt(28)
    ds_read_b64_tr_b16 a[48:49], v3 offset:12288
    ds_read_b64_tr_b16 a[50:51], v3 offset:12544
    ds_read_b64_tr_b16 a[52:53], v3 offset:13312
    ds_read_b64_tr_b16 a[54:55], v3 offset:13568
    ds_read_b64_tr_b16 a[56:57], v3 offset:14336
    ds_read_b64_tr_b16 a[58:59], v3 offset:14592
    ds_read_b64_tr_b16 a[60:61], v3 offset:15360
    ds_read_b64_tr_b16 a[62:63], v3 offset:15616
    s_waitcnt lgkmcnt(0)
    s_add_u32 m0, s44, 12288
    s_nop 0
    buffer_load_dwordx4 v2, s[8:11], s42 offen  lds
    s_add_u32 s42, s42, s43
    s_add_u32 m0, s44, 13312
    s_nop 0
    buffer_load_dwordx4 v2, s[8:11], s42 offen  lds
    s_add_u32 s42, s42, s43
    s_add_u32 m0, s44, 14336
    s_nop 0
    buffer_load_dwordx4 v2, s[8:11], s42 offen  lds
    s_add_u32 s42, s42, s43
    s_add_u32 m0, s44, 15360
    s_nop 0
    buffer_load_dwordx4 v2, s[8:11], s42 offen  lds
    s_add_u32 s42, s42, s43
    s_waitcnt vmcnt(28)
    ds_read_b64_tr_b16 a[64:65], v3 offset:16384
    ds_read_b64_tr_b16 a[66:67], v3 offset:16640
    ds_read_b64_tr_b16 a[68:69], v3 offset:17408
    ds_read_b64_tr_b16 a[70:71], v3 offset:17664
    ds_read_b64_tr_b16 a[72:73], v3 offset:18432
    ds_read_b64_tr_b16 a[74:75], v3 offset:18688
    ds_read_b64_tr_b16 a[76:77], v3 offset:19456
    ds_read_b64_tr_b16 a[78:79], v3 offset:19712
    s_waitcnt lgkmcnt(0)
    s_add_u32 m0, s44, 16384
    s_nop 0
    buffer_load_dwordx4 v2, s[8:11], s42 offen  lds
    s_add_u32 s42, s42, s43
    s_add_u32 m0, s44, 17408
    s_nop 0
    buffer_load_dwordx4 v2, s[8:11], s42 offen  lds
    s_add_u32 s42, s42, s43
    s_add_u32 m0, s44, 18432
    s_nop 0
    buffer_load_dwordx4 v2, s[8:11], s42 offen  lds
    s_add_u32 s42, s42, s43
    s_add_u32 m0, s44, 19456
    s_nop 0
    buffer_load_dwordx4 v2, s[8:11], s42 offen  lds
    s_add_u32 s42, s42, s43
    s_waitcnt vmcnt(28)
    ds_read_b64_tr_b16 a[80:81], v3 offset:20480
    ds_read_b64_tr_b16 a[82:83], v3 offset:20736
    ds_read_b64_tr_b16 a[84:85], v3 offset:21504
    ds_read_b64_tr_b16 a[86:87], v3 offset:21760
    ds_read_b64_tr_b16 a[88:89], v3 offset:22528
    ds_read_b64_tr_b16 a[90:91], v3 offset:22784
    ds_read_b64_tr_b16 a[92:93], v3 offset:23552
    ds_read_b64_tr_b16 a[94:95], v3 offset:23808
    s_waitcnt lgkmcnt(0)
    s_add_u32 m0, s44, 20480
    s_nop 0
    buffer_load_dwordx4 v2, s[8:11], s42 offen  lds
    s_add_u32 s42, s42, s43
    s_add_u32 m0, s44, 21504
    s_nop 0
    buffer_load_dwordx4 v2, s[8:11], s42 offen  lds
    s_add_u32 s42, s42, s43
    s_add_u32 m0, s44, 22528
    s_nop 0
    buffer_load_dwordx4 v2, s[8:11], s42 offen  lds
    s_add_u32 s42, s42, s43
    s_add_u32 m0, s44, 23552
    s_nop 0
    buffer_load_dwordx4 v2, s[8:11], s42 offen  lds
    s_add_u32 s42, s42, s43
    s_waitcnt vmcnt(28)
    ds_read_b64_tr_b16 a[96:97], v3 offset:24576
    ds_read_b64_tr_b16 a[98:99], v3 offset:24832
    ds_read_b64_tr_b16 a[100:101], v3 offset:25600
    ds_read_b64_tr_b16 a[102:103], v3 offset:25856
    ds_read_b64_tr_b16 a[104:105], v3 offset:26624
    ds_read_b64_tr_b16 a[106:107], v3 offset:26880
    ds_read_b64_tr_b16 a[108:109], v3 offset:27648
    ds_read_b64_tr_b16 a[110:111], v3 offset:27904
    s_waitcnt lgkmcnt(0)
    s_add_u32 m0, s44, 24576
    s_nop 0
    buffer_load_dwordx4 v2, s[8:11], s42 offen  lds
    s_add_u32 s42, s42, s43
    s_add_u32 m0, s44, 25600
    s_nop 0
    buffer_load_dwordx4 v2, s[8:11], s42 offen  lds
    s_add_u32 s42, s42, s43
    s_add_u32 m0, s44, 26624
    s_nop 0
    buffer_load_dwordx4 v2, s[8:11], s42 offen  lds
    s_add_u32 s42, s42, s43
    s_add_u32 m0, s44, 27648
    s_nop 0
    buffer_load_dwordx4 v2, s[8:11], s42 offen  lds
    s_add_u32 s42, s42, s43
    s_waitcnt vmcnt(28)
    ds_read_b64_tr_b16 a[112:113], v3 offset:28672
    ds_read_b64_tr_b16 a[114:115], v3 offset:28928
    ds_read_b64_tr_b16 a[116:117], v3 offset:29696
    ds_read_b64_tr_b16 a[118:119], v3 offset:29952
    ds_read_b64_tr_b16 a[120:121], v3 offset:30720
    ds_read_b64_tr_b16 a[122:123], v3 offset:30976
    ds_read_b64_tr_b16 a[124:125], v3 offset:31744
    ds_read_b64_tr_b16 a[126:127], v3 offset:32000
    s_waitcnt lgkmcnt(0)
    s_add_u32 m0, s44, 28672
    s_nop 0
    buffer_load_dwordx4 v2, s[8:11], s42 offen  lds
    s_add_u32 s42, s42, s43
    s_add_u32 m0, s44, 29696
    s_nop 0
    buffer_load_dwordx4 v2, s[8:11], s42 offen  lds
    s_add_u32 s42, s42, s43
    s_add_u32 m0, s44, 30720
    s_nop 0
    buffer_load_dwordx4 v2, s[8:11], s42 offen  lds
    s_add_u32 s42, s42, s43
    s_add_u32 m0, s44, 31744
    s_nop 0
    buffer_load_dwordx4 v2, s[8:11], s42 offen  lds
    s_add_u32 s42, s42, s43
    s_waitcnt vmcnt(28)
    ds_read_b64_tr_b16 a[128:129], v3 offset:0
    ds_read_b64_tr_b16 a[130:131], v3 offset:256
    ds_read_b64_tr_b16 a[132:133], v3 offset:1024
    ds_read_b64_tr_b16 a[134:135], v3 offset:1280
    ds_read_b64_tr_b16 a[136:137], v3 offset:2048
    ds_read_b64_tr_b16 a[138:139], v3 offset:2304
    ds_read_b64_tr_b16 a[140:141], v3 offset:3072
    ds_read_b64_tr_b16 a[142:143], v3 offset:3328
    s_waitcnt lgkmcnt(0)
    s_add_u32 m0, s44, 0
    s_nop 0
    buffer_load_dwordx4 v2, s[8:11], s42 offen  lds
    s_add_u32 s42, s42, s43
    s_add_u32 m0, s44, 1024
    s_nop 0
    buffer_load_dwordx4 v2, s[8:11], s42 offen  lds
    s_add_u32 s42, s42, s43
    s_add_u32 m0, s44, 2048
    s_nop 0
    buffer_load_dwordx4 v2, s[8:11], s42 offen  lds
    s_add_u32 s42, s42, s43
    s_add_u32 m0, s44, 3072
    s_nop 0
    buffer_load_dwordx4 v2, s[8:11], s42 offen  lds
    s_add_u32 s42, s42, s43
    s_waitcnt vmcnt(28)
    ds_read_b64_tr_b16 a[144:145], v3 offset:4096
    ds_read_b64_tr_b16 a[146:147], v3 offset:4352
    ds_read_b64_tr_b16 a[148:149], v3 offset:5120
    ds_read_b64_tr_b16 a[150:151], v3 offset:5376
    ds_read_b64_tr_b16 a[152:153], v3 offset:6144
    ds_read_b64_tr_b16 a[154:155], v3 offset:6400
    ds_read_b64_tr_b16 a[156:157], v3 offset:7168
    ds_read_b64_tr_b16 a[158:159], v3 offset:7424
    s_waitcnt lgkmcnt(0)
    s_add_u32 m0, s44, 4096
    s_nop 0
    buffer_load_dwordx4 v2, s[8:11], s42 offen  lds
    s_add_u32 s42, s42, s43
    s_add_u32 m0, s44, 5120
    s_nop 0
    buffer_load_dwordx4 v2, s[8:11], s42 offen  lds
    s_add_u32 s42, s42, s43
    s_add_u32 m0, s44, 6144
    s_nop 0
    buffer_load_dwordx4 v2, s[8:11], s42 offen  lds
    s_add_u32 s42, s42, s43
    s_add_u32 m0, s44, 7168
    s_nop 0
    buffer_load_dwordx4 v2, s[8:11], s42 offen  lds
    s_add_u32 s42, s42, s43
    s_waitcnt vmcnt(28)
    ds_read_b64_tr_b16 a[160:161], v3 offset:8192
    ds_read_b64_tr_b16 a[162:163], v3 offset:8448
    ds_read_b64_tr_b16 a[164:165], v3 offset:9216
    ds_read_b64_tr_b16 a[166:167], v3 offset:9472
    ds_read_b64_tr_b16 a[168:169], v3 offset:10240
    ds_read_b64_tr_b16 a[170:171], v3 offset:10496
    ds_read_b64_tr_b16 a[172:173], v3 offset:11264
    ds_read_b64_tr_b16 a[174:175], v3 offset:11520
    s_waitcnt lgkmcnt(0)
    s_waitcnt vmcnt(24)
    ds_read_b64_tr_b16 a[176:177], v3 offset:12288
    ds_read_b64_tr_b16 a[178:179], v3 offset:12544
    ds_read_b64_tr_b16 a[180:181], v3 offset:13312
    ds_read_b64_tr_b16 a[182:183], v3 offset:13568
    ds_read_b64_tr_b16 a[184:185], v3 offset:14336
    ds_read_b64_tr_b16 a[186:187], v3 offset:14592
    ds_read_b64_tr_b16 a[188:189], v3 offset:15360
    ds_read_b64_tr_b16 a[190:191], v3 offset:15616
    s_waitcnt lgkmcnt(0)
    s_waitcnt vmcnt(20)
    ds_read_b64_tr_b16 a[192:193], v3 offset:16384
    ds_read_b64_tr_b16 a[194:195], v3 offset:16640
    ds_read_b64_tr_b16 a[196:197], v3 offset:17408
    ds_read_b64_tr_b16 a[198:199], v3 offset:17664
    ds_read_b64_tr_b16 a[200:201], v3 offset:18432
    ds_read_b64_tr_b16 a[202:203], v3 offset:18688
    ds_read_b64_tr_b16 a[204:205], v3 offset:19456
    ds_read_b64_tr_b16 a[206:207], v3 offset:19712
    s_waitcnt lgkmcnt(0)
    s_waitcnt vmcnt(16)
    ds_read_b64_tr_b16 a[208:209], v3 offset:20480
    ds_read_b64_tr_b16 a[210:211], v3 offset:20736
    ds_read_b64_tr_b16 a[212:213], v3 offset:21504
    ds_read_b64_tr_b16 a[214:215], v3 offset:21760
    ds_read_b64_tr_b16 a[216:217], v3 offset:22528
    ds_read_b64_tr_b16 a[218:219], v3 offset:22784
    ds_read_b64_tr_b16 a[220:221], v3 offset:23552
    ds_read_b64_tr_b16 a[222:223], v3 offset:23808
    s_waitcnt lgkmcnt(0)
    s_waitcnt vmcnt(12)
    ds_read_b64_tr_b16 a[224:225], v3 offset:24576
    ds_read_b64_tr_b16 a[226:227], v3 offset:24832
    ds_read_b64_tr_b16 a[228:229], v3 offset:25600
    ds_read_b64_tr_b16 a[230:231], v3 offset:25856
    ds_read_b64_tr_b16 a[232:233], v3 offset:26624
    ds_read_b64_tr_b16 a[234:235], v3 offset:26880
    ds_read_b64_tr_b16 a[236:237], v3 offset:27648
    ds_read_b64_tr_b16 a[238:239], v3 offset:27904
    s_waitcnt lgkmcnt(0)
    s_waitcnt vmcnt(8)
    ds_read_b64_tr_b16 a[240:241], v3 offset:28672
    ds_read_b64_tr_b16 a[242:243], v3 offset:28928
    ds_read_b64_tr_b16 a[244:245], v3 offset:29696
    ds_read_b64_tr_b16 a[246:247], v3 offset:29952
    ds_read_b64_tr_b16 a[248:249], v3 offset:30720
    ds_read_b64_tr_b16 a[250:251], v3 offset:30976
    ds_read_b64_tr_b16 a[252:253], v3 offset:31744
    ds_read_b64_tr_b16 a[254:255], v3 offset:32000
    s_waitcnt lgkmcnt(0)
    s_waitcnt vmcnt(4)
    ds_read_b64_tr_b16 v[224:225], v3 offset:0
    ds_read_b64_tr_b16 v[226:227], v3 offset:256
    ds_read_b64_tr_b16 v[228:229], v3 offset:1024
    ds_read_b64_tr_b16 v[230:231], v3 offset:1280
    ds_read_b64_tr_b16 v[232:233], v3 offset:2048
    ds_read_b64_tr_b16 v[234:235], v3 offset:2304
    ds_read_b64_tr_b16 v[236:237], v3 offset:3072
    ds_read_b64_tr_b16 v[238:239], v3 offset:3328
    s_waitcnt lgkmcnt(0)
    s_waitcnt vmcnt(0)
    ds_read_b64_tr_b16 v[240:241], v3 offset:4096
    ds_read_b64_tr_b16 v[242:243], v3 offset:4352
    ds_read_b64_tr_b16 v[244:245], v3 offset:5120
    ds_read_b64_tr_b16 v[246:247], v3 offset:5376
    ds_read_b64_tr_b16 v[248:249], v3 offset:6144
    ds_read_b64_tr_b16 v[250:251], v3 offset:6400
    ds_read_b64_tr_b16 v[252:253], v3 offset:7168
    ds_read_b64_tr_b16 v[254:255], v3 offset:7424
    s_waitcnt lgkmcnt(0)
    s_barrier
    s_lshl_b32 s42, s14, 12
    v_add_u32 v4, s42, v1
    s_lshl_b32 s42, s14, 10
    v_add_u32 v5, s42, v1
    v_lshrrev_b32 v6, 1, v5
    v_add_u32 v6, 131072, v6
    v_and_b32 v8, 31, v0
    v_mul_u32_u24 v7, 1152, v8
    v_lshrrev_b32 v8, 5, v0
    v_lshl_add_u32 v7, v8, 3, v7
    s_lshl_b32 s42, s16, 6
    s_lshl_b32 s43, s14, 4
    s_add_u32 s42, s42, s43
    v_add_u32 v7, s42, v7
    v_min_u32 v3, 17, v0
    v_lshlrev_b32 v3, 7, v3
    s_mov_b64 s[30:31], -1
    s_mov_b32 s28, 0
    s_mov_b32 s34, 0x1010101
    s_mov_b32 s35, 0x1010101
    s_mov_b32 s28, 63
    s_cmp_eq_u32 s17, 1
    s_cmov_b32 s34, 0x2020202
    s_cmov_b32 s35, 0x2020202
    s_cmov_b32 s28, 127
    s_cmp_eq_u32 s17, 2
    s_cmov_b32 s34, 0x4040404
    s_cmov_b32 s35, 0x4040404
    s_cmov_b32 s28, 0
    s_cmp_eq_u32 s17, 3
    s_cmov_b32 s34, 0x8080808
    s_cmov_b32 s35, 0x8080808
    s_cmov_b32 s28, 0
    s_cmp_eq_u32 s17, 4
    s_cmov_b32 s34, 0x10101010
    s_cmov_b32 s35, 0x10101010
    s_cmov_b32 s28, 0
    s_cmp_eq_u32 s17, 5
    s_cmov_b32 s34, 0x20202020
    s_cmov_b32 s35, 0x20202020
    s_cmov_b32 s28, 0
    s_cmp_eq_u32 s17, 6
    s_cmov_b32 s34, 0x40404040
    s_cmov_b32 s35, 0x40404040
    s_cmov_b32 s28, 62
    s_cmp_eq_u32 s17, 7
    s_cmov_b32 s34, 0x80808080
    s_cmov_b32 s35, 0x80808080
    s_cmov_b32 s28, 126
    s_ff1_i32_b64 s20, s[34:35]
    s_bitset0_b64 s[34:35], s20
sg_171:
    s_mul_hi_u32 s24, s20, 1431655766
    s_mul_i32 s42, s24, 3
    s_sub_u32 s42, s20, s42
    s_lshl_b32 s42, s42, 14
    s_add_u32 s23, s42, 116414464
    s_add_u32 s24, s24, 1
    s_mov_b32 s41, 0
sp_176:
    buffer_load_dword v2, v3, s[4:7], s23 offen sc1
    s_waitcnt vmcnt(0)
    v_cmp_gt_u32 vcc, s24, v2
    s_nop 0
    s_cmp_eq_u64 vcc, 0
    s_cbranch_scc1 sp_177
    s_sleep 40
    s_add_u32 s41, s41, 1
    s_cmp_lt_u32 s41, 2000000
    s_cbranch_scc1 sp_176
    s_branch fin2
sp_177:
    s_mul_i32 s21, s20, 294912
    s_mul_i32 s42, s14, 73728
    s_add_u32 s21, s21, s42
    s_add_u32 s21, s21, 54525952
    buffer_load_dwordx4 v[64:67], v1, s[4:7], s21 offen offset:0 sc1
    buffer_load_dwordx4 v[68:71], v1, s[4:7], s21 offen offset:1024 sc1
    buffer_load_dwordx4 v[72:75], v1, s[4:7], s21 offen offset:2048 sc1
    buffer_load_dwordx4 v[76:79], v1, s[4:7], s21 offen offset:3072 sc1
    s_add_u32 s21, s21, 4096
    buffer_load_dwordx4 v[80:83], v1, s[4:7], s21 offen offset:0 sc1
    buffer_load_dwordx4 v[84:87], v1, s[4:7], s21 offen offset:1024 sc1
    buffer_load_dwordx4 v[88:91], v1, s[4:7], s21 offen offset:2048 sc1
    buffer_load_dwordx4 v[92:95], v1, s[4:7], s21 offen offset:3072 sc1
    s_add_u32 s21, s21, 4096
    buffer_load_dwordx4 v[96:99], v1, s[4:7], s21 offen offset:0 sc1
    buffer_load_dwordx4 v[100:103], v1, s[4:7], s21 offen offset:1024 sc1
    buffer_load_dwordx4 v[104:107], v1, s[4:7], s21 offen offset:2048 sc1
    buffer_load_dwordx4 v[108:111], v1, s[4:7], s21 offen offset:3072 sc1
    s_add_u32 s21, s21, 4096
    buffer_load_dwordx4 v[112:115], v1, s[4:7], s21 offen offset:0 sc1
    buffer_load_dwordx4 v[116:119], v1, s[4:7], s21 offen offset:1024 sc1
    buffer_load_dwordx4 v[120:123], v1, s[4:7], s21 offen offset:2048 sc1
    buffer_load_dwordx4 v[124:127], v1, s[4:7], s21 offen offset:3072 sc1
    s_add_u32 s21, s21, 4096
    buffer_load_dwordx4 v[128:131], v1, s[4:7], s21 offen offset:0 sc1
    buffer_load_dwordx4 v[132:135], v1, s[4:7], s21 offen offset:1024 sc1
    buffer_load_dwordx4 v[136:139], v1, s[4:7], s21 offen offset:2048 sc1
    buffer_load_dwordx4 v[140:143], v1, s[4:7], s21 offen offset:3072 sc1
    s_add_u32 s21, s21, 4096
    buffer_load_dwordx4 v[144:147], v1, s[4:7], s21 offen offset:0 sc1
    buffer_load_dwordx4 v[148:151], v1, s[4:7], s21 offen offset:1024 sc1
    buffer_load_dwordx4 v[152:155], v1, s[4:7], s21 offen offset:2048 sc1
    buffer_load_dwordx4 v[156:159], v1, s[4:7], s21 offen offset:3072 sc1
    s_add_u32 s21, s21, 4096
    buffer_load_dwordx4 v[160:163], v1, s[4:7], s21 offen offset:0 sc1
    buffer_load_dwordx4 v[164:167], v1, s[4:7], s21 offen offset:1024 sc1
    buffer_load_dwordx4 v[168:171], v1, s[4:7], s21 offen offset:2048 sc1
    buffer_load_dwordx4 v[172:175], v1, s[4:7], s21 offen offset:3072 sc1
    s_add_u32 s21, s21, 4096
    buffer_load_dwordx4 v[176:179], v1, s[4:7], s21 offen offset:0 sc1
    buffer_load_dwordx4 v[180:183], v1, s[4:7], s21 offen offset:1024 sc1
    buffer_load_dwordx4 v[184:187], v1, s[4:7], s21 offen offset:2048 sc1
    buffer_load_dwordx4 v[188:191], v1, s[4:7], s21 offen offset:3072 sc1
    s_add_u32 s21, s21, 4096
    buffer_load_dwordx4 v[192:195], v1, s[4:7], s21 offen offset:0 sc1
    buffer_load_dwordx4 v[196:199], v1, s[4:7], s21 offen offset:1024 sc1
    buffer_load_dwordx4 v[200:203], v1, s[4:7], s21 offen offset:2048 sc1
    buffer_load_dwordx4 v[204:207], v1, s[4:7], s21 offen offset:3072 sc1
    s_add_u32 s21, s21, 4096
sg_172:
    s_ff1_i32_b64 s25, s[34:35]
    s_bitset0_b64 s[34:35], s25
    s_and_b32 s44, s25, 63
    s_mul_hi_u32 s24, s44, 1431655766
    s_mul_i32 s42, s24, 3
    s_sub_u32 s42, s44, s42
    s_lshl_b32 s42, s42, 14
    s_add_u32 s23, s42, 116414464
    s_add_u32 s24, s24, 1
    s_mul_i32 s22, s44, 294912
    s_mul_i32 s42, s14, 73728
    s_add_u32 s22, s22, s42
    s_add_u32 s22, s22, 54525952
    s_mul_i32 s26, s20, 36864
    s_waitcnt vmcnt(35)
    v_mfma_f32_32x32x16_bf16 v[16:31], a[0:3], v[64:67], 0
    buffer_load_dwordx4 v[64:67], v1, s[4:7], s21 offen offset:0 sc1
    buffer_load_dword v2, v3, s[4:7], s23 offen sc1
    s_waitcnt vmcnt(35)
    v_mfma_f32_32x32x16_bf16 v[32:47], a[4:7], v[68:71], 0
    buffer_load_dwordx4 v[68:71], v1, s[4:7], s21 offen offset:1024 sc1
    s_waitcnt vmcnt(35)
    v_mfma_f32_32x32x16_bf16 v[16:31], a[8:11], v[72:75], v[16:31]
    buffer_load_dwordx4 v[72:75], v1, s[4:7], s21 offen offset:2048 sc1
    s_waitcnt vmcnt(35)
    v_mfma_f32_32x32x16_bf16 v[32:47], a[12:15], v[76:79], v[32:47]
    buffer_load_dwordx4 v[76:79], v1, s[4:7], s21 offen offset:3072 sc1
    s_add_u32 s21, s21, 4096
    s_waitcnt vmcnt(35)
    v_mfma_f32_32x32x16_bf16 v[16:31], a[16:19], v[80:83], v[16:31]
    buffer_load_dwordx4 v[80:83], v1, s[4:7], s21 offen offset:0 sc1
    s_waitcnt vmcnt(35)
    v_mfma_f32_32x32x16_bf16 v[32:47], a[20:23], v[84:87], v[32:47]
    buffer_load_dwordx4 v[84:87], v1, s[4:7], s21 offen offset:1024 sc1
    s_waitcnt vmcnt(35)
    v_mfma_f32_32x32x16_bf16 v[16:31], a[24:27], v[88:91], v[16:31]
    buffer_load_dwordx4 v[88:91], v1, s[4:7], s21 offen offset:2048 sc1
    s_waitcnt vmcnt(35)
    v_mfma_f32_32x32x16_bf16 v[32:47], a[28:31], v[92:95], v[32:47]
    buffer_load_dwordx4 v[92:95], v1, s[4:7], s21 offen offset:3072 sc1
    s_add_u32 s21, s21, 4096
    s_waitcnt vmcnt(35)
    v_mfma_f32_32x32x16_bf16 v[16:31], a[32:35], v[96:99], v[16:31]
    buffer_load_dwordx4 v[96:99], v1, s[4:7], s21 offen offset:0 sc1
    s_waitcnt vmcnt(35)
    v_mfma_f32_32x32x16_bf16 v[32:47], a[36:39], v[100:103], v[32:47]
    buffer_load_dwordx4 v[100:103], v1, s[4:7], s21 offen offset:1024 sc1
    s_waitcnt vmcnt(35)
    v_mfma_f32_32x32x16_bf16 v[16:31], a[40:43], v[104:107], v[16:31]
    buffer_load_dwordx4 v[104:107], v1, s[4:7], s21 offen offset:2048 sc1
    s_waitcnt vmcnt(35)
    v_mfma_f32_32x32x16_bf16 v[32:47], a[44:47], v[108:111], v[32:47]
    buffer_load_dwordx4 v[108:111], v1, s[4:7], s21 offen offset:3072 sc1
    s_add_u32 s21, s21, 4096
    s_waitcnt vmcnt(35)
    v_mfma_f32_32x32x16_bf16 v[16:31], a[48:51], v[112:115], v[16:31]
    buffer_load_dwordx4 v[112:115], v1, s[4:7], s21 offen offset:0 sc1
    s_waitcnt vmcnt(35)
    v_mfma_f32_32x32x16_bf16 v[32:47], a[52:55], v[116:119], v[32:47]
    buffer_load_dwordx4 v[116:119], v1, s[4:7], s21 offen offset:1024 sc1
    s_waitcnt vmcnt(35)
    v_mfma_f32_32x32x16_bf16 v[16:31], a[56:59], v[120:123], v[16:31]
    buffer_load_dwordx4 v[120:123], v1, s[4:7], s21 offen offset:2048 sc1
    s_waitcnt vmcnt(35)
    v_mfma_f32_32x32x16_bf16 v[32:47], a[60:63], v[124:127], v[32:47]
    buffer_load_dwordx4 v[124:127], v1, s[4:7], s21 offen offset:3072 sc1
    s_add_u32 s21, s21, 4096
    s_waitcnt vmcnt(35)
    v_mfma_f32_32x32x16_bf16 v[16:31], a[64:67], v[128:131], v[16:31]
    buffer_load_dwordx4 v[128:131], v1, s[4:7], s21 offen offset:0 sc1
    s_waitcnt vmcnt(35)
    v_mfma_f32_32x32x16_bf16 v[32:47], a[68:71], v[132:135], v[32:47]
    buffer_load_dwordx4 v[132:135], v1, s[4:7], s21 offen offset:1024 sc1
    s_waitcnt vmcnt(35)
    v_mfma_f32_32x32x16_bf16 v[16:31], a[72:75], v[136:139], v[16:31]
    buffer_load_dwordx4 v[136:139], v1, s[4:7], s21 offen offset:2048 sc1
    s_waitcnt vmcnt(35)
    v_mfma_f32_32x32x16_bf16 v[32:47], a[76:79], v[140:143], v[32:47]
    buffer_load_dwordx4 v[140:143], v1, s[4:7], s21 offen offset:3072 sc1
    s_add_u32 s21, s21, 4096
    s_waitcnt vmcnt(35)
    v_mfma_f32_32x32x16_bf16 v[16:31], a[80:83], v[144:147], v[16:31]
    buffer_load_dwordx4 v[144:147], v1, s[4:7], s21 offen offset:0 sc1
    s_waitcnt vmcnt(35)
    v_mfma_f32_32x32x16_bf16 v[32:47], a[84:87], v[148:151], v[32:47]
    buffer_load_dwordx4 v[148:151], v1, s[4:7], s21 offen offset:1024 sc1
    s_waitcnt vmcnt(35)
    v_mfma_f32_32x32x16_bf16 v[16:31], a[88:91], v[152:155], v[16:31]
    buffer_load_dwordx4 v[152:155], v1, s[4:7], s21 offen offset:2048 sc1
    s_waitcnt vmcnt(35)
    v_mfma_f32_32x32x16_bf16 v[32:47], a[92:95], v[156:159], v[32:47]
    buffer_load_dwordx4 v[156:159], v1, s[4:7], s21 offen offset:3072 sc1
    s_add_u32 s21, s21, 4096
    s_waitcnt vmcnt(35)
    v_mfma_f32_32x32x16_bf16 v[16:31], a[96:99], v[160:163], v[16:31]
    buffer_load_dwordx4 v[160:163], v1, s[4:7], s21 offen offset:0 sc1
    s_waitcnt vmcnt(35)
    v_mfma_f32_32x32x16_bf16 v[32:47], a[100:103], v[164:167], v[32:47]
    buffer_load_dwordx4 v[164:167], v1, s[4:7], s21 offen offset:1024 sc1
    s_waitcnt vmcnt(35)
    v_mfma_f32_32x32x16_bf16 v[16:31], a[104:107], v[168:171], v[16:31]
    buffer_load_dwordx4 v[168:171], v1, s[4:7], s21 offen offset:2048 sc1
    s_waitcnt vmcnt(35)
    v_mfma_f32_32x32x16_bf16 v[32:47], a[108:111], v[172:175], v[32:47]
    buffer_load_dwordx4 v[172:175], v1, s[4:7], s21 offen offset:3072 sc1
    s_add_u32 s21, s21, 4096
    s_waitcnt vmcnt(35)
    v_mfma_f32_32x32x16_bf16 v[16:31], a[112:115], v[176:179], v[16:31]
    buffer_load_dwordx4 v[176:179], v1, s[4:7], s21 offen offset:0 sc1
    s_waitcnt vmcnt(35)
    v_mfma_f32_32x32x16_bf16 v[32:47], a[116:119], v[180:183], v[32:47]
    buffer_load_dwordx4 v[180:183], v1, s[4:7], s21 offen offset:1024 sc1
    s_waitcnt vmcnt(35)
    v_mfma_f32_32x32x16_bf16 v[16:31], a[120:123], v[184:187], v[16:31]
    buffer_load_dwordx4 v[184:187], v1, s[4:7], s21 offen offset:2048 sc1
    s_waitcnt vmcnt(35)
    v_mfma_f32_32x32x16_bf16 v[32:47], a[124:127], v[188:191], v[32:47]
    buffer_load_dwordx4 v[188:191], v1, s[4:7], s21 offen offset:3072 sc1
    s_add_u32 s21, s21, 4096
    s_waitcnt vmcnt(35)
    v_mfma_f32_32x32x16_bf16 v[16:31], a[128:131], v[192:195], v[16:31]
    buffer_load_dwordx4 v[192:195], v1, s[4:7], s21 offen offset:0 sc1
    s_waitcnt vmcnt(35)
    v_mfma_f32_32x32x16_bf16 v[32:47], a[132:135], v[196:199], v[32:47]
    buffer_load_dwordx4 v[196:199], v1, s[4:7], s21 offen offset:1024 sc1
    s_waitcnt vmcnt(35)
    v_mfma_f32_32x32x16_bf16 v[16:31], a[136:139], v[200:203], v[16:31]
    buffer_load_dwordx4 v[200:203], v1, s[4:7], s21 offen offset:2048 sc1
    s_waitcnt vmcnt(35)
    v_mfma_f32_32x32x16_bf16 v[32:47], a[140:143], v[204:207], v[32:47]
    buffer_load_dwordx4 v[204:207], v1, s[4:7], s21 offen offset:3072 sc1
    s_add_u32 s21, s21, 4096
    s_waitcnt vmcnt(35)
    v_cmp_gt_u32 vcc, s24, v2
    s_nop 0
    s_cmp_eq_u64 vcc, 0
    s_cselect_b32 s27, 1, 0
    s_cmp_lt_u32 s25, 64
    s_cselect_b32 s27, s27, 0
    s_cmp_eq_u32 s27, 0
    s_cbranch_scc1 sg_173
    s_waitcnt vmcnt(35)
    v_mfma_f32_32x32x16_bf16 v[16:31], a[144:147], v[64:67], v[16:31]
    buffer_load_dwordx4 v[64:67], v1, s[4:7], s22 offen offset:0 sc1
    s_waitcnt vmcnt(35)
    v_mfma_f32_32x32x16_bf16 v[32:47], a[148:151], v[68:71], v[32:47]
    buffer_load_dwordx4 v[68:71], v1, s[4:7], s22 offen offset:1024 sc1
    s_waitcnt vmcnt(35)
    v_mfma_f32_32x32x16_bf16 v[16:31], a[152:155], v[72:75], v[16:31]
    buffer_load_dwordx4 v[72:75], v1, s[4:7], s22 offen offset:2048 sc1
    s_waitcnt vmcnt(35)
    v_mfma_f32_32x32x16_bf16 v[32:47], a[156:159], v[76:79], v[32:47]
    buffer_load_dwordx4 v[76:79], v1, s[4:7], s22 offen offset:3072 sc1
    s_add_u32 s22, s22, 4096
    s_waitcnt vmcnt(35)
    v_mfma_f32_32x32x16_bf16 v[16:31], a[160:163], v[80:83], v[16:31]
    buffer_load_dwordx4 v[80:83], v1, s[4:7], s22 offen offset:0 sc1
    s_waitcnt vmcnt(35)
    v_mfma_f32_32x32x16_bf16 v[32:47], a[164:167], v[84:87], v[32:47]
    buffer_load_dwordx4 v[84:87], v1, s[4:7], s22 offen offset:1024 sc1
    s_waitcnt vmcnt(35)
    v_mfma_f32_32x32x16_bf16 v[16:31], a[168:171], v[88:91], v[16:31]
    buffer_load_dwordx4 v[88:91], v1, s[4:7], s22 offen offset:2048 sc1
    s_waitcnt vmcnt(35)
    v_mfma_f32_32x32x16_bf16 v[32:47], a[172:175], v[92:95], v[32:47]
    buffer_load_dwordx4 v[92:95], v1, s[4:7], s22 offen offset:3072 sc1
    s_add_u32 s22, s22, 4096
    s_waitcnt vmcnt(35)
    v_mfma_f32_32x32x16_bf16 v[16:31], a[176:179], v[96:99], v[16:31]
    buffer_load_dwordx4 v[96:99], v1, s[4:7], s22 offen offset:0 sc1
    s_waitcnt vmcnt(35)
    v_mfma_f32_32x32x16_bf16 v[32:47], a[180:183], v[100:103], v[32:47]
    buffer_load_dwordx4 v[100:103], v1, s[4:7], s22 offen offset:1024 sc1
    s_waitcnt vmcnt(35)
    v_mfma_f32_32x32x16_bf16 v[16:31], a[184:187], v[104:107], v[16:31]
    buffer_load_dwordx4 v[104:107], v1, s[4:7], s22 offen offset:2048 sc1
    s_waitcnt vmcnt(35)
    v_mfma_f32_32x32x16_bf16 v[32:47], a[188:191], v[108:111], v[32:47]
    buffer_load_dwordx4 v[108:111], v1, s[4:7], s22 offen offset:3072 sc1
    s_add_u32 s22, s22, 4096
    s_waitcnt vmcnt(35)
    v_mfma_f32_32x32x16_bf16 v[16:31], a[192:195], v[112:115], v[16:31]
    buffer_load_dwordx4 v[112:115], v1, s[4:7], s22 offen offset:0 sc1
    s_waitcnt vmcnt(35)
    v_mfma_f32_32x32x16_bf16 v[32:47], a[196:199], v[116:119], v[32:47]
    buffer_load_dwordx4 v[116:119], v1, s[4:7], s22 offen offset:1024 sc1
    s_waitcnt vmcnt(35)
    v_mfma_f32_32x32x16_bf16 v[16:31], a[200:203], v[120:123], v[16:31]
    buffer_load_dwordx4 v[120:123], v1, s[4:7], s22 offen offset:2048 sc1
    s_waitcnt vmcnt(35)
    v_mfma_f32_32x32x16_bf16 v[32:47], a[204:207], v[124:127], v[32:47]
    buffer_load_dwordx4 v[124:127], v1, s[4:7], s22 offen offset:3072 sc1
    s_add_u32 s22, s22, 4096
    s_waitcnt vmcnt(35)
    v_mfma_f32_32x32x16_bf16 v[16:31], a[208:211], v[128:131], v[16:31]
    buffer_load_dwordx4 v[128:131], v1, s[4:7], s22 offen offset:0 sc1
    s_waitcnt vmcnt(35)
    v_mfma_f32_32x32x16_bf16 v[32:47], a[212:215], v[132:135], v[32:47]
    buffer_load_dwordx4 v[132:135], v1, s[4:7], s22 offen offset:1024 sc1
    s_waitcnt vmcnt(35)
    v_mfma_f32_32x32x16_bf16 v[16:31], a[216:219], v[136:139], v[16:31]
    buffer_load_dwordx4 v[136:139], v1, s[4:7], s22 offen offset:2048 sc1
    s_waitcnt vmcnt(35)
    v_mfma_f32_32x32x16_bf16 v[32:47], a[220:223], v[140:143], v[32:47]
    buffer_load_dwordx4 v[140:143], v1, s[4:7], s22 offen offset:3072 sc1
    s_add_u32 s22, s22, 4096
    s_waitcnt vmcnt(35)
    v_mfma_f32_32x32x16_bf16 v[16:31], a[224:227], v[144:147], v[16:31]
    buffer_load_dwordx4 v[144:147], v1, s[4:7], s22 offen offset:0 sc1
    s_waitcnt vmcnt(35)
    v_mfma_f32_32x32x16_bf16 v[32:47], a[228:231], v[148:151], v[32:47]
    buffer_load_dwordx4 v[148:151], v1, s[4:7], s22 offen offset:1024 sc1
    s_waitcnt vmcnt(35)
    v_mfma_f32_32x32x16_bf16 v[16:31], a[232:235], v[152:155], v[16:31]
    buffer_load_dwordx4 v[152:155], v1, s[4:7], s22 offen offset:2048 sc1
    s_waitcnt vmcnt(35)
    v_mfma_f32_32x32x16_bf16 v[32:47], a[236:239], v[156:159], v[32:47]
    buffer_load_dwordx4 v[156:159], v1, s[4:7], s22 offen offset:3072 sc1
    s_add_u32 s22, s22, 4096
    s_waitcnt vmcnt(35)
    v_mfma_f32_32x32x16_bf16 v[16:31], a[240:243], v[160:163], v[16:31]
    buffer_load_dwordx4 v[160:163], v1, s[4:7], s22 offen offset:0 sc1
    s_waitcnt vmcnt(35)
    v_mfma_f32_32x32x16_bf16 v[32:47], a[244:247], v[164:167], v[32:47]
    buffer_load_dwordx4 v[164:167], v1, s[4:7], s22 offen offset:1024 sc1
    s_waitcnt vmcnt(35)
    v_mfma_f32_32x32x16_bf16 v[16:31], a[248:251], v[168:171], v[16:31]
    buffer_load_dwordx4 v[168:171], v1, s[4:7], s22 offen offset:2048 sc1
    s_waitcnt vmcnt(35)
    v_mfma_f32_32x32x16_bf16 v[32:47], a[252:255], v[172:175], v[32:47]
    buffer_load_dwordx4 v[172:175], v1, s[4:7], s22 offen offset:3072 sc1
    s_add_u32 s22, s22, 4096
    s_waitcnt vmcnt(35)
    v_mfma_f32_32x32x16_bf16 v[16:31], v[224:227], v[176:179], v[16:31]
    buffer_load_dwordx4 v[176:179], v1, s[4:7], s22 offen offset:0 sc1
    s_waitcnt vmcnt(35)
    v_mfma_f32_32x32x16_bf16 v[32:47], v[228:231], v[180:183], v[32:47]
    buffer_load_dwordx4 v[180:183], v1, s[4:7], s22 offen offset:1024 sc1
    s_waitcnt vmcnt(35)
    v_mfma_f32_32x32x16_bf16 v[16:31], v[232:235], v[184:187], v[16:31]
    buffer_load_dwordx4 v[184:187], v1, s[4:7], s22 offen offset:2048 sc1
    s_waitcnt vmcnt(35)
    v_mfma_f32_32x32x16_bf16 v[32:47], v[236:239], v[188:191], v[32:47]
    buffer_load_dwordx4 v[188:191], v1, s[4:7], s22 offen offset:3072 sc1
    s_add_u32 s22, s22, 4096
    s_waitcnt vmcnt(35)
    v_mfma_f32_32x32x16_bf16 v[16:31], v[240:243], v[192:195], v[16:31]
    buffer_load_dwordx4 v[192:195], v1, s[4:7], s22 offen offset:0 sc1
    s_waitcnt vmcnt(35)
    v_mfma_f32_32x32x16_bf16 v[32:47], v[244:247], v[196:199], v[32:47]
    buffer_load_dwordx4 v[196:199], v1, s[4:7], s22 offen offset:1024 sc1
    s_waitcnt vmcnt(35)
    v_mfma_f32_32x32x16_bf16 v[16:31], v[248:251], v[200:203], v[16:31]
    buffer_load_dwordx4 v[200:203], v1, s[4:7], s22 offen offset:2048 sc1
    s_waitcnt vmcnt(35)
    v_mfma_f32_32x32x16_bf16 v[32:47], v[252:255], v[204:207], v[32:47]
    buffer_load_dwordx4 v[204:207], v1, s[4:7], s22 offen offset:3072 sc1
    s_add_u32 s22, s22, 4096
    s_mov_b32 s21, s22
    s_nop 8
    s_branch sg_174
sg_173:
    s_waitcnt vmcnt(35)
    v_mfma_f32_32x32x16_bf16 v[16:31], a[144:147], v[64:67], v[16:31]
    s_waitcnt vmcnt(34)
    v_mfma_f32_32x32x16_bf16 v[32:47], a[148:151], v[68:71], v[32:47]
    s_waitcnt vmcnt(33)
    v_mfma_f32_32x32x16_bf16 v[16:31], a[152:155], v[72:75], v[16:31]
    s_waitcnt vmcnt(32)
    v_mfma_f32_32x32x16_bf16 v[32:47], a[156:159], v[76:79], v[32:47]
    s_waitcnt vmcnt(31)
    v_mfma_f32_32x32x16_bf16 v[16:31], a[160:163], v[80:83], v[16:31]
    s_waitcnt vmcnt(30)
    v_mfma_f32_32x32x16_bf16 v[32:47], a[164:167], v[84:87], v[32:47]
    s_waitcnt vmcnt(29)
    v_mfma_f32_32x32x16_bf16 v[16:31], a[168:171], v[88:91], v[16:31]
    s_waitcnt vmcnt(28)
    v_mfma_f32_32x32x16_bf16 v[32:47], a[172:175], v[92:95], v[32:47]
    s_waitcnt vmcnt(27)
    v_mfma_f32_32x32x16_bf16 v[16:31], a[176:179], v[96:99], v[16:31]
    s_waitcnt vmcnt(26)
    v_mfma_f32_32x32x16_bf16 v[32:47], a[180:183], v[100:103], v[32:47]
    s_waitcnt vmcnt(25)
    v_mfma_f32_32x32x16_bf16 v[16:31], a[184:187], v[104:107], v[16:31]
    s_waitcnt vmcnt(24)
    v_mfma_f32_32x32x16_bf16 v[32:47], a[188:191], v[108:111], v[32:47]
    s_waitcnt vmcnt(23)
    v_mfma_f32_32x32x16_bf16 v[16:31], a[192:195], v[112:115], v[16:31]
    s_waitcnt vmcnt(22)
    v_mfma_f32_32x32x16_bf16 v[32:47], a[196:199], v[116:119], v[32:47]
    s_waitcnt vmcnt(21)
    v_mfma_f32_32x32x16_bf16 v[16:31], a[200:203], v[120:123], v[16:31]
    s_waitcnt vmcnt(20)
    v_mfma_f32_32x32x16_bf16 v[32:47], a[204:207], v[124:127], v[32:47]
    s_waitcnt vmcnt(19)
    v_mfma_f32_32x32x16_bf16 v[16:31], a[208:211], v[128:131], v[16:31]
    s_waitcnt vmcnt(18)
    v_mfma_f32_32x32x16_bf16 v[32:47], a[212:215], v[132:135], v[32:47]
    s_waitcnt vmcnt(17)
    v_mfma_f32_32x32x16_bf16 v[16:31], a[216:219], v[136:139], v[16:31]
    s_waitcnt vmcnt(16)
    v_mfma_f32_32x32x16_bf16 v[32:47], a[220:223], v[140:143], v[32:47]
    s_waitcnt vmcnt(15)
    v_mfma_f32_32x32x16_bf16 v[16:31], a[224:227], v[144:147], v[16:31]
    s_waitcnt vmcnt(14)
    v_mfma_f32_32x32x16_bf16 v[32:47], a[228:231], v[148:151], v[32:47]
    s_waitcnt vmcnt(13)
    v_mfma_f32_32x32x16_bf16 v[16:31], a[232:235], v[152:155], v[16:31]
    s_waitcnt vmcnt(12)
    v_mfma_f32_32x32x16_bf16 v[32:47], a[236:239], v[156:159], v[32:47]
    s_waitcnt vmcnt(11)
    v_mfma_f32_32x32x16_bf16 v[16:31], a[240:243], v[160:163], v[16:31]
    s_waitcnt vmcnt(10)
    v_mfma_f32_32x32x16_bf16 v[32:47], a[244:247], v[164:167], v[32:47]
    s_waitcnt vmcnt(9)
    v_mfma_f32_32x32x16_bf16 v[16:31], a[248:251], v[168:171], v[16:31]
    s_waitcnt vmcnt(8)
    v_mfma_f32_32x32x16_bf16 v[32:47], a[252:255], v[172:175], v[32:47]
    s_waitcnt vmcnt(7)
    v_mfma_f32_32x32x16_bf16 v[16:31], v[224:227], v[176:179], v[16:31]
    s_waitcnt vmcnt(6)
    v_mfma_f32_32x32x16_bf16 v[32:47], v[228:231], v[180:183], v[32:47]
    s_waitcnt vmcnt(5)
    v_mfma_f32_32x32x16_bf16 v[16:31], v[232:235], v[184:187], v[16:31]
    s_waitcnt vmcnt(4)
    v_mfma_f32_32x32x16_bf16 v[32:47], v[236:239], v[188:191], v[32:47]
    s_waitcnt vmcnt(3)
    v_mfma_f32_32x32x16_bf16 v[16:31], v[240:243], v[192:195], v[16:31]
    s_waitcnt vmcnt(2)
    v_mfma_f32_32x32x16_bf16 v[32:47], v[244:247], v[196:199], v[32:47]
    s_waitcnt vmcnt(1)
    v_mfma_f32_32x32x16_bf16 v[16:31], v[248:251], v[200:203], v[16:31]
    s_waitcnt vmcnt(0)
    v_mfma_f32_32x32x16_bf16 v[32:47], v[252:255], v[204:207], v[32:47]
    s_nop 11
sg_174:
    v_pk_add_f32 v[16:17], v[16:17], v[32:33]
    v_pk_add_f32 v[18:19], v[18:19], v[34:35]
    v_pk_add_f32 v[20:21], v[20:21], v[36:37]
    v_pk_add_f32 v[22:23], v[22:23], v[38:39]
    v_pk_add_f32 v[24:25], v[24:25], v[40:41]
    v_pk_add_f32 v[26:27], v[26:27], v[42:43]
    v_pk_add_f32 v[28:29], v[28:29], v[44:45]
    v_pk_add_f32 v[30:31], v[30:31], v[46:47]
    ds_write_b128 v4, v[16:19] offset:0
    ds_write_b128 v4, v[20:23] offset:1024
    ds_write_b128 v4, v[24:27] offset:2048
    ds_write_b128 v4, v[28:31] offset:3072
    s_waitcnt lgkmcnt(0)
    s_barrier
    ds_read_b128 v[16:19], v5 offset:0
    ds_read_b128 v[20:23], v5 offset:4096
    ds_read_b128 v[24:27], v5 offset:8192
    ds_read_b128 v[28:31], v5 offset:12288
    v_xor_b32 v4, 0x4000, v4
    v_xor_b32 v5, 0x4000, v5
    s_waitcnt lgkmcnt(0)
sf_178:
    v_pk_add_f32 v[16:17], v[16:17], v[20:21]
    v_pk_add_f32 v[24:25], v[24:25], v[28:29]
    v_pk_add_f32 v[18:19], v[18:19], v[22:23]
    v_pk_add_f32 v[26:27], v[26:27], v[30:31]
    v_pk_add_f32 v[16:17], v[16:17], v[24:25]
    v_pk_add_f32 v[18:19], v[18:19], v[26:27]
    v_cvt_pk_bf16_f32 v20, v16, v17
    v_cvt_pk_bf16_f32 v21, v18, v19
    v_lshlrev_b32 v8, 16, v20
    v_lshlrev_b32 v12, 16, v21
    v_and_b32 v9, 0xffff0000, v20
    v_and_b32 v13, 0xffff0000, v21
    v_mul_f32 v10, 0xbfb8aa3b, v8
    v_mul_f32 v14, 0xbfb8aa3b, v12
    v_mul_f32 v11, 0xbfb8aa3b, v9
    v_mul_f32 v15, 0xbfb8aa3b, v13
    v_exp_f32 v10, v10
    v_exp_f32 v14, v14
    v_exp_f32 v11, v11
    v_exp_f32 v15, v15
    v_add_f32 v10, 1.0, v10
    v_add_f32 v14, 1.0, v14
    v_add_f32 v11, 1.0, v11
    v_add_f32 v15, 1.0, v15
    v_rcp_f32 v10, v10
    v_rcp_f32 v14, v14
    v_rcp_f32 v11, v11
    v_rcp_f32 v15, v15
    v_mul_f32 v8, v8, v10
    v_mul_f32 v12, v12, v14
    v_mul_f32 v9, v9, v11
    v_mul_f32 v13, v13, v15
    v_cvt_pk_bf16_f32 v20, v8, v9
    v_cvt_pk_bf16_f32 v21, v12, v13
    ds_write_b64 v6, v[20:21]
    s_cmp_lt_u32 s20, 62
    s_cbranch_scc1 ng_179
    s_and_b32 s43, s20, 1
    s_lshl_b32 s43, s43, 5
    s_add_u32 s43, s43, s16
    s_lshl_b32 s43, s43, 2
    s_add_u32 s43, s43, s14
    s_lshl_b32 s43, s43, 9
    s_add_u32 s43, s43, 92274688
    v_lshlrev_b32 v11, 3, v0
    v_min_u32 v20, -2, v20
    buffer_store_dwordx2 v[20:21], v11, s[4:7], s43 offen sc1
ng_179:
    v_add_u32 v6, 2048, v6
    s_mov_b32 s20, s25
    s_cmp_eq_u32 s27, 1
    s_cbranch_scc1 sg_172
    s_cmp_lt_u32 s20, 64
    s_cbranch_scc1 sg_171
    s_waitcnt lgkmcnt(0)
    s_mov_b32 s8, s56
    s_mov_b32 s9, s57
    s_mov_b32 s10, 4718592
    s_mov_b32 s11, 0x20000
    s_mov_b32 s19, 1152
    s_mul_i32 s18, s14, 1179648
    s_lshl_b32 s42, s16, 6
    s_add_u32 s18, s18, s42
    s_barrier
    v_lshrrev_b32 v4, 2, v0
    v_mul_lo_u32 v2, v4, s19
    v_and_b32 v4, 3, v0
    v_lshl_add_u32 v2, v4, 4, v2
    v_lshrrev_b32 v4, 5, v0
    v_bfe_u32 v5, v0, 2, 2
    v_lshl_add_u32 v4, v4, 3, v5
    v_mul_u32_u24 v3, 64, v4
    v_bfe_u32 v4, v0, 4, 1
    v_lshl_add_u32 v3, v4, 5, v3
    v_and_b32 v4, 3, v0
    v_lshl_add_u32 v3, v4, 3, v3
    s_mul_i32 s44, s14, 32768
    v_add_u32 v3, s44, v3
    s_mul_i32 s43, s19, 16
    s_mov_b32 s42, s18
    s_add_u32 m0, s44, 0
    s_nop 0
    buffer_load_dwordx4 v2, s[8:11], s42 offen  lds
    s_add_u32 s42, s42, s43
    s_add_u32 m0, s44, 1024
    s_nop 0
    buffer_load_dwordx4 v2, s[8:11], s42 offen  lds
    s_add_u32 s42, s42, s43
    s_add_u32 m0, s44, 2048
    s_nop 0
    buffer_load_dwordx4 v2, s[8:11], s42 offen  lds
    s_add_u32 s42, s42, s43
    s_add_u32 m0, s44, 3072
    s_nop 0
    buffer_load_dwordx4 v2, s[8:11], s42 offen  lds
    s_add_u32 s42, s42, s43
    s_add_u32 m0, s44, 4096
    s_nop 0
    buffer_load_dwordx4 v2, s[8:11], s42 offen  lds
    s_add_u32 s42, s42, s43
    s_add_u32 m0, s44, 5120
    s_nop 0
    buffer_load_dwordx4 v2, s[8:11], s42 offen  lds
    s_add_u32 s42, s42, s43
    s_add_u32 m0, s44, 6144
    s_nop 0
    buffer_load_dwordx4 v2, s[8:11], s42 offen  lds
    s_add_u32 s42, s42, s43
    s_add_u32 m0, s44, 7168
    s_nop 0
    buffer_load_dwordx4 v2, s[8:11], s42 offen  lds
    s_add_u32 s42, s42, s43
    s_add_u32 m0, s44, 8192
    s_nop 0
    buffer_load_dwordx4 v2, s[8:11], s42 offen  lds
    s_add_u32 s42, s42, s43
    s_add_u32 m0, s44, 9216
    s_nop 0
    buffer_load_dwordx4 v2, s[8:11], s42 offen  lds
    s_add_u32 s42, s42, s43
    s_add_u32 m0, s44, 10240
    s_nop 0
    buffer_load_dwordx4 v2, s[8:11], s42 offen  lds
    s_add_u32 s42, s42, s43
    s_add_u32 m0, s44, 11264
    s_nop 0
    buffer_load_dwordx4 v2, s[8:11], s42 offen  lds
    s_add_u32 s42, s42, s43
    s_add_u32 m0, s44, 12288
    s_nop 0
    buffer_load_dwordx4 v2, s[8:11], s42 offen  lds
    s_add_u32 s42, s42, s43
    s_add_u32 m0, s44, 13312
    s_nop 0
    buffer_load_dwordx4 v2, s[8:11], s42 offen  lds
    s_add_u32 s42, s42, s43
    s_add_u32 m0, s44, 14336
    s_nop 0
    buffer_load_dwordx4 v2, s[8:11], s42 offen  lds
    s_add_u32 s42, s42, s43
    s_add_u32 m0, s44, 15360
    s_nop 0
    buffer_load_dwordx4 v2, s[8:11], s42 offen  lds
    s_add_u32 s42, s42, s43
    s_add_u32 m0, s44, 16384
    s_nop 0
    buffer_load_dwordx4 v2, s[8:11], s42 offen  lds
    s_add_u32 s42, s42, s43
    s_add_u32 m0, s44, 17408
    s_nop 0
    buffer_load_dwordx4 v2, s[8:11], s42 offen  lds
    s_add_u32 s42, s42, s43
    s_add_u32 m0, s44, 18432
    s_nop 0
    buffer_load_dwordx4 v2, s[8:11], s42 offen  lds
    s_add_u32 s42, s42, s43
    s_add_u32 m0, s44, 19456
    s_nop 0
    buffer_load_dwordx4 v2, s[8:11], s42 offen  lds
    s_add_u32 s42, s42, s43
    s_add_u32 m0, s44, 20480
    s_nop 0
    buffer_load_dwordx4 v2, s[8:11], s42 offen  lds
    s_add_u32 s42, s42, s43
    s_add_u32 m0, s44, 21504
    s_nop 0
    buffer_load_dwordx4 v2, s[8:11], s42 offen  lds
    s_add_u32 s42, s42, s43
    s_add_u32 m0, s44, 22528
    s_nop 0
    buffer_load_dwordx4 v2, s[8:11], s42 offen  lds
    s_add_u32 s42, s42, s43
    s_add_u32 m0, s44, 23552
    s_nop 0
    buffer_load_dwordx4 v2, s[8:11], s42 offen  lds
    s_add_u32 s42, s42, s43
    s_add_u32 m0, s44, 24576
    s_nop 0
    buffer_load_dwordx4 v2, s[8:11], s42 offen  lds
    s_add_u32 s42, s42, s43
    s_add_u32 m0, s44, 25600
    s_nop 0
    buffer_load_dwordx4 v2, s[8:11], s42 offen  lds
    s_add_u32 s42, s42, s43
    s_add_u32 m0, s44, 26624
    s_nop 0
    buffer_load_dwordx4 v2, s[8:11], s42 offen  lds
    s_add_u32 s42, s42, s43
    s_add_u32 m0, s44, 27648
    s_nop 0
    buffer_load_dwordx4 v2, s[8:11], s42 offen  lds
    s_add_u32 s42, s42, s43
    s_add_u32 m0, s44, 28672
    s_nop 0
    buffer_load_dwordx4 v2, s[8:11], s42 offen  lds
    s_add_u32 s42, s42, s43
    s_add_u32 m0, s44, 29696
    s_nop 0
    buffer_load_dwordx4 v2, s[8:11], s42 offen  lds
    s_add_u32 s42, s42, s43
    s_add_u32 m0, s44, 30720
    s_nop 0
    buffer_load_dwordx4 v2, s[8:11], s42 offen  lds
    s_add_u32 s42, s42, s43
    s_add_u32 m0, s44, 31744
    s_nop 0
    buffer_load_dwordx4 v2, s[8:11], s42 offen  lds
    s_add_u32 s42, s42, s43
    s_waitcnt vmcnt(28)
    ds_read_b64_tr_b16 a[0:1], v3 offset:0
    ds_read_b64_tr_b16 a[2:3], v3 offset:256
    ds_read_b64_tr_b16 a[4:5], v3 offset:1024
    ds_read_b64_tr_b16 a[6:7], v3 offset:1280
    ds_read_b64_tr_b16 a[8:9], v3 offset:2048
    ds_read_b64_tr_b16 a[10:11], v3 offset:2304
    ds_read_b64_tr_b16 a[12:13], v3 offset:3072
    ds_read_b64_tr_b16 a[14:15], v3 offset:3328
    s_waitcnt lgkmcnt(0)
    s_add_u32 m0, s44, 0
    s_nop 0
    buffer_load_dwordx4 v2, s[8:11], s42 offen  lds
    s_add_u32 s42, s42, s43
    s_add_u32 m0, s44, 1024
    s_nop 0
    buffer_load_dwordx4 v2, s[8:11], s42 offen  lds
    s_add_u32 s42, s42, s43
    s_add_u32 m0, s44, 2048
    s_nop 0
    buffer_load_dwordx4 v2, s[8:11], s42 offen  lds
    s_add_u32 s42, s42, s43
    s_add_u32 m0, s44, 3072
    s_nop 0
    buffer_load_dwordx4 v2, s[8:11], s42 offen  lds
    s_add_u32 s42, s42, s43
    s_waitcnt vmcnt(28)
    ds_read_b64_tr_b16 a[16:17], v3 offset:4096
    ds_read_b64_tr_b16 a[18:19], v3 offset:4352
    ds_read_b64_tr_b16 a[20:21], v3 offset:5120
    ds_read_b64_tr_b16 a[22:23], v3 offset:5376
    ds_read_b64_tr_b16 a[24:25], v3 offset:6144
    ds_read_b64_tr_b16 a[26:27], v3 offset:6400
    ds_read_b64_tr_b16 a[28:29], v3 offset:7168
    ds_read_b64_tr_b16 a[30:31], v3 offset:7424
    s_waitcnt lgkmcnt(0)
    s_add_u32 m0, s44, 4096
    s_nop 0
    buffer_load_dwordx4 v2, s[8:11], s42 offen  lds
    s_add_u32 s42, s42, s43
    s_add_u32 m0, s44, 5120
    s_nop 0
    buffer_load_dwordx4 v2, s[8:11], s42 offen  lds
    s_add_u32 s42, s42, s43
    s_add_u32 m0, s44, 6144
    s_nop 0
    buffer_load_dwordx4 v2, s[8:11], s42 offen  lds
    s_add_u32 s42, s42, s43
    s_add_u32 m0, s44, 7168
    s_nop 0
    buffer_load_dwordx4 v2, s[8:11], s42 offen  lds
    s_add_u32 s42, s42, s43
    s_waitcnt vmcnt(28)
    ds_read_b64_tr_b16 a[32:33], v3 offset:8192
    ds_read_b64_tr_b16 a[34:35], v3 offset:8448
    ds_read_b64_tr_b16 a[36:37], v3 offset:9216
    ds_read_b64_tr_b16 a[38:39], v3 offset:9472
    ds_read_b64_tr_b16 a[40:41], v3 offset:10240
    ds_read_b64_tr_b16 a[42:43], v3 offset:10496
    ds_read_b64_tr_b16 a[44:45], v3 offset:11264
    ds_read_b64_tr_b16 a[46:47], v3 offset:11520
    s_waitcnt lgkmcnt(0)
    s_add_u32 m0, s44, 8192
    s_nop 0
    buffer_load_dwordx4 v2, s[8:11], s42 offen  lds
    s_add_u32 s42, s42, s43
    s_add_u32 m0, s44, 9216
    s_nop 0
    buffer_load_dwordx4 v2, s[8:11], s42 offen  lds
    s_add_u32 s42, s42, s43
    s_add_u32 m0, s44, 10240
    s_nop 0
    buffer_load_dwordx4 v2, s[8:11], s42 offen  lds
    s_add_u32 s42, s42, s43
    s_add_u32 m0, s44, 11264
    s_nop 0
    buffer_load_dwordx4 v2, s[8:11], s42 offen  lds
    s_add_u32 s42, s42, s43
    s_waitcnt vmcnt(28)
    ds_read_b64_tr_b16 a[48:49], v3 offset:12288
    ds_read_b64_tr_b16 a[50:51], v3 offset:12544
    ds_read_b64_tr_b16 a[52:53], v3 offset:13312
    ds_read_b64_tr_b16 a[54:55], v3 offset:13568
    ds_read_b64_tr_b16 a[56:57], v3 offset:14336
    ds_read_b64_tr_b16 a[58:59], v3 offset:14592
    ds_read_b64_tr_b16 a[60:61], v3 offset:15360
    ds_read_b64_tr_b16 a[62:63], v3 offset:15616
    s_waitcnt lgkmcnt(0)
    s_add_u32 m0, s44, 12288
    s_nop 0
    buffer_load_dwordx4 v2, s[8:11], s42 offen  lds
    s_add_u32 s42, s42, s43
    s_add_u32 m0, s44, 13312
    s_nop 0
    buffer_load_dwordx4 v2, s[8:11], s42 offen  lds
    s_add_u32 s42, s42, s43
    s_add_u32 m0, s44, 14336
    s_nop 0
    buffer_load_dwordx4 v2, s[8:11], s42 offen  lds
    s_add_u32 s42, s42, s43
    s_add_u32 m0, s44, 15360
    s_nop 0
    buffer_load_dwordx4 v2, s[8:11], s42 offen  lds
    s_add_u32 s42, s42, s43
    s_waitcnt vmcnt(28)
    ds_read_b64_tr_b16 a[64:65], v3 offset:16384
    ds_read_b64_tr_b16 a[66:67], v3 offset:16640
    ds_read_b64_tr_b16 a[68:69], v3 offset:17408
    ds_read_b64_tr_b16 a[70:71], v3 offset:17664
    ds_read_b64_tr_b16 a[72:73], v3 offset:18432
    ds_read_b64_tr_b16 a[74:75], v3 offset:18688
    ds_read_b64_tr_b16 a[76:77], v3 offset:19456
    ds_read_b64_tr_b16 a[78:79], v3 offset:19712
    s_waitcnt lgkmcnt(0)
    s_add_u32 m0, s44, 16384
    s_nop 0
    buffer_load_dwordx4 v2, s[8:11], s42 offen  lds
    s_add_u32 s42, s42, s43
    s_add_u32 m0, s44, 17408
    s_nop 0
    buffer_load_dwordx4 v2, s[8:11], s42 offen  lds
    s_add_u32 s42, s42, s43
    s_add_u32 m0, s44, 18432
    s_nop 0
    buffer_load_dwordx4 v2, s[8:11], s42 offen  lds
    s_add_u32 s42, s42, s43
    s_add_u32 m0, s44, 19456
    s_nop 0
    buffer_load_dwordx4 v2, s[8:11], s42 offen  lds
    s_add_u32 s42, s42, s43
    s_waitcnt vmcnt(28)
    ds_read_b64_tr_b16 a[80:81], v3 offset:20480
    ds_read_b64_tr_b16 a[82:83], v3 offset:20736
    ds_read_b64_tr_b16 a[84:85], v3 offset:21504
    ds_read_b64_tr_b16 a[86:87], v3 offset:21760
    ds_read_b64_tr_b16 a[88:89], v3 offset:22528
    ds_read_b64_tr_b16 a[90:91], v3 offset:22784
    ds_read_b64_tr_b16 a[92:93], v3 offset:23552
    ds_read_b64_tr_b16 a[94:95], v3 offset:23808
    s_waitcnt lgkmcnt(0)
    s_add_u32 m0, s44, 20480
    s_nop 0
    buffer_load_dwordx4 v2, s[8:11], s42 offen  lds
    s_add_u32 s42, s42, s43
    s_add_u32 m0, s44, 21504
    s_nop 0
    buffer_load_dwordx4 v2, s[8:11], s42 offen  lds
    s_add_u32 s42, s42, s43
    s_add_u32 m0, s44, 22528
    s_nop 0
    buffer_load_dwordx4 v2, s[8:11], s42 offen  lds
    s_add_u32 s42, s42, s43
    s_add_u32 m0, s44, 23552
    s_nop 0
    buffer_load_dwordx4 v2, s[8:11], s42 offen  lds
    s_add_u32 s42, s42, s43
    s_waitcnt vmcnt(28)
    ds_read_b64_tr_b16 a[96:97], v3 offset:24576
    ds_read_b64_tr_b16 a[98:99], v3 offset:24832
    ds_read_b64_tr_b16 a[100:101], v3 offset:25600
    ds_read_b64_tr_b16 a[102:103], v3 offset:25856
    ds_read_b64_tr_b16 a[104:105], v3 offset:26624
    ds_read_b64_tr_b16 a[106:107], v3 offset:26880
    ds_read_b64_tr_b16 a[108:109], v3 offset:27648
    ds_read_b64_tr_b16 a[110:111], v3 offset:27904
    s_waitcnt lgkmcnt(0)
    s_add_u32 m0, s44, 24576
    s_nop 0
    buffer_load_dwordx4 v2, s[8:11], s42 offen  lds
    s_add_u32 s42, s42, s43
    s_add_u32 m0, s44, 25600
    s_nop 0
    buffer_load_dwordx4 v2, s[8:11], s42 offen  lds
    s_add_u32 s42, s42, s43
    s_add_u32 m0, s44, 26624
    s_nop 0
    buffer_load_dwordx4 v2, s[8:11], s42 offen  lds
    s_add_u32 s42, s42, s43
    s_add_u32 m0, s44, 27648
    s_nop 0
    buffer_load_dwordx4 v2, s[8:11], s42 offen  lds
    s_add_u32 s42, s42, s43
    s_waitcnt vmcnt(28)
    ds_read_b64_tr_b16 a[112:113], v3 offset:28672
    ds_read_b64_tr_b16 a[114:115], v3 offset:28928
    ds_read_b64_tr_b16 a[116:117], v3 offset:29696
    ds_read_b64_tr_b16 a[118:119], v3 offset:29952
    ds_read_b64_tr_b16 a[120:121], v3 offset:30720
    ds_read_b64_tr_b16 a[122:123], v3 offset:30976
    ds_read_b64_tr_b16 a[124:125], v3 offset:31744
    ds_read_b64_tr_b16 a[126:127], v3 offset:32000
    s_waitcnt lgkmcnt(0)
    s_add_u32 m0, s44, 28672
    s_nop 0
    buffer_load_dwordx4 v2, s[8:11], s42 offen  lds
    s_add_u32 s42, s42, s43
    s_add_u32 m0, s44, 29696
    s_nop 0
    buffer_load_dwordx4 v2, s[8:11], s42 offen  lds
    s_add_u32 s42, s42, s43
    s_add_u32 m0, s44, 30720
    s_nop 0
    buffer_load_dwordx4 v2, s[8:11], s42 offen  lds
    s_add_u32 s42, s42, s43
    s_add_u32 m0, s44, 31744
    s_nop 0
    buffer_load_dwordx4 v2, s[8:11], s42 offen  lds
    s_add_u32 s42, s42, s43
    s_waitcnt vmcnt(28)
    ds_read_b64_tr_b16 a[128:129], v3 offset:0
    ds_read_b64_tr_b16 a[130:131], v3 offset:256
    ds_read_b64_tr_b16 a[132:133], v3 offset:1024
    ds_read_b64_tr_b16 a[134:135], v3 offset:1280
    ds_read_b64_tr_b16 a[136:137], v3 offset:2048
    ds_read_b64_tr_b16 a[138:139], v3 offset:2304
    ds_read_b64_tr_b16 a[140:141], v3 offset:3072
    ds_read_b64_tr_b16 a[142:143], v3 offset:3328
    s_waitcnt lgkmcnt(0)
    s_waitcnt vmcnt(24)
    ds_read_b64_tr_b16 a[144:145], v3 offset:4096
    ds_read_b64_tr_b16 a[146:147], v3 offset:4352
    ds_read_b64_tr_b16 a[148:149], v3 offset:5120
    ds_read_b64_tr_b16 a[150:151], v3 offset:5376
    ds_read_b64_tr_b16 a[152:153], v3 offset:6144
    ds_read_b64_tr_b16 a[154:155], v3 offset:6400
    ds_read_b64_tr_b16 a[156:157], v3 offset:7168
    ds_read_b64_tr_b16 a[158:159], v3 offset:7424
    s_waitcnt lgkmcnt(0)
    s_waitcnt vmcnt(20)
    ds_read_b64_tr_b16 a[160:161], v3 offset:8192
    ds_read_b64_tr_b16 a[162:163], v3 offset:8448
    ds_read_b64_tr_b16 a[164:165], v3 offset:9216
    ds_read_b64_tr_b16 a[166:167], v3 offset:9472
    ds_read_b64_tr_b16 a[168:169], v3 offset:10240
    ds_read_b64_tr_b16 a[170:171], v3 offset:10496
    ds_read_b64_tr_b16 a[172:173], v3 offset:11264
    ds_read_b64_tr_b16 a[174:175], v3 offset:11520
    s_waitcnt lgkmcnt(0)
    s_waitcnt vmcnt(16)
    ds_read_b64_tr_b16 a[176:177], v3 offset:12288
    ds_read_b64_tr_b16 a[178:179], v3 offset:12544
    ds_read_b64_tr_b16 a[180:181], v3 offset:13312
    ds_read_b64_tr_b16 a[182:183], v3 offset:13568
    ds_read_b64_tr_b16 a[184:185], v3 offset:14336
    ds_read_b64_tr_b16 a[186:187], v3 offset:14592
    ds_read_b64_tr_b16 a[188:189], v3 offset:15360
    ds_read_b64_tr_b16 a[190:191], v3 offset:15616
    s_waitcnt lgkmcnt(0)
    s_waitcnt vmcnt(12)
    ds_read_b64_tr_b16 a[192:193], v3 offset:16384
    ds_read_b64_tr_b16 a[194:195], v3 offset:16640
    ds_read_b64_tr_b16 a[196:197], v3 offset:17408
    ds_read_b64_tr_b16 a[198:199], v3 offset:17664
    ds_read_b64_tr_b16 a[200:201], v3 offset:18432
    ds_read_b64_tr_b16 a[202:203], v3 offset:18688
    ds_read_b64_tr_b16 a[204:205], v3 offset:19456
    ds_read_b64_tr_b16 a[206:207], v3 offset:19712
    s_waitcnt lgkmcnt(0)
    s_waitcnt vmcnt(8)
    ds_read_b64_tr_b16 a[208:209], v3 offset:20480
    ds_read_b64_tr_b16 a[210:211], v3 offset:20736
    ds_read_b64_tr_b16 a[212:213], v3 offset:21504
    ds_read_b64_tr_b16 a[214:215], v3 offset:21760
    ds_read_b64_tr_b16 a[216:217], v3 offset:22528
    ds_read_b64_tr_b16 a[218:219], v3 offset:22784
    ds_read_b64_tr_b16 a[220:221], v3 offset:23552
    ds_read_b64_tr_b16 a[222:223], v3 offset:23808
    s_waitcnt lgkmcnt(0)
    s_waitcnt vmcnt(4)
    ds_read_b64_tr_b16 a[224:225], v3 offset:24576
    ds_read_b64_tr_b16 a[226:227], v3 offset:24832
    ds_read_b64_tr_b16 a[228:229], v3 offset:25600
    ds_read_b64_tr_b16 a[230:231], v3 offset:25856
    ds_read_b64_tr_b16 a[232:233], v3 offset:26624
    ds_read_b64_tr_b16 a[234:235], v3 offset:26880
    ds_read_b64_tr_b16 a[236:237], v3 offset:27648
    ds_read_b64_tr_b16 a[238:239], v3 offset:27904
    s_waitcnt lgkmcnt(0)
    s_waitcnt vmcnt(0)
    ds_read_b64_tr_b16 a[240:241], v3 offset:28672
    ds_read_b64_tr_b16 a[242:243], v3 offset:28928
    ds_read_b64_tr_b16 a[244:245], v3 offset:29696
    ds_read_b64_tr_b16 a[246:247], v3 offset:29952
    ds_read_b64_tr_b16 a[248:249], v3 offset:30720
    ds_read_b64_tr_b16 a[250:251], v3 offset:30976
    ds_read_b64_tr_b16 a[252:253], v3 offset:31744
    ds_read_b64_tr_b16 a[254:255], v3 offset:32000
    s_waitcnt lgkmcnt(0)
    s_barrier
    s_lshl_b32 s42, s14, 12
    v_add_u32 v4, s42, v1
    s_lshl_b32 s42, s14, 10
    v_add_u32 v5, s42, v1
    v_lshrrev_b32 v6, 1, v5
    v_add_u32 v6, 131072, v6
    v_and_b32 v8, 31, v0
    v_mul_u32_u24 v7, 1152, v8
    v_lshrrev_b32 v8, 5, v0
    v_lshl_add_u32 v7, v8, 3, v7
    s_lshl_b32 s42, s16, 6
    s_lshl_b32 s43, s14, 4
    s_add_u32 s42, s42, s43
    v_add_u32 v7, s42, v7
    v_and_b32 v3, 7, v0
    s_lshl_b32 s42, s14, 3
    v_add_u32 v3, s42, v3
    v_lshlrev_b32 v3, 7, v3
    s_mov_b64 s[30:31], -1
    s_mov_b32 s28, 0
    s_mov_b32 s34, 0x1010101
    s_mov_b32 s35, 0x1010101
    s_mov_b32 s28, 63
    s_cmp_eq_u32 s17, 1
    s_cmov_b32 s34, 0x2020202
    s_cmov_b32 s35, 0x2020202
    s_cmov_b32 s28, 127
    s_cmp_eq_u32 s17, 2
    s_cmov_b32 s34, 0x4040404
    s_cmov_b32 s35, 0x4040404
    s_cmov_b32 s28, 0
    s_cmp_eq_u32 s17, 3
    s_cmov_b32 s34, 0x8080808
    s_cmov_b32 s35, 0x8080808
    s_cmov_b32 s28, 0
    s_cmp_eq_u32 s17, 4
    s_cmov_b32 s34, 0x10101010
    s_cmov_b32 s35, 0x10101010
    s_cmov_b32 s28, 0
    s_cmp_eq_u32 s17, 5
    s_cmov_b32 s34, 0x20202020
    s_cmov_b32 s35, 0x20202020
    s_cmov_b32 s28, 0
    s_cmp_eq_u32 s17, 6
    s_cmov_b32 s34, 0x40404040
    s_cmov_b32 s35, 0x404040
    s_cmov_b32 s28, 62
    s_cmp_eq_u32 s17, 7
    s_cmov_b32 s34, 0x80808080
    s_cmov_b32 s35, 0x808080
    s_cmov_b32 s28, 126
    s_ff1_i32_b64 s20, s[34:35]
    s_bitset0_b64 s[34:35], s20
sg_180:
    s_and_b32 s42, s20, 3
    s_lshl_b32 s42, s42, 12
    s_add_u32 s23, s42, 116391936
    s_lshr_b32 s24, s20, 2
    s_add_u32 s24, s24, 1
    s_mov_b32 s41, 0
sp_185:
    buffer_load_dword v2, v3, s[4:7], s23 offen sc1
    s_waitcnt vmcnt(0)
    v_cmp_gt_u32 vcc, s24, v2
    s_nop 0
    s_cmp_eq_u64 vcc, 0
    s_cbranch_scc1 sp_186
    s_sleep 4
    s_add_u32 s41, s41, 1
    s_cmp_lt_u32 s41, 2000000
    s_cbranch_scc1 sp_185
    s_branch fin2
sp_186:
    s_mul_i32 s21, s20, 262144
    s_mul_i32 s42, s14, 65536
    s_add_u32 s21, s21, s42
    s_add_u32 s21, s21, 75497472
    buffer_load_dwordx4 v[64:67], v1, s[4:7], s21 offen offset:0 sc1
    buffer_load_dwordx4 v[68:71], v1, s[4:7], s21 offen offset:1024 sc1
    buffer_load_dwordx4 v[72:75], v1, s[4:7], s21 offen offset:2048 sc1
    buffer_load_dwordx4 v[76:79], v1, s[4:7], s21 offen offset:3072 sc1
    s_add_u32 s21, s21, 4096
    buffer_load_dwordx4 v[80:83], v1, s[4:7], s21 offen offset:0 sc1
    buffer_load_dwordx4 v[84:87], v1, s[4:7], s21 offen offset:1024 sc1
    buffer_load_dwordx4 v[88:91], v1, s[4:7], s21 offen offset:2048 sc1
    buffer_load_dwordx4 v[92:95], v1, s[4:7], s21 offen offset:3072 sc1
    s_add_u32 s21, s21, 4096
    buffer_load_dwordx4 v[96:99], v1, s[4:7], s21 offen offset:0 sc1
    buffer_load_dwordx4 v[100:103], v1, s[4:7], s21 offen offset:1024 sc1
    buffer_load_dwordx4 v[104:107], v1, s[4:7], s21 offen offset:2048 sc1
    buffer_load_dwordx4 v[108:111], v1, s[4:7], s21 offen offset:3072 sc1
    s_add_u32 s21, s21, 4096
    buffer_load_dwordx4 v[112:115], v1, s[4:7], s21 offen offset:0 sc1
    buffer_load_dwordx4 v[116:119], v1, s[4:7], s21 offen offset:1024 sc1
    buffer_load_dwordx4 v[120:123], v1, s[4:7], s21 offen offset:2048 sc1
    buffer_load_dwordx4 v[124:127], v1, s[4:7], s21 offen offset:3072 sc1
    s_add_u32 s21, s21, 4096
    buffer_load_dwordx4 v[128:131], v1, s[4:7], s21 offen offset:0 sc1
    buffer_load_dwordx4 v[132:135], v1, s[4:7], s21 offen offset:1024 sc1
    buffer_load_dwordx4 v[136:139], v1, s[4:7], s21 offen offset:2048 sc1
    buffer_load_dwordx4 v[140:143], v1, s[4:7], s21 offen offset:3072 sc1
    s_add_u32 s21, s21, 4096
    buffer_load_dwordx4 v[144:147], v1, s[4:7], s21 offen offset:0 sc1
    buffer_load_dwordx4 v[148:151], v1, s[4:7], s21 offen offset:1024 sc1
    buffer_load_dwordx4 v[152:155], v1, s[4:7], s21 offen offset:2048 sc1
    buffer_load_dwordx4 v[156:159], v1, s[4:7], s21 offen offset:3072 sc1
    s_add_u32 s21, s21, 4096
    buffer_load_dwordx4 v[160:163], v1, s[4:7], s21 offen offset:0 sc1
    buffer_load_dwordx4 v[164:167], v1, s[4:7], s21 offen offset:1024 sc1
    buffer_load_dwordx4 v[168:171], v1, s[4:7], s21 offen offset:2048 sc1
    buffer_load_dwordx4 v[172:175], v1, s[4:7], s21 offen offset:3072 sc1
    s_add_u32 s21, s21, 4096
    buffer_load_dwordx4 v[176:179], v1, s[4:7], s21 offen offset:0 sc1
    buffer_load_dwordx4 v[180:183], v1, s[4:7], s21 offen offset:1024 sc1
    buffer_load_dwordx4 v[184:187], v1, s[4:7], s21 offen offset:2048 sc1
    buffer_load_dwordx4 v[188:191], v1, s[4:7], s21 offen offset:3072 sc1
    s_add_u32 s21, s21, 4096
sg_181:
    s_ff1_i32_b64 s25, s[34:35]
    s_bitset0_b64 s[34:35], s25
    s_and_b32 s44, s25, 63
    s_and_b32 s42, s44, 3
    s_lshl_b32 s42, s42, 12
    s_add_u32 s23, s42, 116391936
    s_lshr_b32 s24, s44, 2
    s_add_u32 s24, s24, 1
    s_mul_i32 s22, s44, 262144
    s_mul_i32 s42, s14, 65536
    s_add_u32 s22, s22, s42
    s_add_u32 s22, s22, 75497472
    s_mul_i32 s26, s20, 36864
    s_waitcnt vmcnt(31)
    v_mfma_f32_32x32x16_bf16 v[16:31], a[0:3], v[64:67], 0
    buffer_load_dwordx4 v[64:67], v1, s[4:7], s21 offen offset:0 sc1
    buffer_load_dword v2, v3, s[4:7], s23 offen sc1
    buffer_load_dwordx2 v[14:15], v7, s[68:71], s26 offen
    s_waitcnt vmcnt(31)
    v_mfma_f32_32x32x16_bf16 v[32:47], a[4:7], v[68:71], 0
    buffer_load_dwordx4 v[68:71], v1, s[4:7], s21 offen offset:1024 sc1
    s_waitcnt vmcnt(31)
    v_mfma_f32_32x32x16_bf16 v[16:31], a[8:11], v[72:75], v[16:31]
    buffer_load_dwordx4 v[72:75], v1, s[4:7], s21 offen offset:2048 sc1
    s_waitcnt vmcnt(31)
    v_mfma_f32_32x32x16_bf16 v[32:47], a[12:15], v[76:79], v[32:47]
    buffer_load_dwordx4 v[76:79], v1, s[4:7], s21 offen offset:3072 sc1
    s_add_u32 s21, s21, 4096
    s_waitcnt vmcnt(31)
    v_mfma_f32_32x32x16_bf16 v[16:31], a[16:19], v[80:83], v[16:31]
    buffer_load_dwordx4 v[80:83], v1, s[4:7], s21 offen offset:0 sc1
    s_waitcnt vmcnt(31)
    v_mfma_f32_32x32x16_bf16 v[32:47], a[20:23], v[84:87], v[32:47]
    buffer_load_dwordx4 v[84:87], v1, s[4:7], s21 offen offset:1024 sc1
    s_waitcnt vmcnt(31)
    v_mfma_f32_32x32x16_bf16 v[16:31], a[24:27], v[88:91], v[16:31]
    buffer_load_dwordx4 v[88:91], v1, s[4:7], s21 offen offset:2048 sc1
    s_waitcnt vmcnt(31)
    v_mfma_f32_32x32x16_bf16 v[32:47], a[28:31], v[92:95], v[32:47]
    buffer_load_dwordx4 v[92:95], v1, s[4:7], s21 offen offset:3072 sc1
    s_add_u32 s21, s21, 4096
    s_waitcnt vmcnt(31)
    v_mfma_f32_32x32x16_bf16 v[16:31], a[32:35], v[96:99], v[16:31]
    buffer_load_dwordx4 v[96:99], v1, s[4:7], s21 offen offset:0 sc1
    s_waitcnt vmcnt(31)
    v_mfma_f32_32x32x16_bf16 v[32:47], a[36:39], v[100:103], v[32:47]
    buffer_load_dwordx4 v[100:103], v1, s[4:7], s21 offen offset:1024 sc1
    s_waitcnt vmcnt(31)
    v_mfma_f32_32x32x16_bf16 v[16:31], a[40:43], v[104:107], v[16:31]
    buffer_load_dwordx4 v[104:107], v1, s[4:7], s21 offen offset:2048 sc1
    s_waitcnt vmcnt(31)
    v_mfma_f32_32x32x16_bf16 v[32:47], a[44:47], v[108:111], v[32:47]
    buffer_load_dwordx4 v[108:111], v1, s[4:7], s21 offen offset:3072 sc1
    s_add_u32 s21, s21, 4096
    s_waitcnt vmcnt(31)
    v_mfma_f32_32x32x16_bf16 v[16:31], a[48:51], v[112:115], v[16:31]
    buffer_load_dwordx4 v[112:115], v1, s[4:7], s21 offen offset:0 sc1
    s_waitcnt vmcnt(31)
    v_mfma_f32_32x32x16_bf16 v[32:47], a[52:55], v[116:119], v[32:47]
    buffer_load_dwordx4 v[116:119], v1, s[4:7], s21 offen offset:1024 sc1
    s_waitcnt vmcnt(31)
    v_mfma_f32_32x32x16_bf16 v[16:31], a[56:59], v[120:123], v[16:31]
    buffer_load_dwordx4 v[120:123], v1, s[4:7], s21 offen offset:2048 sc1
    s_waitcnt vmcnt(31)
    v_mfma_f32_32x32x16_bf16 v[32:47], a[60:63], v[124:127], v[32:47]
    buffer_load_dwordx4 v[124:127], v1, s[4:7], s21 offen offset:3072 sc1
    s_add_u32 s21, s21, 4096
    s_waitcnt vmcnt(31)
    v_mfma_f32_32x32x16_bf16 v[16:31], a[64:67], v[128:131], v[16:31]
    buffer_load_dwordx4 v[128:131], v1, s[4:7], s21 offen offset:0 sc1
    s_waitcnt vmcnt(31)
    v_mfma_f32_32x32x16_bf16 v[32:47], a[68:71], v[132:135], v[32:47]
    buffer_load_dwordx4 v[132:135], v1, s[4:7], s21 offen offset:1024 sc1
    s_waitcnt vmcnt(31)
    v_mfma_f32_32x32x16_bf16 v[16:31], a[72:75], v[136:139], v[16:31]
    buffer_load_dwordx4 v[136:139], v1, s[4:7], s21 offen offset:2048 sc1
    s_waitcnt vmcnt(31)
    v_mfma_f32_32x32x16_bf16 v[32:47], a[76:79], v[140:143], v[32:47]
    buffer_load_dwordx4 v[140:143], v1, s[4:7], s21 offen offset:3072 sc1
    s_add_u32 s21, s21, 4096
    s_waitcnt vmcnt(31)
    v_mfma_f32_32x32x16_bf16 v[16:31], a[80:83], v[144:147], v[16:31]
    buffer_load_dwordx4 v[144:147], v1, s[4:7], s21 offen offset:0 sc1
    s_waitcnt vmcnt(31)
    v_mfma_f32_32x32x16_bf16 v[32:47], a[84:87], v[148:151], v[32:47]
    buffer_load_dwordx4 v[148:151], v1, s[4:7], s21 offen offset:1024 sc1
    s_waitcnt vmcnt(31)
    v_mfma_f32_32x32x16_bf16 v[16:31], a[88:91], v[152:155], v[16:31]
    buffer_load_dwordx4 v[152:155], v1, s[4:7], s21 offen offset:2048 sc1
    s_waitcnt vmcnt(31)
    v_mfma_f32_32x32x16_bf16 v[32:47], a[92:95], v[156:159], v[32:47]
    buffer_load_dwordx4 v[156:159], v1, s[4:7], s21 offen offset:3072 sc1
    s_add_u32 s21, s21, 4096
    s_waitcnt vmcnt(31)
    v_mfma_f32_32x32x16_bf16 v[16:31], a[96:99], v[160:163], v[16:31]
    buffer_load_dwordx4 v[160:163], v1, s[4:7], s21 offen offset:0 sc1
    s_waitcnt vmcnt(31)
    v_mfma_f32_32x32x16_bf16 v[32:47], a[100:103], v[164:167], v[32:47]
    buffer_load_dwordx4 v[164:167], v1, s[4:7], s21 offen offset:1024 sc1
    s_waitcnt vmcnt(31)
    v_mfma_f32_32x32x16_bf16 v[16:31], a[104:107], v[168:171], v[16:31]
    buffer_load_dwordx4 v[168:171], v1, s[4:7], s21 offen offset:2048 sc1
    s_waitcnt vmcnt(31)
    v_mfma_f32_32x32x16_bf16 v[32:47], a[108:111], v[172:175], v[32:47]
    buffer_load_dwordx4 v[172:175], v1, s[4:7], s21 offen offset:3072 sc1
    s_add_u32 s21, s21, 4096
    s_waitcnt vmcnt(31)
    v_mfma_f32_32x32x16_bf16 v[16:31], a[112:115], v[176:179], v[16:31]
    buffer_load_dwordx4 v[176:179], v1, s[4:7], s21 offen offset:0 sc1
    s_waitcnt vmcnt(31)
    v_mfma_f32_32x32x16_bf16 v[32:47], a[116:119], v[180:183], v[32:47]
    buffer_load_dwordx4 v[180:183], v1, s[4:7], s21 offen offset:1024 sc1
    s_waitcnt vmcnt(31)
    v_mfma_f32_32x32x16_bf16 v[16:31], a[120:123], v[184:187], v[16:31]
    buffer_load_dwordx4 v[184:187], v1, s[4:7], s21 offen offset:2048 sc1
    s_waitcnt vmcnt(31)
    v_mfma_f32_32x32x16_bf16 v[32:47], a[124:127], v[188:191], v[32:47]
    buffer_load_dwordx4 v[188:191], v1, s[4:7], s21 offen offset:3072 sc1
    s_add_u32 s21, s21, 4096
    s_waitcnt vmcnt(31)
    v_cmp_gt_u32 vcc, s24, v2
    s_nop 0
    s_cmp_eq_u64 vcc, 0
    s_cselect_b32 s27, 1, 0
    s_cmp_lt_u32 s25, 64
    s_cselect_b32 s27, s27, 0
    s_cmp_eq_u32 s27, 0
    s_cbranch_scc1 sg_182
    s_waitcnt vmcnt(31)
    v_mfma_f32_32x32x16_bf16 v[16:31], a[128:131], v[64:67], v[16:31]
    buffer_load_dwordx4 v[64:67], v1, s[4:7], s22 offen offset:0 sc1
    s_waitcnt vmcnt(31)
    v_mfma_f32_32x32x16_bf16 v[32:47], a[132:135], v[68:71], v[32:47]
    buffer_load_dwordx4 v[68:71], v1, s[4:7], s22 offen offset:1024 sc1
    s_waitcnt vmcnt(31)
    v_mfma_f32_32x32x16_bf16 v[16:31], a[136:139], v[72:75], v[16:31]
    buffer_load_dwordx4 v[72:75], v1, s[4:7], s22 offen offset:2048 sc1
    s_waitcnt vmcnt(31)
    v_mfma_f32_32x32x16_bf16 v[32:47], a[140:143], v[76:79], v[32:47]
    buffer_load_dwordx4 v[76:79], v1, s[4:7], s22 offen offset:3072 sc1
    s_add_u32 s22, s22, 4096
    s_waitcnt vmcnt(31)
    v_mfma_f32_32x32x16_bf16 v[16:31], a[144:147], v[80:83], v[16:31]
    buffer_load_dwordx4 v[80:83], v1, s[4:7], s22 offen offset:0 sc1
    s_waitcnt vmcnt(31)
    v_mfma_f32_32x32x16_bf16 v[32:47], a[148:151], v[84:87], v[32:47]
    buffer_load_dwordx4 v[84:87], v1, s[4:7], s22 offen offset:1024 sc1
    s_waitcnt vmcnt(31)
    v_mfma_f32_32x32x16_bf16 v[16:31], a[152:155], v[88:91], v[16:31]
    buffer_load_dwordx4 v[88:91], v1, s[4:7], s22 offen offset:2048 sc1
    s_waitcnt vmcnt(31)
    v_mfma_f32_32x32x16_bf16 v[32:47], a[156:159], v[92:95], v[32:47]
    buffer_load_dwordx4 v[92:95], v1, s[4:7], s22 offen offset:3072 sc1
    s_add_u32 s22, s22, 4096
    s_waitcnt vmcnt(31)
    v_mfma_f32_32x32x16_bf16 v[16:31], a[160:163], v[96:99], v[16:31]
    buffer_load_dwordx4 v[96:99], v1, s[4:7], s22 offen offset:0 sc1
    s_waitcnt vmcnt(31)
    v_mfma_f32_32x32x16_bf16 v[32:47], a[164:167], v[100:103], v[32:47]
    buffer_load_dwordx4 v[100:103], v1, s[4:7], s22 offen offset:1024 sc1
    s_waitcnt vmcnt(31)
    v_mfma_f32_32x32x16_bf16 v[16:31], a[168:171], v[104:107], v[16:31]
    buffer_load_dwordx4 v[104:107], v1, s[4:7], s22 offen offset:2048 sc1
    s_waitcnt vmcnt(31)
    v_mfma_f32_32x32x16_bf16 v[32:47], a[172:175], v[108:111], v[32:47]
    buffer_load_dwordx4 v[108:111], v1, s[4:7], s22 offen offset:3072 sc1
    s_add_u32 s22, s22, 4096
    s_waitcnt vmcnt(31)
    v_mfma_f32_32x32x16_bf16 v[16:31], a[176:179], v[112:115], v[16:31]
    buffer_load_dwordx4 v[112:115], v1, s[4:7], s22 offen offset:0 sc1
    s_waitcnt vmcnt(31)
    v_mfma_f32_32x32x16_bf16 v[32:47], a[180:183], v[116:119], v[32:47]
    buffer_load_dwordx4 v[116:119], v1, s[4:7], s22 offen offset:1024 sc1
    s_waitcnt vmcnt(31)
    v_mfma_f32_32x32x16_bf16 v[16:31], a[184:187], v[120:123], v[16:31]
    buffer_load_dwordx4 v[120:123], v1, s[4:7], s22 offen offset:2048 sc1
    s_waitcnt vmcnt(31)
    v_mfma_f32_32x32x16_bf16 v[32:47], a[188:191], v[124:127], v[32:47]
    buffer_load_dwordx4 v[124:127], v1, s[4:7], s22 offen offset:3072 sc1
    s_add_u32 s22, s22, 4096
    s_waitcnt vmcnt(31)
    v_mfma_f32_32x32x16_bf16 v[16:31], a[192:195], v[128:131], v[16:31]
    buffer_load_dwordx4 v[128:131], v1, s[4:7], s22 offen offset:0 sc1
    s_waitcnt vmcnt(31)
    v_mfma_f32_32x32x16_bf16 v[32:47], a[196:199], v[132:135], v[32:47]
    buffer_load_dwordx4 v[132:135], v1, s[4:7], s22 offen offset:1024 sc1
    s_waitcnt vmcnt(31)
    v_mfma_f32_32x32x16_bf16 v[16:31], a[200:203], v[136:139], v[16:31]
    buffer_load_dwordx4 v[136:139], v1, s[4:7], s22 offen offset:2048 sc1
    s_waitcnt vmcnt(31)
    v_mfma_f32_32x32x16_bf16 v[32:47], a[204:207], v[140:143], v[32:47]
    buffer_load_dwordx4 v[140:143], v1, s[4:7], s22 offen offset:3072 sc1
    s_add_u32 s22, s22, 4096
    s_waitcnt vmcnt(31)
    v_mfma_f32_32x32x16_bf16 v[16:31], a[208:211], v[144:147], v[16:31]
    buffer_load_dwordx4 v[144:147], v1, s[4:7], s22 offen offset:0 sc1
    s_waitcnt vmcnt(31)
    v_mfma_f32_32x32x16_bf16 v[32:47], a[212:215], v[148:151], v[32:47]
    buffer_load_dwordx4 v[148:151], v1, s[4:7], s22 offen offset:1024 sc1
    s_waitcnt vmcnt(31)
    v_mfma_f32_32x32x16_bf16 v[16:31], a[216:219], v[152:155], v[16:31]
    buffer_load_dwordx4 v[152:155], v1, s[4:7], s22 offen offset:2048 sc1
    s_waitcnt vmcnt(31)
    v_mfma_f32_32x32x16_bf16 v[32:47], a[220:223], v[156:159], v[32:47]
    buffer_load_dwordx4 v[156:159], v1, s[4:7], s22 offen offset:3072 sc1
    s_add_u32 s22, s22, 4096
    s_waitcnt vmcnt(31)
    v_mfma_f32_32x32x16_bf16 v[16:31], a[224:227], v[160:163], v[16:31]
    buffer_load_dwordx4 v[160:163], v1, s[4:7], s22 offen offset:0 sc1
    s_waitcnt vmcnt(31)
    v_mfma_f32_32x32x16_bf16 v[32:47], a[228:231], v[164:167], v[32:47]
    buffer_load_dwordx4 v[164:167], v1, s[4:7], s22 offen offset:1024 sc1
    s_waitcnt vmcnt(31)
    v_mfma_f32_32x32x16_bf16 v[16:31], a[232:235], v[168:171], v[16:31]
    buffer_load_dwordx4 v[168:171], v1, s[4:7], s22 offen offset:2048 sc1
    s_waitcnt vmcnt(31)
    v_mfma_f32_32x32x16_bf16 v[32:47], a[236:239], v[172:175], v[32:47]
    buffer_load_dwordx4 v[172:175], v1, s[4:7], s22 offen offset:3072 sc1
    s_add_u32 s22, s22, 4096
    s_waitcnt vmcnt(31)
    v_mfma_f32_32x32x16_bf16 v[16:31], a[240:243], v[176:179], v[16:31]
    buffer_load_dwordx4 v[176:179], v1, s[4:7], s22 offen offset:0 sc1
    s_waitcnt vmcnt(31)
    v_mfma_f32_32x32x16_bf16 v[32:47], a[244:247], v[180:183], v[32:47]
    buffer_load_dwordx4 v[180:183], v1, s[4:7], s22 offen offset:1024 sc1
    s_waitcnt vmcnt(31)
    v_mfma_f32_32x32x16_bf16 v[16:31], a[248:251], v[184:187], v[16:31]
    buffer_load_dwordx4 v[184:187], v1, s[4:7], s22 offen offset:2048 sc1
    s_waitcnt vmcnt(31)
    v_mfma_f32_32x32x16_bf16 v[32:47], a[252:255], v[188:191], v[32:47]
    buffer_load_dwordx4 v[188:191], v1, s[4:7], s22 offen offset:3072 sc1
    s_add_u32 s22, s22, 4096
    s_mov_b32 s21, s22
    s_nop 8
    s_branch sg_183
sg_182:
    s_waitcnt vmcnt(31)
    v_mfma_f32_32x32x16_bf16 v[16:31], a[128:131], v[64:67], v[16:31]
    s_waitcnt vmcnt(30)
    v_mfma_f32_32x32x16_bf16 v[32:47], a[132:135], v[68:71], v[32:47]
    s_waitcnt vmcnt(29)
    v_mfma_f32_32x32x16_bf16 v[16:31], a[136:139], v[72:75], v[16:31]
    s_waitcnt vmcnt(28)
    v_mfma_f32_32x32x16_bf16 v[32:47], a[140:143], v[76:79], v[32:47]
    s_waitcnt vmcnt(27)
    v_mfma_f32_32x32x16_bf16 v[16:31], a[144:147], v[80:83], v[16:31]
    s_waitcnt vmcnt(26)
    v_mfma_f32_32x32x16_bf16 v[32:47], a[148:151], v[84:87], v[32:47]
    s_waitcnt vmcnt(25)
    v_mfma_f32_32x32x16_bf16 v[16:31], a[152:155], v[88:91], v[16:31]
    s_waitcnt vmcnt(24)
    v_mfma_f32_32x32x16_bf16 v[32:47], a[156:159], v[92:95], v[32:47]
    s_waitcnt vmcnt(23)
    v_mfma_f32_32x32x16_bf16 v[16:31], a[160:163], v[96:99], v[16:31]
    s_waitcnt vmcnt(22)
    v_mfma_f32_32x32x16_bf16 v[32:47], a[164:167], v[100:103], v[32:47]
    s_waitcnt vmcnt(21)
    v_mfma_f32_32x32x16_bf16 v[16:31], a[168:171], v[104:107], v[16:31]
    s_waitcnt vmcnt(20)
    v_mfma_f32_32x32x16_bf16 v[32:47], a[172:175], v[108:111], v[32:47]
    s_waitcnt vmcnt(19)
    v_mfma_f32_32x32x16_bf16 v[16:31], a[176:179], v[112:115], v[16:31]
    s_waitcnt vmcnt(18)
    v_mfma_f32_32x32x16_bf16 v[32:47], a[180:183], v[116:119], v[32:47]
    s_waitcnt vmcnt(17)
    v_mfma_f32_32x32x16_bf16 v[16:31], a[184:187], v[120:123], v[16:31]
    s_waitcnt vmcnt(16)
    v_mfma_f32_32x32x16_bf16 v[32:47], a[188:191], v[124:127], v[32:47]
    s_waitcnt vmcnt(15)
    v_mfma_f32_32x32x16_bf16 v[16:31], a[192:195], v[128:131], v[16:31]
    s_waitcnt vmcnt(14)
    v_mfma_f32_32x32x16_bf16 v[32:47], a[196:199], v[132:135], v[32:47]
    s_waitcnt vmcnt(13)
    v_mfma_f32_32x32x16_bf16 v[16:31], a[200:203], v[136:139], v[16:31]
    s_waitcnt vmcnt(12)
    v_mfma_f32_32x32x16_bf16 v[32:47], a[204:207], v[140:143], v[32:47]
    s_waitcnt vmcnt(11)
    v_mfma_f32_32x32x16_bf16 v[16:31], a[208:211], v[144:147], v[16:31]
    s_waitcnt vmcnt(10)
    v_mfma_f32_32x32x16_bf16 v[32:47], a[212:215], v[148:151], v[32:47]
    s_waitcnt vmcnt(9)
    v_mfma_f32_32x32x16_bf16 v[16:31], a[216:219], v[152:155], v[16:31]
    s_waitcnt vmcnt(8)
    v_mfma_f32_32x32x16_bf16 v[32:47], a[220:223], v[156:159], v[32:47]
    s_waitcnt vmcnt(7)
    v_mfma_f32_32x32x16_bf16 v[16:31], a[224:227], v[160:163], v[16:31]
    s_waitcnt vmcnt(6)
    v_mfma_f32_32x32x16_bf16 v[32:47], a[228:231], v[164:167], v[32:47]
    s_waitcnt vmcnt(5)
    v_mfma_f32_32x32x16_bf16 v[16:31], a[232:235], v[168:171], v[16:31]
    s_waitcnt vmcnt(4)
    v_mfma_f32_32x32x16_bf16 v[32:47], a[236:239], v[172:175], v[32:47]
    s_waitcnt vmcnt(3)
    v_mfma_f32_32x32x16_bf16 v[16:31], a[240:243], v[176:179], v[16:31]
    s_waitcnt vmcnt(2)
    v_mfma_f32_32x32x16_bf16 v[32:47], a[244:247], v[180:183], v[32:47]
    s_waitcnt vmcnt(1)
    v_mfma_f32_32x32x16_bf16 v[16:31], a[248:251], v[184:187], v[16:31]
    s_waitcnt vmcnt(0)
    v_mfma_f32_32x32x16_bf16 v[32:47], a[252:255], v[188:191], v[32:47]
    s_nop 11
sg_183:
    v_pk_add_f32 v[16:17], v[16:17], v[32:33]
    v_pk_add_f32 v[18:19], v[18:19], v[34:35]
    v_pk_add_f32 v[20:21], v[20:21], v[36:37]
    v_pk_add_f32 v[22:23], v[22:23], v[38:39]
    v_pk_add_f32 v[24:25], v[24:25], v[40:41]
    v_pk_add_f32 v[26:27], v[26:27], v[42:43]
    v_pk_add_f32 v[28:29], v[28:29], v[44:45]
    v_pk_add_f32 v[30:31], v[30:31], v[46:47]
    ds_write_b128 v4, v[16:19] offset:0
    ds_write_b128 v4, v[20:23] offset:1024
    ds_write_b128 v4, v[24:27] offset:2048
    ds_write_b128 v4, v[28:31] offset:3072
    s_waitcnt lgkmcnt(0)
    s_barrier
    ds_read_b128 v[16:19], v5 offset:0
    ds_read_b128 v[20:23], v5 offset:4096
    ds_read_b128 v[24:27], v5 offset:8192
    ds_read_b128 v[28:31], v5 offset:12288
    ds_read_b64 v[12:13], v6
    v_xor_b32 v4, 0x4000, v4
    v_xor_b32 v5, 0x4000, v5
    s_waitcnt lgkmcnt(0)
sf_187:
    v_pk_add_f32 v[16:17], v[16:17], v[20:21]
    v_pk_add_f32 v[24:25], v[24:25], v[28:29]
    v_pk_add_f32 v[18:19], v[18:19], v[22:23]
    v_pk_add_f32 v[26:27], v[26:27], v[30:31]
    v_pk_add_f32 v[16:17], v[16:17], v[24:25]
    v_pk_add_f32 v[18:19], v[18:19], v[26:27]
    v_cvt_pk_bf16_f32 v20, v16, v17
    v_cvt_pk_bf16_f32 v21, v18, v19
    v_lshlrev_b32 v24, 16, v20
    v_and_b32 v25, 0xffff0000, v20
    v_lshlrev_b32 v26, 16, v12
    v_and_b32 v27, 0xffff0000, v12
    v_mul_f32 v24, v24, v26
    v_mul_f32 v25, v25, v27
    v_cvt_pk_bf16_f32 v20, v24, v25
    v_lshlrev_b32 v24, 16, v20
    v_and_b32 v25, 0xffff0000, v20
    v_lshlrev_b32 v26, 16, v14
    v_and_b32 v27, 0xffff0000, v14
    v_add_f32 v24, v24, v26
    v_add_f32 v25, v25, v27
    v_cvt_pk_bf16_f32 v20, v24, v25
    v_lshlrev_b32 v24, 16, v21
    v_and_b32 v25, 0xffff0000, v21
    v_lshlrev_b32 v26, 16, v13
    v_and_b32 v27, 0xffff0000, v13
    v_mul_f32 v24, v24, v26
    v_mul_f32 v25, v25, v27
    v_cvt_pk_bf16_f32 v21, v24, v25
    v_lshlrev_b32 v24, 16, v21
    v_and_b32 v25, 0xffff0000, v21
    v_lshlrev_b32 v26, 16, v15
    v_and_b32 v27, 0xffff0000, v15
    v_add_f32 v24, v24, v26
    v_add_f32 v25, v25, v27
    v_cvt_pk_bf16_f32 v21, v24, v25
    s_mov_b64 exec, s[30:31]
    buffer_store_dwordx2 v[20:21], v7, s[72:75], s26 offen
    s_mov_b64 exec, -1
    v_add_u32 v6, 2048, v6
    s_mov_b32 s20, s25
    s_cmp_eq_u32 s27, 1
    s_cbranch_scc1 sg_181
    s_cmp_lt_u32 s20, 64
    s_cbranch_scc1 sg_180
    s_waitcnt lgkmcnt(0)
    s_cmp_eq_u32 s28, 0
    s_cbranch_scc1 sg_184
    s_and_b32 s20, s28, 63
    s_cmp_ge_u32 s28, 64
    s_mov_b32 s28, 0
    s_cselect_b32 s43, 256, 0
    s_cselect_b32 s30, 16, 0
    s_lshl_b32 s30, 0xffff, s30
    s_mov_b32 s31, s30
    v_xor_b32 v9, s43, v1
    v_and_b32 v9, 256, v9
    v_xor_b32 v8, v9, v1
    v_lshl_add_u32 v8, v9, 2, v8
    s_mul_i32 s26, s20, 36864
    buffer_load_dwordx2 v[14:15], v7, s[68:71], s26 offen
    s_and_b32 s43, s20, 1
    s_lshl_b32 s43, s43, 5
    s_add_u32 s43, s43, s16
    s_lshl_b32 s43, s43, 2
    s_add_u32 s43, s43, s14
    s_lshl_b32 s43, s43, 9
    s_add_u32 s43, s43, 92274688
    v_lshlrev_b32 v11, 3, v0
    s_mov_b32 s41, 0
    s_nop 0
sp_188:
    buffer_load_dwordx2 v[12:13], v11, s[4:7], s43 offen sc1
    s_waitcnt vmcnt(0)
    v_cmp_eq_u32 vcc, -1, v12
    s_nop 0
    s_cmp_eq_u64 vcc, 0
    s_cbranch_scc1 sp_189
    s_sleep 8
    s_add_u32 s41, s41, 1
    s_cmp_lt_u32 s41, 2000000
    s_cbranch_scc1 sp_188
    s_branch fin2
sp_189:
    v_and_b32 v4, 0x3fff, v4
    v_and_b32 v5, 0x3fff, v5
    v_xor_b32 v10, 256, v5
    s_and_b32 s42, s20, 3
    s_lshl_b32 s42, s42, 12
    s_add_u32 s23, s42, 116391936
    s_lshr_b32 s24, s20, 2
    s_add_u32 s24, s24, 1
    s_mul_i32 s21, s20, 262144
    s_mul_i32 s42, s14, 65536
    s_add_u32 s21, s21, s42
    s_add_u32 s21, s21, 75497472
    s_waitcnt lgkmcnt(0)
    s_barrier
    s_getpc_b64 s[32:33]
    v_lshlrev_b32 v11, 6, v0
    global_load_dword v11, v11, s[32:33]
    s_mov_b32 s41, 0
sp_190:
    buffer_load_dword v2, v3, s[4:7], s23 offen sc1
    s_waitcnt vmcnt(0)
    v_cmp_gt_u32 vcc, s24, v2
    s_nop 0
    s_cmp_eq_u64 vcc, 0
    s_cbranch_scc1 sp_191
    s_sleep 1
    s_add_u32 s41, s41, 1
    s_cmp_lt_u32 s41, 2000000
    s_cbranch_scc1 sp_190
    s_branch fin2
sp_191:
    s_mov_b32 s41, 0
sa_192:
    s_mov_b32 s22, s21
    buffer_load_dwordx4 v[64:67], v8, s[4:7], s22 offen offset:0 sc1
    buffer_load_dwordx4 v[68:71], v8, s[4:7], s22 offen offset:2048 sc1
    s_add_u32 s22, s22, 4096
    buffer_load_dwordx4 v[72:75], v8, s[4:7], s22 offen offset:0 sc1
    buffer_load_dwordx4 v[76:79], v8, s[4:7], s22 offen offset:2048 sc1
    s_add_u32 s22, s22, 4096
    buffer_load_dwordx4 v[80:83], v8, s[4:7], s22 offen offset:0 sc1
    buffer_load_dwordx4 v[84:87], v8, s[4:7], s22 offen offset:2048 sc1
    s_add_u32 s22, s22, 4096
    buffer_load_dwordx4 v[88:91], v8, s[4:7], s22 offen offset:0 sc1
    buffer_load_dwordx4 v[92:95], v8, s[4:7], s22 offen offset:2048 sc1
    s_add_u32 s22, s22, 4096
    buffer_load_dwordx4 v[96:99], v8, s[4:7], s22 offen offset:0 sc1
    buffer_load_dwordx4 v[100:103], v8, s[4:7], s22 offen offset:2048 sc1
    s_add_u32 s22, s22, 4096
    buffer_load_dwordx4 v[104:107], v8, s[4:7], s22 offen offset:0 sc1
    buffer_load_dwordx4 v[108:111], v8, s[4:7], s22 offen offset:2048 sc1
    s_add_u32 s22, s22, 4096
    buffer_load_dwordx4 v[112:115], v8, s[4:7], s22 offen offset:0 sc1
    buffer_load_dwordx4 v[116:119], v8, s[4:7], s22 offen offset:2048 sc1
    s_add_u32 s22, s22, 4096
    buffer_load_dwordx4 v[120:123], v8, s[4:7], s22 offen offset:0 sc1
    buffer_load_dwordx4 v[124:127], v8, s[4:7], s22 offen offset:2048 sc1
    s_add_u32 s22, s22, 4096
    buffer_load_dwordx4 v[128:131], v8, s[4:7], s22 offen offset:0 sc1
    buffer_load_dwordx4 v[132:135], v8, s[4:7], s22 offen offset:2048 sc1
    s_add_u32 s22, s22, 4096
    buffer_load_dwordx4 v[136:139], v8, s[4:7], s22 offen offset:0 sc1
    buffer_load_dwordx4 v[140:143], v8, s[4:7], s22 offen offset:2048 sc1
    s_add_u32 s22, s22, 4096
    buffer_load_dwordx4 v[144:147], v8, s[4:7], s22 offen offset:0 sc1
    buffer_load_dwordx4 v[148:151], v8, s[4:7], s22 offen offset:2048 sc1
    s_add_u32 s22, s22, 4096
    buffer_load_dwordx4 v[152:155], v8, s[4:7], s22 offen offset:0 sc1
    buffer_load_dwordx4 v[156:159], v8, s[4:7], s22 offen offset:2048 sc1
    s_add_u32 s22, s22, 4096
    buffer_load_dwordx4 v[160:163], v8, s[4:7], s22 offen offset:0 sc1
    buffer_load_dwordx4 v[164:167], v8, s[4:7], s22 offen offset:2048 sc1
    s_add_u32 s22, s22, 4096
    buffer_load_dwordx4 v[168:171], v8, s[4:7], s22 offen offset:0 sc1
    buffer_load_dwordx4 v[172:175], v8, s[4:7], s22 offen offset:2048 sc1
    s_add_u32 s22, s22, 4096
    buffer_load_dwordx4 v[176:179], v8, s[4:7], s22 offen offset:0 sc1
    buffer_load_dwordx4 v[180:183], v8, s[4:7], s22 offen offset:2048 sc1
    s_add_u32 s22, s22, 4096
    buffer_load_dwordx4 v[184:187], v8, s[4:7], s22 offen offset:0 sc1
    buffer_load_dwordx4 v[188:191], v8, s[4:7], s22 offen offset:2048 sc1
    s_add_u32 s22, s22, 4096
    s_add_u32 s41, s41, 1
    s_cmp_gt_u32 s41, 2000000
    s_cbranch_scc1 fin2
    v_mov_b32 v2, 0
    s_waitcnt vmcnt(31)
    v_mfma_f32_32x32x16_bf16 v[16:31], a[0:3], v[64:67], 0
    v_max_u32 v2, v2, v64
    v_mfma_f32_32x32x16_bf16 v[32:47], a[4:7], v[64:67], 0
    s_waitcnt vmcnt(30)
    v_mfma_f32_32x32x16_bf16 v[16:31], a[8:11], v[68:71], v[16:31]
    v_max_u32 v2, v2, v68
    v_mfma_f32_32x32x16_bf16 v[32:47], a[12:15], v[68:71], v[32:47]
    s_waitcnt vmcnt(29)
    v_mfma_f32_32x32x16_bf16 v[16:31], a[16:19], v[72:75], v[16:31]
    v_max_u32 v2, v2, v72
    v_mfma_f32_32x32x16_bf16 v[32:47], a[20:23], v[72:75], v[32:47]
    s_waitcnt vmcnt(28)
    v_mfma_f32_32x32x16_bf16 v[16:31], a[24:27], v[76:79], v[16:31]
    v_max_u32 v2, v2, v76
    v_mfma_f32_32x32x16_bf16 v[32:47], a[28:31], v[76:79], v[32:47]
    v_cmp_eq_u32 vcc, -1, v2
    s_cbranch_vccnz sa_192
    s_waitcnt vmcnt(27)
    v_mfma_f32_32x32x16_bf16 v[16:31], a[32:35], v[80:83], v[16:31]
    v_max_u32 v2, v2, v80
    v_mfma_f32_32x32x16_bf16 v[32:47], a[36:39], v[80:83], v[32:47]
    s_waitcnt vmcnt(26)
    v_mfma_f32_32x32x16_bf16 v[16:31], a[40:43], v[84:87], v[16:31]
    v_max_u32 v2, v2, v84
    v_mfma_f32_32x32x16_bf16 v[32:47], a[44:47], v[84:87], v[32:47]
    s_waitcnt vmcnt(25)
    v_mfma_f32_32x32x16_bf16 v[16:31], a[48:51], v[88:91], v[16:31]
    v_max_u32 v2, v2, v88
    v_mfma_f32_32x32x16_bf16 v[32:47], a[52:55], v[88:91], v[32:47]
    s_waitcnt vmcnt(24)
    v_mfma_f32_32x32x16_bf16 v[16:31], a[56:59], v[92:95], v[16:31]
    v_max_u32 v2, v2, v92
    v_mfma_f32_32x32x16_bf16 v[32:47], a[60:63], v[92:95], v[32:47]
    s_waitcnt vmcnt(23)
    v_mfma_f32_32x32x16_bf16 v[16:31], a[64:67], v[96:99], v[16:31]
    v_max_u32 v2, v2, v96
    v_mfma_f32_32x32x16_bf16 v[32:47], a[68:71], v[96:99], v[32:47]
    s_waitcnt vmcnt(22)
    v_mfma_f32_32x32x16_bf16 v[16:31], a[72:75], v[100:103], v[16:31]
    v_max_u32 v2, v2, v100
    v_mfma_f32_32x32x16_bf16 v[32:47], a[76:79], v[100:103], v[32:47]
    s_waitcnt vmcnt(21)
    v_mfma_f32_32x32x16_bf16 v[16:31], a[80:83], v[104:107], v[16:31]
    v_max_u32 v2, v2, v104
    v_mfma_f32_32x32x16_bf16 v[32:47], a[84:87], v[104:107], v[32:47]
    s_waitcnt vmcnt(20)
    v_mfma_f32_32x32x16_bf16 v[16:31], a[88:91], v[108:111], v[16:31]
    v_max_u32 v2, v2, v108
    v_mfma_f32_32x32x16_bf16 v[32:47], a[92:95], v[108:111], v[32:47]
    s_waitcnt vmcnt(19)
    v_mfma_f32_32x32x16_bf16 v[16:31], a[96:99], v[112:115], v[16:31]
    v_max_u32 v2, v2, v112
    v_mfma_f32_32x32x16_bf16 v[32:47], a[100:103], v[112:115], v[32:47]
    s_waitcnt vmcnt(18)
    v_mfma_f32_32x32x16_bf16 v[16:31], a[104:107], v[116:119], v[16:31]
    v_max_u32 v2, v2, v116
    v_mfma_f32_32x32x16_bf16 v[32:47], a[108:111], v[116:119], v[32:47]
    s_waitcnt vmcnt(17)
    v_mfma_f32_32x32x16_bf16 v[16:31], a[112:115], v[120:123], v[16:31]
    v_max_u32 v2, v2, v120
    v_mfma_f32_32x32x16_bf16 v[32:47], a[116:119], v[120:123], v[32:47]
    s_waitcnt vmcnt(16)
    v_mfma_f32_32x32x16_bf16 v[16:31], a[120:123], v[124:127], v[16:31]
    v_max_u32 v2, v2, v124
    v_mfma_f32_32x32x16_bf16 v[32:47], a[124:127], v[124:127], v[32:47]
    s_waitcnt vmcnt(15)
    v_mfma_f32_32x32x16_bf16 v[16:31], a[128:131], v[128:131], v[16:31]
    v_max_u32 v2, v2, v128
    v_mfma_f32_32x32x16_bf16 v[32:47], a[132:135], v[128:131], v[32:47]
    s_waitcnt vmcnt(14)
    v_mfma_f32_32x32x16_bf16 v[16:31], a[136:139], v[132:135], v[16:31]
    v_max_u32 v2, v2, v132
    v_mfma_f32_32x32x16_bf16 v[32:47], a[140:143], v[132:135], v[32:47]
    s_waitcnt vmcnt(13)
    v_mfma_f32_32x32x16_bf16 v[16:31], a[144:147], v[136:139], v[16:31]
    v_max_u32 v2, v2, v136
    v_mfma_f32_32x32x16_bf16 v[32:47], a[148:151], v[136:139], v[32:47]
    s_waitcnt vmcnt(12)
    v_mfma_f32_32x32x16_bf16 v[16:31], a[152:155], v[140:143], v[16:31]
    v_max_u32 v2, v2, v140
    v_mfma_f32_32x32x16_bf16 v[32:47], a[156:159], v[140:143], v[32:47]
    s_waitcnt vmcnt(11)
    v_mfma_f32_32x32x16_bf16 v[16:31], a[160:163], v[144:147], v[16:31]
    v_max_u32 v2, v2, v144
    v_mfma_f32_32x32x16_bf16 v[32:47], a[164:167], v[144:147], v[32:47]
    s_waitcnt vmcnt(10)
    v_mfma_f32_32x32x16_bf16 v[16:31], a[168:171], v[148:151], v[16:31]
    v_max_u32 v2, v2, v148
    v_mfma_f32_32x32x16_bf16 v[32:47], a[172:175], v[148:151], v[32:47]
    s_waitcnt vmcnt(9)
    v_mfma_f32_32x32x16_bf16 v[16:31], a[176:179], v[152:155], v[16:31]
    v_max_u32 v2, v2, v152
    v_mfma_f32_32x32x16_bf16 v[32:47], a[180:183], v[152:155], v[32:47]
    s_waitcnt vmcnt(8)
    v_mfma_f32_32x32x16_bf16 v[16:31], a[184:187], v[156:159], v[16:31]
    v_max_u32 v2, v2, v156
    v_mfma_f32_32x32x16_bf16 v[32:47], a[188:191], v[156:159], v[32:47]
    s_waitcnt vmcnt(7)
    v_mfma_f32_32x32x16_bf16 v[16:31], a[192:195], v[160:163], v[16:31]
    v_max_u32 v2, v2, v160
    v_mfma_f32_32x32x16_bf16 v[32:47], a[196:199], v[160:163], v[32:47]
    s_waitcnt vmcnt(6)
    v_mfma_f32_32x32x16_bf16 v[16:31], a[200:203], v[164:167], v[16:31]
    v_max_u32 v2, v2, v164
    v_mfma_f32_32x32x16_bf16 v[32:47], a[204:207], v[164:167], v[32:47]
    s_waitcnt vmcnt(5)
    v_mfma_f32_32x32x16_bf16 v[16:31], a[208:211], v[168:171], v[16:31]
    v_max_u32 v2, v2, v168
    v_mfma_f32_32x32x16_bf16 v[32:47], a[212:215], v[168:171], v[32:47]
    s_waitcnt vmcnt(4)
    v_mfma_f32_32x32x16_bf16 v[16:31], a[216:219], v[172:175], v[16:31]
    v_max_u32 v2, v2, v172
    v_mfma_f32_32x32x16_bf16 v[32:47], a[220:223], v[172:175], v[32:47]
    s_waitcnt vmcnt(3)
    v_mfma_f32_32x32x16_bf16 v[16:31], a[224:227], v[176:179], v[16:31]
    v_max_u32 v2, v2, v176
    v_mfma_f32_32x32x16_bf16 v[32:47], a[228:231], v[176:179], v[32:47]
    s_waitcnt vmcnt(2)
    v_mfma_f32_32x32x16_bf16 v[16:31], a[232:235], v[180:183], v[16:31]
    v_max_u32 v2, v2, v180
    v_mfma_f32_32x32x16_bf16 v[32:47], a[236:239], v[180:183], v[32:47]
    s_waitcnt vmcnt(1)
    v_mfma_f32_32x32x16_bf16 v[16:31], a[240:243], v[184:187], v[16:31]
    v_max_u32 v2, v2, v184
    v_mfma_f32_32x32x16_bf16 v[32:47], a[244:247], v[184:187], v[32:47]
    s_waitcnt vmcnt(0)
    v_mfma_f32_32x32x16_bf16 v[16:31], a[248:251], v[188:191], v[16:31]
    v_max_u32 v2, v2, v188
    v_cmp_eq_u32 vcc, -1, v2
    s_cbranch_vccnz sa_192
    v_mfma_f32_32x32x16_bf16 v[32:47], a[252:255], v[188:191], v[32:47]
    s_nop 3
    ds_write_b128 v4, v[16:19] offset:0
    ds_write_b128 v4, v[20:23] offset:1024
    ds_write_b128 v4, v[24:27] offset:2048
    ds_write_b128 v4, v[28:31] offset:3072
    s_nop 3
    ds_write_b128 v4, v[32:35] offset:16384
    ds_write_b128 v4, v[36:39] offset:17408
    ds_write_b128 v4, v[40:43] offset:18432
    ds_write_b128 v4, v[44:47] offset:19456
    s_waitcnt lgkmcnt(0)
    s_barrier
    ds_read_b128 v[16:19], v5 offset:0
    ds_read_b128 v[32:35], v10 offset:16384
    ds_read_b128 v[20:23], v5 offset:4096
    ds_read_b128 v[36:39], v10 offset:20480
    ds_read_b128 v[24:27], v5 offset:8192
    ds_read_b128 v[40:43], v10 offset:24576
    ds_read_b128 v[28:31], v5 offset:12288
    ds_read_b128 v[44:47], v10 offset:28672
    s_waitcnt lgkmcnt(0)
    v_pk_add_f32 v[16:17], v[16:17], v[32:33]
    v_pk_add_f32 v[18:19], v[18:19], v[34:35]
    v_pk_add_f32 v[20:21], v[20:21], v[36:37]
    v_pk_add_f32 v[22:23], v[22:23], v[38:39]
    v_pk_add_f32 v[24:25], v[24:25], v[40:41]
    v_pk_add_f32 v[26:27], v[26:27], v[42:43]
    v_pk_add_f32 v[28:29], v[28:29], v[44:45]
    v_pk_add_f32 v[30:31], v[30:31], v[46:47]
    s_mov_b32 s27, 0
    s_nop 0
    s_branch sf_187
sg_184:
    s_branch bend
fin2:
    s_endpgm
attn:
    s_mul_i32 s16, s36, 6
    s_add_u32 s16, s16, s37
    s_cmp_ge_u32 s16, 32
    s_cbranch_scc1 bend
    s_lshl_b32 s16, s16, 2
    s_add_u32 s16, s16, s14
    s_mov_b32 s24, 0x3fb8aa3b
    s_mov_b32 s25, s24
    s_mov_b32 s26, 0x3db504f3
    s_mov_b32 s27, s26
    s_lshl_b32 s22, s14, 12
    v_and_b32 v10, 31, v0
    v_lshrrev_b32 v11, 5, v0
    v_and_b32 v2, 7, v10
    v_bfe_u32 v12, v10, 3, 1
    v_lshl_add_u32 v2, v12, 4, v2
    v_bfe_u32 v12, v10, 4, 1
    v_lshl_add_u32 v2, v12, 3, v2
    v_lshlrev_b32 v2, 4, v2
    v_lshl_add_u32 v2, v11, 9, v2
    v_lshlrev_b32 v12, 3, v11
    v_sub_u32 v12, v10, v12
    v_mov_b32 v13, 0xff800000
    v_cmp_le_i32 vcc, 0, v12
    s_nop 1
    v_cndmask_b32 v16, v13, 0, vcc
    v_cmp_le_i32 vcc, 1, v12
    s_nop 1
    v_cndmask_b32 v17, v13, 0, vcc
    v_cmp_le_i32 vcc, 2, v12
    s_nop 1
    v_cndmask_b32 v18, v13, 0, vcc
    v_cmp_le_i32 vcc, 3, v12
    s_nop 1
    v_cndmask_b32 v19, v13, 0, vcc
    v_cmp_le_i32 vcc, 4, v12
    s_nop 1
    v_cndmask_b32 v20, v13, 0, vcc
    v_cmp_le_i32 vcc, 5, v12
    s_nop 1
    v_cndmask_b32 v21, v13, 0, vcc
    v_cmp_le_i32 vcc, 6, v12
    s_nop 1
    v_cndmask_b32 v22, v13, 0, vcc
    v_cmp_le_i32 vcc, 7, v12
    s_nop 1
    v_cndmask_b32 v23, v13, 0, vcc
    v_cmp_le_i32 vcc, 16, v12
    s_nop 1
    v_cndmask_b32 v24, v13, 0, vcc
    v_cmp_le_i32 vcc, 17, v12
    s_nop 1
    v_cndmask_b32 v25, v13, 0, vcc
    v_cmp_le_i32 vcc, 18, v12
    s_nop 1
    v_cndmask_b32 v26, v13, 0, vcc
    v_cmp_le_i32 vcc, 19, v12
    s_nop 1
    v_cndmask_b32 v27, v13, 0, vcc
    v_cmp_le_i32 vcc, 20, v12
    s_nop 1
    v_cndmask_b32 v28, v13, 0, vcc
    v_cmp_le_i32 vcc, 21, v12
    s_nop 1
    v_cndmask_b32 v29, v13, 0, vcc
    v_cmp_le_i32 vcc, 22, v12
    s_nop 1
    v_cndmask_b32 v30, v13, 0, vcc
    v_cmp_le_i32 vcc, 23, v12
    s_nop 1
    v_cndmask_b32 v31, v13, 0, vcc
    v_and_b32 v12, 15, v0
    v_lshrrev_b32 v13, 4, v0
    v_lshlrev_b32 v5, 4, v12
    v_lshl_add_u32 v5, v13, 2, v5
    v_add_u32 v5, s22, v5
    v_and_b32 v12, 12, v0
    v_lshl_add_u32 v15, v12, 4, v5
    v_bfe_u32 v12, v0, 2, 2
    v_lshl_add_u32 v12, v11, 3, v12
    v_lshlrev_b32 v6, 4, v12
    v_and_b32 v12, 1, v0
    v_lshl_add_u32 v6, v12, 3, v6
    v_add_u32 v6, s22, v6
    v_lshlrev_b32 v7, 4, v10
    v_lshl_add_u32 v7, v11, 3, v7
    v_add_u32 v7, s22, v7
at_193:
    s_lshr_b32 s17, s16, 5
    s_and_b32 s18, s16, 31
    s_lshl_b32 s19, s16, 13
    s_mul_hi_u32 s21, s17, 1431655766
    s_mul_i32 s42, s21, 3
    s_sub_u32 s42, s17, s42
    s_lshr_b32 s44, s17, 1
    s_and_b32 s43, s17, 1
    s_cmp_ge_u32 s18, 20
    s_cselect_b32 s43, s43, s42
    s_cselect_b32 s44, s44, s21
    v_mov_b32 v14, s44
    v_writelane_b32 v14, s21, 0
    s_lshl_b32 s42, s42, 7
    s_add_u32 s42, s42, s18
    s_lshl_b32 s42, s42, 7
    s_lshl_b32 s43, s43, 7
    s_lshr_b32 s44, s18, 1
    s_add_u32 s43, s43, s44
    s_add_u32 s43, s43, 32
    s_lshl_b32 s43, s43, 7
    v_mov_b32 v4, s43
    v_writelane_b32 v4, s42, 0
    s_mov_b32 s20, 116408320
    s_mov_b32 s41, 0
sp_195:
    buffer_load_dword v3, v4, s[4:7], s20 offen sc1
    s_waitcnt vmcnt(0)
    v_cmp_ge_u32 vcc, v14, v3
    s_nop 0
    s_cmp_eq_u64 vcc, 0
    s_cbranch_scc1 sp_196
    s_sleep 40
    s_add_u32 s41, s41, 1
    s_cmp_lt_u32 s41, 2000000
    s_cbranch_scc1 sp_195
    s_branch fin2
sp_196:
    s_add_u32 s42, s19, 37748736
    buffer_load_dwordx4 v[32:35], v1, s[4:7], s42 offen offset:0 sc1
    buffer_load_dwordx4 v[36:39], v1, s[4:7], s42 offen offset:1024 sc1
    buffer_load_dwordx4 v[40:43], v1, s[4:7], s42 offen offset:2048 sc1
    buffer_load_dwordx4 v[44:47], v1, s[4:7], s42 offen offset:3072 sc1
    s_add_u32 s42, s19, 37752832
    buffer_load_dwordx4 v[48:51], v1, s[4:7], s42 offen offset:0 sc1
    buffer_load_dwordx4 v[52:55], v1, s[4:7], s42 offen offset:1024 sc1
    buffer_load_dwordx4 v[56:59], v1, s[4:7], s42 offen offset:2048 sc1
    buffer_load_dwordx4 v[60:63], v1, s[4:7], s42 offen offset:3072 sc1
    s_add_u32 s42, s19, 4194304
    buffer_load_dwordx4 v[64:67], v2, s[4:7], s42 offen offset:0 sc1
    buffer_load_dwordx4 v[68:71], v2, s[4:7], s42 offen offset:1024 sc1
    buffer_load_dwordx4 v[72:75], v2, s[4:7], s42 offen offset:2048 sc1
    buffer_load_dwordx4 v[76:79], v2, s[4:7], s42 offen offset:3072 sc1
    s_add_u32 s42, s19, 4198400
    buffer_load_dwordx4 v[80:83], v2, s[4:7], s42 offen offset:0 sc1
    buffer_load_dwordx4 v[84:87], v2, s[4:7], s42 offen offset:1024 sc1
    buffer_load_dwordx4 v[88:91], v2, s[4:7], s42 offen offset:2048 sc1
    buffer_load_dwordx4 v[92:95], v2, s[4:7], s42 offen offset:3072 sc1
    s_add_u32 s42, s19, 20971520
    buffer_load_dwordx4 v[96:99], v1, s[4:7], s42 offen offset:0 sc1
    buffer_load_dwordx4 v[100:103], v1, s[4:7], s42 offen offset:1024 sc1
    buffer_load_dwordx4 v[104:107], v1, s[4:7], s42 offen offset:2048 sc1
    buffer_load_dwordx4 v[108:111], v1, s[4:7], s42 offen offset:3072 sc1
    s_add_u32 s42, s19, 20975616
    buffer_load_dwordx4 v[112:115], v1, s[4:7], s42 offen offset:0 sc1
    buffer_load_dwordx4 v[116:119], v1, s[4:7], s42 offen offset:1024 sc1
    buffer_load_dwordx4 v[120:123], v1, s[4:7], s42 offen offset:2048 sc1
    buffer_load_dwordx4 v[124:127], v1, s[4:7], s42 offen offset:3072 sc1
    s_waitcnt vmcnt(8)
    v_mfma_f32_32x32x16_bf16 v[128:143], v[64:67], v[32:35], v[16:31]
    v_mfma_f32_32x32x16_bf16 v[128:143], v[68:71], v[36:39], v[128:143]
    v_mfma_f32_32x32x16_bf16 v[128:143], v[72:75], v[40:43], v[128:143]
    v_mfma_f32_32x32x16_bf16 v[128:143], v[76:79], v[44:47], v[128:143]
    v_mfma_f32_32x32x16_bf16 v[128:143], v[80:83], v[48:51], v[128:143]
    v_mfma_f32_32x32x16_bf16 v[128:143], v[84:87], v[52:55], v[128:143]
    v_mfma_f32_32x32x16_bf16 v[128:143], v[88:91], v[56:59], v[128:143]
    v_mfma_f32_32x32x16_bf16 v[128:143], v[92:95], v[60:63], v[128:143]
    s_nop 11
    v_cvt_pk_bf16_f32 v129, v128, v129
    v_cvt_pk_bf16_f32 v131, v130, v131
    v_cvt_pk_bf16_f32 v133, v132, v133
    v_cvt_pk_bf16_f32 v135, v134, v135
    v_cvt_pk_bf16_f32 v137, v136, v137
    v_cvt_pk_bf16_f32 v139, v138, v139
    v_cvt_pk_bf16_f32 v141, v140, v141
    v_cvt_pk_bf16_f32 v143, v142, v143
    v_lshlrev_b32 v128, 16, v129
    v_and_b32 v129, 0xffff0000, v129
    v_lshlrev_b32 v130, 16, v131
    v_and_b32 v131, 0xffff0000, v131
    v_lshlrev_b32 v132, 16, v133
    v_and_b32 v133, 0xffff0000, v133
    v_lshlrev_b32 v134, 16, v135
    v_and_b32 v135, 0xffff0000, v135
    v_lshlrev_b32 v136, 16, v137
    v_and_b32 v137, 0xffff0000, v137
    v_lshlrev_b32 v138, 16, v139
    v_and_b32 v139, 0xffff0000, v139
    v_lshlrev_b32 v140, 16, v141
    v_and_b32 v141, 0xffff0000, v141
    v_lshlrev_b32 v142, 16, v143
    v_and_b32 v143, 0xffff0000, v143
    v_pk_mul_f32 v[128:129], v[128:129], s[26:27]
    v_pk_mul_f32 v[130:131], v[130:131], s[26:27]
    v_pk_mul_f32 v[132:133], v[132:133], s[26:27]
    v_pk_mul_f32 v[134:135], v[134:135], s[26:27]
    v_pk_mul_f32 v[136:137], v[136:137], s[26:27]
    v_pk_mul_f32 v[138:139], v[138:139], s[26:27]
    v_pk_mul_f32 v[140:141], v[140:141], s[26:27]
    v_pk_mul_f32 v[142:143], v[142:143], s[26:27]
    v_cvt_pk_bf16_f32 v129, v128, v129
    v_cvt_pk_bf16_f32 v131, v130, v131
    v_cvt_pk_bf16_f32 v133, v132, v133
    v_cvt_pk_bf16_f32 v135, v134, v135
    v_cvt_pk_bf16_f32 v137, v136, v137
    v_cvt_pk_bf16_f32 v139, v138, v139
    v_cvt_pk_bf16_f32 v141, v140, v141
    v_cvt_pk_bf16_f32 v143, v142, v143
    v_lshlrev_b32 v128, 16, v129
    v_and_b32 v129, 0xffff0000, v129
    v_lshlrev_b32 v130, 16, v131
    v_and_b32 v131, 0xffff0000, v131
    v_lshlrev_b32 v132, 16, v133
    v_and_b32 v133, 0xffff0000, v133
    v_lshlrev_b32 v134, 16, v135
    v_and_b32 v135, 0xffff0000, v135
    v_lshlrev_b32 v136, 16, v137
    v_and_b32 v137, 0xffff0000, v137
    v_lshlrev_b32 v138, 16, v139
    v_and_b32 v139, 0xffff0000, v139
    v_lshlrev_b32 v140, 16, v141
    v_and_b32 v141, 0xffff0000, v141
    v_lshlrev_b32 v142, 16, v143
    v_and_b32 v143, 0xffff0000, v143
    v_max3_f32 v8, v128, v129, v130
    v_max3_f32 v8, v8, v131, v132
    v_max3_f32 v8, v8, v133, v134
    v_max3_f32 v8, v8, v135, v136
    v_max3_f32 v8, v8, v137, v138
    v_max3_f32 v8, v8, v139, v140
    v_max3_f32 v8, v8, v141, v142
    v_max_f32 v8, v8, v143
    s_lshl_b32 s44, s18, 7
    s_add_u32 s44, s44, 116420608
    s_add_u32 s21, s17, 1
    s_lshl_b32 s42, s16, 12
    s_add_u32 s42, s42, 100663296
    s_cmp_ge_u32 s17, 60
    s_cbranch_scc1 ad_197
    s_mov_b32 s41, 0
sp_199:
    buffer_load_dword v3, off, s[4:7], s44 sc1
    s_waitcnt vmcnt(0)
    v_readfirstlane_b32 s45, v3
    s_nop 0
    s_cmp_ge_u32 s45, s21
    s_cbranch_scc1 sp_200
    s_sleep 8
    s_add_u32 s41, s41, 1
    s_cmp_lt_u32 s41, 2000000
    s_cbranch_scc1 sp_199
    s_branch fin2
sp_200:
    buffer_load_dwordx4 v[200:203], v1, s[4:7], s42 offen offset:0 sc1
    buffer_load_dwordx4 v[204:207], v1, s[4:7], s42 offen offset:1024 sc1
    buffer_load_dwordx4 v[208:211], v1, s[4:7], s42 offen offset:2048 sc1
    buffer_load_dwordx4 v[212:215], v1, s[4:7], s42 offen offset:3072 sc1
    s_waitcnt vmcnt(0)
    s_branch ah_198
ad_197:
    s_mov_b32 s41, 0
sp_201:
    buffer_load_dwordx4 v[200:203], v1, s[4:7], s42 offen offset:0 sc1
    buffer_load_dwordx4 v[204:207], v1, s[4:7], s42 offen offset:1024 sc1
    buffer_load_dwordx4 v[208:211], v1, s[4:7], s42 offen offset:2048 sc1
    buffer_load_dwordx4 v[212:215], v1, s[4:7], s42 offen offset:3072 sc1
    s_waitcnt vmcnt(0)
    v_max3_u32 v3, v200, v204, v208
    v_max_u32 v3, v3, v212
    v_cmp_eq_u32 vcc, -1, v3
    s_nop 0
    s_cmp_eq_u64 vcc, 0
    s_cbranch_scc1 sp_202
    s_sleep 1
    s_add_u32 s41, s41, 1
    s_cmp_lt_u32 s41, 2000000
    s_cbranch_scc1 sp_201
    s_branch fin2
sp_202:
ah_198:
    ds_write_b32 v15, v201 offset:0
    ds_write_b32 v15, v203 offset:64
    ds_write2st64_b32 v5, v200, v202 offset0:8 offset1:9
    ds_write_b32 v15, v205 offset:512
    ds_write_b32 v15, v207 offset:576
    ds_write2st64_b32 v5, v204, v206 offset0:10 offset1:11
    ds_write_b32 v15, v209 offset:1024
    ds_write_b32 v15, v211 offset:1088
    ds_write2st64_b32 v5, v208, v210 offset0:12 offset1:13
    ds_write_b32 v15, v213 offset:1536
    ds_write_b32 v15, v215 offset:1600
    ds_write2st64_b32 v5, v212, v214 offset0:14 offset1:15
    s_waitcnt lgkmcnt(0)
    ds_read_b64_tr_b16 v[160:161], v6 offset:0
    ds_read_b64_tr_b16 v[162:163], v6 offset:64
    ds_read_b64_tr_b16 v[164:165], v6 offset:256
    ds_read_b64_tr_b16 v[166:167], v6 offset:320
    ds_read_b64_tr_b16 v[168:169], v6 offset:512
    ds_read_b64_tr_b16 v[170:171], v6 offset:576
    ds_read_b64_tr_b16 v[172:173], v6 offset:768
    ds_read_b64_tr_b16 v[174:175], v6 offset:832
    ds_read_b64_tr_b16 v[176:177], v6 offset:1024
    ds_read_b64_tr_b16 v[178:179], v6 offset:1088
    s_waitcnt lgkmcnt(8)
    v_mfma_f32_32x32x16_bf16 v[144:159], v[160:163], v[32:35], 0
    ds_read_b64_tr_b16 v[180:181], v6 offset:1280
    ds_read_b64_tr_b16 v[182:183], v6 offset:1344
    s_waitcnt lgkmcnt(8)
    v_mfma_f32_32x32x16_bf16 v[144:159], v[164:167], v[36:39], v[144:159]
    ds_read_b64_tr_b16 v[184:185], v6 offset:1536
    ds_read_b64_tr_b16 v[186:187], v6 offset:1600
    s_waitcnt lgkmcnt(8)
    v_mfma_f32_32x32x16_bf16 v[144:159], v[168:171], v[40:43], v[144:159]
    ds_read_b64_tr_b16 v[188:189], v6 offset:1792
    ds_read_b64_tr_b16 v[190:191], v6 offset:1856
    s_waitcnt lgkmcnt(8)
    v_mfma_f32_32x32x16_bf16 v[144:159], v[172:175], v[44:47], v[144:159]
    ds_read_b64 v[192:193], v7 offset:2048
    ds_read_b64 v[194:195], v7 offset:2560
    ds_read_b64 v[196:197], v7 offset:3072
    ds_read_b64 v[198:199], v7 offset:3584
    s_waitcnt lgkmcnt(10)
    v_mfma_f32_32x32x16_bf16 v[144:159], v[176:179], v[48:51], v[144:159]
    s_waitcnt lgkmcnt(8)
    v_mfma_f32_32x32x16_bf16 v[144:159], v[180:183], v[52:55], v[144:159]
    s_waitcnt lgkmcnt(6)
    v_mfma_f32_32x32x16_bf16 v[144:159], v[184:187], v[56:59], v[144:159]
    s_waitcnt lgkmcnt(4)
    v_mfma_f32_32x32x16_bf16 v[144:159], v[188:191], v[60:63], v[144:159]
    s_nop 11
    v_cvt_pk_bf16_f32 v145, v144, v145
    v_cvt_pk_bf16_f32 v147, v146, v147
    v_lshlrev_b32 v144, 16, v145
    v_and_b32 v145, 0xffff0000, v145
    v_lshlrev_b32 v146, 16, v147
    v_and_b32 v147, 0xffff0000, v147
    v_pk_mul_f32 v[144:145], v[144:145], s[26:27]
    v_pk_mul_f32 v[146:147], v[146:147], s[26:27]
    v_cvt_pk_bf16_f32 v145, v144, v145
    v_cvt_pk_bf16_f32 v147, v146, v147
    v_lshlrev_b32 v144, 16, v145
    v_and_b32 v145, 0xffff0000, v145
    v_lshlrev_b32 v146, 16, v147
    v_and_b32 v147, 0xffff0000, v147
    v_max3_f32 v8, v8, v144, v145
    v_max3_f32 v8, v8, v146, v147
    v_mov_b32 v10, v8
    s_nop 1
    v_permlane32_swap_b32 v8, v10
    v_max_f32 v8, v8, v10
    v_pk_add_f32 v[128:129], v[128:129], v[8:9] op_sel_hi:[1,0] neg_lo:[0,1] neg_hi:[0,1]
    v_pk_add_f32 v[130:131], v[130:131], v[8:9] op_sel_hi:[1,0] neg_lo:[0,1] neg_hi:[0,1]
    v_pk_add_f32 v[132:133], v[132:133], v[8:9] op_sel_hi:[1,0] neg_lo:[0,1] neg_hi:[0,1]
    v_pk_add_f32 v[134:135], v[134:135], v[8:9] op_sel_hi:[1,0] neg_lo:[0,1] neg_hi:[0,1]
    v_pk_add_f32 v[136:137], v[136:137], v[8:9] op_sel_hi:[1,0] neg_lo:[0,1] neg_hi:[0,1]
    v_pk_add_f32 v[138:139], v[138:139], v[8:9] op_sel_hi:[1,0] neg_lo:[0,1] neg_hi:[0,1]
    v_pk_add_f32 v[140:141], v[140:141], v[8:9] op_sel_hi:[1,0] neg_lo:[0,1] neg_hi:[0,1]
    v_pk_add_f32 v[142:143], v[142:143], v[8:9] op_sel_hi:[1,0] neg_lo:[0,1] neg_hi:[0,1]
    v_pk_add_f32 v[144:145], v[144:145], v[8:9] op_sel_hi:[1,0] neg_lo:[0,1] neg_hi:[0,1]
    v_pk_add_f32 v[146:147], v[146:147], v[8:9] op_sel_hi:[1,0] neg_lo:[0,1] neg_hi:[0,1]
    v_pk_mul_f32 v[128:129], v[128:129], s[24:25]
    v_pk_mul_f32 v[130:131], v[130:131], s[24:25]
    v_pk_mul_f32 v[132:133], v[132:133], s[24:25]
    v_pk_mul_f32 v[134:135], v[134:135], s[24:25]
    v_pk_mul_f32 v[136:137], v[136:137], s[24:25]
    v_pk_mul_f32 v[138:139], v[138:139], s[24:25]
    v_pk_mul_f32 v[140:141], v[140:141], s[24:25]
    v_pk_mul_f32 v[142:143], v[142:143], s[24:25]
    v_pk_mul_f32 v[144:145], v[144:145], s[24:25]
    v_pk_mul_f32 v[146:147], v[146:147], s[24:25]
    v_exp_f32 v128, v128
    v_exp_f32 v129, v129
    v_exp_f32 v130, v130
    v_exp_f32 v131, v131
    v_exp_f32 v132, v132
    v_exp_f32 v133, v133
    v_exp_f32 v134, v134
    v_exp_f32 v135, v135
    v_exp_f32 v136, v136
    v_exp_f32 v137, v137
    v_exp_f32 v138, v138
    v_exp_f32 v139, v139
    v_exp_f32 v140, v140
    v_exp_f32 v141, v141
    v_exp_f32 v142, v142
    v_exp_f32 v143, v143
    v_exp_f32 v144, v144
    v_exp_f32 v145, v145
    v_exp_f32 v146, v146
    v_exp_f32 v147, v147
    v_pk_add_f32 v[10:11], v[128:129], v[130:131]
    v_pk_add_f32 v[10:11], v[10:11], v[132:133]
    v_pk_add_f32 v[10:11], v[10:11], v[134:135]
    v_pk_add_f32 v[10:11], v[10:11], v[136:137]
    v_pk_add_f32 v[10:11], v[10:11], v[138:139]
    v_pk_add_f32 v[10:11], v[10:11], v[140:141]
    v_pk_add_f32 v[10:11], v[10:11], v[142:143]
    v_pk_add_f32 v[10:11], v[10:11], v[144:145]
    v_pk_add_f32 v[10:11], v[10:11], v[146:147]
    v_add_f32 v8, v10, v11
    v_mov_b32 v10, v8
    s_nop 1
    v_permlane32_swap_b32 v8, v10
    v_add_f32 v8, v8, v10
    v_rcp_f32 v8, v8
    s_nop 0
    v_pk_mul_f32 v[128:129], v[128:129], v[8:9] op_sel_hi:[1,0]
    v_pk_mul_f32 v[130:131], v[130:131], v[8:9] op_sel_hi:[1,0]
    v_pk_mul_f32 v[132:133], v[132:133], v[8:9] op_sel_hi:[1,0]
    v_pk_mul_f32 v[134:135], v[134:135], v[8:9] op_sel_hi:[1,0]
    v_pk_mul_f32 v[136:137], v[136:137], v[8:9] op_sel_hi:[1,0]
    v_pk_mul_f32 v[138:139], v[138:139], v[8:9] op_sel_hi:[1,0]
    v_pk_mul_f32 v[140:141], v[140:141], v[8:9] op_sel_hi:[1,0]
    v_pk_mul_f32 v[142:143], v[142:143], v[8:9] op_sel_hi:[1,0]
    v_pk_mul_f32 v[144:145], v[144:145], v[8:9] op_sel_hi:[1,0]
    v_pk_mul_f32 v[146:147], v[146:147], v[8:9] op_sel_hi:[1,0]
    v_cvt_pk_bf16_f32 v216, v128, v129
    v_cvt_pk_bf16_f32 v217, v130, v131
    v_cvt_pk_bf16_f32 v218, v132, v133
    v_cvt_pk_bf16_f32 v219, v134, v135
    v_cvt_pk_bf16_f32 v220, v136, v137
    v_cvt_pk_bf16_f32 v221, v138, v139
    v_cvt_pk_bf16_f32 v222, v140, v141
    v_cvt_pk_bf16_f32 v223, v142, v143
    v_cvt_pk_bf16_f32 v224, v144, v145
    v_cvt_pk_bf16_f32 v225, v146, v147
    s_and_b32 s20, s16, 127
    s_lshl_b32 s20, s20, 7
    s_add_u32 s20, s20, 116391936
    s_lshr_b32 s43, s16, 7
    s_add_u32 s43, s43, 1
    v_mov_b32 v3, s43
    s_waitcnt lgkmcnt(0)
    v_mfma_f32_32x32x16_bf16 v[32:47], v[96:99], v[216:219], 0
    v_mfma_f32_32x32x16_bf16 v[48:63], v[104:107], v[216:219], 0
    v_mfma_f32_32x32x16_bf16 v[32:47], v[100:103], v[220:223], v[32:47]
    v_mfma_f32_32x32x16_bf16 v[48:63], v[108:111], v[220:223], v[48:63]
    v_mfma_f32_32x32x8_bf16 v[32:47], v[192:193], v[224:225], v[32:47]
    v_mfma_f32_32x32x8_bf16 v[48:63], v[194:195], v[224:225], v[48:63]
    v_mfma_f32_32x32x16_bf16 v[64:79], v[112:115], v[216:219], 0
    v_mfma_f32_32x32x16_bf16 v[80:95], v[120:123], v[216:219], 0
    v_mfma_f32_32x32x16_bf16 v[64:79], v[116:119], v[220:223], v[64:79]
    v_mfma_f32_32x32x16_bf16 v[80:95], v[124:127], v[220:223], v[80:95]
    v_mfma_f32_32x32x8_bf16 v[64:79], v[196:197], v[224:225], v[64:79]
    v_mfma_f32_32x32x8_bf16 v[80:95], v[198:199], v[224:225], v[80:95]
    s_cmp_lt_u32 s17, 62
    s_cbranch_scc1 ne_203
    s_mov_b64 exec, 1
    buffer_store_dword v3, off, s[4:7], s20 sc1
    s_mov_b64 exec, -1
ne_203:
    s_add_u32 s42, s19, 75497472
    s_add_u32 s43, s42, 4096
    v_cvt_pk_bf16_f32 v160, v32, v33
    v_cvt_pk_bf16_f32 v161, v34, v35
    v_cvt_pk_bf16_f32 v162, v36, v37
    v_cvt_pk_bf16_f32 v163, v38, v39
    s_nop 0
    v_permlane32_swap_b32 v160, v162
    v_permlane32_swap_b32 v161, v163
    v_min_u32 v160, -2, v160
    buffer_store_dwordx4 v[160:163], v1, s[4:7], s42 offen offset:0 sc1
    v_cvt_pk_bf16_f32 v164, v40, v41
    v_cvt_pk_bf16_f32 v165, v42, v43
    v_cvt_pk_bf16_f32 v166, v44, v45
    v_cvt_pk_bf16_f32 v167, v46, v47
    s_nop 0
    v_permlane32_swap_b32 v164, v166
    v_permlane32_swap_b32 v165, v167
    v_min_u32 v164, -2, v164
    buffer_store_dwordx4 v[164:167], v1, s[4:7], s42 offen offset:1024 sc1
    v_cvt_pk_bf16_f32 v168, v48, v49
    v_cvt_pk_bf16_f32 v169, v50, v51
    v_cvt_pk_bf16_f32 v170, v52, v53
    v_cvt_pk_bf16_f32 v171, v54, v55
    s_nop 0
    v_permlane32_swap_b32 v168, v170
    v_permlane32_swap_b32 v169, v171
    v_min_u32 v168, -2, v168
    buffer_store_dwordx4 v[168:171], v1, s[4:7], s42 offen offset:2048 sc1
    v_cvt_pk_bf16_f32 v172, v56, v57
    v_cvt_pk_bf16_f32 v173, v58, v59
    v_cvt_pk_bf16_f32 v174, v60, v61
    v_cvt_pk_bf16_f32 v175, v62, v63
    s_nop 0
    v_permlane32_swap_b32 v172, v174
    v_permlane32_swap_b32 v173, v175
    v_min_u32 v172, -2, v172
    buffer_store_dwordx4 v[172:175], v1, s[4:7], s42 offen offset:3072 sc1
    v_cvt_pk_bf16_f32 v176, v64, v65
    v_cvt_pk_bf16_f32 v177, v66, v67
    v_cvt_pk_bf16_f32 v178, v68, v69
    v_cvt_pk_bf16_f32 v179, v70, v71
    s_nop 0
    v_permlane32_swap_b32 v176, v178
    v_permlane32_swap_b32 v177, v179
    v_min_u32 v176, -2, v176
    buffer_store_dwordx4 v[176:179], v1, s[4:7], s43 offen offset:0 sc1
    v_cvt_pk_bf16_f32 v180, v72, v73
    v_cvt_pk_bf16_f32 v181, v74, v75
    v_cvt_pk_bf16_f32 v182, v76, v77
    v_cvt_pk_bf16_f32 v183, v78, v79
    s_nop 0
    v_permlane32_swap_b32 v180, v182
    v_permlane32_swap_b32 v181, v183
    v_min_u32 v180, -2, v180
    buffer_store_dwordx4 v[180:183], v1, s[4:7], s43 offen offset:1024 sc1
    v_cvt_pk_bf16_f32 v184, v80, v81
    v_cvt_pk_bf16_f32 v185, v82, v83
    v_cvt_pk_bf16_f32 v186, v84, v85
    v_cvt_pk_bf16_f32 v187, v86, v87
    s_nop 0
    v_permlane32_swap_b32 v184, v186
    v_permlane32_swap_b32 v185, v187
    v_min_u32 v184, -2, v184
    buffer_store_dwordx4 v[184:187], v1, s[4:7], s43 offen offset:2048 sc1
    v_cvt_pk_bf16_f32 v188, v88, v89
    v_cvt_pk_bf16_f32 v189, v90, v91
    v_cvt_pk_bf16_f32 v190, v92, v93
    v_cvt_pk_bf16_f32 v191, v94, v95
    s_nop 0
    v_permlane32_swap_b32 v188, v190
    v_permlane32_swap_b32 v189, v191
    v_min_u32 v188, -2, v188
    buffer_store_dwordx4 v[188:191], v1, s[4:7], s43 offen offset:3072 sc1
    s_waitcnt vmcnt(0)
    s_mov_b64 exec, 1
    buffer_store_dword v3, off, s[4:7], s20 sc1
    s_mov_b64 exec, -1
    s_add_u32 s16, s16, 128
    s_cmp_lt_u32 s16, 2048
    s_cbranch_scc1 at_193
bend:
    s_endpgm
.section .rodata,"a"
.p2align 6
.amdhsa_kernel recurrent_scan__memory_aug_recurrent_mem_tr__dense_activation_silu__prompt_kernel
  .amdhsa_next_free_vgpr 512
  .amdhsa_next_free_sgpr 102
  .amdhsa_accum_offset 256
  .amdhsa_group_segment_fixed_size 0
  .amdhsa_kernarg_size 104
  .amdhsa_user_sgpr_count 2
  .amdhsa_user_sgpr_kernarg_segment_ptr 1
  .amdhsa_system_sgpr_workgroup_id_x 1
.end_amdhsa_kernel
```
